```python
import torch

def _softmax(x, axis=-1):
    return torch.softmax(x, dim=axis)
def _gelu(x):
    return torch.nn.functional.gelu(x, approximate="tanh")
def _silu(x):
    return torch.nn.functional.silu(x)
def _sigmoid(x):
    return torch.sigmoid(x)
def _layernorm(x, axis=-1, eps=1e-5):
    m = x.mean(dim=axis, keepdim=True)
    v = x.var(dim=axis, keepdim=True, unbiased=False)
    return (x - m) / torch.sqrt(v + eps)
def _scatter_add(tgt, idx, src, axis=0):
    return tgt.clone().index_add_(axis, idx, src)
def _segment_sum(src, seg, n):
    out = torch.zeros((n,) + src.shape[1:], dtype=src.dtype)
    return out.index_add_(0, seg, src)
def _pad(x, pw):
    flat = tuple(v for pair in reversed(pw) for v in pair)
    return torch.nn.functional.pad(x, flat)

kernel_name = 'recurrent_scan__ssm_conv_s5__dense_activation_mish__prompt'

def setup_inputs():

    _w = (lambda a: (lambda t: t.to(torch.bfloat16) if t.is_floating_point() else t)(torch.as_tensor(a)))
    def _A_setup():
        B, S, D = 1, 2048, 576
        P = D
        Lambda_re = -0.5 * (lambda _x: torch.exp(torch.as_tensor(_x)))((lambda *s: torch.randn(*s, dtype=torch.bfloat16) * 0.4)(P))
        Lambda_im = (lambda *s: torch.randn(*s, dtype=torch.bfloat16) * 0.8)(P) * 1.0
        B_re = (lambda *s: torch.randn(*s, dtype=torch.bfloat16) * 0.4)(P, D) * (D ** -0.5)
        B_im = (lambda *s: torch.randn(*s, dtype=torch.bfloat16) * 0.8)(P, D) * (D ** -0.5)
        C_re = (lambda *s: torch.randn(*s, dtype=torch.bfloat16) * 0.8)(D, P) * (P ** -0.5)
        C_im = (lambda *s: torch.randn(*s, dtype=torch.bfloat16) * 0.8)(D, P) * (P ** -0.5)
        log_dt = (lambda *s: torch.randn(*s, dtype=torch.bfloat16) * 0.4)(P) * 0.3 - 2.0
        Dskip = (lambda *s: torch.randn(*s, dtype=torch.bfloat16) * 0.2)(D)
        return {
            "x": _w((lambda *s: torch.randn(*s, dtype=torch.bfloat16) * 0.05)(B, S, D)),
            "Lambda_re": _w(Lambda_re),
            "Lambda_im": _w(Lambda_im),
            "B_re": _w(B_re),
            "B_im": _w(B_im),
            "C_re": _w(C_re),
            "C_im": _w(C_im),
            "log_dt": _w(log_dt),
            "Dskip": _w(Dskip),
        }
    _A_in = _A_setup()

    def _B_setup():
        B, S, D, F = 1, 2048, 576, 4608
        return {
            "x": _w((lambda *s: torch.randn(*s, dtype=torch.bfloat16) * 0.05)(B, S, D)),
            "w1": _w((lambda *s: torch.randn(*s, dtype=torch.bfloat16) * 0.8)(D, F) * (D ** -0.5)),
            "b1": _w((lambda *s: torch.randn(*s, dtype=torch.bfloat16) * 0.4)(F)),
            "w2": _w((lambda *s: torch.randn(*s, dtype=torch.bfloat16) * 0.1)(F, D) * (F ** -0.5)),
        }
    _B_in = _B_setup()

    return {
        "A_x": _A_in["x"],
        "A_Lambda_re": _A_in["Lambda_re"],
        "A_Lambda_im": _A_in["Lambda_im"],
        "A_B_re": _A_in["B_re"],
        "A_B_im": _A_in["B_im"],
        "A_C_re": _A_in["C_re"],
        "A_C_im": _A_in["C_im"],
        "A_log_dt": _A_in["log_dt"],
        "A_Dskip": _A_in["Dskip"],
        "B_x": _B_in["x"],
        "B_w1": _B_in["w1"],
        "B_b1": _B_in["b1"],
        "B_w2": _B_in["w2"],
    }

def reference(A_x, A_Lambda_re, A_Lambda_im, A_B_re, A_B_im, A_C_re, A_C_im, A_log_dt, A_Dskip, B_x, B_w1, B_b1, B_w2):
    def _A_ref(x, Lambda_re, Lambda_im, B_re, B_im, C_re, C_im, log_dt, Dskip):
        Bsz, L, H = x.shape
        Lam = Lambda_re + 1j * Lambda_im
        Bmat = B_re + 1j * B_im
        Cmat = C_re + 1j * C_im
        dt = torch.exp(log_dt)
        Lam_bar = torch.exp(dt * Lam)
        B_bar = ((Lam_bar - 1.0) / Lam)[:, None] * Bmat
        Bu = torch.einsum("bld,pd->blp", x + 0j, B_bar)
        h = torch.zeros_like(Bu[:, 0, :])
        hs = []
        for t in range(L):
            h = Lam_bar[None, :] * h + Bu[:, t, :]
            hs.append(h)
        hseq = torch.stack(hs, 1)
        y = 2.0 * torch.einsum("blp,dp->bld", hseq, Cmat).real + x * Dskip[None, None, :]
        return y

    def _B_ref(x, w1, b1, w2):
        h = torch.einsum("bsd,df->bsf", x, w1) + b1
        sp = torch.log1p(torch.exp(-torch.abs(h))) + torch.where(h > 0, h, torch.zeros_like(h))
        act = h * torch.tanh(sp)
        return torch.einsum("bsf,fd->bsd", act, w2)

    x = A_x
    xn = _layernorm(x, axis=-1)
    s = _A_ref(xn, A_Lambda_re, A_Lambda_im, A_B_re, A_B_im, A_C_re, A_C_im, A_log_dt, A_Dskip)
    g = _silu(_B_ref(xn, B_w1, B_b1, B_w2))
    return x + s * g
```

```asm
; @launch grid=(256,1,1) block=(512,1,1) lds=163840
.amdgcn_target "amdgcn-amd-amdhsa--gfx950"
.text
.globl recurrent_scan__ssm_conv_s5__dense_activation_mish__prompt_kernel
.p2align 8
.type recurrent_scan__ssm_conv_s5__dense_activation_mish__prompt_kernel,@function
recurrent_scan__ssm_conv_s5__dense_activation_mish__prompt_kernel:
    v_lshrrev_b32 v1, 6, v0
    v_and_b32 v0, 63, v0
    s_cmp_ge_u32 s2, 256
    v_readfirstlane_b32 s44, v1
    s_cbranch_scc1 .Lexit
    s_and_b32 s47, s2, 7
    s_lshl_b32 s47, s47, 1
    s_bfe_u32 s49, s2, 0x10003
    s_add_u32 s47, s47, s49
    s_lshr_b32 s48, s2, 4
    s_add_u32 s48, s48, 12
    s_and_b32 s48, s48, 15
    s_lshr_b32 s83, s47, 1
    s_and_b32 s49, s48, 3
    s_lshl_b32 s49, s49, 2
    s_lshr_b32 s49, 0x3570, s49
    s_and_b32 s49, s49, 15
    s_add_u32 s83, s83, s49
    s_lshr_b32 s46, s44, 2
    s_and_b32 s45, s44, 3

    s_mov_b32 s6, 2359296
    s_mov_b32 s7, 0x00020000
    s_mov_b32 s18, 268435456
    s_mov_b32 s19, 0x00020000
    s_cmp_ge_u32 s48, 12
    s_cbranch_scc1 .Lssm
    s_load_dwordx2 s[4:5], s[0:1], 0
    s_load_dwordx2 s[8:9], s[0:1], 80
    s_load_dwordx2 s[12:13], s[0:1], 96
    s_load_dwordx2 s[20:21], s[0:1], 88
    s_load_dwordx2 s[16:17], s[0:1], 120
    s_load_dwordx2 s[24:25], s[0:1], 64
    s_load_dwordx2 s[32:33], s[0:1], 104
    s_load_dwordx2 s[28:29], s[0:1], 112
    s_mov_b32 s98, 0x3fb8aa3b
    s_mov_b32 s99, 0xffff0000

    s_mov_b32 s10, 5308416
    s_mov_b32 s11, 0x00020000
    s_mov_b32 s14, 5308416
    s_mov_b32 s15, 0x00020000
    s_mov_b32 s22, 9216
    s_mov_b32 s23, 0x00020000
    s_mov_b32 s26, 1152
    s_mov_b32 s27, 0x00020000
    s_mov_b32 s34, 4718592
    s_mov_b32 s35, 0x00020000
    s_mov_b32 s30, 256
    s_mov_b32 s31, 0x00020000
    v_lshrrev_b32 v104, 3, v0
    v_and_b32 v105, 7, v0
    v_mul_u32_u24 v106, 1152, v104
    v_lshl_add_u32 v106, v105, 4, v106
    s_mul_i32 s49, s47, 147456
    s_mul_i32 s50, s44, 9216
    s_add_u32 s49, s49, s50
    s_add_u32 s50, s49, 73728

    s_waitcnt lgkmcnt(0)
    buffer_load_dwordx4 v[16:19], v106, s[4:7], s49 offen offset:0
    buffer_load_dwordx4 v[20:23], v106, s[4:7], s49 offen offset:128
    buffer_load_dwordx4 v[24:27], v106, s[4:7], s49 offen offset:256
    buffer_load_dwordx4 v[28:31], v106, s[4:7], s49 offen offset:384
    buffer_load_dwordx4 v[32:35], v106, s[4:7], s49 offen offset:512
    buffer_load_dwordx4 v[36:39], v106, s[4:7], s49 offen offset:640
    buffer_load_dwordx4 v[40:43], v106, s[4:7], s49 offen offset:768
    buffer_load_dwordx4 v[44:47], v106, s[4:7], s49 offen offset:896
    buffer_load_dwordx4 v[48:51], v106, s[4:7], s49 offen offset:1024
    buffer_load_dwordx4 v[52:55], v106, s[4:7], s50 offen offset:0
    buffer_load_dwordx4 v[56:59], v106, s[4:7], s50 offen offset:128
    buffer_load_dwordx4 v[60:63], v106, s[4:7], s50 offen offset:256
    buffer_load_dwordx4 v[64:67], v106, s[4:7], s50 offen offset:384
    buffer_load_dwordx4 v[68:71], v106, s[4:7], s50 offen offset:512
    buffer_load_dwordx4 v[72:75], v106, s[4:7], s50 offen offset:640
    buffer_load_dwordx4 v[76:79], v106, s[4:7], s50 offen offset:768
    buffer_load_dwordx4 v[80:83], v106, s[4:7], s50 offen offset:896
    buffer_load_dwordx4 v[84:87], v106, s[4:7], s50 offen offset:1024
    v_mov_b32 v96, 0
    s_and_b32 s49, s48, 3
    s_cmp_eq_u32 s49, 0
    s_cselect_b32 s100, 3, 2
    s_lshl_b32 s42, s47, 9
    s_lshl_b32 s50, s44, 4
    s_add_u32 s42, s42, s50
    s_and_b32 s50, s48, 12
    s_add_u32 s42, s42, s50
    s_add_u32 s42, s42, 37748736
    s_add_u32 s50, s49, 3
    s_and_b32 s50, s50, 3
    s_lshl_b32 s50, s50, 7
    s_add_u32 s43, s42, s50
    s_lshl_b32 s49, s49, 7
    s_add_u32 s42, s42, s49
    s_getreg_b32 s93, hwreg(HW_REG_XCC_ID, 0, 4)
    s_or_b32 s93, s93, 0x80
    s_mov_b64 exec, 1

    buffer_store_dword v96, off, s[16:19], s42 sc0 sc1
    s_mov_b64 exec, -1
    v_lshrrev_b32 v108, 5, v0
    v_bfe_u32 v109, v0, 2, 2
    v_lshl_add_u32 v108, v108, 2, v109
    v_bfe_u32 v109, v0, 4, 1
    v_lshlrev_b32 v109, 6, v109
    v_and_b32 v110, 3, v0
    v_lshl_add_u32 v109, v110, 4, v109
    v_mul_u32_u24 v1, 9216, v108
    v_add_u32 v1, v1, v109
    v_mul_u32_u24 v2, 1152, v108
    v_add_u32 v2, v2, v109

    s_mul_i32 s51, s48, 0
    s_add_u32 s51, s51, s83
    s_mul_i32 s49, s51, 43
    s_lshr_b32 s49, s49, 8
    s_mul_i32 s49, s49, 6
    s_sub_u32 s49, s51, s49
    s_mul_i32 s54, s48, 768
    s_mul_i32 s50, s44, 147456
    s_add_u32 s54, s54, s50
    s_mul_i32 s55, s48, 442368
    s_mul_i32 s50, s45, 18432
    s_add_u32 s55, s55, s50
    s_lshl_b32 s52, s44, 11

    s_lshl_b32 s50, s49, 7
    s_add_u32 s58, s54, s50
    s_mul_i32 s50, s49, 73728
    s_add_u32 s50, s55, s50
    s_mov_b32 s67, s50
    s_add_u32 s49, s49, 1
    s_cmp_ge_u32 s49, 6
    s_cselect_b32 s49, 0, s49
    s_lshl_b32 s50, s49, 7
    s_add_u32 s59, s54, s50
    s_mul_i32 s50, s49, 73728
    s_add_u32 s50, s55, s50
    s_cmp_eq_u32 s46, 1
    s_cselect_b32 s67, s50, s67
    s_add_u32 s50, s58, 4718592
    s_sub_u32 s51, s59, 589824
    s_cmp_eq_u32 s46, 1
    s_cselect_b32 s64, s51, s50
    s_add_u32 s49, s49, 1
    s_cmp_ge_u32 s49, 6
    s_cselect_b32 s49, 0, s49
    s_lshl_b32 s50, s49, 7
    s_add_u32 s60, s54, s50
    s_mul_i32 s50, s49, 73728
    s_add_u32 s50, s55, s50
    s_mov_b32 s68, s50
    s_add_u32 s49, s49, 1
    s_cmp_ge_u32 s49, 6
    s_cselect_b32 s49, 0, s49
    s_lshl_b32 s50, s49, 7
    s_add_u32 s61, s54, s50
    s_mul_i32 s50, s49, 73728
    s_add_u32 s50, s55, s50
    s_cmp_eq_u32 s46, 1
    s_cselect_b32 s68, s50, s68
    s_add_u32 s50, s60, 4718592
    s_sub_u32 s51, s61, 589824
    s_cmp_eq_u32 s46, 1
    s_cselect_b32 s65, s51, s50
    s_add_u32 s49, s49, 1
    s_cmp_ge_u32 s49, 6
    s_cselect_b32 s49, 0, s49
    s_lshl_b32 s50, s49, 7
    s_add_u32 s62, s54, s50
    s_mul_i32 s50, s49, 73728
    s_add_u32 s50, s55, s50
    s_mov_b32 s69, s50
    s_add_u32 s49, s49, 1
    s_cmp_ge_u32 s49, 6
    s_cselect_b32 s49, 0, s49
    s_lshl_b32 s50, s49, 7
    s_add_u32 s63, s54, s50
    s_mul_i32 s50, s49, 73728
    s_add_u32 s50, s55, s50
    s_cmp_eq_u32 s46, 1
    s_cselect_b32 s69, s50, s69
    s_add_u32 s50, s62, 4718592
    s_sub_u32 s51, s63, 589824
    s_cmp_eq_u32 s46, 1
    s_cselect_b32 s66, s51, s50
    s_add_u32 s49, s49, 1
    s_cmp_ge_u32 s49, 6
    s_cselect_b32 s49, 0, s49
    s_add_u32 m0, s52, 0
    s_add_u32 s49, s58, 0
    buffer_load_dwordx4 v1, s[8:11], s49 offen lds
    s_add_u32 m0, s52, 1024
    s_add_u32 s49, s58, 73728
    buffer_load_dwordx4 v1, s[8:11], s49 offen lds
    s_add_u32 m0, s52, 16384
    s_add_u32 s49, s58, 1179648
    buffer_load_dwordx4 v1, s[8:11], s49 offen lds
    s_add_u32 m0, s52, 17408
    s_add_u32 s49, s58, 1253376
    buffer_load_dwordx4 v1, s[8:11], s49 offen lds
    s_add_u32 m0, s52, 32768
    s_add_u32 s49, s58, 2359296
    buffer_load_dwordx4 v1, s[8:11], s49 offen lds
    s_add_u32 m0, s52, 33792
    s_add_u32 s49, s58, 2433024
    buffer_load_dwordx4 v1, s[8:11], s49 offen lds
    s_add_u32 m0, s52, 49152
    s_add_u32 s49, s58, 3538944
    buffer_load_dwordx4 v1, s[8:11], s49 offen lds
    s_add_u32 m0, s52, 50176
    s_add_u32 s49, s58, 3612672
    buffer_load_dwordx4 v1, s[8:11], s49 offen lds
    s_lshl_b32 s49, s44, 6
    v_add_u32 v108, s49, v0
    v_lshlrev_b32 v109, 2, v108
    v_lshlrev_b32 v110, 3, v108
    v_add_u32 v110, 147456, v110
    v_cmp_gt_u32 vcc, 192, v108
    s_mul_i32 s49, s48, 768
    s_and_saveexec_b64 s[80:81], vcc

    buffer_load_dword v111, v109, s[20:23], s49 offen
    s_mov_b64 exec, s[80:81]
    s_cmp_ge_u32 s83, 9
    s_cselect_b32 s49, 9, 0
    s_sub_u32 s49, s83, s49

    s_lshl_b32 s70, s49, 7
    s_add_u32 s49, s49, 1
    s_cmp_ge_u32 s49, 9
    s_cselect_b32 s49, 0, s49
    s_lshl_b32 s71, s49, 7
    s_add_u32 s49, s49, 1
    s_cmp_ge_u32 s49, 9
    s_cselect_b32 s49, 0, s49
    s_lshl_b32 s72, s49, 7
    s_add_u32 s49, s49, 1
    s_cmp_ge_u32 s49, 9
    s_cselect_b32 s49, 0, s49
    s_lshl_b32 s73, s49, 7
    s_add_u32 s49, s49, 1
    s_cmp_ge_u32 s49, 9
    s_cselect_b32 s49, 0, s49
    s_lshl_b32 s74, s49, 7
    s_add_u32 s49, s49, 1
    s_cmp_ge_u32 s49, 9
    s_cselect_b32 s49, 0, s49
    s_lshl_b32 s75, s49, 7
    s_add_u32 s49, s49, 1
    s_cmp_ge_u32 s49, 9
    s_cselect_b32 s49, 0, s49
    s_lshl_b32 s76, s49, 7
    s_add_u32 s49, s49, 1
    s_cmp_ge_u32 s49, 9
    s_cselect_b32 s49, 0, s49
    s_lshl_b32 s77, s49, 7
    s_add_u32 s49, s49, 1
    s_cmp_ge_u32 s49, 9
    s_cselect_b32 s49, 0, s49
    s_lshl_b32 s78, s49, 7
    s_add_u32 s49, s49, 1
    s_cmp_ge_u32 s49, 9
    s_cselect_b32 s49, 0, s49
    s_lshr_b32 s56, s48, 2
    s_mul_i32 s56, s56, 2359296
    s_mul_i32 s49, s47, 147456
    s_add_u32 s56, s56, s49
    s_lshl_b32 s49, s44, 11
    s_add_u32 s56, s56, s49
    v_lshlrev_b32 v12, 4, v0

    v_bfe_u32 v100, v0, 2, 2
    v_lshlrev_b32 v100, 6, v100
    v_bfe_u32 v101, v0, 4, 1
    v_lshl_add_u32 v100, v101, 5, v100
    v_and_b32 v101, 3, v0
    v_lshl_add_u32 v100, v101, 3, v100
    s_lshl_b32 s49, s46, 8
    v_add_u32 v100, s49, v100
    v_lshrrev_b32 v101, 5, v0
    v_lshl_add_u32 v3, v101, 10, v100
    v_add_u32 v4, 0x10000, v3
    v_add_u32 v5, 0x20000, v3
    v_lshl_add_u32 v6, v101, 9, v100
    s_lshl_b32 s49, s46, 12
    v_add_u32 v6, s49, v6
    v_add_u32 v7, 0x10000, v6
    v_add_u32 v8, 0x20000, v6
    v_xor_b32 v9, 0x1000, v6
    v_xor_b32 v10, 0x1000, v7
    v_xor_b32 v11, 0x1000, v8
    v_lshlrev_b32 v101, 4, v101
    s_lshl_b32 s49, s46, 7
    s_add_u32 s49, s49, 147456
    v_add_u32 v13, s49, v101
    v_add_u32 v14, s52, v12
    v_xor_b32 v15, 0x2000, v14

    s_waitcnt vmcnt(0)
    v_lshlrev_b32 v100, 16, v111
    v_and_b32 v101, 0xffff0000, v111
    s_and_saveexec_b64 s[80:81], vcc

    ds_write_b64 v110, v[100:101]
    s_mov_b64 exec, s[80:81]
    s_mul_i32 s49, s44, 9344
    s_add_u32 s49, s49, 65536
    v_mul_u32_u24 v106, 1168, v104
    v_lshl_add_u32 v106, v105, 4, v106
    v_add_u32 v106, s49, v106
    s_and_b32 s49, s45, 1
    s_mul_i32 s49, s49, 37376
    s_add_u32 s49, s49, 65536

    v_and_b32 v107, 31, v0
    v_mul_u32_u24 v107, 1168, v107
    v_lshrrev_b32 v108, 5, v0
    v_lshl_add_u32 v107, v108, 4, v107
    v_add_u32 v107, s49, v107

    s_waitcnt lgkmcnt(0)
    v_mov_b32 v90, 0x3f803f80
    v_mov_b32 v88, 0
    v_mov_b32 v89, 0
    v_mov_b32 v91, 0
    v_mov_b32 v92, 0
    v_dot2_f32_bf16 v88, v16, v90, v88
    v_dot2_f32_bf16 v89, v16, v16, v89
    v_dot2_f32_bf16 v91, v17, v90, v91
    v_dot2_f32_bf16 v92, v17, v17, v92
    v_dot2_f32_bf16 v88, v18, v90, v88
    v_dot2_f32_bf16 v89, v18, v18, v89
    v_dot2_f32_bf16 v91, v19, v90, v91
    v_dot2_f32_bf16 v92, v19, v19, v92
    v_dot2_f32_bf16 v88, v20, v90, v88
    v_dot2_f32_bf16 v89, v20, v20, v89
    v_dot2_f32_bf16 v91, v21, v90, v91
    v_dot2_f32_bf16 v92, v21, v21, v92
    v_dot2_f32_bf16 v88, v22, v90, v88
    v_dot2_f32_bf16 v89, v22, v22, v89
    v_dot2_f32_bf16 v91, v23, v90, v91
    v_dot2_f32_bf16 v92, v23, v23, v92
    v_dot2_f32_bf16 v88, v24, v90, v88
    v_dot2_f32_bf16 v89, v24, v24, v89
    v_dot2_f32_bf16 v91, v25, v90, v91
    v_dot2_f32_bf16 v92, v25, v25, v92
    v_dot2_f32_bf16 v88, v26, v90, v88
    v_dot2_f32_bf16 v89, v26, v26, v89
    v_dot2_f32_bf16 v91, v27, v90, v91
    v_dot2_f32_bf16 v92, v27, v27, v92
    v_dot2_f32_bf16 v88, v28, v90, v88
    v_dot2_f32_bf16 v89, v28, v28, v89
    v_dot2_f32_bf16 v91, v29, v90, v91
    v_dot2_f32_bf16 v92, v29, v29, v92
    v_dot2_f32_bf16 v88, v30, v90, v88
    v_dot2_f32_bf16 v89, v30, v30, v89
    v_dot2_f32_bf16 v91, v31, v90, v91
    v_dot2_f32_bf16 v92, v31, v31, v92
    v_dot2_f32_bf16 v88, v32, v90, v88
    v_dot2_f32_bf16 v89, v32, v32, v89
    v_dot2_f32_bf16 v91, v33, v90, v91
    v_dot2_f32_bf16 v92, v33, v33, v92
    v_dot2_f32_bf16 v88, v34, v90, v88
    v_dot2_f32_bf16 v89, v34, v34, v89
    v_dot2_f32_bf16 v91, v35, v90, v91
    v_dot2_f32_bf16 v92, v35, v35, v92
    v_dot2_f32_bf16 v88, v36, v90, v88
    v_dot2_f32_bf16 v89, v36, v36, v89
    v_dot2_f32_bf16 v91, v37, v90, v91
    v_dot2_f32_bf16 v92, v37, v37, v92
    v_dot2_f32_bf16 v88, v38, v90, v88
    v_dot2_f32_bf16 v89, v38, v38, v89
    v_dot2_f32_bf16 v91, v39, v90, v91
    v_dot2_f32_bf16 v92, v39, v39, v92
    v_dot2_f32_bf16 v88, v40, v90, v88
    v_dot2_f32_bf16 v89, v40, v40, v89
    v_dot2_f32_bf16 v91, v41, v90, v91
    v_dot2_f32_bf16 v92, v41, v41, v92
    v_dot2_f32_bf16 v88, v42, v90, v88
    v_dot2_f32_bf16 v89, v42, v42, v89
    v_dot2_f32_bf16 v91, v43, v90, v91
    v_dot2_f32_bf16 v92, v43, v43, v92
    v_dot2_f32_bf16 v88, v44, v90, v88
    v_dot2_f32_bf16 v89, v44, v44, v89
    v_dot2_f32_bf16 v91, v45, v90, v91
    v_dot2_f32_bf16 v92, v45, v45, v92
    v_dot2_f32_bf16 v88, v46, v90, v88
    v_dot2_f32_bf16 v89, v46, v46, v89
    v_dot2_f32_bf16 v91, v47, v90, v91
    v_dot2_f32_bf16 v92, v47, v47, v92
    v_dot2_f32_bf16 v88, v48, v90, v88
    v_dot2_f32_bf16 v89, v48, v48, v89
    v_dot2_f32_bf16 v91, v49, v90, v91
    v_dot2_f32_bf16 v92, v49, v49, v92
    v_dot2_f32_bf16 v88, v50, v90, v88
    v_dot2_f32_bf16 v89, v50, v50, v89
    v_dot2_f32_bf16 v91, v51, v90, v91
    v_dot2_f32_bf16 v92, v51, v51, v92
    s_nop 3
    v_add_f32 v88, v88, v91
    v_add_f32 v89, v89, v92
    s_nop 1
    v_add_f32_dpp v88, v88, v88 quad_perm:[1,0,3,2] row_mask:0xf bank_mask:0xf
    v_add_f32_dpp v89, v89, v89 quad_perm:[1,0,3,2] row_mask:0xf bank_mask:0xf
    s_nop 1
    v_add_f32_dpp v88, v88, v88 quad_perm:[2,3,0,1] row_mask:0xf bank_mask:0xf
    v_add_f32_dpp v89, v89, v89 quad_perm:[2,3,0,1] row_mask:0xf bank_mask:0xf
    s_nop 1
    v_add_f32_dpp v88, v88, v88 row_half_mirror row_mask:0xf bank_mask:0xf
    v_add_f32_dpp v89, v89, v89 row_half_mirror row_mask:0xf bank_mask:0xf
    v_mul_f32 v88, 0x3ae38e39, v88
    v_mul_f32 v89, 0x3ae38e39, v89
    v_fma_f32 v89, -v88, v88, v89
    v_max_f32 v89, 0, v89
    v_cvt_pk_bf16_f32 v90, v88, v89
    v_lshlrev_b32 v88, 16, v90
    v_and_b32 v89, 0xffff0000, v90
    v_add_f32 v89, 0x3727c5ac, v89
    v_cvt_pk_bf16_f32 v90, v89, v89
    v_lshlrev_b32 v89, 16, v90
    v_sqrt_f32 v89, v89
    s_nop 0
    v_cvt_pk_bf16_f32 v90, v89, v89
    v_lshlrev_b32 v89, 16, v90
    v_rcp_f32 v92, v89
    s_nop 0
    v_mul_f32 v94, v88, v92
    v_sub_f32 v94, 0, v94

    s_lshl_b32 s49, s44, 6
    s_add_u32 s49, s49, 153600
    v_lshlrev_b32 v96, 3, v104
    v_add_u32 v96, s49, v96

    ds_write2_b32 v96, v92, v94 offset0:0 offset1:1
    v_lshlrev_b32 v96, 16, v16
    v_and_b32 v97, 0xffff0000, v16
    v_pk_fma_f32 v[96:97], v[96:97], v[92:93], v[94:95] op_sel_hi:[1,0,0]
    v_cvt_pk_bf16_f32 v16, v96, v97
    v_lshlrev_b32 v98, 16, v17
    v_and_b32 v99, 0xffff0000, v17
    v_pk_fma_f32 v[98:99], v[98:99], v[92:93], v[94:95] op_sel_hi:[1,0,0]
    v_cvt_pk_bf16_f32 v17, v98, v99
    v_lshlrev_b32 v100, 16, v18
    v_and_b32 v101, 0xffff0000, v18
    v_pk_fma_f32 v[100:101], v[100:101], v[92:93], v[94:95] op_sel_hi:[1,0,0]
    v_cvt_pk_bf16_f32 v18, v100, v101
    v_lshlrev_b32 v102, 16, v19
    v_and_b32 v103, 0xffff0000, v19
    v_pk_fma_f32 v[102:103], v[102:103], v[92:93], v[94:95] op_sel_hi:[1,0,0]
    v_cvt_pk_bf16_f32 v19, v102, v103
    v_lshlrev_b32 v96, 16, v20
    v_and_b32 v97, 0xffff0000, v20
    v_pk_fma_f32 v[96:97], v[96:97], v[92:93], v[94:95] op_sel_hi:[1,0,0]
    v_cvt_pk_bf16_f32 v20, v96, v97
    v_lshlrev_b32 v98, 16, v21
    v_and_b32 v99, 0xffff0000, v21
    v_pk_fma_f32 v[98:99], v[98:99], v[92:93], v[94:95] op_sel_hi:[1,0,0]
    v_cvt_pk_bf16_f32 v21, v98, v99
    v_lshlrev_b32 v100, 16, v22
    v_and_b32 v101, 0xffff0000, v22
    v_pk_fma_f32 v[100:101], v[100:101], v[92:93], v[94:95] op_sel_hi:[1,0,0]
    v_cvt_pk_bf16_f32 v22, v100, v101
    v_lshlrev_b32 v102, 16, v23
    v_and_b32 v103, 0xffff0000, v23
    v_pk_fma_f32 v[102:103], v[102:103], v[92:93], v[94:95] op_sel_hi:[1,0,0]
    v_cvt_pk_bf16_f32 v23, v102, v103
    v_lshlrev_b32 v96, 16, v24
    v_and_b32 v97, 0xffff0000, v24
    v_pk_fma_f32 v[96:97], v[96:97], v[92:93], v[94:95] op_sel_hi:[1,0,0]
    v_cvt_pk_bf16_f32 v24, v96, v97
    v_lshlrev_b32 v98, 16, v25
    v_and_b32 v99, 0xffff0000, v25
    v_pk_fma_f32 v[98:99], v[98:99], v[92:93], v[94:95] op_sel_hi:[1,0,0]
    v_cvt_pk_bf16_f32 v25, v98, v99
    v_lshlrev_b32 v100, 16, v26
    v_and_b32 v101, 0xffff0000, v26
    v_pk_fma_f32 v[100:101], v[100:101], v[92:93], v[94:95] op_sel_hi:[1,0,0]
    v_cvt_pk_bf16_f32 v26, v100, v101
    v_lshlrev_b32 v102, 16, v27
    v_and_b32 v103, 0xffff0000, v27
    v_pk_fma_f32 v[102:103], v[102:103], v[92:93], v[94:95] op_sel_hi:[1,0,0]
    v_cvt_pk_bf16_f32 v27, v102, v103
    v_lshlrev_b32 v96, 16, v28
    v_and_b32 v97, 0xffff0000, v28
    v_pk_fma_f32 v[96:97], v[96:97], v[92:93], v[94:95] op_sel_hi:[1,0,0]
    v_cvt_pk_bf16_f32 v28, v96, v97
    v_lshlrev_b32 v98, 16, v29
    v_and_b32 v99, 0xffff0000, v29
    v_pk_fma_f32 v[98:99], v[98:99], v[92:93], v[94:95] op_sel_hi:[1,0,0]
    v_cvt_pk_bf16_f32 v29, v98, v99
    v_lshlrev_b32 v100, 16, v30
    v_and_b32 v101, 0xffff0000, v30
    v_pk_fma_f32 v[100:101], v[100:101], v[92:93], v[94:95] op_sel_hi:[1,0,0]
    v_cvt_pk_bf16_f32 v30, v100, v101
    v_lshlrev_b32 v102, 16, v31
    v_and_b32 v103, 0xffff0000, v31
    v_pk_fma_f32 v[102:103], v[102:103], v[92:93], v[94:95] op_sel_hi:[1,0,0]
    v_cvt_pk_bf16_f32 v31, v102, v103
    v_lshlrev_b32 v96, 16, v32
    v_and_b32 v97, 0xffff0000, v32
    v_pk_fma_f32 v[96:97], v[96:97], v[92:93], v[94:95] op_sel_hi:[1,0,0]
    v_cvt_pk_bf16_f32 v32, v96, v97
    v_lshlrev_b32 v98, 16, v33
    v_and_b32 v99, 0xffff0000, v33
    v_pk_fma_f32 v[98:99], v[98:99], v[92:93], v[94:95] op_sel_hi:[1,0,0]
    v_cvt_pk_bf16_f32 v33, v98, v99
    v_lshlrev_b32 v100, 16, v34
    v_and_b32 v101, 0xffff0000, v34
    v_pk_fma_f32 v[100:101], v[100:101], v[92:93], v[94:95] op_sel_hi:[1,0,0]
    v_cvt_pk_bf16_f32 v34, v100, v101
    v_lshlrev_b32 v102, 16, v35
    v_and_b32 v103, 0xffff0000, v35
    v_pk_fma_f32 v[102:103], v[102:103], v[92:93], v[94:95] op_sel_hi:[1,0,0]
    v_cvt_pk_bf16_f32 v35, v102, v103
    v_lshlrev_b32 v96, 16, v36
    v_and_b32 v97, 0xffff0000, v36
    v_pk_fma_f32 v[96:97], v[96:97], v[92:93], v[94:95] op_sel_hi:[1,0,0]
    v_cvt_pk_bf16_f32 v36, v96, v97
    v_lshlrev_b32 v98, 16, v37
    v_and_b32 v99, 0xffff0000, v37
    v_pk_fma_f32 v[98:99], v[98:99], v[92:93], v[94:95] op_sel_hi:[1,0,0]
    v_cvt_pk_bf16_f32 v37, v98, v99
    v_lshlrev_b32 v100, 16, v38
    v_and_b32 v101, 0xffff0000, v38
    v_pk_fma_f32 v[100:101], v[100:101], v[92:93], v[94:95] op_sel_hi:[1,0,0]
    v_cvt_pk_bf16_f32 v38, v100, v101
    v_lshlrev_b32 v102, 16, v39
    v_and_b32 v103, 0xffff0000, v39
    v_pk_fma_f32 v[102:103], v[102:103], v[92:93], v[94:95] op_sel_hi:[1,0,0]
    v_cvt_pk_bf16_f32 v39, v102, v103
    v_lshlrev_b32 v96, 16, v40
    v_and_b32 v97, 0xffff0000, v40
    v_pk_fma_f32 v[96:97], v[96:97], v[92:93], v[94:95] op_sel_hi:[1,0,0]
    v_cvt_pk_bf16_f32 v40, v96, v97
    v_lshlrev_b32 v98, 16, v41
    v_and_b32 v99, 0xffff0000, v41
    v_pk_fma_f32 v[98:99], v[98:99], v[92:93], v[94:95] op_sel_hi:[1,0,0]
    v_cvt_pk_bf16_f32 v41, v98, v99
    v_lshlrev_b32 v100, 16, v42
    v_and_b32 v101, 0xffff0000, v42
    v_pk_fma_f32 v[100:101], v[100:101], v[92:93], v[94:95] op_sel_hi:[1,0,0]
    v_cvt_pk_bf16_f32 v42, v100, v101
    v_lshlrev_b32 v102, 16, v43
    v_and_b32 v103, 0xffff0000, v43
    v_pk_fma_f32 v[102:103], v[102:103], v[92:93], v[94:95] op_sel_hi:[1,0,0]
    v_cvt_pk_bf16_f32 v43, v102, v103
    v_lshlrev_b32 v96, 16, v44
    v_and_b32 v97, 0xffff0000, v44
    v_pk_fma_f32 v[96:97], v[96:97], v[92:93], v[94:95] op_sel_hi:[1,0,0]
    v_cvt_pk_bf16_f32 v44, v96, v97
    v_lshlrev_b32 v98, 16, v45
    v_and_b32 v99, 0xffff0000, v45
    v_pk_fma_f32 v[98:99], v[98:99], v[92:93], v[94:95] op_sel_hi:[1,0,0]
    v_cvt_pk_bf16_f32 v45, v98, v99
    v_lshlrev_b32 v100, 16, v46
    v_and_b32 v101, 0xffff0000, v46
    v_pk_fma_f32 v[100:101], v[100:101], v[92:93], v[94:95] op_sel_hi:[1,0,0]
    v_cvt_pk_bf16_f32 v46, v100, v101
    v_lshlrev_b32 v102, 16, v47
    v_and_b32 v103, 0xffff0000, v47
    v_pk_fma_f32 v[102:103], v[102:103], v[92:93], v[94:95] op_sel_hi:[1,0,0]
    v_cvt_pk_bf16_f32 v47, v102, v103
    v_lshlrev_b32 v96, 16, v48
    v_and_b32 v97, 0xffff0000, v48
    v_pk_fma_f32 v[96:97], v[96:97], v[92:93], v[94:95] op_sel_hi:[1,0,0]
    v_cvt_pk_bf16_f32 v48, v96, v97
    v_lshlrev_b32 v98, 16, v49
    v_and_b32 v99, 0xffff0000, v49
    v_pk_fma_f32 v[98:99], v[98:99], v[92:93], v[94:95] op_sel_hi:[1,0,0]
    v_cvt_pk_bf16_f32 v49, v98, v99
    v_lshlrev_b32 v100, 16, v50
    v_and_b32 v101, 0xffff0000, v50
    v_pk_fma_f32 v[100:101], v[100:101], v[92:93], v[94:95] op_sel_hi:[1,0,0]
    v_cvt_pk_bf16_f32 v50, v100, v101
    v_lshlrev_b32 v102, 16, v51
    v_and_b32 v103, 0xffff0000, v51
    v_pk_fma_f32 v[102:103], v[102:103], v[92:93], v[94:95] op_sel_hi:[1,0,0]
    v_cvt_pk_bf16_f32 v51, v102, v103
    ds_write_b128 v106, v[16:19] offset:0
    ds_write_b128 v106, v[20:23] offset:128
    ds_write_b128 v106, v[24:27] offset:256
    ds_write_b128 v106, v[28:31] offset:384
    ds_write_b128 v106, v[32:35] offset:512
    ds_write_b128 v106, v[36:39] offset:640
    ds_write_b128 v106, v[40:43] offset:768
    ds_write_b128 v106, v[44:47] offset:896
    ds_write_b128 v106, v[48:51] offset:1024
    s_waitcnt lgkmcnt(0)
    s_barrier
    s_lshr_b32 s49, s45, 1
    s_cmp_lg_u32 s49, 0
    s_cbranch_scc1 .xr_1
    ds_read_b128 a[0:3], v107 offset:0
    ds_read_b128 a[4:7], v107 offset:32
    ds_read_b128 a[8:11], v107 offset:64
    ds_read_b128 a[12:15], v107 offset:96
    ds_read_b128 a[16:19], v107 offset:128
    ds_read_b128 a[20:23], v107 offset:160
    ds_read_b128 a[24:27], v107 offset:192
    ds_read_b128 a[28:31], v107 offset:224
    ds_read_b128 a[32:35], v107 offset:256
    ds_read_b128 a[36:39], v107 offset:288
    ds_read_b128 a[40:43], v107 offset:320
    ds_read_b128 a[44:47], v107 offset:352
    ds_read_b128 a[48:51], v107 offset:384
    ds_read_b128 a[52:55], v107 offset:416
    ds_read_b128 a[56:59], v107 offset:448
    ds_read_b128 a[60:63], v107 offset:480
    ds_read_b128 a[64:67], v107 offset:512
    ds_read_b128 a[68:71], v107 offset:544
    ds_read_b128 a[72:75], v107 offset:576
    ds_read_b128 a[76:79], v107 offset:608
    ds_read_b128 a[80:83], v107 offset:640
    ds_read_b128 a[84:87], v107 offset:672
    ds_read_b128 a[88:91], v107 offset:704
    ds_read_b128 a[92:95], v107 offset:736
    ds_read_b128 a[96:99], v107 offset:768
    ds_read_b128 a[100:103], v107 offset:800
    ds_read_b128 a[104:107], v107 offset:832
    ds_read_b128 a[108:111], v107 offset:864
    ds_read_b128 a[112:115], v107 offset:896
    ds_read_b128 a[116:119], v107 offset:928
    ds_read_b128 a[120:123], v107 offset:960
    ds_read_b128 a[124:127], v107 offset:992
    ds_read_b128 a[128:131], v107 offset:1024
    ds_read_b128 a[132:135], v107 offset:1056
    ds_read_b128 a[136:139], v107 offset:1088
    ds_read_b128 a[140:143], v107 offset:1120
.xr_1:
    v_mov_b32 v90, 0x3f803f80
    v_mov_b32 v88, 0
    v_mov_b32 v89, 0
    v_mov_b32 v91, 0
    v_mov_b32 v92, 0
    v_dot2_f32_bf16 v88, v52, v90, v88
    v_dot2_f32_bf16 v89, v52, v52, v89
    v_dot2_f32_bf16 v91, v53, v90, v91
    v_dot2_f32_bf16 v92, v53, v53, v92
    v_dot2_f32_bf16 v88, v54, v90, v88
    v_dot2_f32_bf16 v89, v54, v54, v89
    v_dot2_f32_bf16 v91, v55, v90, v91
    v_dot2_f32_bf16 v92, v55, v55, v92
    v_dot2_f32_bf16 v88, v56, v90, v88
    v_dot2_f32_bf16 v89, v56, v56, v89
    v_dot2_f32_bf16 v91, v57, v90, v91
    v_dot2_f32_bf16 v92, v57, v57, v92
    v_dot2_f32_bf16 v88, v58, v90, v88
    v_dot2_f32_bf16 v89, v58, v58, v89
    v_dot2_f32_bf16 v91, v59, v90, v91
    v_dot2_f32_bf16 v92, v59, v59, v92
    v_dot2_f32_bf16 v88, v60, v90, v88
    v_dot2_f32_bf16 v89, v60, v60, v89
    v_dot2_f32_bf16 v91, v61, v90, v91
    v_dot2_f32_bf16 v92, v61, v61, v92
    v_dot2_f32_bf16 v88, v62, v90, v88
    v_dot2_f32_bf16 v89, v62, v62, v89
    v_dot2_f32_bf16 v91, v63, v90, v91
    v_dot2_f32_bf16 v92, v63, v63, v92
    v_dot2_f32_bf16 v88, v64, v90, v88
    v_dot2_f32_bf16 v89, v64, v64, v89
    v_dot2_f32_bf16 v91, v65, v90, v91
    v_dot2_f32_bf16 v92, v65, v65, v92
    v_dot2_f32_bf16 v88, v66, v90, v88
    v_dot2_f32_bf16 v89, v66, v66, v89
    v_dot2_f32_bf16 v91, v67, v90, v91
    v_dot2_f32_bf16 v92, v67, v67, v92
    v_dot2_f32_bf16 v88, v68, v90, v88
    v_dot2_f32_bf16 v89, v68, v68, v89
    v_dot2_f32_bf16 v91, v69, v90, v91
    v_dot2_f32_bf16 v92, v69, v69, v92
    v_dot2_f32_bf16 v88, v70, v90, v88
    v_dot2_f32_bf16 v89, v70, v70, v89
    v_dot2_f32_bf16 v91, v71, v90, v91
    v_dot2_f32_bf16 v92, v71, v71, v92
    v_dot2_f32_bf16 v88, v72, v90, v88
    v_dot2_f32_bf16 v89, v72, v72, v89
    v_dot2_f32_bf16 v91, v73, v90, v91
    v_dot2_f32_bf16 v92, v73, v73, v92
    v_dot2_f32_bf16 v88, v74, v90, v88
    v_dot2_f32_bf16 v89, v74, v74, v89
    v_dot2_f32_bf16 v91, v75, v90, v91
    v_dot2_f32_bf16 v92, v75, v75, v92
    v_dot2_f32_bf16 v88, v76, v90, v88
    v_dot2_f32_bf16 v89, v76, v76, v89
    v_dot2_f32_bf16 v91, v77, v90, v91
    v_dot2_f32_bf16 v92, v77, v77, v92
    v_dot2_f32_bf16 v88, v78, v90, v88
    v_dot2_f32_bf16 v89, v78, v78, v89
    v_dot2_f32_bf16 v91, v79, v90, v91
    v_dot2_f32_bf16 v92, v79, v79, v92
    v_dot2_f32_bf16 v88, v80, v90, v88
    v_dot2_f32_bf16 v89, v80, v80, v89
    v_dot2_f32_bf16 v91, v81, v90, v91
    v_dot2_f32_bf16 v92, v81, v81, v92
    v_dot2_f32_bf16 v88, v82, v90, v88
    v_dot2_f32_bf16 v89, v82, v82, v89
    v_dot2_f32_bf16 v91, v83, v90, v91
    v_dot2_f32_bf16 v92, v83, v83, v92
    v_dot2_f32_bf16 v88, v84, v90, v88
    v_dot2_f32_bf16 v89, v84, v84, v89
    v_dot2_f32_bf16 v91, v85, v90, v91
    v_dot2_f32_bf16 v92, v85, v85, v92
    v_dot2_f32_bf16 v88, v86, v90, v88
    v_dot2_f32_bf16 v89, v86, v86, v89
    v_dot2_f32_bf16 v91, v87, v90, v91
    v_dot2_f32_bf16 v92, v87, v87, v92
    s_nop 3
    v_add_f32 v88, v88, v91
    v_add_f32 v89, v89, v92
    s_nop 1
    v_add_f32_dpp v88, v88, v88 quad_perm:[1,0,3,2] row_mask:0xf bank_mask:0xf
    v_add_f32_dpp v89, v89, v89 quad_perm:[1,0,3,2] row_mask:0xf bank_mask:0xf
    s_nop 1
    v_add_f32_dpp v88, v88, v88 quad_perm:[2,3,0,1] row_mask:0xf bank_mask:0xf
    v_add_f32_dpp v89, v89, v89 quad_perm:[2,3,0,1] row_mask:0xf bank_mask:0xf
    s_nop 1
    v_add_f32_dpp v88, v88, v88 row_half_mirror row_mask:0xf bank_mask:0xf
    v_add_f32_dpp v89, v89, v89 row_half_mirror row_mask:0xf bank_mask:0xf
    v_mul_f32 v88, 0x3ae38e39, v88
    v_mul_f32 v89, 0x3ae38e39, v89
    v_fma_f32 v89, -v88, v88, v89
    v_max_f32 v89, 0, v89
    v_cvt_pk_bf16_f32 v90, v88, v89
    v_lshlrev_b32 v88, 16, v90
    v_and_b32 v89, 0xffff0000, v90
    v_add_f32 v89, 0x3727c5ac, v89
    v_cvt_pk_bf16_f32 v90, v89, v89
    v_lshlrev_b32 v89, 16, v90
    v_sqrt_f32 v89, v89
    s_nop 0
    v_cvt_pk_bf16_f32 v90, v89, v89
    v_lshlrev_b32 v89, 16, v90
    v_rcp_f32 v92, v89
    s_nop 0
    v_mul_f32 v94, v88, v92
    v_sub_f32 v94, 0, v94

    s_lshl_b32 s49, s44, 6
    s_add_u32 s49, s49, 154112
    v_lshlrev_b32 v96, 3, v104
    v_add_u32 v96, s49, v96

    ds_write2_b32 v96, v92, v94 offset0:0 offset1:1
    v_lshlrev_b32 v96, 16, v52
    v_and_b32 v97, 0xffff0000, v52
    v_pk_fma_f32 v[96:97], v[96:97], v[92:93], v[94:95] op_sel_hi:[1,0,0]
    v_cvt_pk_bf16_f32 v52, v96, v97
    v_lshlrev_b32 v98, 16, v53
    v_and_b32 v99, 0xffff0000, v53
    v_pk_fma_f32 v[98:99], v[98:99], v[92:93], v[94:95] op_sel_hi:[1,0,0]
    v_cvt_pk_bf16_f32 v53, v98, v99
    v_lshlrev_b32 v100, 16, v54
    v_and_b32 v101, 0xffff0000, v54
    v_pk_fma_f32 v[100:101], v[100:101], v[92:93], v[94:95] op_sel_hi:[1,0,0]
    v_cvt_pk_bf16_f32 v54, v100, v101
    v_lshlrev_b32 v102, 16, v55
    v_and_b32 v103, 0xffff0000, v55
    v_pk_fma_f32 v[102:103], v[102:103], v[92:93], v[94:95] op_sel_hi:[1,0,0]
    v_cvt_pk_bf16_f32 v55, v102, v103
    v_lshlrev_b32 v96, 16, v56
    v_and_b32 v97, 0xffff0000, v56
    v_pk_fma_f32 v[96:97], v[96:97], v[92:93], v[94:95] op_sel_hi:[1,0,0]
    v_cvt_pk_bf16_f32 v56, v96, v97
    v_lshlrev_b32 v98, 16, v57
    v_and_b32 v99, 0xffff0000, v57
    v_pk_fma_f32 v[98:99], v[98:99], v[92:93], v[94:95] op_sel_hi:[1,0,0]
    v_cvt_pk_bf16_f32 v57, v98, v99
    v_lshlrev_b32 v100, 16, v58
    v_and_b32 v101, 0xffff0000, v58
    v_pk_fma_f32 v[100:101], v[100:101], v[92:93], v[94:95] op_sel_hi:[1,0,0]
    v_cvt_pk_bf16_f32 v58, v100, v101
    v_lshlrev_b32 v102, 16, v59
    v_and_b32 v103, 0xffff0000, v59
    v_pk_fma_f32 v[102:103], v[102:103], v[92:93], v[94:95] op_sel_hi:[1,0,0]
    v_cvt_pk_bf16_f32 v59, v102, v103
    v_lshlrev_b32 v96, 16, v60
    v_and_b32 v97, 0xffff0000, v60
    v_pk_fma_f32 v[96:97], v[96:97], v[92:93], v[94:95] op_sel_hi:[1,0,0]
    v_cvt_pk_bf16_f32 v60, v96, v97
    v_lshlrev_b32 v98, 16, v61
    v_and_b32 v99, 0xffff0000, v61
    v_pk_fma_f32 v[98:99], v[98:99], v[92:93], v[94:95] op_sel_hi:[1,0,0]
    v_cvt_pk_bf16_f32 v61, v98, v99
    v_lshlrev_b32 v100, 16, v62
    v_and_b32 v101, 0xffff0000, v62
    v_pk_fma_f32 v[100:101], v[100:101], v[92:93], v[94:95] op_sel_hi:[1,0,0]
    v_cvt_pk_bf16_f32 v62, v100, v101
    v_lshlrev_b32 v102, 16, v63
    v_and_b32 v103, 0xffff0000, v63
    v_pk_fma_f32 v[102:103], v[102:103], v[92:93], v[94:95] op_sel_hi:[1,0,0]
    v_cvt_pk_bf16_f32 v63, v102, v103
    v_lshlrev_b32 v96, 16, v64
    v_and_b32 v97, 0xffff0000, v64
    v_pk_fma_f32 v[96:97], v[96:97], v[92:93], v[94:95] op_sel_hi:[1,0,0]
    v_cvt_pk_bf16_f32 v64, v96, v97
    v_lshlrev_b32 v98, 16, v65
    v_and_b32 v99, 0xffff0000, v65
    v_pk_fma_f32 v[98:99], v[98:99], v[92:93], v[94:95] op_sel_hi:[1,0,0]
    v_cvt_pk_bf16_f32 v65, v98, v99
    v_lshlrev_b32 v100, 16, v66
    v_and_b32 v101, 0xffff0000, v66
    v_pk_fma_f32 v[100:101], v[100:101], v[92:93], v[94:95] op_sel_hi:[1,0,0]
    v_cvt_pk_bf16_f32 v66, v100, v101
    v_lshlrev_b32 v102, 16, v67
    v_and_b32 v103, 0xffff0000, v67
    v_pk_fma_f32 v[102:103], v[102:103], v[92:93], v[94:95] op_sel_hi:[1,0,0]
    v_cvt_pk_bf16_f32 v67, v102, v103
    v_lshlrev_b32 v96, 16, v68
    v_and_b32 v97, 0xffff0000, v68
    v_pk_fma_f32 v[96:97], v[96:97], v[92:93], v[94:95] op_sel_hi:[1,0,0]
    v_cvt_pk_bf16_f32 v68, v96, v97
    v_lshlrev_b32 v98, 16, v69
    v_and_b32 v99, 0xffff0000, v69
    v_pk_fma_f32 v[98:99], v[98:99], v[92:93], v[94:95] op_sel_hi:[1,0,0]
    v_cvt_pk_bf16_f32 v69, v98, v99
    v_lshlrev_b32 v100, 16, v70
    v_and_b32 v101, 0xffff0000, v70
    v_pk_fma_f32 v[100:101], v[100:101], v[92:93], v[94:95] op_sel_hi:[1,0,0]
    v_cvt_pk_bf16_f32 v70, v100, v101
    v_lshlrev_b32 v102, 16, v71
    v_and_b32 v103, 0xffff0000, v71
    v_pk_fma_f32 v[102:103], v[102:103], v[92:93], v[94:95] op_sel_hi:[1,0,0]
    v_cvt_pk_bf16_f32 v71, v102, v103
    v_lshlrev_b32 v96, 16, v72
    v_and_b32 v97, 0xffff0000, v72
    v_pk_fma_f32 v[96:97], v[96:97], v[92:93], v[94:95] op_sel_hi:[1,0,0]
    v_cvt_pk_bf16_f32 v72, v96, v97
    v_lshlrev_b32 v98, 16, v73
    v_and_b32 v99, 0xffff0000, v73
    v_pk_fma_f32 v[98:99], v[98:99], v[92:93], v[94:95] op_sel_hi:[1,0,0]
    v_cvt_pk_bf16_f32 v73, v98, v99
    v_lshlrev_b32 v100, 16, v74
    v_and_b32 v101, 0xffff0000, v74
    v_pk_fma_f32 v[100:101], v[100:101], v[92:93], v[94:95] op_sel_hi:[1,0,0]
    v_cvt_pk_bf16_f32 v74, v100, v101
    v_lshlrev_b32 v102, 16, v75
    v_and_b32 v103, 0xffff0000, v75
    v_pk_fma_f32 v[102:103], v[102:103], v[92:93], v[94:95] op_sel_hi:[1,0,0]
    v_cvt_pk_bf16_f32 v75, v102, v103
    v_lshlrev_b32 v96, 16, v76
    v_and_b32 v97, 0xffff0000, v76
    v_pk_fma_f32 v[96:97], v[96:97], v[92:93], v[94:95] op_sel_hi:[1,0,0]
    v_cvt_pk_bf16_f32 v76, v96, v97
    v_lshlrev_b32 v98, 16, v77
    v_and_b32 v99, 0xffff0000, v77
    v_pk_fma_f32 v[98:99], v[98:99], v[92:93], v[94:95] op_sel_hi:[1,0,0]
    v_cvt_pk_bf16_f32 v77, v98, v99
    v_lshlrev_b32 v100, 16, v78
    v_and_b32 v101, 0xffff0000, v78
    v_pk_fma_f32 v[100:101], v[100:101], v[92:93], v[94:95] op_sel_hi:[1,0,0]
    v_cvt_pk_bf16_f32 v78, v100, v101
    v_lshlrev_b32 v102, 16, v79
    v_and_b32 v103, 0xffff0000, v79
    v_pk_fma_f32 v[102:103], v[102:103], v[92:93], v[94:95] op_sel_hi:[1,0,0]
    v_cvt_pk_bf16_f32 v79, v102, v103
    v_lshlrev_b32 v96, 16, v80
    v_and_b32 v97, 0xffff0000, v80
    v_pk_fma_f32 v[96:97], v[96:97], v[92:93], v[94:95] op_sel_hi:[1,0,0]
    v_cvt_pk_bf16_f32 v80, v96, v97
    v_lshlrev_b32 v98, 16, v81
    v_and_b32 v99, 0xffff0000, v81
    v_pk_fma_f32 v[98:99], v[98:99], v[92:93], v[94:95] op_sel_hi:[1,0,0]
    v_cvt_pk_bf16_f32 v81, v98, v99
    v_lshlrev_b32 v100, 16, v82
    v_and_b32 v101, 0xffff0000, v82
    v_pk_fma_f32 v[100:101], v[100:101], v[92:93], v[94:95] op_sel_hi:[1,0,0]
    v_cvt_pk_bf16_f32 v82, v100, v101
    v_lshlrev_b32 v102, 16, v83
    v_and_b32 v103, 0xffff0000, v83
    v_pk_fma_f32 v[102:103], v[102:103], v[92:93], v[94:95] op_sel_hi:[1,0,0]
    v_cvt_pk_bf16_f32 v83, v102, v103
    v_lshlrev_b32 v96, 16, v84
    v_and_b32 v97, 0xffff0000, v84
    v_pk_fma_f32 v[96:97], v[96:97], v[92:93], v[94:95] op_sel_hi:[1,0,0]
    v_cvt_pk_bf16_f32 v84, v96, v97
    v_lshlrev_b32 v98, 16, v85
    v_and_b32 v99, 0xffff0000, v85
    v_pk_fma_f32 v[98:99], v[98:99], v[92:93], v[94:95] op_sel_hi:[1,0,0]
    v_cvt_pk_bf16_f32 v85, v98, v99
    v_lshlrev_b32 v100, 16, v86
    v_and_b32 v101, 0xffff0000, v86
    v_pk_fma_f32 v[100:101], v[100:101], v[92:93], v[94:95] op_sel_hi:[1,0,0]
    v_cvt_pk_bf16_f32 v86, v100, v101
    v_lshlrev_b32 v102, 16, v87
    v_and_b32 v103, 0xffff0000, v87
    v_pk_fma_f32 v[102:103], v[102:103], v[92:93], v[94:95] op_sel_hi:[1,0,0]
    v_cvt_pk_bf16_f32 v87, v102, v103
    s_waitcnt lgkmcnt(0)
    s_barrier
    ds_write_b128 v106, v[52:55] offset:0
    ds_write_b128 v106, v[56:59] offset:128
    ds_write_b128 v106, v[60:63] offset:256
    ds_write_b128 v106, v[64:67] offset:384
    ds_write_b128 v106, v[68:71] offset:512
    ds_write_b128 v106, v[72:75] offset:640
    ds_write_b128 v106, v[76:79] offset:768
    ds_write_b128 v106, v[80:83] offset:896
    ds_write_b128 v106, v[84:87] offset:1024
    s_waitcnt lgkmcnt(0)
    s_barrier
    s_lshr_b32 s49, s45, 1
    s_cmp_lg_u32 s49, 1
    s_cbranch_scc1 .xr_2
    ds_read_b128 a[0:3], v107 offset:0
    ds_read_b128 a[4:7], v107 offset:32
    ds_read_b128 a[8:11], v107 offset:64
    ds_read_b128 a[12:15], v107 offset:96
    ds_read_b128 a[16:19], v107 offset:128
    ds_read_b128 a[20:23], v107 offset:160
    ds_read_b128 a[24:27], v107 offset:192
    ds_read_b128 a[28:31], v107 offset:224
    ds_read_b128 a[32:35], v107 offset:256
    ds_read_b128 a[36:39], v107 offset:288
    ds_read_b128 a[40:43], v107 offset:320
    ds_read_b128 a[44:47], v107 offset:352
    ds_read_b128 a[48:51], v107 offset:384
    ds_read_b128 a[52:55], v107 offset:416
    ds_read_b128 a[56:59], v107 offset:448
    ds_read_b128 a[60:63], v107 offset:480
    ds_read_b128 a[64:67], v107 offset:512
    ds_read_b128 a[68:71], v107 offset:544
    ds_read_b128 a[72:75], v107 offset:576
    ds_read_b128 a[76:79], v107 offset:608
    ds_read_b128 a[80:83], v107 offset:640
    ds_read_b128 a[84:87], v107 offset:672
    ds_read_b128 a[88:91], v107 offset:704
    ds_read_b128 a[92:95], v107 offset:736
    ds_read_b128 a[96:99], v107 offset:768
    ds_read_b128 a[100:103], v107 offset:800
    ds_read_b128 a[104:107], v107 offset:832
    ds_read_b128 a[108:111], v107 offset:864
    ds_read_b128 a[112:115], v107 offset:896
    ds_read_b128 a[116:119], v107 offset:928
    ds_read_b128 a[120:123], v107 offset:960
    ds_read_b128 a[124:127], v107 offset:992
    ds_read_b128 a[128:131], v107 offset:1024
    ds_read_b128 a[132:135], v107 offset:1056
    ds_read_b128 a[136:139], v107 offset:1088
    ds_read_b128 a[140:143], v107 offset:1120
.xr_2:
    s_waitcnt lgkmcnt(0)
    s_barrier
    s_sub_u32 s50, s58, s54
    s_lshl_b32 s50, s50, 1
    v_add_u32 v0, s50, v13
    ds_read_b128 v[32:35], v0 offset:0
    ds_read_b128 v[36:39], v0 offset:32
    ds_read_b128 v[40:43], v0 offset:64
    ds_read_b128 v[44:47], v0 offset:96
    ds_read_b64_tr_b16 v[16:17], v3 offset:0
    ds_read_b64_tr_b16 v[18:19], v3 offset:512
    ds_read_b64_tr_b16 v[20:21], v3 offset:2048
    ds_read_b64_tr_b16 v[22:23], v3 offset:2560
    ds_read_b64_tr_b16 v[24:25], v3 offset:4096
    ds_read_b64_tr_b16 v[26:27], v3 offset:4608
    s_waitcnt lgkmcnt(4)
    v_mfma_f32_32x32x16_bf16 v[32:47], v[16:19], a[0:3], v[32:47]
    ds_read_b64_tr_b16 v[28:29], v3 offset:6144
    ds_read_b64_tr_b16 v[30:31], v3 offset:6656
    s_add_u32 m0, s52, 65536
    s_add_u32 s49, s64, 0
    buffer_load_dwordx4 v1, s[8:11], s49 offen lds
    s_waitcnt lgkmcnt(4)
    v_mfma_f32_32x32x16_bf16 v[32:47], v[20:23], a[4:7], v[32:47]
    ds_read_b64_tr_b16 v[16:17], v3 offset:8192
    ds_read_b64_tr_b16 v[18:19], v3 offset:8704
    s_add_u32 m0, s52, 66560
    s_add_u32 s49, s64, 73728
    buffer_load_dwordx4 v1, s[8:11], s49 offen lds
    s_waitcnt lgkmcnt(4)
    v_mfma_f32_32x32x16_bf16 v[32:47], v[24:27], a[8:11], v[32:47]
    ds_read_b64_tr_b16 v[20:21], v3 offset:10240
    ds_read_b64_tr_b16 v[22:23], v3 offset:10752
    s_add_u32 m0, s52, 81920
    s_add_u32 s49, s59, 589824
    buffer_load_dwordx4 v1, s[8:11], s49 offen lds
    s_waitcnt lgkmcnt(4)
    v_mfma_f32_32x32x16_bf16 v[32:47], v[28:31], a[12:15], v[32:47]
    ds_read_b64_tr_b16 v[24:25], v3 offset:12288
    ds_read_b64_tr_b16 v[26:27], v3 offset:12800
    s_add_u32 m0, s52, 82944
    s_add_u32 s49, s59, 663552
    buffer_load_dwordx4 v1, s[8:11], s49 offen lds
    s_waitcnt lgkmcnt(4)
    v_mfma_f32_32x32x16_bf16 v[32:47], v[16:19], a[16:19], v[32:47]
    ds_read_b64_tr_b16 v[28:29], v3 offset:14336
    ds_read_b64_tr_b16 v[30:31], v3 offset:14848
    s_waitcnt lgkmcnt(4)
    v_mfma_f32_32x32x16_bf16 v[32:47], v[20:23], a[20:23], v[32:47]
    ds_read_b64_tr_b16 v[16:17], v3 offset:16384
    ds_read_b64_tr_b16 v[18:19], v3 offset:16896
    s_waitcnt lgkmcnt(4)
    v_mfma_f32_32x32x16_bf16 v[32:47], v[24:27], a[24:27], v[32:47]
    ds_read_b64_tr_b16 v[20:21], v3 offset:18432
    ds_read_b64_tr_b16 v[22:23], v3 offset:18944
    s_waitcnt lgkmcnt(4)
    v_mfma_f32_32x32x16_bf16 v[32:47], v[28:31], a[28:31], v[32:47]
    s_barrier
    s_waitcnt lgkmcnt(2)
    v_mfma_f32_32x32x16_bf16 v[32:47], v[16:19], a[32:35], v[32:47]
    ds_read_b64_tr_b16 v[24:25], v3 offset:20480
    ds_read_b64_tr_b16 v[26:27], v3 offset:20992
    ds_read_b64_tr_b16 v[28:29], v3 offset:22528
    ds_read_b64_tr_b16 v[30:31], v3 offset:23040
    s_add_u32 m0, s52, 0
    s_add_u32 s49, s59, 1769472
    buffer_load_dwordx4 v1, s[8:11], s49 offen lds
    s_waitcnt lgkmcnt(4)
    v_mfma_f32_32x32x16_bf16 v[32:47], v[20:23], a[36:39], v[32:47]
    ds_read_b64_tr_b16 v[16:17], v3 offset:24576
    ds_read_b64_tr_b16 v[18:19], v3 offset:25088
    s_add_u32 m0, s52, 1024
    s_add_u32 s49, s59, 1843200
    buffer_load_dwordx4 v1, s[8:11], s49 offen lds
    s_waitcnt lgkmcnt(4)
    v_mfma_f32_32x32x16_bf16 v[32:47], v[24:27], a[40:43], v[32:47]
    ds_read_b64_tr_b16 v[20:21], v3 offset:26624
    ds_read_b64_tr_b16 v[22:23], v3 offset:27136
    s_add_u32 m0, s52, 98304
    s_add_u32 s49, s59, 2949120
    buffer_load_dwordx4 v1, s[8:11], s49 offen lds
    s_waitcnt lgkmcnt(4)
    v_mfma_f32_32x32x16_bf16 v[32:47], v[28:31], a[44:47], v[32:47]
    ds_read_b64_tr_b16 v[24:25], v3 offset:28672
    ds_read_b64_tr_b16 v[26:27], v3 offset:29184
    s_add_u32 m0, s52, 99328
    s_add_u32 s49, s59, 3022848
    buffer_load_dwordx4 v1, s[8:11], s49 offen lds
    s_waitcnt lgkmcnt(4)
    v_mfma_f32_32x32x16_bf16 v[32:47], v[16:19], a[48:51], v[32:47]
    ds_read_b64_tr_b16 v[28:29], v3 offset:30720
    ds_read_b64_tr_b16 v[30:31], v3 offset:31232
    s_waitcnt lgkmcnt(4)
    v_mfma_f32_32x32x16_bf16 v[32:47], v[20:23], a[52:55], v[32:47]
    ds_read_b64_tr_b16 v[16:17], v3 offset:32768
    ds_read_b64_tr_b16 v[18:19], v3 offset:33280
    s_waitcnt lgkmcnt(4)
    v_mfma_f32_32x32x16_bf16 v[32:47], v[24:27], a[56:59], v[32:47]
    ds_read_b64_tr_b16 v[20:21], v3 offset:34816
    ds_read_b64_tr_b16 v[22:23], v3 offset:35328
    s_waitcnt lgkmcnt(4)
    v_mfma_f32_32x32x16_bf16 v[32:47], v[28:31], a[60:63], v[32:47]
    s_barrier
    s_waitcnt lgkmcnt(2)
    v_mfma_f32_32x32x16_bf16 v[32:47], v[16:19], a[64:67], v[32:47]
    ds_read_b64_tr_b16 v[24:25], v3 offset:36864
    ds_read_b64_tr_b16 v[26:27], v3 offset:37376
    ds_read_b64_tr_b16 v[28:29], v3 offset:38912
    ds_read_b64_tr_b16 v[30:31], v3 offset:39424
    s_add_u32 m0, s52, 16384
    s_add_u32 s49, s59, 4128768
    buffer_load_dwordx4 v1, s[8:11], s49 offen lds
    s_waitcnt lgkmcnt(4)
    v_mfma_f32_32x32x16_bf16 v[32:47], v[20:23], a[68:71], v[32:47]
    ds_read_b64_tr_b16 v[16:17], v3 offset:40960
    ds_read_b64_tr_b16 v[18:19], v3 offset:41472
    s_add_u32 m0, s52, 17408
    s_add_u32 s49, s59, 4202496
    buffer_load_dwordx4 v1, s[8:11], s49 offen lds
    s_waitcnt lgkmcnt(4)
    v_mfma_f32_32x32x16_bf16 v[32:47], v[24:27], a[72:75], v[32:47]
    ds_read_b64_tr_b16 v[20:21], v3 offset:43008
    ds_read_b64_tr_b16 v[22:23], v3 offset:43520
    s_add_u32 m0, s52, 114688
    s_add_u32 s49, s60, 0
    buffer_load_dwordx4 v1, s[8:11], s49 offen lds
    s_waitcnt lgkmcnt(4)
    v_mfma_f32_32x32x16_bf16 v[32:47], v[28:31], a[76:79], v[32:47]
    ds_read_b64_tr_b16 v[24:25], v3 offset:45056
    ds_read_b64_tr_b16 v[26:27], v3 offset:45568
    s_add_u32 m0, s52, 115712
    s_add_u32 s49, s60, 73728
    buffer_load_dwordx4 v1, s[8:11], s49 offen lds
    s_waitcnt lgkmcnt(4)
    v_mfma_f32_32x32x16_bf16 v[32:47], v[16:19], a[80:83], v[32:47]
    ds_read_b64_tr_b16 v[28:29], v3 offset:47104
    ds_read_b64_tr_b16 v[30:31], v3 offset:47616
    s_waitcnt lgkmcnt(4)
    v_mfma_f32_32x32x16_bf16 v[32:47], v[20:23], a[84:87], v[32:47]
    ds_read_b64_tr_b16 v[16:17], v3 offset:49152
    ds_read_b64_tr_b16 v[18:19], v3 offset:49664
    s_waitcnt lgkmcnt(4)
    v_mfma_f32_32x32x16_bf16 v[32:47], v[24:27], a[88:91], v[32:47]
    ds_read_b64_tr_b16 v[20:21], v3 offset:51200
    ds_read_b64_tr_b16 v[22:23], v3 offset:51712
    s_waitcnt lgkmcnt(4)
    v_mfma_f32_32x32x16_bf16 v[32:47], v[28:31], a[92:95], v[32:47]
    s_waitcnt vmcnt(10)
    s_barrier
    s_waitcnt lgkmcnt(2)
    v_mfma_f32_32x32x16_bf16 v[32:47], v[16:19], a[96:99], v[32:47]
    ds_read_b64_tr_b16 v[24:25], v3 offset:53248
    ds_read_b64_tr_b16 v[26:27], v3 offset:53760
    ds_read_b64_tr_b16 v[28:29], v3 offset:55296
    ds_read_b64_tr_b16 v[30:31], v3 offset:55808
    s_add_u32 m0, s52, 32768
    s_add_u32 s49, s60, 1179648
    buffer_load_dwordx4 v1, s[8:11], s49 offen lds
    s_waitcnt lgkmcnt(4)
    v_mfma_f32_32x32x16_bf16 v[32:47], v[20:23], a[100:103], v[32:47]
    ds_read_b64_tr_b16 v[16:17], v3 offset:57344
    ds_read_b64_tr_b16 v[18:19], v3 offset:57856
    s_add_u32 m0, s52, 33792
    s_add_u32 s49, s60, 1253376
    buffer_load_dwordx4 v1, s[8:11], s49 offen lds
    s_waitcnt lgkmcnt(4)
    v_mfma_f32_32x32x16_bf16 v[32:47], v[24:27], a[104:107], v[32:47]
    ds_read_b64_tr_b16 v[20:21], v3 offset:59392
    ds_read_b64_tr_b16 v[22:23], v3 offset:59904
    s_add_u32 m0, s52, 131072
    s_add_u32 s49, s60, 2359296
    buffer_load_dwordx4 v1, s[8:11], s49 offen lds
    s_waitcnt lgkmcnt(4)
    v_mfma_f32_32x32x16_bf16 v[32:47], v[28:31], a[108:111], v[32:47]
    ds_read_b64_tr_b16 v[24:25], v3 offset:61440
    ds_read_b64_tr_b16 v[26:27], v3 offset:61952
    s_add_u32 m0, s52, 132096
    s_add_u32 s49, s60, 2433024
    buffer_load_dwordx4 v1, s[8:11], s49 offen lds
    s_waitcnt lgkmcnt(4)
    v_mfma_f32_32x32x16_bf16 v[32:47], v[16:19], a[112:115], v[32:47]
    ds_read_b64_tr_b16 v[28:29], v3 offset:63488
    ds_read_b64_tr_b16 v[30:31], v3 offset:64000
    s_waitcnt lgkmcnt(4)
    v_mfma_f32_32x32x16_bf16 v[32:47], v[20:23], a[116:119], v[32:47]
    ds_read_b64_tr_b16 v[16:17], v4 offset:0
    ds_read_b64_tr_b16 v[18:19], v4 offset:512
    s_waitcnt lgkmcnt(4)
    v_mfma_f32_32x32x16_bf16 v[32:47], v[24:27], a[120:123], v[32:47]
    ds_read_b64_tr_b16 v[20:21], v4 offset:2048
    ds_read_b64_tr_b16 v[22:23], v4 offset:2560
    s_waitcnt lgkmcnt(4)
    v_mfma_f32_32x32x16_bf16 v[32:47], v[28:31], a[124:127], v[32:47]
    s_waitcnt vmcnt(12)
    s_barrier
    s_waitcnt lgkmcnt(2)
    v_mfma_f32_32x32x16_bf16 v[32:47], v[16:19], a[128:131], v[32:47]
    ds_read_b64_tr_b16 v[24:25], v4 offset:4096
    ds_read_b64_tr_b16 v[26:27], v4 offset:4608
    ds_read_b64_tr_b16 v[28:29], v4 offset:6144
    ds_read_b64_tr_b16 v[30:31], v4 offset:6656
    s_add_u32 m0, s52, 49152
    s_add_u32 s49, s60, 3538944
    buffer_load_dwordx4 v1, s[8:11], s49 offen lds
    s_waitcnt lgkmcnt(4)
    v_mfma_f32_32x32x16_bf16 v[32:47], v[20:23], a[132:135], v[32:47]
    ds_read_b64_tr_b16 v[16:17], v4 offset:8192
    ds_read_b64_tr_b16 v[18:19], v4 offset:8704
    s_add_u32 m0, s52, 50176
    s_add_u32 s49, s60, 3612672
    buffer_load_dwordx4 v1, s[8:11], s49 offen lds
    s_waitcnt lgkmcnt(4)
    v_mfma_f32_32x32x16_bf16 v[32:47], v[24:27], a[136:139], v[32:47]
    ds_read_b64_tr_b16 v[20:21], v4 offset:10240
    ds_read_b64_tr_b16 v[22:23], v4 offset:10752
    s_sub_u32 s50, s59, s54
    s_lshl_b32 s50, s50, 1
    v_add_u32 v0, s50, v13
    ds_read_b128 v[48:51], v0 offset:0
    ds_read_b128 v[52:55], v0 offset:32
    ds_read_b128 v[56:59], v0 offset:64
    ds_read_b128 v[60:63], v0 offset:96
    s_waitcnt lgkmcnt(8)
    v_mfma_f32_32x32x16_bf16 v[32:47], v[28:31], a[140:143], v[32:47]
    ds_read_b64_tr_b16 v[24:25], v4 offset:12288
    ds_read_b64_tr_b16 v[26:27], v4 offset:12800
    s_waitcnt lgkmcnt(2)
    v_mfma_f32_32x32x16_bf16 v[48:63], v[16:19], a[0:3], v[48:63]
    ds_read_b64_tr_b16 v[28:29], v4 offset:14336
    ds_read_b64_tr_b16 v[30:31], v4 offset:14848
    v_mfma_f32_32x32x16_bf16 v[48:63], v[20:23], a[4:7], v[48:63]
    ds_read_b64_tr_b16 v[16:17], v4 offset:16384
    ds_read_b64_tr_b16 v[18:19], v4 offset:16896
    s_waitcnt lgkmcnt(4)
    v_mfma_f32_32x32x16_bf16 v[48:63], v[24:27], a[8:11], v[48:63]
    ds_read_b64_tr_b16 v[20:21], v4 offset:18432
    ds_read_b64_tr_b16 v[22:23], v4 offset:18944
    v_mul_f32 v64, s98, v32
    v_mul_f32 v66, s98, v33
    v_mul_f32 v68, s98, v34
    s_waitcnt lgkmcnt(4)
    v_mfma_f32_32x32x16_bf16 v[48:63], v[28:31], a[12:15], v[48:63]
    s_waitcnt vmcnt(12)
    s_barrier
    s_waitcnt lgkmcnt(2)
    v_mfma_f32_32x32x16_bf16 v[48:63], v[16:19], a[16:19], v[48:63]
    ds_read_b64_tr_b16 v[24:25], v4 offset:20480
    ds_read_b64_tr_b16 v[26:27], v4 offset:20992
    ds_read_b64_tr_b16 v[28:29], v4 offset:22528
    ds_read_b64_tr_b16 v[30:31], v4 offset:23040
    v_mul_f32 v70, s98, v35
    v_exp_f32 v64, v64
    v_exp_f32 v66, v66
    v_exp_f32 v68, v68
    v_exp_f32 v70, v70
    v_fmaak_f32 v65, -0.5, v64, 0xbf800000
    v_fmaak_f32 v67, -0.5, v66, 0xbf800000
    s_add_u32 m0, s52, 65536
    s_add_u32 s49, s65, 0
    buffer_load_dwordx4 v1, s[8:11], s49 offen lds
    s_waitcnt lgkmcnt(4)
    v_mfma_f32_32x32x16_bf16 v[48:63], v[20:23], a[20:23], v[48:63]
    ds_read_b64_tr_b16 v[16:17], v4 offset:24576
    ds_read_b64_tr_b16 v[18:19], v4 offset:25088
    v_fmaak_f32 v69, -0.5, v68, 0xbf800000
    v_fmaak_f32 v71, -0.5, v70, 0xbf800000
    v_fmaak_f32 v65, v64, v65, 0xbf800000
    s_add_u32 m0, s52, 66560
    s_add_u32 s49, s65, 73728
    buffer_load_dwordx4 v1, s[8:11], s49 offen lds
    s_waitcnt lgkmcnt(4)
    v_mfma_f32_32x32x16_bf16 v[48:63], v[24:27], a[24:27], v[48:63]
    ds_read_b64_tr_b16 v[20:21], v4 offset:26624
    ds_read_b64_tr_b16 v[22:23], v4 offset:27136
    v_fmaak_f32 v67, v66, v67, 0xbf800000
    v_fmaak_f32 v69, v68, v69, 0xbf800000
    v_fmaak_f32 v71, v70, v71, 0xbf800000
    v_rcp_f32 v65, v65
    s_waitcnt lgkmcnt(4)
    v_mfma_f32_32x32x16_bf16 v[48:63], v[28:31], a[28:31], v[48:63]
    ds_read_b64_tr_b16 v[24:25], v4 offset:28672
    ds_read_b64_tr_b16 v[26:27], v4 offset:29184
    v_rcp_f32 v67, v67
    v_rcp_f32 v69, v69
    v_rcp_f32 v71, v71
    s_waitcnt lgkmcnt(4)
    v_mfma_f32_32x32x16_bf16 v[48:63], v[16:19], a[32:35], v[48:63]
    ds_read_b64_tr_b16 v[28:29], v4 offset:30720
    ds_read_b64_tr_b16 v[30:31], v4 offset:31232
    v_fmac_f32 v32, v32, v65
    v_fmac_f32 v33, v33, v67
    v_fmac_f32 v34, v34, v69
    s_waitcnt lgkmcnt(4)
    v_mfma_f32_32x32x16_bf16 v[48:63], v[20:23], a[36:39], v[48:63]
    ds_read_b64_tr_b16 v[16:17], v3 offset:0
    ds_read_b64_tr_b16 v[18:19], v3 offset:512
    v_fmac_f32 v35, v35, v71
    v_cvt_pk_bf16_f32 v72, v32, v33
    v_cvt_pk_bf16_f32 v73, v34, v35
    v_mul_f32 v64, s98, v36
    s_waitcnt lgkmcnt(4)
    v_mfma_f32_32x32x16_bf16 v[48:63], v[24:27], a[40:43], v[48:63]
    ds_read_b64_tr_b16 v[20:21], v3 offset:2048
    ds_read_b64_tr_b16 v[22:23], v3 offset:2560
    v_mul_f32 v66, s98, v37
    v_mul_f32 v68, s98, v38
    v_mul_f32 v70, s98, v39
    s_waitcnt lgkmcnt(4)
    v_mfma_f32_32x32x16_bf16 v[48:63], v[28:31], a[44:47], v[48:63]
    s_waitcnt vmcnt(12)
    s_barrier
    s_waitcnt lgkmcnt(2)
    v_mfma_f32_32x32x16_bf16 v[48:63], v[16:19], a[48:51], v[48:63]
    ds_read_b64_tr_b16 v[24:25], v3 offset:4096
    ds_read_b64_tr_b16 v[26:27], v3 offset:4608
    ds_read_b64_tr_b16 v[28:29], v3 offset:6144
    ds_read_b64_tr_b16 v[30:31], v3 offset:6656
    v_exp_f32 v64, v64
    v_exp_f32 v66, v66
    v_exp_f32 v68, v68
    v_exp_f32 v70, v70
    v_fmaak_f32 v65, -0.5, v64, 0xbf800000
    v_fmaak_f32 v67, -0.5, v66, 0xbf800000
    v_fmaak_f32 v69, -0.5, v68, 0xbf800000
    s_add_u32 m0, s52, 81920
    s_add_u32 s49, s61, 589824
    buffer_load_dwordx4 v1, s[8:11], s49 offen lds
    s_waitcnt lgkmcnt(4)
    v_mfma_f32_32x32x16_bf16 v[48:63], v[20:23], a[52:55], v[48:63]
    ds_read_b64_tr_b16 v[16:17], v3 offset:8192
    ds_read_b64_tr_b16 v[18:19], v3 offset:8704
    v_fmaak_f32 v71, -0.5, v70, 0xbf800000
    v_fmaak_f32 v65, v64, v65, 0xbf800000
    v_fmaak_f32 v67, v66, v67, 0xbf800000
    s_lshl_b32 s50, s47, 4
    s_add_u32 s50, s50, s48
    v_mov_b32 v0, s93
    s_cmp_eq_u32 s44, 0
    s_cselect_b64 exec, 1, 0

    buffer_store_byte v0, off, s[28:31], s50 sc0 sc1
    s_mov_b64 exec, -1
    s_add_u32 m0, s52, 82944
    s_add_u32 s49, s61, 663552
    buffer_load_dwordx4 v1, s[8:11], s49 offen lds
    s_waitcnt lgkmcnt(4)
    v_mfma_f32_32x32x16_bf16 v[48:63], v[24:27], a[56:59], v[48:63]
    ds_read_b64_tr_b16 v[20:21], v3 offset:10240
    ds_read_b64_tr_b16 v[22:23], v3 offset:10752
    v_fmaak_f32 v69, v68, v69, 0xbf800000
    v_fmaak_f32 v71, v70, v71, 0xbf800000
    v_rcp_f32 v65, v65
    v_rcp_f32 v67, v67
    s_waitcnt lgkmcnt(4)
    v_mfma_f32_32x32x16_bf16 v[48:63], v[28:31], a[60:63], v[48:63]
    ds_read_b64_tr_b16 v[24:25], v3 offset:12288
    ds_read_b64_tr_b16 v[26:27], v3 offset:12800
    v_rcp_f32 v69, v69
    v_rcp_f32 v71, v71
    v_fmac_f32 v36, v36, v65
    s_waitcnt lgkmcnt(4)
    v_mfma_f32_32x32x16_bf16 v[48:63], v[16:19], a[64:67], v[48:63]
    ds_read_b64_tr_b16 v[28:29], v3 offset:14336
    ds_read_b64_tr_b16 v[30:31], v3 offset:14848
    v_fmac_f32 v37, v37, v67
    v_fmac_f32 v38, v38, v69
    v_fmac_f32 v39, v39, v71
    s_waitcnt lgkmcnt(4)
    v_mfma_f32_32x32x16_bf16 v[48:63], v[20:23], a[68:71], v[48:63]
    ds_read_b64_tr_b16 v[16:17], v4 offset:32768
    ds_read_b64_tr_b16 v[18:19], v4 offset:33280
    v_cvt_pk_bf16_f32 v74, v36, v37
    v_cvt_pk_bf16_f32 v75, v38, v39
    v_mul_f32 v64, s98, v40
    v_mul_f32 v66, s98, v41
    s_waitcnt lgkmcnt(4)
    v_mfma_f32_32x32x16_bf16 v[48:63], v[24:27], a[72:75], v[48:63]
    ds_read_b64_tr_b16 v[20:21], v4 offset:34816
    ds_read_b64_tr_b16 v[22:23], v4 offset:35328
    v_mul_f32 v68, s98, v42
    v_mul_f32 v70, s98, v43
    v_exp_f32 v64, v64
    s_waitcnt lgkmcnt(4)
    v_mfma_f32_32x32x16_bf16 v[48:63], v[28:31], a[76:79], v[48:63]
    s_waitcnt vmcnt(13)
    s_barrier
    s_waitcnt lgkmcnt(2)
    v_mfma_f32_32x32x16_bf16 v[48:63], v[16:19], a[80:83], v[48:63]
    ds_read_b64_tr_b16 v[24:25], v4 offset:36864
    ds_read_b64_tr_b16 v[26:27], v4 offset:37376
    ds_read_b64_tr_b16 v[28:29], v4 offset:38912
    ds_read_b64_tr_b16 v[30:31], v4 offset:39424
    v_exp_f32 v66, v66
    v_exp_f32 v68, v68
    v_exp_f32 v70, v70
    v_fmaak_f32 v65, -0.5, v64, 0xbf800000
    v_fmaak_f32 v67, -0.5, v66, 0xbf800000
    v_fmaak_f32 v69, -0.5, v68, 0xbf800000
    v_fmaak_f32 v71, -0.5, v70, 0xbf800000
    s_add_u32 m0, s52, 0
    s_add_u32 s49, s61, 1769472
    buffer_load_dwordx4 v1, s[8:11], s49 offen lds
    s_waitcnt lgkmcnt(4)
    v_mfma_f32_32x32x16_bf16 v[48:63], v[20:23], a[84:87], v[48:63]
    ds_read_b64_tr_b16 v[16:17], v4 offset:40960
    ds_read_b64_tr_b16 v[18:19], v4 offset:41472
    v_fmaak_f32 v65, v64, v65, 0xbf800000
    v_fmaak_f32 v67, v66, v67, 0xbf800000
    v_fmaak_f32 v69, v68, v69, 0xbf800000
    s_add_u32 m0, s52, 1024
    s_add_u32 s49, s61, 1843200
    buffer_load_dwordx4 v1, s[8:11], s49 offen lds
    s_waitcnt lgkmcnt(4)
    v_mfma_f32_32x32x16_bf16 v[48:63], v[24:27], a[88:91], v[48:63]
    ds_read_b64_tr_b16 v[20:21], v4 offset:43008
    ds_read_b64_tr_b16 v[22:23], v4 offset:43520
    v_fmaak_f32 v71, v70, v71, 0xbf800000
    v_rcp_f32 v65, v65
    v_rcp_f32 v67, v67
    s_waitcnt lgkmcnt(4)
    v_mfma_f32_32x32x16_bf16 v[48:63], v[28:31], a[92:95], v[48:63]
    ds_read_b64_tr_b16 v[24:25], v4 offset:45056
    ds_read_b64_tr_b16 v[26:27], v4 offset:45568
    v_rcp_f32 v69, v69
    v_rcp_f32 v71, v71
    v_fmac_f32 v40, v40, v65
    v_fmac_f32 v41, v41, v67
    s_waitcnt lgkmcnt(4)
    v_mfma_f32_32x32x16_bf16 v[48:63], v[16:19], a[96:99], v[48:63]
    ds_read_b64_tr_b16 v[28:29], v4 offset:47104
    ds_read_b64_tr_b16 v[30:31], v4 offset:47616
    v_fmac_f32 v42, v42, v69
    v_fmac_f32 v43, v43, v71
    v_cvt_pk_bf16_f32 v76, v40, v41
    s_waitcnt lgkmcnt(4)
    v_mfma_f32_32x32x16_bf16 v[48:63], v[20:23], a[100:103], v[48:63]
    ds_read_b64_tr_b16 v[16:17], v3 offset:16384
    ds_read_b64_tr_b16 v[18:19], v3 offset:16896
    v_cvt_pk_bf16_f32 v77, v42, v43
    v_mul_f32 v64, s98, v44
    v_mul_f32 v66, s98, v45
    v_mul_f32 v68, s98, v46
    s_waitcnt lgkmcnt(4)
    v_mfma_f32_32x32x16_bf16 v[48:63], v[24:27], a[104:107], v[48:63]
    ds_read_b64_tr_b16 v[20:21], v3 offset:18432
    ds_read_b64_tr_b16 v[22:23], v3 offset:18944
    v_mul_f32 v70, s98, v47
    v_exp_f32 v64, v64
    v_exp_f32 v66, v66
    s_waitcnt lgkmcnt(4)
    v_mfma_f32_32x32x16_bf16 v[48:63], v[28:31], a[108:111], v[48:63]
    s_waitcnt vmcnt(13)
    s_barrier
    s_waitcnt lgkmcnt(2)
    v_mfma_f32_32x32x16_bf16 v[48:63], v[16:19], a[112:115], v[48:63]
    ds_read_b64_tr_b16 v[24:25], v3 offset:20480
    ds_read_b64_tr_b16 v[26:27], v3 offset:20992
    ds_read_b64_tr_b16 v[28:29], v3 offset:22528
    ds_read_b64_tr_b16 v[30:31], v3 offset:23040
    v_exp_f32 v68, v68
    v_exp_f32 v70, v70
    v_fmaak_f32 v65, -0.5, v64, 0xbf800000
    v_fmaak_f32 v67, -0.5, v66, 0xbf800000
    v_fmaak_f32 v69, -0.5, v68, 0xbf800000
    v_fmaak_f32 v71, -0.5, v70, 0xbf800000
    v_fmaak_f32 v65, v64, v65, 0xbf800000
    s_add_u32 m0, s52, 98304
    s_add_u32 s49, s61, 2949120
    buffer_load_dwordx4 v1, s[8:11], s49 offen lds
    s_waitcnt lgkmcnt(4)
    v_mfma_f32_32x32x16_bf16 v[48:63], v[20:23], a[116:119], v[48:63]
    ds_read_b64_tr_b16 v[16:17], v3 offset:24576
    ds_read_b64_tr_b16 v[18:19], v3 offset:25088
    v_fmaak_f32 v67, v66, v67, 0xbf800000
    v_fmaak_f32 v69, v68, v69, 0xbf800000
    v_fmaak_f32 v71, v70, v71, 0xbf800000
    s_add_u32 m0, s52, 99328
    s_add_u32 s49, s61, 3022848
    buffer_load_dwordx4 v1, s[8:11], s49 offen lds
    s_waitcnt lgkmcnt(4)
    v_mfma_f32_32x32x16_bf16 v[48:63], v[24:27], a[120:123], v[48:63]
    ds_read_b64_tr_b16 v[20:21], v3 offset:26624
    ds_read_b64_tr_b16 v[22:23], v3 offset:27136
    v_rcp_f32 v65, v65
    v_rcp_f32 v67, v67
    v_rcp_f32 v69, v69
    s_waitcnt lgkmcnt(4)
    v_mfma_f32_32x32x16_bf16 v[48:63], v[28:31], a[124:127], v[48:63]
    ds_read_b64_tr_b16 v[24:25], v3 offset:28672
    ds_read_b64_tr_b16 v[26:27], v3 offset:29184
    v_rcp_f32 v71, v71
    v_fmac_f32 v44, v44, v65
    v_fmac_f32 v45, v45, v67
    v_fmac_f32 v46, v46, v69
    s_waitcnt lgkmcnt(4)
    v_mfma_f32_32x32x16_bf16 v[48:63], v[16:19], a[128:131], v[48:63]
    ds_read_b64_tr_b16 v[28:29], v3 offset:30720
    ds_read_b64_tr_b16 v[30:31], v3 offset:31232
    v_fmac_f32 v47, v47, v71
    v_cvt_pk_bf16_f32 v78, v44, v45
    v_cvt_pk_bf16_f32 v79, v46, v47
    s_waitcnt lgkmcnt(4)
    v_mfma_f32_32x32x16_bf16 v[48:63], v[20:23], a[132:135], v[48:63]
    ds_read_b64_tr_b16 v[16:17], v4 offset:49152
    ds_read_b64_tr_b16 v[18:19], v4 offset:49664
    s_waitcnt lgkmcnt(4)
    v_mfma_f32_32x32x16_bf16 v[48:63], v[24:27], a[136:139], v[48:63]
    ds_read_b64_tr_b16 v[20:21], v4 offset:51200
    ds_read_b64_tr_b16 v[22:23], v4 offset:51712
    s_sub_u32 s50, s60, s54
    s_lshl_b32 s50, s50, 1
    v_add_u32 v0, s50, v13
    ds_read_b128 v[32:35], v0 offset:0
    ds_read_b128 v[36:39], v0 offset:32
    ds_read_b128 v[40:43], v0 offset:64
    ds_read_b128 v[44:47], v0 offset:96
    s_waitcnt lgkmcnt(8)
    v_mfma_f32_32x32x16_bf16 v[48:63], v[28:31], a[140:143], v[48:63]
    s_waitcnt vmcnt(13)
    s_barrier
    s_waitcnt lgkmcnt(0)
    v_mfma_f32_32x32x16_bf16 v[32:47], v[16:19], a[0:3], v[32:47]
    ds_read_b64_tr_b16 v[24:25], v4 offset:53248
    ds_read_b64_tr_b16 v[26:27], v4 offset:53760
    ds_read_b64_tr_b16 v[28:29], v4 offset:55296
    ds_read_b64_tr_b16 v[30:31], v4 offset:55808
    s_add_u32 m0, s52, 16384
    s_add_u32 s49, s61, 4128768
    buffer_load_dwordx4 v1, s[8:11], s49 offen lds
    v_mfma_f32_32x32x16_bf16 v[32:47], v[20:23], a[4:7], v[32:47]
    ds_read_b64_tr_b16 v[16:17], v4 offset:57344
    ds_read_b64_tr_b16 v[18:19], v4 offset:57856
    s_add_u32 m0, s52, 17408
    s_add_u32 s49, s61, 4202496
    buffer_load_dwordx4 v1, s[8:11], s49 offen lds
    s_waitcnt lgkmcnt(4)
    v_mfma_f32_32x32x16_bf16 v[32:47], v[24:27], a[8:11], v[32:47]
    ds_read_b64_tr_b16 v[20:21], v4 offset:59392
    ds_read_b64_tr_b16 v[22:23], v4 offset:59904
    v_mul_f32 v64, s98, v48
    v_mul_f32 v66, s98, v49
    v_mul_f32 v68, s98, v50
    s_waitcnt lgkmcnt(4)
    v_mfma_f32_32x32x16_bf16 v[32:47], v[28:31], a[12:15], v[32:47]
    ds_read_b64_tr_b16 v[24:25], v4 offset:61440
    ds_read_b64_tr_b16 v[26:27], v4 offset:61952
    v_mul_f32 v70, s98, v51
    v_exp_f32 v64, v64
    v_exp_f32 v66, v66
    v_exp_f32 v68, v68
    s_waitcnt lgkmcnt(4)
    v_mfma_f32_32x32x16_bf16 v[32:47], v[16:19], a[16:19], v[32:47]
    ds_read_b64_tr_b16 v[28:29], v4 offset:63488
    ds_read_b64_tr_b16 v[30:31], v4 offset:64000
    v_exp_f32 v70, v70
    v_fmaak_f32 v65, -0.5, v64, 0xbf800000
    v_fmaak_f32 v67, -0.5, v66, 0xbf800000
    s_waitcnt lgkmcnt(4)
    v_mfma_f32_32x32x16_bf16 v[32:47], v[20:23], a[20:23], v[32:47]
    ds_read_b64_tr_b16 v[16:17], v3 offset:32768
    ds_read_b64_tr_b16 v[18:19], v3 offset:33280
    v_fmaak_f32 v69, -0.5, v68, 0xbf800000
    v_fmaak_f32 v71, -0.5, v70, 0xbf800000
    v_fmaak_f32 v65, v64, v65, 0xbf800000
    s_waitcnt lgkmcnt(4)
    v_mfma_f32_32x32x16_bf16 v[32:47], v[24:27], a[24:27], v[32:47]
    ds_read_b64_tr_b16 v[20:21], v3 offset:34816
    ds_read_b64_tr_b16 v[22:23], v3 offset:35328
    v_fmaak_f32 v67, v66, v67, 0xbf800000
    v_fmaak_f32 v69, v68, v69, 0xbf800000
    v_fmaak_f32 v71, v70, v71, 0xbf800000
    v_rcp_f32 v65, v65
    s_waitcnt lgkmcnt(4)
    v_mfma_f32_32x32x16_bf16 v[32:47], v[28:31], a[28:31], v[32:47]
    s_waitcnt vmcnt(13)
    s_barrier
    s_waitcnt lgkmcnt(2)
    v_mfma_f32_32x32x16_bf16 v[32:47], v[16:19], a[32:35], v[32:47]
    ds_read_b64_tr_b16 v[24:25], v3 offset:36864
    ds_read_b64_tr_b16 v[26:27], v3 offset:37376
    ds_read_b64_tr_b16 v[28:29], v3 offset:38912
    ds_read_b64_tr_b16 v[30:31], v3 offset:39424
    v_rcp_f32 v67, v67
    v_rcp_f32 v69, v69
    v_rcp_f32 v71, v71
    v_fmac_f32 v48, v48, v65
    v_fmac_f32 v49, v49, v67
    v_fmac_f32 v50, v50, v69
    s_add_u32 m0, s52, 114688
    s_add_u32 s49, s62, 0
    buffer_load_dwordx4 v1, s[8:11], s49 offen lds
    s_waitcnt lgkmcnt(4)
    v_mfma_f32_32x32x16_bf16 v[32:47], v[20:23], a[36:39], v[32:47]
    ds_read_b64_tr_b16 v[16:17], v3 offset:40960
    ds_read_b64_tr_b16 v[18:19], v3 offset:41472
    v_fmac_f32 v51, v51, v71
    v_cvt_pk_bf16_f32 v80, v48, v49
    v_cvt_pk_bf16_f32 v81, v50, v51
    v_mul_f32 v64, s98, v52
    s_add_u32 m0, s52, 115712
    s_add_u32 s49, s62, 73728
    buffer_load_dwordx4 v1, s[8:11], s49 offen lds
    s_waitcnt lgkmcnt(4)
    v_mfma_f32_32x32x16_bf16 v[32:47], v[24:27], a[40:43], v[32:47]
    ds_read_b64_tr_b16 v[20:21], v3 offset:43008
    ds_read_b64_tr_b16 v[22:23], v3 offset:43520
    v_mul_f32 v66, s98, v53
    v_mul_f32 v68, s98, v54
    v_mul_f32 v70, s98, v55
    s_waitcnt lgkmcnt(4)
    v_mfma_f32_32x32x16_bf16 v[32:47], v[28:31], a[44:47], v[32:47]
    ds_read_b64_tr_b16 v[24:25], v3 offset:45056
    ds_read_b64_tr_b16 v[26:27], v3 offset:45568
    v_exp_f32 v64, v64
    v_exp_f32 v66, v66
    v_exp_f32 v68, v68
    v_exp_f32 v70, v70
    s_waitcnt lgkmcnt(4)
    v_mfma_f32_32x32x16_bf16 v[32:47], v[16:19], a[48:51], v[32:47]
    ds_read_b64_tr_b16 v[28:29], v3 offset:47104
    ds_read_b64_tr_b16 v[30:31], v3 offset:47616
    v_fmaak_f32 v65, -0.5, v64, 0xbf800000
    v_fmaak_f32 v67, -0.5, v66, 0xbf800000
    v_fmaak_f32 v69, -0.5, v68, 0xbf800000
    s_waitcnt lgkmcnt(4)
    v_mfma_f32_32x32x16_bf16 v[32:47], v[20:23], a[52:55], v[32:47]
    ds_read_b64_tr_b16 v[16:17], v5 offset:0
    ds_read_b64_tr_b16 v[18:19], v5 offset:512
    v_fmaak_f32 v71, -0.5, v70, 0xbf800000
    v_fmaak_f32 v65, v64, v65, 0xbf800000
    v_fmaak_f32 v67, v66, v67, 0xbf800000
    s_waitcnt lgkmcnt(4)
    v_mfma_f32_32x32x16_bf16 v[32:47], v[24:27], a[56:59], v[32:47]
    ds_read_b64_tr_b16 v[20:21], v5 offset:2048
    ds_read_b64_tr_b16 v[22:23], v5 offset:2560
    v_fmaak_f32 v69, v68, v69, 0xbf800000
    v_fmaak_f32 v71, v70, v71, 0xbf800000
    v_rcp_f32 v65, v65
    v_rcp_f32 v67, v67
    s_waitcnt lgkmcnt(4)
    v_mfma_f32_32x32x16_bf16 v[32:47], v[28:31], a[60:63], v[32:47]
    s_waitcnt vmcnt(13)
    s_barrier
    s_waitcnt lgkmcnt(2)
    v_mfma_f32_32x32x16_bf16 v[32:47], v[16:19], a[64:67], v[32:47]
    ds_read_b64_tr_b16 v[24:25], v5 offset:4096
    ds_read_b64_tr_b16 v[26:27], v5 offset:4608
    ds_read_b64_tr_b16 v[28:29], v5 offset:6144
    ds_read_b64_tr_b16 v[30:31], v5 offset:6656
    v_rcp_f32 v69, v69
    v_rcp_f32 v71, v71
    v_fmac_f32 v52, v52, v65
    v_fmac_f32 v53, v53, v67
    v_fmac_f32 v54, v54, v69
    v_fmac_f32 v55, v55, v71
    s_add_u32 m0, s52, 32768
    s_add_u32 s49, s62, 1179648
    buffer_load_dwordx4 v1, s[8:11], s49 offen lds
    s_waitcnt lgkmcnt(4)
    v_mfma_f32_32x32x16_bf16 v[32:47], v[20:23], a[68:71], v[32:47]
    ds_read_b64_tr_b16 v[16:17], v5 offset:8192
    ds_read_b64_tr_b16 v[18:19], v5 offset:8704
    v_cvt_pk_bf16_f32 v82, v52, v53
    v_cvt_pk_bf16_f32 v83, v54, v55
    v_mul_f32 v64, s98, v56
    v_mul_f32 v66, s98, v57
    s_add_u32 m0, s52, 33792
    s_add_u32 s49, s62, 1253376
    buffer_load_dwordx4 v1, s[8:11], s49 offen lds
    s_waitcnt lgkmcnt(4)
    v_mfma_f32_32x32x16_bf16 v[32:47], v[24:27], a[72:75], v[32:47]
    ds_read_b64_tr_b16 v[20:21], v5 offset:10240
    ds_read_b64_tr_b16 v[22:23], v5 offset:10752
    v_mul_f32 v68, s98, v58
    v_mul_f32 v70, s98, v59
    v_exp_f32 v64, v64
    s_waitcnt lgkmcnt(4)
    v_mfma_f32_32x32x16_bf16 v[32:47], v[28:31], a[76:79], v[32:47]
    ds_read_b64_tr_b16 v[24:25], v5 offset:12288
    ds_read_b64_tr_b16 v[26:27], v5 offset:12800
    v_exp_f32 v66, v66
    v_exp_f32 v68, v68
    v_exp_f32 v70, v70
    s_waitcnt lgkmcnt(4)
    v_mfma_f32_32x32x16_bf16 v[32:47], v[16:19], a[80:83], v[32:47]
    ds_read_b64_tr_b16 v[28:29], v5 offset:14336
    ds_read_b64_tr_b16 v[30:31], v5 offset:14848
    v_fmaak_f32 v65, -0.5, v64, 0xbf800000
    v_fmaak_f32 v67, -0.5, v66, 0xbf800000
    v_fmaak_f32 v69, -0.5, v68, 0xbf800000
    v_fmaak_f32 v71, -0.5, v70, 0xbf800000
    s_waitcnt lgkmcnt(4)
    v_mfma_f32_32x32x16_bf16 v[32:47], v[20:23], a[84:87], v[32:47]
    ds_read_b64_tr_b16 v[16:17], v3 offset:49152
    ds_read_b64_tr_b16 v[18:19], v3 offset:49664
    v_fmaak_f32 v65, v64, v65, 0xbf800000
    v_fmaak_f32 v67, v66, v67, 0xbf800000
    v_fmaak_f32 v69, v68, v69, 0xbf800000
    s_waitcnt lgkmcnt(4)
    v_mfma_f32_32x32x16_bf16 v[32:47], v[24:27], a[88:91], v[32:47]
    ds_read_b64_tr_b16 v[20:21], v3 offset:51200
    ds_read_b64_tr_b16 v[22:23], v3 offset:51712
    v_fmaak_f32 v71, v70, v71, 0xbf800000
    v_rcp_f32 v65, v65
    v_rcp_f32 v67, v67
    s_waitcnt lgkmcnt(4)
    v_mfma_f32_32x32x16_bf16 v[32:47], v[28:31], a[92:95], v[32:47]
    s_waitcnt vmcnt(13)
    s_barrier
    s_waitcnt lgkmcnt(2)
    v_mfma_f32_32x32x16_bf16 v[32:47], v[16:19], a[96:99], v[32:47]
    ds_read_b64_tr_b16 v[24:25], v3 offset:53248
    ds_read_b64_tr_b16 v[26:27], v3 offset:53760
    ds_read_b64_tr_b16 v[28:29], v3 offset:55296
    ds_read_b64_tr_b16 v[30:31], v3 offset:55808
    v_rcp_f32 v69, v69
    v_rcp_f32 v71, v71
    v_fmac_f32 v56, v56, v65
    v_fmac_f32 v57, v57, v67
    v_fmac_f32 v58, v58, v69
    v_fmac_f32 v59, v59, v71
    v_cvt_pk_bf16_f32 v84, v56, v57
    s_add_u32 m0, s52, 131072
    s_add_u32 s49, s62, 2359296
    buffer_load_dwordx4 v1, s[8:11], s49 offen lds
    s_waitcnt lgkmcnt(4)
    v_mfma_f32_32x32x16_bf16 v[32:47], v[20:23], a[100:103], v[32:47]
    ds_read_b64_tr_b16 v[16:17], v3 offset:57344
    ds_read_b64_tr_b16 v[18:19], v3 offset:57856
    v_cvt_pk_bf16_f32 v85, v58, v59
    v_mul_f32 v64, s98, v60
    v_mul_f32 v66, s98, v61
    v_mul_f32 v68, s98, v62
    s_add_u32 m0, s52, 132096
    s_add_u32 s49, s62, 2433024
    buffer_load_dwordx4 v1, s[8:11], s49 offen lds
    s_waitcnt lgkmcnt(4)
    v_mfma_f32_32x32x16_bf16 v[32:47], v[24:27], a[104:107], v[32:47]
    ds_read_b64_tr_b16 v[20:21], v3 offset:59392
    ds_read_b64_tr_b16 v[22:23], v3 offset:59904
    v_mul_f32 v70, s98, v63
    v_exp_f32 v64, v64
    v_exp_f32 v66, v66
    s_waitcnt lgkmcnt(4)
    v_mfma_f32_32x32x16_bf16 v[32:47], v[28:31], a[108:111], v[32:47]
    ds_read_b64_tr_b16 v[24:25], v3 offset:61440
    ds_read_b64_tr_b16 v[26:27], v3 offset:61952
    v_exp_f32 v68, v68
    v_exp_f32 v70, v70
    v_fmaak_f32 v65, -0.5, v64, 0xbf800000
    s_waitcnt lgkmcnt(4)
    v_mfma_f32_32x32x16_bf16 v[32:47], v[16:19], a[112:115], v[32:47]
    ds_read_b64_tr_b16 v[28:29], v3 offset:63488
    ds_read_b64_tr_b16 v[30:31], v3 offset:64000
    v_fmaak_f32 v67, -0.5, v66, 0xbf800000
    v_fmaak_f32 v69, -0.5, v68, 0xbf800000
    v_fmaak_f32 v71, -0.5, v70, 0xbf800000
    v_fmaak_f32 v65, v64, v65, 0xbf800000
    s_waitcnt lgkmcnt(4)
    v_mfma_f32_32x32x16_bf16 v[32:47], v[20:23], a[116:119], v[32:47]
    ds_read_b64_tr_b16 v[16:17], v4 offset:0
    ds_read_b64_tr_b16 v[18:19], v4 offset:512
    v_fmaak_f32 v67, v66, v67, 0xbf800000
    v_fmaak_f32 v69, v68, v69, 0xbf800000
    v_fmaak_f32 v71, v70, v71, 0xbf800000
    s_waitcnt lgkmcnt(4)
    v_mfma_f32_32x32x16_bf16 v[32:47], v[24:27], a[120:123], v[32:47]
    ds_read_b64_tr_b16 v[20:21], v4 offset:2048
    ds_read_b64_tr_b16 v[22:23], v4 offset:2560
    v_rcp_f32 v65, v65
    v_rcp_f32 v67, v67
    v_rcp_f32 v69, v69
    s_waitcnt lgkmcnt(4)
    v_mfma_f32_32x32x16_bf16 v[32:47], v[28:31], a[124:127], v[32:47]
    s_waitcnt vmcnt(12)
    s_barrier
    s_waitcnt lgkmcnt(2)
    v_mfma_f32_32x32x16_bf16 v[32:47], v[16:19], a[128:131], v[32:47]
    ds_read_b64_tr_b16 v[24:25], v4 offset:4096
    ds_read_b64_tr_b16 v[26:27], v4 offset:4608
    ds_read_b64_tr_b16 v[28:29], v4 offset:6144
    ds_read_b64_tr_b16 v[30:31], v4 offset:6656
    v_rcp_f32 v71, v71
    v_fmac_f32 v60, v60, v65
    v_fmac_f32 v61, v61, v67
    v_fmac_f32 v62, v62, v69
    v_fmac_f32 v63, v63, v71
    v_cvt_pk_bf16_f32 v86, v60, v61
    v_cvt_pk_bf16_f32 v87, v62, v63
    s_add_u32 m0, s52, 49152
    s_add_u32 s49, s62, 3538944
    buffer_load_dwordx4 v1, s[8:11], s49 offen lds
    s_waitcnt lgkmcnt(4)
    v_mfma_f32_32x32x16_bf16 v[32:47], v[20:23], a[132:135], v[32:47]
    ds_read_b64_tr_b16 v[16:17], v4 offset:8192
    ds_read_b64_tr_b16 v[18:19], v4 offset:8704
    s_add_u32 m0, s52, 50176
    s_add_u32 s49, s62, 3612672
    buffer_load_dwordx4 v1, s[8:11], s49 offen lds
    s_waitcnt lgkmcnt(4)
    v_mfma_f32_32x32x16_bf16 v[32:47], v[24:27], a[136:139], v[32:47]
    ds_read_b64_tr_b16 v[20:21], v4 offset:10240
    ds_read_b64_tr_b16 v[22:23], v4 offset:10752
    s_sub_u32 s50, s61, s54
    s_lshl_b32 s50, s50, 1
    v_add_u32 v0, s50, v13
    ds_read_b128 v[48:51], v0 offset:0
    ds_read_b128 v[52:55], v0 offset:32
    ds_read_b128 v[56:59], v0 offset:64
    ds_read_b128 v[60:63], v0 offset:96
    s_waitcnt lgkmcnt(8)
    v_mfma_f32_32x32x16_bf16 v[32:47], v[28:31], a[140:143], v[32:47]
    ds_read_b64_tr_b16 v[24:25], v4 offset:12288
    ds_read_b64_tr_b16 v[26:27], v4 offset:12800
    s_waitcnt lgkmcnt(2)
    v_mfma_f32_32x32x16_bf16 v[48:63], v[16:19], a[0:3], v[48:63]
    ds_read_b64_tr_b16 v[28:29], v4 offset:14336
    ds_read_b64_tr_b16 v[30:31], v4 offset:14848
    v_mfma_f32_32x32x16_bf16 v[48:63], v[20:23], a[4:7], v[48:63]
    ds_read_b64_tr_b16 v[16:17], v4 offset:16384
    ds_read_b64_tr_b16 v[18:19], v4 offset:16896
    s_waitcnt lgkmcnt(4)
    v_mfma_f32_32x32x16_bf16 v[48:63], v[24:27], a[8:11], v[48:63]
    ds_read_b64_tr_b16 v[20:21], v4 offset:18432
    ds_read_b64_tr_b16 v[22:23], v4 offset:18944
    v_mul_f32 v64, s98, v32
    v_mul_f32 v66, s98, v33
    v_mul_f32 v68, s98, v34
    s_waitcnt lgkmcnt(4)
    v_mfma_f32_32x32x16_bf16 v[48:63], v[28:31], a[12:15], v[48:63]
    s_waitcnt vmcnt(12)
    s_barrier
    s_waitcnt lgkmcnt(2)
    v_mfma_f32_32x32x16_bf16 v[48:63], v[16:19], a[16:19], v[48:63]
    ds_read_b64_tr_b16 v[24:25], v4 offset:20480
    ds_read_b64_tr_b16 v[26:27], v4 offset:20992
    ds_read_b64_tr_b16 v[28:29], v4 offset:22528
    ds_read_b64_tr_b16 v[30:31], v4 offset:23040
    v_mul_f32 v70, s98, v35
    v_exp_f32 v64, v64
    v_exp_f32 v66, v66
    v_exp_f32 v68, v68
    v_exp_f32 v70, v70
    v_fmaak_f32 v65, -0.5, v64, 0xbf800000
    v_fmaak_f32 v67, -0.5, v66, 0xbf800000
    s_add_u32 m0, s52, 65536
    s_add_u32 s49, s66, 0
    buffer_load_dwordx4 v1, s[8:11], s49 offen lds
    s_waitcnt lgkmcnt(4)
    v_mfma_f32_32x32x16_bf16 v[48:63], v[20:23], a[20:23], v[48:63]
    ds_read_b64_tr_b16 v[16:17], v4 offset:24576
    ds_read_b64_tr_b16 v[18:19], v4 offset:25088
    v_fmaak_f32 v69, -0.5, v68, 0xbf800000
    v_fmaak_f32 v71, -0.5, v70, 0xbf800000
    v_fmaak_f32 v65, v64, v65, 0xbf800000
    s_add_u32 m0, s52, 66560
    s_add_u32 s49, s66, 73728
    buffer_load_dwordx4 v1, s[8:11], s49 offen lds
    s_waitcnt lgkmcnt(4)
    v_mfma_f32_32x32x16_bf16 v[48:63], v[24:27], a[24:27], v[48:63]
    ds_read_b64_tr_b16 v[20:21], v4 offset:26624
    ds_read_b64_tr_b16 v[22:23], v4 offset:27136
    v_fmaak_f32 v67, v66, v67, 0xbf800000
    v_fmaak_f32 v69, v68, v69, 0xbf800000
    v_fmaak_f32 v71, v70, v71, 0xbf800000
    v_rcp_f32 v65, v65
    s_waitcnt lgkmcnt(4)
    v_mfma_f32_32x32x16_bf16 v[48:63], v[28:31], a[28:31], v[48:63]
    ds_read_b64_tr_b16 v[24:25], v4 offset:28672
    ds_read_b64_tr_b16 v[26:27], v4 offset:29184
    v_rcp_f32 v67, v67
    v_rcp_f32 v69, v69
    v_rcp_f32 v71, v71
    s_waitcnt lgkmcnt(4)
    v_mfma_f32_32x32x16_bf16 v[48:63], v[16:19], a[32:35], v[48:63]
    ds_read_b64_tr_b16 v[28:29], v4 offset:30720
    ds_read_b64_tr_b16 v[30:31], v4 offset:31232
    v_fmac_f32 v32, v32, v65
    v_fmac_f32 v33, v33, v67
    v_fmac_f32 v34, v34, v69
    s_waitcnt lgkmcnt(4)
    v_mfma_f32_32x32x16_bf16 v[48:63], v[20:23], a[36:39], v[48:63]
    ds_read_b64_tr_b16 v[16:17], v3 offset:0
    ds_read_b64_tr_b16 v[18:19], v3 offset:512
    v_fmac_f32 v35, v35, v71
    v_cvt_pk_bf16_f32 v88, v32, v33
    v_cvt_pk_bf16_f32 v89, v34, v35
    v_mul_f32 v64, s98, v36
    s_waitcnt lgkmcnt(4)
    v_mfma_f32_32x32x16_bf16 v[48:63], v[24:27], a[40:43], v[48:63]
    ds_read_b64_tr_b16 v[20:21], v3 offset:2048
    ds_read_b64_tr_b16 v[22:23], v3 offset:2560
    v_mul_f32 v66, s98, v37
    v_mul_f32 v68, s98, v38
    v_mul_f32 v70, s98, v39
    s_waitcnt lgkmcnt(4)
    v_mfma_f32_32x32x16_bf16 v[48:63], v[28:31], a[44:47], v[48:63]
    s_waitcnt vmcnt(12)
    s_barrier
    s_waitcnt lgkmcnt(2)
    v_mfma_f32_32x32x16_bf16 v[48:63], v[16:19], a[48:51], v[48:63]
    ds_read_b64_tr_b16 v[24:25], v3 offset:4096
    ds_read_b64_tr_b16 v[26:27], v3 offset:4608
    ds_read_b64_tr_b16 v[28:29], v3 offset:6144
    ds_read_b64_tr_b16 v[30:31], v3 offset:6656
    v_exp_f32 v64, v64
    v_exp_f32 v66, v66
    v_exp_f32 v68, v68
    v_exp_f32 v70, v70
    v_fmaak_f32 v65, -0.5, v64, 0xbf800000
    v_fmaak_f32 v67, -0.5, v66, 0xbf800000
    v_fmaak_f32 v69, -0.5, v68, 0xbf800000
    s_add_u32 m0, s52, 81920
    s_add_u32 s49, s63, 589824
    buffer_load_dwordx4 v1, s[8:11], s49 offen lds
    s_waitcnt lgkmcnt(4)
    v_mfma_f32_32x32x16_bf16 v[48:63], v[20:23], a[52:55], v[48:63]
    ds_read_b64_tr_b16 v[16:17], v3 offset:8192
    ds_read_b64_tr_b16 v[18:19], v3 offset:8704
    v_fmaak_f32 v71, -0.5, v70, 0xbf800000
    v_fmaak_f32 v65, v64, v65, 0xbf800000
    v_fmaak_f32 v67, v66, v67, 0xbf800000
    s_add_u32 m0, s52, 82944
    s_add_u32 s49, s63, 663552
    buffer_load_dwordx4 v1, s[8:11], s49 offen lds
    s_waitcnt lgkmcnt(4)
    v_mfma_f32_32x32x16_bf16 v[48:63], v[24:27], a[56:59], v[48:63]
    ds_read_b64_tr_b16 v[20:21], v3 offset:10240
    ds_read_b64_tr_b16 v[22:23], v3 offset:10752
    v_fmaak_f32 v69, v68, v69, 0xbf800000
    v_fmaak_f32 v71, v70, v71, 0xbf800000
    v_rcp_f32 v65, v65
    v_rcp_f32 v67, v67
    s_waitcnt lgkmcnt(4)
    v_mfma_f32_32x32x16_bf16 v[48:63], v[28:31], a[60:63], v[48:63]
    ds_read_b64_tr_b16 v[24:25], v3 offset:12288
    ds_read_b64_tr_b16 v[26:27], v3 offset:12800
    v_rcp_f32 v69, v69
    v_rcp_f32 v71, v71
    v_fmac_f32 v36, v36, v65
    s_waitcnt lgkmcnt(4)
    v_mfma_f32_32x32x16_bf16 v[48:63], v[16:19], a[64:67], v[48:63]
    ds_read_b64_tr_b16 v[28:29], v3 offset:14336
    ds_read_b64_tr_b16 v[30:31], v3 offset:14848
    v_fmac_f32 v37, v37, v67
    v_fmac_f32 v38, v38, v69
    v_fmac_f32 v39, v39, v71
    s_waitcnt lgkmcnt(4)
    v_mfma_f32_32x32x16_bf16 v[48:63], v[20:23], a[68:71], v[48:63]
    ds_read_b64_tr_b16 v[16:17], v4 offset:32768
    ds_read_b64_tr_b16 v[18:19], v4 offset:33280
    v_cvt_pk_bf16_f32 v90, v36, v37
    v_cvt_pk_bf16_f32 v91, v38, v39
    v_mul_f32 v64, s98, v40
    v_mul_f32 v66, s98, v41
    s_waitcnt lgkmcnt(4)
    v_mfma_f32_32x32x16_bf16 v[48:63], v[24:27], a[72:75], v[48:63]
    ds_read_b64_tr_b16 v[20:21], v4 offset:34816
    ds_read_b64_tr_b16 v[22:23], v4 offset:35328
    v_mul_f32 v68, s98, v42
    v_mul_f32 v70, s98, v43
    v_exp_f32 v64, v64
    s_waitcnt lgkmcnt(4)
    v_mfma_f32_32x32x16_bf16 v[48:63], v[28:31], a[76:79], v[48:63]
    s_waitcnt vmcnt(12)
    s_barrier
    s_waitcnt lgkmcnt(2)
    v_mfma_f32_32x32x16_bf16 v[48:63], v[16:19], a[80:83], v[48:63]
    ds_read_b64_tr_b16 v[24:25], v4 offset:36864
    ds_read_b64_tr_b16 v[26:27], v4 offset:37376
    ds_read_b64_tr_b16 v[28:29], v4 offset:38912
    ds_read_b64_tr_b16 v[30:31], v4 offset:39424
    v_exp_f32 v66, v66
    v_exp_f32 v68, v68
    v_exp_f32 v70, v70
    v_fmaak_f32 v65, -0.5, v64, 0xbf800000
    v_fmaak_f32 v67, -0.5, v66, 0xbf800000
    v_fmaak_f32 v69, -0.5, v68, 0xbf800000
    v_fmaak_f32 v71, -0.5, v70, 0xbf800000
    s_waitcnt lgkmcnt(4)
    v_mfma_f32_32x32x16_bf16 v[48:63], v[20:23], a[84:87], v[48:63]
    ds_read_b64_tr_b16 v[16:17], v4 offset:40960
    ds_read_b64_tr_b16 v[18:19], v4 offset:41472
    v_fmaak_f32 v65, v64, v65, 0xbf800000
    v_fmaak_f32 v67, v66, v67, 0xbf800000
    v_fmaak_f32 v69, v68, v69, 0xbf800000
    s_waitcnt lgkmcnt(4)
    v_mfma_f32_32x32x16_bf16 v[48:63], v[24:27], a[88:91], v[48:63]
    ds_read_b64_tr_b16 v[20:21], v4 offset:43008
    ds_read_b64_tr_b16 v[22:23], v4 offset:43520
    v_fmaak_f32 v71, v70, v71, 0xbf800000
    v_rcp_f32 v65, v65
    v_rcp_f32 v67, v67
    s_waitcnt lgkmcnt(4)
    v_mfma_f32_32x32x16_bf16 v[48:63], v[28:31], a[92:95], v[48:63]
    ds_read_b64_tr_b16 v[24:25], v4 offset:45056
    ds_read_b64_tr_b16 v[26:27], v4 offset:45568
    v_rcp_f32 v69, v69
    v_rcp_f32 v71, v71
    v_fmac_f32 v40, v40, v65
    v_fmac_f32 v41, v41, v67
    s_waitcnt lgkmcnt(4)
    v_mfma_f32_32x32x16_bf16 v[48:63], v[16:19], a[96:99], v[48:63]
    ds_read_b64_tr_b16 v[28:29], v4 offset:47104
    ds_read_b64_tr_b16 v[30:31], v4 offset:47616
    v_fmac_f32 v42, v42, v69
    v_fmac_f32 v43, v43, v71
    v_cvt_pk_bf16_f32 v92, v40, v41
    s_waitcnt lgkmcnt(4)
    v_mfma_f32_32x32x16_bf16 v[48:63], v[20:23], a[100:103], v[48:63]
    ds_read_b64_tr_b16 v[16:17], v3 offset:16384
    ds_read_b64_tr_b16 v[18:19], v3 offset:16896
    v_cvt_pk_bf16_f32 v93, v42, v43
    v_mul_f32 v64, s98, v44
    v_mul_f32 v66, s98, v45
    v_mul_f32 v68, s98, v46
    s_waitcnt lgkmcnt(4)
    v_mfma_f32_32x32x16_bf16 v[48:63], v[24:27], a[104:107], v[48:63]
    ds_read_b64_tr_b16 v[20:21], v3 offset:18432
    ds_read_b64_tr_b16 v[22:23], v3 offset:18944
    v_mul_f32 v70, s98, v47
    v_exp_f32 v64, v64
    v_exp_f32 v66, v66
    s_waitcnt lgkmcnt(4)
    v_mfma_f32_32x32x16_bf16 v[48:63], v[28:31], a[108:111], v[48:63]
    s_waitcnt vmcnt(10)
    s_barrier
    s_waitcnt lgkmcnt(2)
    v_mfma_f32_32x32x16_bf16 v[48:63], v[16:19], a[112:115], v[48:63]
    ds_read_b64_tr_b16 v[24:25], v3 offset:20480
    ds_read_b64_tr_b16 v[26:27], v3 offset:20992
    ds_read_b64_tr_b16 v[28:29], v3 offset:22528
    ds_read_b64_tr_b16 v[30:31], v3 offset:23040
    v_exp_f32 v68, v68
    v_exp_f32 v70, v70
    v_fmaak_f32 v65, -0.5, v64, 0xbf800000
    v_fmaak_f32 v67, -0.5, v66, 0xbf800000
    v_fmaak_f32 v69, -0.5, v68, 0xbf800000
    v_fmaak_f32 v71, -0.5, v70, 0xbf800000
    v_fmaak_f32 v65, v64, v65, 0xbf800000
    s_add_u32 m0, s52, 98304
    s_add_u32 s49, s63, 1769472
    buffer_load_dwordx4 v1, s[8:11], s49 offen lds
    s_waitcnt lgkmcnt(4)
    v_mfma_f32_32x32x16_bf16 v[48:63], v[20:23], a[116:119], v[48:63]
    ds_read_b64_tr_b16 v[16:17], v3 offset:24576
    ds_read_b64_tr_b16 v[18:19], v3 offset:25088
    v_fmaak_f32 v67, v66, v67, 0xbf800000
    v_fmaak_f32 v69, v68, v69, 0xbf800000
    v_fmaak_f32 v71, v70, v71, 0xbf800000
    s_add_u32 m0, s52, 99328
    s_add_u32 s49, s63, 1843200
    buffer_load_dwordx4 v1, s[8:11], s49 offen lds
    s_waitcnt lgkmcnt(4)
    v_mfma_f32_32x32x16_bf16 v[48:63], v[24:27], a[120:123], v[48:63]
    ds_read_b64_tr_b16 v[20:21], v3 offset:26624
    ds_read_b64_tr_b16 v[22:23], v3 offset:27136
    v_rcp_f32 v65, v65
    v_rcp_f32 v67, v67
    v_rcp_f32 v69, v69
    s_waitcnt lgkmcnt(4)
    v_mfma_f32_32x32x16_bf16 v[48:63], v[28:31], a[124:127], v[48:63]
    ds_read_b64_tr_b16 v[24:25], v3 offset:28672
    ds_read_b64_tr_b16 v[26:27], v3 offset:29184
    v_rcp_f32 v71, v71
    v_fmac_f32 v44, v44, v65
    v_fmac_f32 v45, v45, v67
    v_fmac_f32 v46, v46, v69
    s_waitcnt lgkmcnt(4)
    v_mfma_f32_32x32x16_bf16 v[48:63], v[16:19], a[128:131], v[48:63]
    ds_read_b64_tr_b16 v[28:29], v3 offset:30720
    ds_read_b64_tr_b16 v[30:31], v3 offset:31232
    v_fmac_f32 v47, v47, v71
    v_cvt_pk_bf16_f32 v94, v44, v45
    v_cvt_pk_bf16_f32 v95, v46, v47
    s_waitcnt lgkmcnt(4)
    v_mfma_f32_32x32x16_bf16 v[48:63], v[20:23], a[132:135], v[48:63]
    ds_read_b64_tr_b16 v[16:17], v4 offset:49152
    ds_read_b64_tr_b16 v[18:19], v4 offset:49664
    s_waitcnt lgkmcnt(4)
    v_mfma_f32_32x32x16_bf16 v[48:63], v[24:27], a[136:139], v[48:63]
    ds_read_b64_tr_b16 v[20:21], v4 offset:51200
    ds_read_b64_tr_b16 v[22:23], v4 offset:51712
    s_sub_u32 s50, s62, s54
    s_lshl_b32 s50, s50, 1
    v_add_u32 v0, s50, v13
    ds_read_b128 v[32:35], v0 offset:0
    ds_read_b128 v[36:39], v0 offset:32
    ds_read_b128 v[40:43], v0 offset:64
    ds_read_b128 v[44:47], v0 offset:96
    s_waitcnt lgkmcnt(8)
    v_mfma_f32_32x32x16_bf16 v[48:63], v[28:31], a[140:143], v[48:63]
    s_waitcnt vmcnt(10)
    s_barrier
    s_waitcnt lgkmcnt(0)
    v_mfma_f32_32x32x16_bf16 v[32:47], v[16:19], a[0:3], v[32:47]
    ds_read_b64_tr_b16 v[24:25], v4 offset:53248
    ds_read_b64_tr_b16 v[26:27], v4 offset:53760
    ds_read_b64_tr_b16 v[28:29], v4 offset:55296
    ds_read_b64_tr_b16 v[30:31], v4 offset:55808
    v_mfma_f32_32x32x16_bf16 v[32:47], v[20:23], a[4:7], v[32:47]
    ds_read_b64_tr_b16 v[16:17], v4 offset:57344
    ds_read_b64_tr_b16 v[18:19], v4 offset:57856
    s_waitcnt lgkmcnt(4)
    v_mfma_f32_32x32x16_bf16 v[32:47], v[24:27], a[8:11], v[32:47]
    ds_read_b64_tr_b16 v[20:21], v4 offset:59392
    ds_read_b64_tr_b16 v[22:23], v4 offset:59904
    v_mul_f32 v64, s98, v48
    v_mul_f32 v66, s98, v49
    v_mul_f32 v68, s98, v50
    s_waitcnt lgkmcnt(4)
    v_mfma_f32_32x32x16_bf16 v[32:47], v[28:31], a[12:15], v[32:47]
    ds_read_b64_tr_b16 v[24:25], v4 offset:61440
    ds_read_b64_tr_b16 v[26:27], v4 offset:61952
    v_mul_f32 v70, s98, v51
    v_exp_f32 v64, v64
    v_exp_f32 v66, v66
    v_exp_f32 v68, v68
    s_waitcnt lgkmcnt(4)
    v_mfma_f32_32x32x16_bf16 v[32:47], v[16:19], a[16:19], v[32:47]
    ds_read_b64_tr_b16 v[28:29], v4 offset:63488
    ds_read_b64_tr_b16 v[30:31], v4 offset:64000
    v_exp_f32 v70, v70
    v_fmaak_f32 v65, -0.5, v64, 0xbf800000
    v_fmaak_f32 v67, -0.5, v66, 0xbf800000
    s_waitcnt lgkmcnt(4)
    v_mfma_f32_32x32x16_bf16 v[32:47], v[20:23], a[20:23], v[32:47]
    ds_read_b64_tr_b16 v[16:17], v3 offset:32768
    ds_read_b64_tr_b16 v[18:19], v3 offset:33280
    v_fmaak_f32 v69, -0.5, v68, 0xbf800000
    v_fmaak_f32 v71, -0.5, v70, 0xbf800000
    v_fmaak_f32 v65, v64, v65, 0xbf800000
    s_waitcnt lgkmcnt(4)
    v_mfma_f32_32x32x16_bf16 v[32:47], v[24:27], a[24:27], v[32:47]
    ds_read_b64_tr_b16 v[20:21], v3 offset:34816
    ds_read_b64_tr_b16 v[22:23], v3 offset:35328
    v_fmaak_f32 v67, v66, v67, 0xbf800000
    v_fmaak_f32 v69, v68, v69, 0xbf800000
    v_fmaak_f32 v71, v70, v71, 0xbf800000
    v_rcp_f32 v65, v65
    s_waitcnt lgkmcnt(4)
    v_mfma_f32_32x32x16_bf16 v[32:47], v[28:31], a[28:31], v[32:47]
    s_waitcnt vmcnt(8)
    s_barrier
    s_waitcnt lgkmcnt(2)
    v_mfma_f32_32x32x16_bf16 v[32:47], v[16:19], a[32:35], v[32:47]
    ds_read_b64_tr_b16 v[24:25], v3 offset:36864
    ds_read_b64_tr_b16 v[26:27], v3 offset:37376
    ds_read_b64_tr_b16 v[28:29], v3 offset:38912
    ds_read_b64_tr_b16 v[30:31], v3 offset:39424
    v_rcp_f32 v67, v67
    v_rcp_f32 v69, v69
    v_rcp_f32 v71, v71
    v_fmac_f32 v48, v48, v65
    v_fmac_f32 v49, v49, v67
    v_fmac_f32 v50, v50, v69
    s_add_u32 m0, s52, 114688
    s_add_u32 s49, s63, 2949120
    buffer_load_dwordx4 v1, s[8:11], s49 offen lds
    s_waitcnt lgkmcnt(4)
    v_mfma_f32_32x32x16_bf16 v[32:47], v[20:23], a[36:39], v[32:47]
    ds_read_b64_tr_b16 v[16:17], v3 offset:40960
    ds_read_b64_tr_b16 v[18:19], v3 offset:41472
    v_fmac_f32 v51, v51, v71
    v_cvt_pk_bf16_f32 v96, v48, v49
    v_cvt_pk_bf16_f32 v97, v50, v51
    v_mul_f32 v64, s98, v52
    s_lshl_b32 s41, s47, 4
    s_cmp_eq_u32 s44, 0
    s_cselect_b64 exec, 1, 0

    buffer_load_dwordx4 v[108:111], off, s[28:31], s41 sc0 sc1
    s_mov_b64 exec, -1
    s_add_u32 m0, s52, 115712
    s_add_u32 s49, s63, 3022848
    buffer_load_dwordx4 v1, s[8:11], s49 offen lds
    s_waitcnt lgkmcnt(4)
    v_mfma_f32_32x32x16_bf16 v[32:47], v[24:27], a[40:43], v[32:47]
    ds_read_b64_tr_b16 v[20:21], v3 offset:43008
    ds_read_b64_tr_b16 v[22:23], v3 offset:43520
    v_mul_f32 v66, s98, v53
    v_mul_f32 v68, s98, v54
    v_mul_f32 v70, s98, v55
    s_waitcnt lgkmcnt(4)
    v_mfma_f32_32x32x16_bf16 v[32:47], v[28:31], a[44:47], v[32:47]
    ds_read_b64_tr_b16 v[24:25], v3 offset:45056
    ds_read_b64_tr_b16 v[26:27], v3 offset:45568
    v_exp_f32 v64, v64
    v_exp_f32 v66, v66
    v_exp_f32 v68, v68
    v_exp_f32 v70, v70
    s_waitcnt lgkmcnt(4)
    v_mfma_f32_32x32x16_bf16 v[32:47], v[16:19], a[48:51], v[32:47]
    ds_read_b64_tr_b16 v[28:29], v3 offset:47104
    ds_read_b64_tr_b16 v[30:31], v3 offset:47616
    v_fmaak_f32 v65, -0.5, v64, 0xbf800000
    v_fmaak_f32 v67, -0.5, v66, 0xbf800000
    v_fmaak_f32 v69, -0.5, v68, 0xbf800000
    s_waitcnt lgkmcnt(4)
    v_mfma_f32_32x32x16_bf16 v[32:47], v[20:23], a[52:55], v[32:47]
    ds_read_b64_tr_b16 v[16:17], v5 offset:0
    ds_read_b64_tr_b16 v[18:19], v5 offset:512
    v_fmaak_f32 v71, -0.5, v70, 0xbf800000
    v_fmaak_f32 v65, v64, v65, 0xbf800000
    v_fmaak_f32 v67, v66, v67, 0xbf800000
    s_waitcnt lgkmcnt(4)
    v_mfma_f32_32x32x16_bf16 v[32:47], v[24:27], a[56:59], v[32:47]
    ds_read_b64_tr_b16 v[20:21], v5 offset:2048
    ds_read_b64_tr_b16 v[22:23], v5 offset:2560
    v_fmaak_f32 v69, v68, v69, 0xbf800000
    v_fmaak_f32 v71, v70, v71, 0xbf800000
    v_rcp_f32 v65, v65
    v_rcp_f32 v67, v67
    s_waitcnt lgkmcnt(4)
    v_mfma_f32_32x32x16_bf16 v[32:47], v[28:31], a[60:63], v[32:47]
    s_waitcnt vmcnt(9)
    s_barrier
    s_waitcnt lgkmcnt(2)
    v_mfma_f32_32x32x16_bf16 v[32:47], v[16:19], a[64:67], v[32:47]
    ds_read_b64_tr_b16 v[24:25], v5 offset:4096
    ds_read_b64_tr_b16 v[26:27], v5 offset:4608
    ds_read_b64_tr_b16 v[28:29], v5 offset:6144
    ds_read_b64_tr_b16 v[30:31], v5 offset:6656
    v_rcp_f32 v69, v69
    v_rcp_f32 v71, v71
    v_fmac_f32 v52, v52, v65
    v_fmac_f32 v53, v53, v67
    v_fmac_f32 v54, v54, v69
    v_fmac_f32 v55, v55, v71
    s_add_u32 m0, s52, 32768
    s_add_u32 s49, s63, 4128768
    buffer_load_dwordx4 v1, s[8:11], s49 offen lds
    s_waitcnt lgkmcnt(4)
    v_mfma_f32_32x32x16_bf16 v[32:47], v[20:23], a[68:71], v[32:47]
    ds_read_b64_tr_b16 v[16:17], v5 offset:8192
    ds_read_b64_tr_b16 v[18:19], v5 offset:8704
    v_cvt_pk_bf16_f32 v98, v52, v53
    v_cvt_pk_bf16_f32 v99, v54, v55
    v_mul_f32 v64, s98, v56
    v_mul_f32 v66, s98, v57
    s_add_u32 m0, s52, 33792
    s_add_u32 s49, s63, 4202496
    buffer_load_dwordx4 v1, s[8:11], s49 offen lds
    s_waitcnt lgkmcnt(4)
    v_mfma_f32_32x32x16_bf16 v[32:47], v[24:27], a[72:75], v[32:47]
    ds_read_b64_tr_b16 v[20:21], v5 offset:10240
    ds_read_b64_tr_b16 v[22:23], v5 offset:10752
    v_mul_f32 v68, s98, v58
    v_mul_f32 v70, s98, v59
    v_exp_f32 v64, v64
    s_waitcnt lgkmcnt(4)
    v_mfma_f32_32x32x16_bf16 v[32:47], v[28:31], a[76:79], v[32:47]
    ds_read_b64_tr_b16 v[24:25], v5 offset:12288
    ds_read_b64_tr_b16 v[26:27], v5 offset:12800
    v_exp_f32 v66, v66
    v_exp_f32 v68, v68
    v_exp_f32 v70, v70
    s_waitcnt lgkmcnt(4)
    v_mfma_f32_32x32x16_bf16 v[32:47], v[16:19], a[80:83], v[32:47]
    ds_read_b64_tr_b16 v[28:29], v5 offset:14336
    ds_read_b64_tr_b16 v[30:31], v5 offset:14848
    v_fmaak_f32 v65, -0.5, v64, 0xbf800000
    v_fmaak_f32 v67, -0.5, v66, 0xbf800000
    v_fmaak_f32 v69, -0.5, v68, 0xbf800000
    v_fmaak_f32 v71, -0.5, v70, 0xbf800000
    s_waitcnt lgkmcnt(4)
    v_mfma_f32_32x32x16_bf16 v[32:47], v[20:23], a[84:87], v[32:47]
    ds_read_b64_tr_b16 v[16:17], v3 offset:49152
    ds_read_b64_tr_b16 v[18:19], v3 offset:49664
    v_fmaak_f32 v65, v64, v65, 0xbf800000
    v_fmaak_f32 v67, v66, v67, 0xbf800000
    v_fmaak_f32 v69, v68, v69, 0xbf800000
    s_waitcnt lgkmcnt(4)
    v_mfma_f32_32x32x16_bf16 v[32:47], v[24:27], a[88:91], v[32:47]
    ds_read_b64_tr_b16 v[20:21], v3 offset:51200
    ds_read_b64_tr_b16 v[22:23], v3 offset:51712
    v_fmaak_f32 v71, v70, v71, 0xbf800000
    v_rcp_f32 v65, v65
    v_rcp_f32 v67, v67
    s_waitcnt lgkmcnt(4)
    v_mfma_f32_32x32x16_bf16 v[32:47], v[28:31], a[92:95], v[32:47]
    s_waitcnt vmcnt(9)
    s_barrier
    s_waitcnt lgkmcnt(2)
    v_mfma_f32_32x32x16_bf16 v[32:47], v[16:19], a[96:99], v[32:47]
    ds_read_b64_tr_b16 v[24:25], v3 offset:53248
    ds_read_b64_tr_b16 v[26:27], v3 offset:53760
    ds_read_b64_tr_b16 v[28:29], v3 offset:55296
    ds_read_b64_tr_b16 v[30:31], v3 offset:55808
    v_rcp_f32 v69, v69
    v_rcp_f32 v71, v71
    v_fmac_f32 v56, v56, v65
    v_fmac_f32 v57, v57, v67
    v_fmac_f32 v58, v58, v69
    v_fmac_f32 v59, v59, v71
    v_cvt_pk_bf16_f32 v100, v56, v57
    s_add_u32 m0, s52, 131072
    s_add_u32 s49, s67, s70
    buffer_load_dwordx4 v2, s[12:15], s49 offen lds
    s_waitcnt lgkmcnt(4)
    v_mfma_f32_32x32x16_bf16 v[32:47], v[20:23], a[100:103], v[32:47]
    ds_read_b64_tr_b16 v[16:17], v3 offset:57344
    ds_read_b64_tr_b16 v[18:19], v3 offset:57856
    v_cvt_pk_bf16_f32 v101, v58, v59
    v_mul_f32 v64, s98, v60
    v_mul_f32 v66, s98, v61
    v_mul_f32 v68, s98, v62
    s_add_u32 m0, s52, 132096
    s_add_u32 s49, s67, s70
    s_add_u32 s49, s49, 9216
    buffer_load_dwordx4 v2, s[12:15], s49 offen lds
    s_waitcnt lgkmcnt(4)
    v_mfma_f32_32x32x16_bf16 v[32:47], v[24:27], a[104:107], v[32:47]
    ds_read_b64_tr_b16 v[20:21], v3 offset:59392
    ds_read_b64_tr_b16 v[22:23], v3 offset:59904
    v_mul_f32 v70, s98, v63
    v_exp_f32 v64, v64
    v_exp_f32 v66, v66
    s_waitcnt lgkmcnt(4)
    v_mfma_f32_32x32x16_bf16 v[32:47], v[28:31], a[108:111], v[32:47]
    ds_read_b64_tr_b16 v[24:25], v3 offset:61440
    ds_read_b64_tr_b16 v[26:27], v3 offset:61952
    v_exp_f32 v68, v68
    v_exp_f32 v70, v70
    v_fmaak_f32 v65, -0.5, v64, 0xbf800000
    s_waitcnt lgkmcnt(4)
    v_mfma_f32_32x32x16_bf16 v[32:47], v[16:19], a[112:115], v[32:47]
    ds_read_b64_tr_b16 v[28:29], v3 offset:63488
    ds_read_b64_tr_b16 v[30:31], v3 offset:64000
    v_fmaak_f32 v67, -0.5, v66, 0xbf800000
    v_fmaak_f32 v69, -0.5, v68, 0xbf800000
    v_fmaak_f32 v71, -0.5, v70, 0xbf800000
    v_fmaak_f32 v65, v64, v65, 0xbf800000
    s_waitcnt lgkmcnt(4)
    v_mfma_f32_32x32x16_bf16 v[32:47], v[20:23], a[116:119], v[32:47]
    ds_read_b64_tr_b16 v[16:17], v4 offset:0
    ds_read_b64_tr_b16 v[18:19], v4 offset:512
    v_fmaak_f32 v67, v66, v67, 0xbf800000
    v_fmaak_f32 v69, v68, v69, 0xbf800000
    v_fmaak_f32 v71, v70, v71, 0xbf800000
    s_waitcnt lgkmcnt(4)
    v_mfma_f32_32x32x16_bf16 v[32:47], v[24:27], a[120:123], v[32:47]
    ds_read_b64_tr_b16 v[20:21], v4 offset:2048
    ds_read_b64_tr_b16 v[22:23], v4 offset:2560
    v_rcp_f32 v65, v65
    v_rcp_f32 v67, v67
    v_rcp_f32 v69, v69
    s_waitcnt lgkmcnt(4)
    v_mfma_f32_32x32x16_bf16 v[32:47], v[28:31], a[124:127], v[32:47]
    s_waitcnt vmcnt(9)
    s_barrier
    s_waitcnt lgkmcnt(2)
    v_mfma_f32_32x32x16_bf16 v[32:47], v[16:19], a[128:131], v[32:47]
    ds_read_b64_tr_b16 v[24:25], v4 offset:4096
    ds_read_b64_tr_b16 v[26:27], v4 offset:4608
    ds_read_b64_tr_b16 v[28:29], v4 offset:6144
    ds_read_b64_tr_b16 v[30:31], v4 offset:6656
    v_rcp_f32 v71, v71
    v_fmac_f32 v60, v60, v65
    v_fmac_f32 v61, v61, v67
    v_fmac_f32 v62, v62, v69
    v_fmac_f32 v63, v63, v71
    v_cvt_pk_bf16_f32 v102, v60, v61
    v_cvt_pk_bf16_f32 v103, v62, v63
    s_add_u32 m0, s52, 49152
    s_add_u32 s49, s68, s70
    buffer_load_dwordx4 v2, s[12:15], s49 offen lds
    s_waitcnt lgkmcnt(4)
    v_mfma_f32_32x32x16_bf16 v[32:47], v[20:23], a[132:135], v[32:47]
    ds_read_b64_tr_b16 v[16:17], v4 offset:8192
    ds_read_b64_tr_b16 v[18:19], v4 offset:8704
    s_waitcnt vmcnt(6)
    s_cmp_lg_u32 s44, 0
    s_cbranch_scc1 .mk_3
    s_mov_b32 s82, 20000

.mc_4:
    v_readfirstlane_b32 s36, v108
    v_readfirstlane_b32 s37, v109
    v_readfirstlane_b32 s38, v110
    v_readfirstlane_b32 s39, v111
    s_and_b32 s40, s36, s37
    s_or_b32 s36, s36, s37
    s_and_b32 s37, s38, s39
    s_or_b32 s38, s38, s39
    s_and_b32 s40, s40, s37
    s_or_b32 s36, s36, s38
    s_and_b32 s37, s40, 0x80808080
    s_cmp_eq_u32 s37, 0x80808080
    s_cbranch_scc1 .mo_5
    s_sub_u32 s82, s82, 1
    s_cmp_lt_i32 s82, 1
    s_cbranch_scc1 .mo_5
    s_sleep 2
    s_mov_b64 exec, 1
    buffer_load_dwordx4 v[108:111], off, s[28:31], s41 sc0 sc1
    s_mov_b64 exec, -1
    s_waitcnt vmcnt(0)
    s_branch .mc_4

.mo_5:
    s_mul_i32 s37, s93, 0x01010101
    s_xor_b32 s36, s36, s37
    s_xor_b32 s40, s40, s37
    s_or_b32 s36, s36, s40
    s_cmp_eq_u32 s36, 0
    s_cselect_b32 s36, 1, 0
    v_mov_b32 v108, s36
    v_mov_b32 v109, 155648
    ds_write_b32 v109, v108
    s_waitcnt lgkmcnt(0)

.mk_3:
    s_add_u32 m0, s52, 50176
    s_add_u32 s49, s68, s70
    s_add_u32 s49, s49, 9216
    buffer_load_dwordx4 v2, s[12:15], s49 offen lds
    s_waitcnt lgkmcnt(4)
    v_mfma_f32_32x32x16_bf16 v[32:47], v[24:27], a[136:139], v[32:47]
    ds_read_b64_tr_b16 v[20:21], v4 offset:10240
    ds_read_b64_tr_b16 v[22:23], v4 offset:10752
    s_sub_u32 s50, s63, s54
    s_lshl_b32 s50, s50, 1
    v_add_u32 v0, s50, v13
    ds_read_b128 v[48:51], v0 offset:0
    ds_read_b128 v[52:55], v0 offset:32
    ds_read_b128 v[56:59], v0 offset:64
    ds_read_b128 v[60:63], v0 offset:96
    s_waitcnt lgkmcnt(8)
    v_mfma_f32_32x32x16_bf16 v[32:47], v[28:31], a[140:143], v[32:47]
    ds_read_b64_tr_b16 v[24:25], v4 offset:12288
    ds_read_b64_tr_b16 v[26:27], v4 offset:12800
    s_waitcnt lgkmcnt(2)
    v_mfma_f32_32x32x16_bf16 v[48:63], v[16:19], a[0:3], v[48:63]
    ds_read_b64_tr_b16 v[28:29], v4 offset:14336
    ds_read_b64_tr_b16 v[30:31], v4 offset:14848
    v_mfma_f32_32x32x16_bf16 v[48:63], v[20:23], a[4:7], v[48:63]
    ds_read_b64_tr_b16 v[16:17], v4 offset:16384
    ds_read_b64_tr_b16 v[18:19], v4 offset:16896
    s_waitcnt lgkmcnt(4)
    v_mfma_f32_32x32x16_bf16 v[48:63], v[24:27], a[8:11], v[48:63]
    ds_read_b64_tr_b16 v[20:21], v4 offset:18432
    ds_read_b64_tr_b16 v[22:23], v4 offset:18944
    v_mul_f32 v64, s98, v32
    v_mul_f32 v66, s98, v33
    v_mul_f32 v68, s98, v34
    ds_write_b128 v14, v[72:75] offset:0
    ds_write_b128 v14, v[76:79] offset:1024
    s_waitcnt lgkmcnt(6)
    v_mfma_f32_32x32x16_bf16 v[48:63], v[28:31], a[12:15], v[48:63]
    s_waitcnt lgkmcnt(0)
    s_barrier
    v_mfma_f32_32x32x16_bf16 v[48:63], v[16:19], a[16:19], v[48:63]
    ds_read_b64_tr_b16 v[24:25], v4 offset:20480
    ds_read_b64_tr_b16 v[26:27], v4 offset:20992
    ds_read_b64_tr_b16 v[28:29], v4 offset:22528
    ds_read_b64_tr_b16 v[30:31], v4 offset:23040
    v_mul_f32 v70, s98, v35
    v_exp_f32 v64, v64
    v_exp_f32 v66, v66
    v_exp_f32 v68, v68
    v_exp_f32 v70, v70
    v_fmaak_f32 v65, -0.5, v64, 0xbf800000
    v_fmaak_f32 v67, -0.5, v66, 0xbf800000
    ds_read_b128 a[0:3], v15 offset:0
    ds_read_b128 a[4:7], v15 offset:1024
    s_add_u32 m0, s52, 65536
    s_add_u32 s49, s69, s70
    buffer_load_dwordx4 v2, s[12:15], s49 offen lds
    v_mfma_f32_32x32x16_bf16 v[48:63], v[20:23], a[20:23], v[48:63]
    ds_read_b64_tr_b16 v[16:17], v4 offset:24576
    ds_read_b64_tr_b16 v[18:19], v4 offset:25088
    v_fmaak_f32 v69, -0.5, v68, 0xbf800000
    v_fmaak_f32 v71, -0.5, v70, 0xbf800000
    v_fmaak_f32 v65, v64, v65, 0xbf800000
    s_add_u32 m0, s52, 66560
    s_add_u32 s49, s69, s70
    s_add_u32 s49, s49, 9216
    buffer_load_dwordx4 v2, s[12:15], s49 offen lds
    s_waitcnt lgkmcnt(6)
    v_mfma_f32_32x32x16_bf16 v[48:63], v[24:27], a[24:27], v[48:63]
    ds_read_b64_tr_b16 v[20:21], v4 offset:26624
    ds_read_b64_tr_b16 v[22:23], v4 offset:27136
    v_fmaak_f32 v67, v66, v67, 0xbf800000
    v_fmaak_f32 v69, v68, v69, 0xbf800000
    v_fmaak_f32 v71, v70, v71, 0xbf800000
    v_rcp_f32 v65, v65
    s_waitcnt lgkmcnt(6)
    v_mfma_f32_32x32x16_bf16 v[48:63], v[28:31], a[28:31], v[48:63]
    ds_read_b64_tr_b16 v[24:25], v4 offset:28672
    ds_read_b64_tr_b16 v[26:27], v4 offset:29184
    v_rcp_f32 v67, v67
    v_rcp_f32 v69, v69
    v_rcp_f32 v71, v71
    s_waitcnt lgkmcnt(4)
    v_mfma_f32_32x32x16_bf16 v[48:63], v[16:19], a[32:35], v[48:63]
    ds_read_b64_tr_b16 v[28:29], v4 offset:30720
    ds_read_b64_tr_b16 v[30:31], v4 offset:31232
    v_fmac_f32 v32, v32, v65
    v_fmac_f32 v33, v33, v67
    v_fmac_f32 v34, v34, v69
    s_waitcnt lgkmcnt(4)
    v_mfma_f32_32x32x16_bf16 v[48:63], v[20:23], a[36:39], v[48:63]
    ds_read_b64_tr_b16 v[16:17], v4 offset:32768
    ds_read_b64_tr_b16 v[18:19], v4 offset:33280
    v_fmac_f32 v35, v35, v71
    v_cvt_pk_bf16_f32 v104, v32, v33
    v_cvt_pk_bf16_f32 v105, v34, v35
    v_mul_f32 v64, s98, v36
    s_waitcnt lgkmcnt(4)
    v_mfma_f32_32x32x16_bf16 v[48:63], v[24:27], a[40:43], v[48:63]
    ds_read_b64_tr_b16 v[20:21], v4 offset:34816
    ds_read_b64_tr_b16 v[22:23], v4 offset:35328
    v_mul_f32 v66, s98, v37
    v_mul_f32 v68, s98, v38
    v_mul_f32 v70, s98, v39
    ds_write_b128 v14, v[80:83] offset:16384
    ds_write_b128 v14, v[84:87] offset:17408
    s_waitcnt lgkmcnt(6)
    v_mfma_f32_32x32x16_bf16 v[48:63], v[28:31], a[44:47], v[48:63]
    s_waitcnt vmcnt(8) lgkmcnt(0)
    s_barrier
    v_mfma_f32_32x32x16_bf16 v[48:63], v[16:19], a[48:51], v[48:63]
    ds_read_b64_tr_b16 v[24:25], v4 offset:36864
    ds_read_b64_tr_b16 v[26:27], v4 offset:37376
    ds_read_b64_tr_b16 v[28:29], v4 offset:38912
    ds_read_b64_tr_b16 v[30:31], v4 offset:39424
    v_exp_f32 v64, v64
    v_exp_f32 v66, v66
    v_exp_f32 v68, v68
    v_exp_f32 v70, v70
    v_fmaak_f32 v65, -0.5, v64, 0xbf800000
    v_fmaak_f32 v67, -0.5, v66, 0xbf800000
    v_fmaak_f32 v69, -0.5, v68, 0xbf800000
    ds_read_b128 a[8:11], v15 offset:16384
    ds_read_b128 a[12:15], v15 offset:17408
    s_add_u32 m0, s52, 81920
    s_add_u32 s49, s67, s71
    buffer_load_dwordx4 v2, s[12:15], s49 offen lds
    v_mfma_f32_32x32x16_bf16 v[48:63], v[20:23], a[52:55], v[48:63]
    ds_read_b64_tr_b16 v[16:17], v4 offset:40960
    ds_read_b64_tr_b16 v[18:19], v4 offset:41472
    v_fmaak_f32 v71, -0.5, v70, 0xbf800000
    v_fmaak_f32 v65, v64, v65, 0xbf800000
    v_fmaak_f32 v67, v66, v67, 0xbf800000
    s_add_u32 m0, s52, 82944
    s_add_u32 s49, s67, s71
    s_add_u32 s49, s49, 9216
    buffer_load_dwordx4 v2, s[12:15], s49 offen lds
    s_waitcnt lgkmcnt(6)
    v_mfma_f32_32x32x16_bf16 v[48:63], v[24:27], a[56:59], v[48:63]
    ds_read_b64_tr_b16 v[20:21], v4 offset:43008
    ds_read_b64_tr_b16 v[22:23], v4 offset:43520
    v_fmaak_f32 v69, v68, v69, 0xbf800000
    v_fmaak_f32 v71, v70, v71, 0xbf800000
    v_rcp_f32 v65, v65
    v_rcp_f32 v67, v67
    s_waitcnt lgkmcnt(6)
    v_mfma_f32_32x32x16_bf16 v[48:63], v[28:31], a[60:63], v[48:63]
    ds_read_b64_tr_b16 v[24:25], v4 offset:45056
    ds_read_b64_tr_b16 v[26:27], v4 offset:45568
    v_rcp_f32 v69, v69
    v_rcp_f32 v71, v71
    v_fmac_f32 v36, v36, v65
    s_waitcnt lgkmcnt(4)
    v_mfma_f32_32x32x16_bf16 v[48:63], v[16:19], a[64:67], v[48:63]
    ds_read_b64_tr_b16 v[28:29], v4 offset:47104
    ds_read_b64_tr_b16 v[30:31], v4 offset:47616
    v_fmac_f32 v37, v37, v67
    v_fmac_f32 v38, v38, v69
    v_fmac_f32 v39, v39, v71
    s_waitcnt lgkmcnt(4)
    v_mfma_f32_32x32x16_bf16 v[48:63], v[20:23], a[68:71], v[48:63]
    ds_read_b64_tr_b16 v[16:17], v4 offset:49152
    ds_read_b64_tr_b16 v[18:19], v4 offset:49664
    v_cvt_pk_bf16_f32 v106, v36, v37
    v_cvt_pk_bf16_f32 v107, v38, v39
    v_mul_f32 v64, s98, v40
    v_mul_f32 v66, s98, v41
    s_waitcnt lgkmcnt(4)
    v_mfma_f32_32x32x16_bf16 v[48:63], v[24:27], a[72:75], v[48:63]
    ds_read_b64_tr_b16 v[20:21], v4 offset:51200
    ds_read_b64_tr_b16 v[22:23], v4 offset:51712
    v_mul_f32 v68, s98, v42
    v_mul_f32 v70, s98, v43
    v_exp_f32 v64, v64
    ds_write_b128 v14, v[88:91] offset:0
    ds_write_b128 v14, v[92:95] offset:1024
    s_waitcnt lgkmcnt(6)
    v_mfma_f32_32x32x16_bf16 v[48:63], v[28:31], a[76:79], v[48:63]
    s_waitcnt vmcnt(8) lgkmcnt(0)
    s_barrier
    v_mfma_f32_32x32x16_bf16 v[48:63], v[16:19], a[80:83], v[48:63]
    ds_read_b64_tr_b16 v[24:25], v4 offset:53248
    ds_read_b64_tr_b16 v[26:27], v4 offset:53760
    ds_read_b64_tr_b16 v[28:29], v4 offset:55296
    ds_read_b64_tr_b16 v[30:31], v4 offset:55808
    v_exp_f32 v66, v66
    v_exp_f32 v68, v68
    v_exp_f32 v70, v70
    v_fmaak_f32 v65, -0.5, v64, 0xbf800000
    v_fmaak_f32 v67, -0.5, v66, 0xbf800000
    v_fmaak_f32 v69, -0.5, v68, 0xbf800000
    v_fmaak_f32 v71, -0.5, v70, 0xbf800000
    ds_read_b128 a[16:19], v15 offset:0
    ds_read_b128 a[20:23], v15 offset:1024
    s_add_u32 m0, s52, 98304
    s_add_u32 s49, s68, s71
    buffer_load_dwordx4 v2, s[12:15], s49 offen lds
    v_mfma_f32_32x32x16_bf16 v[48:63], v[20:23], a[84:87], v[48:63]
    ds_read_b64_tr_b16 v[16:17], v4 offset:57344
    ds_read_b64_tr_b16 v[18:19], v4 offset:57856
    v_fmaak_f32 v65, v64, v65, 0xbf800000
    v_fmaak_f32 v67, v66, v67, 0xbf800000
    v_fmaak_f32 v69, v68, v69, 0xbf800000
    v_mov_b32 v0, 155648
    ds_read_b32 v0, v0
    s_add_u32 m0, s52, 99328
    s_add_u32 s49, s68, s71
    s_add_u32 s49, s49, 9216
    buffer_load_dwordx4 v2, s[12:15], s49 offen lds
    s_waitcnt lgkmcnt(7)
    v_mfma_f32_32x32x16_bf16 v[48:63], v[24:27], a[88:91], v[48:63]
    ds_read_b64_tr_b16 v[20:21], v4 offset:59392
    ds_read_b64_tr_b16 v[22:23], v4 offset:59904
    v_fmaak_f32 v71, v70, v71, 0xbf800000
    v_rcp_f32 v65, v65
    v_rcp_f32 v67, v67
    s_waitcnt lgkmcnt(7)
    v_mfma_f32_32x32x16_bf16 v[48:63], v[28:31], a[92:95], v[48:63]
    ds_read_b64_tr_b16 v[24:25], v4 offset:61440
    ds_read_b64_tr_b16 v[26:27], v4 offset:61952
    v_rcp_f32 v69, v69
    v_rcp_f32 v71, v71
    v_fmac_f32 v40, v40, v65
    v_fmac_f32 v41, v41, v67
    s_waitcnt lgkmcnt(5)
    v_mfma_f32_32x32x16_bf16 v[48:63], v[16:19], a[96:99], v[48:63]
    ds_read_b64_tr_b16 v[28:29], v4 offset:63488
    ds_read_b64_tr_b16 v[30:31], v4 offset:64000
    v_fmac_f32 v42, v42, v69
    v_fmac_f32 v43, v43, v71
    v_cvt_pk_bf16_f32 v108, v40, v41
    s_waitcnt lgkmcnt(4)
    v_mfma_f32_32x32x16_bf16 v[48:63], v[20:23], a[100:103], v[48:63]
    ds_read_b64_tr_b16 v[16:17], v3 offset:32768
    ds_read_b64_tr_b16 v[18:19], v3 offset:33280
    v_cvt_pk_bf16_f32 v109, v42, v43
    v_mul_f32 v64, s98, v44
    v_mul_f32 v66, s98, v45
    v_mul_f32 v68, s98, v46
    s_waitcnt lgkmcnt(4)
    v_mfma_f32_32x32x16_bf16 v[48:63], v[24:27], a[104:107], v[48:63]
    ds_read_b64_tr_b16 v[20:21], v3 offset:34816
    ds_read_b64_tr_b16 v[22:23], v3 offset:35328
    v_mul_f32 v70, s98, v47
    v_exp_f32 v64, v64
    v_exp_f32 v66, v66
    ds_write_b128 v14, v[96:99] offset:16384
    ds_write_b128 v14, v[100:103] offset:17408
    s_waitcnt lgkmcnt(6)
    v_mfma_f32_32x32x16_bf16 v[48:63], v[28:31], a[108:111], v[48:63]
    s_waitcnt vmcnt(6) lgkmcnt(0)
    s_barrier
    v_mfma_f32_32x32x16_bf16 v[48:63], v[16:19], a[112:115], v[48:63]
    ds_read_b64_tr_b16 v[24:25], v3 offset:36864
    ds_read_b64_tr_b16 v[26:27], v3 offset:37376
    ds_read_b64_tr_b16 v[28:29], v3 offset:38912
    ds_read_b64_tr_b16 v[30:31], v3 offset:39424
    v_exp_f32 v68, v68
    v_exp_f32 v70, v70
    v_fmaak_f32 v65, -0.5, v64, 0xbf800000
    v_fmaak_f32 v67, -0.5, v66, 0xbf800000
    v_fmaak_f32 v69, -0.5, v68, 0xbf800000
    v_fmaak_f32 v71, -0.5, v70, 0xbf800000
    v_fmaak_f32 v65, v64, v65, 0xbf800000
    ds_read_b128 a[24:27], v15 offset:16384
    ds_read_b128 a[28:31], v15 offset:17408
    s_add_u32 m0, s52, 114688
    s_add_u32 s49, s69, s71
    buffer_load_dwordx4 v2, s[12:15], s49 offen lds
    v_mfma_f32_32x32x16_bf16 v[48:63], v[20:23], a[116:119], v[48:63]
    ds_read_b64_tr_b16 v[16:17], v3 offset:40960
    ds_read_b64_tr_b16 v[18:19], v3 offset:41472
    v_fmaak_f32 v67, v66, v67, 0xbf800000
    v_fmaak_f32 v69, v68, v69, 0xbf800000
    v_fmaak_f32 v71, v70, v71, 0xbf800000
    s_add_u32 m0, s52, 115712
    s_add_u32 s49, s69, s71
    s_add_u32 s49, s49, 9216
    buffer_load_dwordx4 v2, s[12:15], s49 offen lds
    s_waitcnt lgkmcnt(6)
    v_mfma_f32_32x32x16_bf16 v[48:63], v[24:27], a[120:123], v[48:63]
    ds_read_b64_tr_b16 v[20:21], v3 offset:43008
    ds_read_b64_tr_b16 v[22:23], v3 offset:43520
    v_rcp_f32 v65, v65
    v_rcp_f32 v67, v67
    v_rcp_f32 v69, v69
    s_waitcnt lgkmcnt(6)
    v_mfma_f32_32x32x16_bf16 v[48:63], v[28:31], a[124:127], v[48:63]
    ds_read_b64_tr_b16 v[24:25], v3 offset:45056
    ds_read_b64_tr_b16 v[26:27], v3 offset:45568
    v_rcp_f32 v71, v71
    v_fmac_f32 v44, v44, v65
    v_fmac_f32 v45, v45, v67
    v_fmac_f32 v46, v46, v69
    s_waitcnt lgkmcnt(4)
    v_mfma_f32_32x32x16_bf16 v[48:63], v[16:19], a[128:131], v[48:63]
    ds_read_b64_tr_b16 v[28:29], v3 offset:47104
    ds_read_b64_tr_b16 v[30:31], v3 offset:47616
    v_fmac_f32 v47, v47, v71
    v_cvt_pk_bf16_f32 v110, v44, v45
    v_cvt_pk_bf16_f32 v111, v46, v47
    s_waitcnt lgkmcnt(4)
    v_mfma_f32_32x32x16_bf16 v[48:63], v[20:23], a[132:135], v[48:63]
    ds_read_b64_tr_b16 v[16:17], v8 offset:0
    ds_read_b64_tr_b16 v[18:19], v8 offset:1024
    s_waitcnt lgkmcnt(4)
    v_mfma_f32_32x32x16_bf16 v[48:63], v[24:27], a[136:139], v[48:63]
    ds_read_b64_tr_b16 v[20:21], v8 offset:2048
    ds_read_b64_tr_b16 v[22:23], v8 offset:3072
    ds_write_b128 v14, v[104:107] offset:0
    ds_write_b128 v14, v[108:111] offset:1024
    s_waitcnt lgkmcnt(6)
    v_mfma_f32_32x32x16_bf16 v[48:63], v[28:31], a[140:143], v[48:63]
    s_waitcnt vmcnt(6) lgkmcnt(0)
    s_barrier
    ds_read_b64_tr_b16 v[24:25], v8 offset:8192
    ds_read_b64_tr_b16 v[26:27], v8 offset:9216
    v_readfirstlane_b32 s83, v0
    s_cmp_eq_u32 s83, 0
    s_cbranch_scc1 .slow_6
    v_mfma_f32_32x32x16_bf16 v[32:47], v[72:75], v[16:19], 0
    ds_read_b64_tr_b16 v[28:29], v8 offset:10240
    ds_read_b64_tr_b16 v[30:31], v8 offset:11264
    ds_read_b128 a[32:35], v15 offset:0
    ds_read_b128 a[36:39], v15 offset:1024
    s_add_u32 m0, s52, 32768
    s_add_u32 s49, s67, s72
    buffer_load_dwordx4 v2, s[12:15], s49 offen lds
    v_mfma_f32_32x32x16_bf16 v[32:47], v[76:79], v[20:23], v[32:47]
    ds_read_b64_tr_b16 v[16:17], v6 offset:49152
    ds_read_b64_tr_b16 v[18:19], v6 offset:50176
    s_lshr_b32 s49, s48, 2
    s_lshl_b32 s50, s47, 3
    s_lshl_b32 s51, s45, 1
    s_add_u32 s50, s50, s51
    s_add_u32 s50, s50, s49
    s_mul_i32 s50, s50, 36864
    s_lshl_b32 s51, s46, 7
    s_add_u32 s50, s50, s51
    v_lshrrev_b32 v0, 9, v12
    v_bfe_u32 v13, v12, 6, 2
    v_lshl_add_u32 v0, v0, 2, v13
    v_mul_u32_u24 v0, 2304, v0
    v_bfe_u32 v13, v12, 8, 1
    v_lshl_add_u32 v0, v13, 6, v0
    v_and_b32 v13, 0x30, v12
    v_add_u32 v0, v0, v13
    s_movk_i32 s51, 1024
    s_cmp_lt_u32 s49, 2
    s_cselect_b32 s56, s50, s56
    s_cselect_b32 s20, s32, s16
    s_cselect_b32 s21, s33, s17
    s_cselect_b32 s22, s34, s18
    s_cselect_b32 s8, 1, 7
    s_cselect_b32 s9, 18432, s51
    s_cselect_b64 vcc, -1, 0
    s_nop 1
    v_cndmask_b32 v1, v12, v0, vcc

    s_add_u32 m0, s52, 33792
    s_add_u32 s49, s67, s72
    s_add_u32 s49, s49, 9216
    buffer_load_dwordx4 v2, s[12:15], s49 offen lds
    s_waitcnt lgkmcnt(6)
    v_mfma_f32_32x32x16_bf16 v[32:47], v[80:83], v[24:27], v[32:47]
    ds_read_b64_tr_b16 v[20:21], v6 offset:51200
    ds_read_b64_tr_b16 v[22:23], v6 offset:52224
    v_mul_f32 v64, s98, v48
    v_mul_f32 v66, s98, v49
    v_mul_f32 v68, s98, v50
    v_mul_f32 v70, s98, v51
    v_exp_f32 v64, v64
    v_exp_f32 v66, v66
    v_exp_f32 v68, v68
    v_exp_f32 v70, v70
    v_fmaak_f32 v65, -0.5, v64, 0xbf800000
    s_waitcnt lgkmcnt(6)
    v_mfma_f32_32x32x16_bf16 v[32:47], v[84:87], v[28:31], v[32:47]
    ds_read_b64_tr_b16 v[24:25], v6 offset:57344
    ds_read_b64_tr_b16 v[26:27], v6 offset:58368
    v_fmaak_f32 v67, -0.5, v66, 0xbf800000
    v_fmaak_f32 v69, -0.5, v68, 0xbf800000
    v_fmaak_f32 v71, -0.5, v70, 0xbf800000
    v_fmaak_f32 v65, v64, v65, 0xbf800000
    v_fmaak_f32 v67, v66, v67, 0xbf800000
    v_fmaak_f32 v69, v68, v69, 0xbf800000
    v_fmaak_f32 v71, v70, v71, 0xbf800000
    v_rcp_f32 v65, v65
    s_waitcnt lgkmcnt(4)
    v_mfma_f32_32x32x16_bf16 v[32:47], v[88:91], v[16:19], v[32:47]
    ds_read_b64_tr_b16 v[28:29], v6 offset:59392
    ds_read_b64_tr_b16 v[30:31], v6 offset:60416
    v_rcp_f32 v67, v67
    v_rcp_f32 v69, v69
    v_rcp_f32 v71, v71
    v_fmac_f32 v48, v48, v65
    v_fmac_f32 v49, v49, v67
    v_fmac_f32 v50, v50, v69
    v_fmac_f32 v51, v51, v71
    v_cvt_pk_bf16_f32 v48, v48, v49
    v_cvt_pk_bf16_f32 v49, v50, v51
    s_waitcnt lgkmcnt(4)
    v_mfma_f32_32x32x16_bf16 v[32:47], v[92:95], v[20:23], v[32:47]
    ds_read_b64_tr_b16 v[16:17], v7 offset:0
    ds_read_b64_tr_b16 v[18:19], v7 offset:1024
    v_mul_f32 v64, s98, v52
    v_mul_f32 v66, s98, v53
    v_mul_f32 v68, s98, v54
    v_mul_f32 v70, s98, v55
    v_exp_f32 v64, v64
    v_exp_f32 v66, v66
    v_exp_f32 v68, v68
    v_exp_f32 v70, v70
    v_fmaak_f32 v65, -0.5, v64, 0xbf800000
    s_waitcnt lgkmcnt(4)
    v_mfma_f32_32x32x16_bf16 v[32:47], v[96:99], v[24:27], v[32:47]
    ds_read_b64_tr_b16 v[20:21], v7 offset:2048
    ds_read_b64_tr_b16 v[22:23], v7 offset:3072
    v_fmaak_f32 v67, -0.5, v66, 0xbf800000
    v_fmaak_f32 v69, -0.5, v68, 0xbf800000
    v_fmaak_f32 v71, -0.5, v70, 0xbf800000
    v_fmaak_f32 v65, v64, v65, 0xbf800000
    v_fmaak_f32 v67, v66, v67, 0xbf800000
    v_fmaak_f32 v69, v68, v69, 0xbf800000
    v_fmaak_f32 v71, v70, v71, 0xbf800000
    v_rcp_f32 v65, v65
    s_waitcnt lgkmcnt(4)
    v_mfma_f32_32x32x16_bf16 v[32:47], v[100:103], v[28:31], v[32:47]
    s_barrier
    s_waitcnt lgkmcnt(2)
    v_mfma_f32_32x32x16_bf16 v[32:47], v[104:107], v[16:19], v[32:47]
    ds_read_b64_tr_b16 v[24:25], v11 offset:0
    ds_read_b64_tr_b16 v[26:27], v11 offset:1024
    ds_read_b64_tr_b16 v[28:29], v11 offset:2048
    ds_read_b64_tr_b16 v[30:31], v11 offset:3072
    v_rcp_f32 v67, v67
    v_rcp_f32 v69, v69
    v_rcp_f32 v71, v71
    v_fmac_f32 v52, v52, v65
    v_fmac_f32 v53, v53, v67
    v_fmac_f32 v54, v54, v69
    v_fmac_f32 v55, v55, v71
    v_cvt_pk_bf16_f32 v50, v52, v53
    v_cvt_pk_bf16_f32 v51, v54, v55
    v_mul_f32 v64, s98, v56
    v_mul_f32 v66, s98, v57
    v_mul_f32 v68, s98, v58
    v_mul_f32 v70, s98, v59
    v_exp_f32 v64, v64
    v_exp_f32 v66, v66
    v_exp_f32 v68, v68
    v_exp_f32 v70, v70
    v_fmaak_f32 v65, -0.5, v64, 0xbf800000
    s_add_u32 m0, s52, 0
    s_add_u32 s49, s68, s72
    buffer_load_dwordx4 v2, s[12:15], s49 offen lds
    s_waitcnt lgkmcnt(4)
    v_mfma_f32_32x32x16_bf16 v[32:47], v[108:111], v[20:23], v[32:47]
    ds_read_b64_tr_b16 v[16:17], v11 offset:8192
    ds_read_b64_tr_b16 v[18:19], v11 offset:9216
    v_fmaak_f32 v67, -0.5, v66, 0xbf800000
    v_fmaak_f32 v69, -0.5, v68, 0xbf800000
    v_fmaak_f32 v71, -0.5, v70, 0xbf800000
    v_fmaak_f32 v65, v64, v65, 0xbf800000
    v_fmaak_f32 v67, v66, v67, 0xbf800000
    v_fmaak_f32 v69, v68, v69, 0xbf800000
    v_fmaak_f32 v71, v70, v71, 0xbf800000
    v_rcp_f32 v65, v65
    s_add_u32 m0, s52, 1024
    s_add_u32 s49, s68, s72
    s_add_u32 s49, s49, 9216
    buffer_load_dwordx4 v2, s[12:15], s49 offen lds
    s_waitcnt lgkmcnt(4)
    v_mfma_f32_32x32x16_bf16 v[32:47], a[0:3], v[24:27], v[32:47]
    ds_read_b64_tr_b16 v[20:21], v11 offset:10240
    ds_read_b64_tr_b16 v[22:23], v11 offset:11264
    v_rcp_f32 v67, v67
    v_rcp_f32 v69, v69
    v_rcp_f32 v71, v71
    v_fmac_f32 v56, v56, v65
    v_fmac_f32 v57, v57, v67
    v_fmac_f32 v58, v58, v69
    v_fmac_f32 v59, v59, v71
    v_cvt_pk_bf16_f32 v52, v56, v57
    v_cvt_pk_bf16_f32 v53, v58, v59
    s_waitcnt lgkmcnt(4)
    v_mfma_f32_32x32x16_bf16 v[32:47], a[4:7], v[28:31], v[32:47]
    ds_read_b64_tr_b16 v[24:25], v9 offset:49152
    ds_read_b64_tr_b16 v[26:27], v9 offset:50176
    v_mul_f32 v64, s98, v60
    v_mul_f32 v66, s98, v61
    v_mul_f32 v68, s98, v62
    v_mul_f32 v70, s98, v63
    v_exp_f32 v64, v64
    v_exp_f32 v66, v66
    v_exp_f32 v68, v68
    v_exp_f32 v70, v70
    v_fmaak_f32 v65, -0.5, v64, 0xbf800000
    s_waitcnt lgkmcnt(4)
    v_mfma_f32_32x32x16_bf16 v[32:47], a[8:11], v[16:19], v[32:47]
    ds_read_b64_tr_b16 v[28:29], v9 offset:51200
    ds_read_b64_tr_b16 v[30:31], v9 offset:52224
    v_fmaak_f32 v67, -0.5, v66, 0xbf800000
    v_fmaak_f32 v69, -0.5, v68, 0xbf800000
    v_fmaak_f32 v71, -0.5, v70, 0xbf800000
    v_fmaak_f32 v65, v64, v65, 0xbf800000
    v_fmaak_f32 v67, v66, v67, 0xbf800000
    v_fmaak_f32 v69, v68, v69, 0xbf800000
    v_fmaak_f32 v71, v70, v71, 0xbf800000
    v_rcp_f32 v65, v65
    s_waitcnt lgkmcnt(4)
    v_mfma_f32_32x32x16_bf16 v[32:47], a[12:15], v[20:23], v[32:47]
    ds_read_b64_tr_b16 v[16:17], v9 offset:57344
    ds_read_b64_tr_b16 v[18:19], v9 offset:58368
    v_rcp_f32 v67, v67
    v_rcp_f32 v69, v69
    v_rcp_f32 v71, v71
    v_fmac_f32 v60, v60, v65
    v_fmac_f32 v61, v61, v67
    v_fmac_f32 v62, v62, v69
    v_fmac_f32 v63, v63, v71
    v_cvt_pk_bf16_f32 v54, v60, v61
    v_cvt_pk_bf16_f32 v55, v62, v63
    s_waitcnt lgkmcnt(4)
    v_mfma_f32_32x32x16_bf16 v[32:47], a[16:19], v[24:27], v[32:47]
    ds_read_b64_tr_b16 v[20:21], v9 offset:59392
    ds_read_b64_tr_b16 v[22:23], v9 offset:60416
    ds_write_b128 v14, v[48:51] offset:16384
    ds_write_b128 v14, v[52:55] offset:17408
    s_waitcnt lgkmcnt(6)
    v_mfma_f32_32x32x16_bf16 v[32:47], a[20:23], v[28:31], v[32:47]
    s_waitcnt vmcnt(8) lgkmcnt(0)
    s_barrier
    v_mfma_f32_32x32x16_bf16 v[32:47], a[24:27], v[16:19], v[32:47]
    ds_read_b64_tr_b16 v[24:25], v10 offset:0
    ds_read_b64_tr_b16 v[26:27], v10 offset:1024
    ds_read_b64_tr_b16 v[28:29], v10 offset:2048
    ds_read_b64_tr_b16 v[30:31], v10 offset:3072
    ds_read_b128 a[40:43], v15 offset:16384
    ds_read_b128 a[44:47], v15 offset:17408
    ds_read_b128 a[48:51], v14 offset:16384
    ds_read_b128 a[52:55], v14 offset:17408
    s_add_u32 m0, s52, 131072
    s_add_u32 s49, s69, s72
    buffer_load_dwordx4 v2, s[12:15], s49 offen lds
    v_mfma_f32_32x32x16_bf16 v[32:47], a[28:31], v[20:23], v[32:47]
    ds_read_b64_tr_b16 v[16:17], v7 offset:8192
    ds_read_b64_tr_b16 v[18:19], v7 offset:9216
    s_add_u32 m0, s52, 132096
    s_add_u32 s49, s69, s72
    s_add_u32 s49, s49, 9216
    buffer_load_dwordx4 v2, s[12:15], s49 offen lds
    s_waitcnt lgkmcnt(8)
    v_mfma_f32_32x32x16_bf16 v[32:47], a[32:35], v[24:27], v[32:47]
    ds_read_b64_tr_b16 v[20:21], v7 offset:10240
    ds_read_b64_tr_b16 v[22:23], v7 offset:11264
    s_waitcnt lgkmcnt(8)
    v_mfma_f32_32x32x16_bf16 v[32:47], a[36:39], v[28:31], v[32:47]
    ds_read_b64_tr_b16 v[24:25], v10 offset:8192
    ds_read_b64_tr_b16 v[26:27], v10 offset:9216
    s_waitcnt lgkmcnt(4)
    v_mfma_f32_32x32x16_bf16 v[32:47], a[48:51], v[16:19], v[32:47]
    ds_read_b64_tr_b16 v[28:29], v10 offset:10240
    ds_read_b64_tr_b16 v[30:31], v10 offset:11264
    s_waitcnt lgkmcnt(4)
    v_mfma_f32_32x32x16_bf16 v[32:47], a[52:55], v[20:23], v[32:47]
    ds_read_b64_tr_b16 v[16:17], v7 offset:16384
    ds_read_b64_tr_b16 v[18:19], v7 offset:17408
    s_waitcnt lgkmcnt(4)
    v_mfma_f32_32x32x16_bf16 v[32:47], a[40:43], v[24:27], v[32:47]
    ds_read_b64_tr_b16 v[20:21], v7 offset:18432
    ds_read_b64_tr_b16 v[22:23], v7 offset:19456
    s_waitcnt lgkmcnt(4)
    v_mfma_f32_32x32x16_bf16 v[32:47], a[44:47], v[28:31], v[32:47]
    s_waitcnt vmcnt(8)
    s_barrier
    s_waitcnt lgkmcnt(2)
    v_mfma_f32_32x32x16_bf16 v[48:63], v[72:75], v[16:19], 0
    ds_read_b64_tr_b16 v[24:25], v7 offset:24576
    ds_read_b64_tr_b16 v[26:27], v7 offset:25600
    ds_read_b64_tr_b16 v[28:29], v7 offset:26624
    ds_read_b64_tr_b16 v[30:31], v7 offset:27648
    s_add_u32 m0, s52, 16384
    s_add_u32 s49, s67, s73
    buffer_load_dwordx4 v2, s[12:15], s49 offen lds
    s_waitcnt lgkmcnt(4)
    v_mfma_f32_32x32x16_bf16 v[48:63], v[76:79], v[20:23], v[48:63]
    ds_read_b64_tr_b16 v[16:17], v10 offset:16384
    ds_read_b64_tr_b16 v[18:19], v10 offset:17408
    s_add_u32 m0, s52, 17408
    s_add_u32 s49, s67, s73
    s_add_u32 s49, s49, 9216
    buffer_load_dwordx4 v2, s[12:15], s49 offen lds
    s_waitcnt lgkmcnt(4)
    v_mfma_f32_32x32x16_bf16 v[48:63], v[80:83], v[24:27], v[48:63]
    ds_read_b64_tr_b16 v[20:21], v10 offset:18432
    ds_read_b64_tr_b16 v[22:23], v10 offset:19456
    v_cvt_pk_f16_f32 v32, v32, v33
    v_cvt_pk_f16_f32 v33, v34, v35
    v_cvt_pk_f16_f32 v34, v36, v37
    s_add_u32 m0, s52, 49152
    s_add_u32 s49, s68, s73
    buffer_load_dwordx4 v2, s[12:15], s49 offen lds
    s_waitcnt lgkmcnt(4)
    v_mfma_f32_32x32x16_bf16 v[48:63], v[84:87], v[28:31], v[48:63]
    ds_read_b64_tr_b16 v[24:25], v10 offset:24576
    ds_read_b64_tr_b16 v[26:27], v10 offset:25600
    v_cvt_pk_f16_f32 v35, v38, v39
    v_cvt_pk_f16_f32 v36, v40, v41
    s_add_u32 m0, s52, 50176
    s_add_u32 s49, s68, s73
    s_add_u32 s49, s49, 9216
    buffer_load_dwordx4 v2, s[12:15], s49 offen lds
    s_waitcnt lgkmcnt(4)
    v_mfma_f32_32x32x16_bf16 v[48:63], a[0:3], v[16:19], v[48:63]
    ds_read_b64_tr_b16 v[28:29], v10 offset:26624
    ds_read_b64_tr_b16 v[30:31], v10 offset:27648
    v_cvt_pk_f16_f32 v37, v42, v43
    v_cvt_pk_f16_f32 v38, v44, v45
    v_cvt_pk_f16_f32 v39, v46, v47
    s_waitcnt lgkmcnt(4)
    v_mfma_f32_32x32x16_bf16 v[48:63], a[4:7], v[20:23], v[48:63]
    ds_read_b64_tr_b16 v[16:17], v7 offset:32768
    ds_read_b64_tr_b16 v[18:19], v7 offset:33792
    v_mov_b32 v64, 0
    v_mov_b32 v65, 0
    v_mov_b32 v66, 0
    v_mov_b32 v67, 0
    v_mov_b32 v68, 0
    v_mov_b32 v69, 0
    v_mov_b32 v70, 0
    v_mov_b32 v71, 0
    s_mov_b32 s82, 30000
    s_lshl_b32 s50, s70, s8
    s_add_u32 s50, s50, s56
    s_add_u32 s51, s50, s9
    buffer_store_dwordx4 v[32:35], v1, s[20:23], s50 offen
    buffer_store_dwordx4 v[36:39], v1, s[20:23], s51 offen
    s_waitcnt lgkmcnt(4)
    v_mfma_f32_32x32x16_bf16 v[48:63], a[8:11], v[24:27], v[48:63]
    ds_read_b64_tr_b16 v[20:21], v7 offset:34816
    ds_read_b64_tr_b16 v[22:23], v7 offset:35840
    s_waitcnt lgkmcnt(4)
    v_mfma_f32_32x32x16_bf16 v[48:63], a[12:15], v[28:31], v[48:63]
    s_waitcnt vmcnt(12)
    s_barrier
    s_waitcnt lgkmcnt(2)
    v_mfma_f32_32x32x16_bf16 v[48:63], v[88:91], v[16:19], v[48:63]
    ds_read_b64_tr_b16 v[24:25], v7 offset:40960
    ds_read_b64_tr_b16 v[26:27], v7 offset:41984
    ds_read_b64_tr_b16 v[28:29], v7 offset:43008
    ds_read_b64_tr_b16 v[30:31], v7 offset:44032
    s_add_u32 m0, s52, 65536
    s_add_u32 s49, s69, s73
    buffer_load_dwordx4 v2, s[12:15], s49 offen lds
    s_waitcnt lgkmcnt(4)
    v_mfma_f32_32x32x16_bf16 v[48:63], v[92:95], v[20:23], v[48:63]
    ds_read_b64_tr_b16 v[16:17], v10 offset:32768
    ds_read_b64_tr_b16 v[18:19], v10 offset:33792
    s_add_u32 m0, s52, 66560
    s_add_u32 s49, s69, s73
    s_add_u32 s49, s49, 9216
    buffer_load_dwordx4 v2, s[12:15], s49 offen lds
    s_waitcnt lgkmcnt(4)
    v_mfma_f32_32x32x16_bf16 v[48:63], v[96:99], v[24:27], v[48:63]
    ds_read_b64_tr_b16 v[20:21], v10 offset:34816
    ds_read_b64_tr_b16 v[22:23], v10 offset:35840
    s_add_u32 m0, s52, 81920
    s_add_u32 s49, s67, s74
    buffer_load_dwordx4 v2, s[12:15], s49 offen lds
    s_waitcnt lgkmcnt(4)
    v_mfma_f32_32x32x16_bf16 v[48:63], v[100:103], v[28:31], v[48:63]
    ds_read_b64_tr_b16 v[24:25], v10 offset:40960
    ds_read_b64_tr_b16 v[26:27], v10 offset:41984
    s_add_u32 m0, s52, 82944
    s_add_u32 s49, s67, s74
    s_add_u32 s49, s49, 9216
    buffer_load_dwordx4 v2, s[12:15], s49 offen lds
    s_waitcnt lgkmcnt(4)
    v_mfma_f32_32x32x16_bf16 v[48:63], a[16:19], v[16:19], v[48:63]
    ds_read_b64_tr_b16 v[28:29], v10 offset:43008
    ds_read_b64_tr_b16 v[30:31], v10 offset:44032
    s_waitcnt lgkmcnt(4)
    v_mfma_f32_32x32x16_bf16 v[48:63], a[20:23], v[20:23], v[48:63]
    ds_read_b64_tr_b16 v[16:17], v7 offset:49152
    ds_read_b64_tr_b16 v[18:19], v7 offset:50176
    s_waitcnt lgkmcnt(4)
    v_mfma_f32_32x32x16_bf16 v[48:63], a[24:27], v[24:27], v[48:63]
    ds_read_b64_tr_b16 v[20:21], v7 offset:51200
    ds_read_b64_tr_b16 v[22:23], v7 offset:52224
    v_mov_b32 v14, 1
    s_waitcnt vmcnt(4)
    s_mov_b64 exec, 1
    buffer_store_dword v14, off, s[16:19], s42
    s_mov_b64 exec, -1
    s_waitcnt lgkmcnt(4)
    v_mfma_f32_32x32x16_bf16 v[48:63], a[28:31], v[28:31], v[48:63]
    s_barrier
    s_waitcnt lgkmcnt(2)
    v_mfma_f32_32x32x16_bf16 v[48:63], v[104:107], v[16:19], v[48:63]
    ds_read_b64_tr_b16 v[24:25], v7 offset:57344
    ds_read_b64_tr_b16 v[26:27], v7 offset:58368
    ds_read_b64_tr_b16 v[28:29], v7 offset:59392
    ds_read_b64_tr_b16 v[30:31], v7 offset:60416
    s_add_u32 m0, s52, 98304
    s_add_u32 s49, s68, s74
    buffer_load_dwordx4 v2, s[12:15], s49 offen lds
    s_waitcnt lgkmcnt(4)
    v_mfma_f32_32x32x16_bf16 v[48:63], v[108:111], v[20:23], v[48:63]
    ds_read_b64_tr_b16 v[16:17], v10 offset:49152
    ds_read_b64_tr_b16 v[18:19], v10 offset:50176
    s_add_u32 m0, s52, 99328
    s_add_u32 s49, s68, s74
    s_add_u32 s49, s49, 9216
    buffer_load_dwordx4 v2, s[12:15], s49 offen lds
    s_waitcnt lgkmcnt(4)
    v_mfma_f32_32x32x16_bf16 v[48:63], a[48:51], v[24:27], v[48:63]
    ds_read_b64_tr_b16 v[20:21], v10 offset:51200
    ds_read_b64_tr_b16 v[22:23], v10 offset:52224
    s_waitcnt lgkmcnt(4)
    v_mfma_f32_32x32x16_bf16 v[48:63], a[52:55], v[28:31], v[48:63]
    ds_read_b64_tr_b16 v[24:25], v10 offset:57344
    ds_read_b64_tr_b16 v[26:27], v10 offset:58368
    s_waitcnt lgkmcnt(4)
    v_mfma_f32_32x32x16_bf16 v[48:63], a[32:35], v[16:19], v[48:63]
    ds_read_b64_tr_b16 v[28:29], v10 offset:59392
    ds_read_b64_tr_b16 v[30:31], v10 offset:60416
    s_waitcnt lgkmcnt(4)
    v_mfma_f32_32x32x16_bf16 v[48:63], a[36:39], v[20:23], v[48:63]
    ds_read_b64_tr_b16 v[16:17], v6 offset:32768
    ds_read_b64_tr_b16 v[18:19], v6 offset:33792
    s_waitcnt lgkmcnt(4)
    v_mfma_f32_32x32x16_bf16 v[48:63], a[40:43], v[24:27], v[48:63]
    ds_read_b64_tr_b16 v[20:21], v6 offset:34816
    ds_read_b64_tr_b16 v[22:23], v6 offset:35840
    s_waitcnt lgkmcnt(4)
    v_mfma_f32_32x32x16_bf16 v[48:63], a[44:47], v[28:31], v[48:63]
    s_barrier
    s_waitcnt lgkmcnt(2)
    v_mfma_f32_32x32x16_bf16 v[32:47], v[72:75], v[16:19], 0
    ds_read_b64_tr_b16 v[24:25], v6 offset:40960
    ds_read_b64_tr_b16 v[26:27], v6 offset:41984
    ds_read_b64_tr_b16 v[28:29], v6 offset:43008
    ds_read_b64_tr_b16 v[30:31], v6 offset:44032
    s_add_u32 m0, s52, 114688
    s_add_u32 s49, s69, s74
    buffer_load_dwordx4 v2, s[12:15], s49 offen lds
    s_waitcnt lgkmcnt(4)
    v_mfma_f32_32x32x16_bf16 v[32:47], v[76:79], v[20:23], v[32:47]
    ds_read_b64_tr_b16 v[16:17], v9 offset:32768
    ds_read_b64_tr_b16 v[18:19], v9 offset:33792
    s_add_u32 m0, s52, 115712
    s_add_u32 s49, s69, s74
    s_add_u32 s49, s49, 9216
    buffer_load_dwordx4 v2, s[12:15], s49 offen lds
    s_waitcnt lgkmcnt(4)
    v_mfma_f32_32x32x16_bf16 v[32:47], v[80:83], v[24:27], v[32:47]
    ds_read_b64_tr_b16 v[20:21], v9 offset:34816
    ds_read_b64_tr_b16 v[22:23], v9 offset:35840
    v_cvt_pk_f16_f32 v48, v48, v49
    v_cvt_pk_f16_f32 v49, v50, v51
    v_cvt_pk_f16_f32 v50, v52, v53
    s_waitcnt lgkmcnt(4)
    v_mfma_f32_32x32x16_bf16 v[32:47], v[84:87], v[28:31], v[32:47]
    ds_read_b64_tr_b16 v[24:25], v9 offset:40960
    ds_read_b64_tr_b16 v[26:27], v9 offset:41984
    v_cvt_pk_f16_f32 v51, v54, v55
    v_cvt_pk_f16_f32 v52, v56, v57
    s_waitcnt lgkmcnt(4)
    v_mfma_f32_32x32x16_bf16 v[32:47], a[0:3], v[16:19], v[32:47]
    ds_read_b64_tr_b16 v[28:29], v9 offset:43008
    ds_read_b64_tr_b16 v[30:31], v9 offset:44032
    v_cvt_pk_f16_f32 v53, v58, v59
    v_cvt_pk_f16_f32 v54, v60, v61
    v_cvt_pk_f16_f32 v55, v62, v63
    s_waitcnt lgkmcnt(4)
    v_mfma_f32_32x32x16_bf16 v[32:47], a[4:7], v[20:23], v[32:47]
    ds_read_b64_tr_b16 v[16:17], v6 offset:0
    ds_read_b64_tr_b16 v[18:19], v6 offset:1024
    s_lshl_b32 s50, s71, s8
    s_add_u32 s50, s50, s56
    s_add_u32 s51, s50, s9
    buffer_store_dwordx4 v[48:51], v1, s[20:23], s50 offen
    buffer_store_dwordx4 v[52:55], v1, s[20:23], s51 offen
    buffer_load_dword v13, off, s[16:19], s43 sc1
    s_waitcnt lgkmcnt(4)
    v_mfma_f32_32x32x16_bf16 v[32:47], a[8:11], v[24:27], v[32:47]
    ds_read_b64_tr_b16 v[20:21], v6 offset:2048
    ds_read_b64_tr_b16 v[22:23], v6 offset:3072
    s_waitcnt lgkmcnt(4)
    v_mfma_f32_32x32x16_bf16 v[32:47], a[12:15], v[28:31], v[32:47]
    s_barrier
    s_waitcnt lgkmcnt(2)
    v_mfma_f32_32x32x16_bf16 v[32:47], v[88:91], v[16:19], v[32:47]
    ds_read_b64_tr_b16 v[24:25], v6 offset:8192
    ds_read_b64_tr_b16 v[26:27], v6 offset:9216
    ds_read_b64_tr_b16 v[28:29], v6 offset:10240
    ds_read_b64_tr_b16 v[30:31], v6 offset:11264
    s_add_u32 m0, s52, 32768
    s_add_u32 s49, s67, s75
    buffer_load_dwordx4 v2, s[12:15], s49 offen lds
    s_waitcnt lgkmcnt(4)
    v_mfma_f32_32x32x16_bf16 v[32:47], v[92:95], v[20:23], v[32:47]
    ds_read_b64_tr_b16 v[16:17], v9 offset:0
    ds_read_b64_tr_b16 v[18:19], v9 offset:1024
    s_add_u32 m0, s52, 33792
    s_add_u32 s49, s67, s75
    s_add_u32 s49, s49, 9216
    buffer_load_dwordx4 v2, s[12:15], s49 offen lds
    s_waitcnt lgkmcnt(4)
    v_mfma_f32_32x32x16_bf16 v[32:47], v[96:99], v[24:27], v[32:47]
    ds_read_b64_tr_b16 v[20:21], v9 offset:2048
    ds_read_b64_tr_b16 v[22:23], v9 offset:3072
    s_waitcnt lgkmcnt(4)
    v_mfma_f32_32x32x16_bf16 v[32:47], v[100:103], v[28:31], v[32:47]
    ds_read_b64_tr_b16 v[24:25], v9 offset:8192
    ds_read_b64_tr_b16 v[26:27], v9 offset:9216
    s_waitcnt lgkmcnt(4)
    v_mfma_f32_32x32x16_bf16 v[32:47], a[16:19], v[16:19], v[32:47]
    ds_read_b64_tr_b16 v[28:29], v9 offset:10240
    ds_read_b64_tr_b16 v[30:31], v9 offset:11264
    s_waitcnt lgkmcnt(4)
    v_mfma_f32_32x32x16_bf16 v[32:47], a[20:23], v[20:23], v[32:47]
    ds_read_b64_tr_b16 v[16:17], v8 offset:0
    ds_read_b64_tr_b16 v[18:19], v8 offset:1024
    s_waitcnt vmcnt(2)
.sp_7:
    v_readfirstlane_b32 s50, v13
    s_add_u32 s50, s50, s100
    s_cmp_ge_u32 s50, 3
    s_cbranch_scc1 .ok_8
    s_sub_u32 s82, s82, 1
    s_cmp_lt_i32 s82, 1
    s_cbranch_scc1 .ok_8
    buffer_load_dword v13, off, s[16:19], s43 sc1
    s_waitcnt vmcnt(0)
    s_branch .sp_7

.ok_8:
    s_lshl_b32 s50, s72, s8
    s_add_u32 s50, s50, s56
    s_add_u32 s51, s50, s9
    s_cmp_eq_u32 s100, 2
    s_cselect_b64 exec, -1, 0
    buffer_load_dwordx4 v[64:67], v1, s[20:23], s50 offen sc1
    buffer_load_dwordx4 v[68:71], v1, s[20:23], s51 offen sc1
    s_mov_b64 exec, -1
    s_waitcnt lgkmcnt(4)
    v_mfma_f32_32x32x16_bf16 v[32:47], a[24:27], v[24:27], v[32:47]
    ds_read_b64_tr_b16 v[20:21], v8 offset:2048
    ds_read_b64_tr_b16 v[22:23], v8 offset:3072
    v_mov_b32 v14, 2
    s_mov_b64 exec, 1
    buffer_store_dword v14, off, s[16:19], s42
    s_mov_b64 exec, -1
    s_waitcnt lgkmcnt(4)
    v_mfma_f32_32x32x16_bf16 v[32:47], a[28:31], v[28:31], v[32:47]
    s_barrier
    s_waitcnt lgkmcnt(2)
    v_mfma_f32_32x32x16_bf16 v[32:47], v[104:107], v[16:19], v[32:47]
    ds_read_b64_tr_b16 v[24:25], v8 offset:8192
    ds_read_b64_tr_b16 v[26:27], v8 offset:9216
    ds_read_b64_tr_b16 v[28:29], v8 offset:10240
    ds_read_b64_tr_b16 v[30:31], v8 offset:11264
    s_add_u32 m0, s52, 0
    s_add_u32 s49, s68, s75
    buffer_load_dwordx4 v2, s[12:15], s49 offen lds
    s_waitcnt lgkmcnt(4)
    v_mfma_f32_32x32x16_bf16 v[32:47], v[108:111], v[20:23], v[32:47]
    ds_read_b64_tr_b16 v[16:17], v11 offset:0
    ds_read_b64_tr_b16 v[18:19], v11 offset:1024
    s_add_u32 m0, s52, 1024
    s_add_u32 s49, s68, s75
    s_add_u32 s49, s49, 9216
    buffer_load_dwordx4 v2, s[12:15], s49 offen lds
    s_waitcnt lgkmcnt(4)
    v_mfma_f32_32x32x16_bf16 v[32:47], a[48:51], v[24:27], v[32:47]
    ds_read_b64_tr_b16 v[20:21], v11 offset:2048
    ds_read_b64_tr_b16 v[22:23], v11 offset:3072
    s_waitcnt lgkmcnt(4)
    v_mfma_f32_32x32x16_bf16 v[32:47], a[52:55], v[28:31], v[32:47]
    ds_read_b64_tr_b16 v[24:25], v11 offset:8192
    ds_read_b64_tr_b16 v[26:27], v11 offset:9216
    s_waitcnt lgkmcnt(4)
    v_mfma_f32_32x32x16_bf16 v[32:47], a[32:35], v[16:19], v[32:47]
    ds_read_b64_tr_b16 v[28:29], v11 offset:10240
    ds_read_b64_tr_b16 v[30:31], v11 offset:11264
    s_waitcnt lgkmcnt(4)
    v_mfma_f32_32x32x16_bf16 v[32:47], a[36:39], v[20:23], v[32:47]
    ds_read_b64_tr_b16 v[16:17], v6 offset:16384
    ds_read_b64_tr_b16 v[18:19], v6 offset:17408
    s_waitcnt lgkmcnt(4)
    v_mfma_f32_32x32x16_bf16 v[32:47], a[40:43], v[24:27], v[32:47]
    ds_read_b64_tr_b16 v[20:21], v6 offset:18432
    ds_read_b64_tr_b16 v[22:23], v6 offset:19456
    s_waitcnt lgkmcnt(4)
    v_mfma_f32_32x32x16_bf16 v[32:47], a[44:47], v[28:31], v[32:47]
    s_barrier
    s_waitcnt lgkmcnt(2)
    v_mfma_f32_32x32x16_bf16 v[48:63], v[72:75], v[16:19], 0
    ds_read_b64_tr_b16 v[24:25], v6 offset:24576
    ds_read_b64_tr_b16 v[26:27], v6 offset:25600
    ds_read_b64_tr_b16 v[28:29], v6 offset:26624
    ds_read_b64_tr_b16 v[30:31], v6 offset:27648
    s_add_u32 m0, s52, 131072
    s_add_u32 s49, s69, s75
    buffer_load_dwordx4 v2, s[12:15], s49 offen lds
    s_waitcnt lgkmcnt(4)
    v_mfma_f32_32x32x16_bf16 v[48:63], v[76:79], v[20:23], v[48:63]
    ds_read_b64_tr_b16 v[16:17], v9 offset:16384
    ds_read_b64_tr_b16 v[18:19], v9 offset:17408
    s_add_u32 m0, s52, 132096
    s_add_u32 s49, s69, s75
    s_add_u32 s49, s49, 9216
    buffer_load_dwordx4 v2, s[12:15], s49 offen lds
    s_waitcnt lgkmcnt(4)
    v_mfma_f32_32x32x16_bf16 v[48:63], v[80:83], v[24:27], v[48:63]
    ds_read_b64_tr_b16 v[20:21], v9 offset:18432
    ds_read_b64_tr_b16 v[22:23], v9 offset:19456
    s_waitcnt vmcnt(5)
    v_fma_mix_f32 v32, v64, 1.0, v32 op_sel:[0,0,0] op_sel_hi:[1,0,0]
    v_fma_mix_f32 v33, v64, 1.0, v33 op_sel:[1,0,0] op_sel_hi:[1,0,0]
    v_fma_mix_f32 v34, v65, 1.0, v34 op_sel:[0,0,0] op_sel_hi:[1,0,0]
    s_waitcnt lgkmcnt(4)
    v_mfma_f32_32x32x16_bf16 v[48:63], v[84:87], v[28:31], v[48:63]
    ds_read_b64_tr_b16 v[24:25], v9 offset:24576
    ds_read_b64_tr_b16 v[26:27], v9 offset:25600
    v_fma_mix_f32 v35, v65, 1.0, v35 op_sel:[1,0,0] op_sel_hi:[1,0,0]
    v_fma_mix_f32 v36, v66, 1.0, v36 op_sel:[0,0,0] op_sel_hi:[1,0,0]
    v_fma_mix_f32 v37, v66, 1.0, v37 op_sel:[1,0,0] op_sel_hi:[1,0,0]
    v_fma_mix_f32 v38, v67, 1.0, v38 op_sel:[0,0,0] op_sel_hi:[1,0,0]
    s_waitcnt lgkmcnt(4)
    v_mfma_f32_32x32x16_bf16 v[48:63], a[0:3], v[16:19], v[48:63]
    ds_read_b64_tr_b16 v[28:29], v9 offset:26624
    ds_read_b64_tr_b16 v[30:31], v9 offset:27648
    v_fma_mix_f32 v39, v67, 1.0, v39 op_sel:[1,0,0] op_sel_hi:[1,0,0]
    v_fma_mix_f32 v40, v68, 1.0, v40 op_sel:[0,0,0] op_sel_hi:[1,0,0]
    v_fma_mix_f32 v41, v68, 1.0, v41 op_sel:[1,0,0] op_sel_hi:[1,0,0]
    v_fma_mix_f32 v42, v69, 1.0, v42 op_sel:[0,0,0] op_sel_hi:[1,0,0]
    s_waitcnt lgkmcnt(4)
    v_mfma_f32_32x32x16_bf16 v[48:63], a[4:7], v[20:23], v[48:63]
    ds_read_b64_tr_b16 v[16:17], v6 offset:49152
    ds_read_b64_tr_b16 v[18:19], v6 offset:50176
    v_fma_mix_f32 v43, v69, 1.0, v43 op_sel:[1,0,0] op_sel_hi:[1,0,0]
    v_fma_mix_f32 v44, v70, 1.0, v44 op_sel:[0,0,0] op_sel_hi:[1,0,0]
    v_fma_mix_f32 v45, v70, 1.0, v45 op_sel:[1,0,0] op_sel_hi:[1,0,0]
    v_fma_mix_f32 v46, v71, 1.0, v46 op_sel:[0,0,0] op_sel_hi:[1,0,0]
    v_fma_mix_f32 v47, v71, 1.0, v47 op_sel:[1,0,0] op_sel_hi:[1,0,0]
    buffer_load_dword v13, off, s[16:19], s43 sc1
    s_waitcnt lgkmcnt(4)
    v_mfma_f32_32x32x16_bf16 v[48:63], a[8:11], v[24:27], v[48:63]
    ds_read_b64_tr_b16 v[20:21], v6 offset:51200
    ds_read_b64_tr_b16 v[22:23], v6 offset:52224
    v_cvt_pk_f16_f32 v32, v32, v33
    v_cvt_pk_f16_f32 v33, v34, v35
    v_cvt_pk_f16_f32 v34, v36, v37
    v_cvt_pk_f16_f32 v35, v38, v39
    s_waitcnt lgkmcnt(4)
    v_mfma_f32_32x32x16_bf16 v[48:63], a[12:15], v[28:31], v[48:63]
    s_barrier
    s_waitcnt lgkmcnt(2)
    v_mfma_f32_32x32x16_bf16 v[48:63], v[88:91], v[16:19], v[48:63]
    ds_read_b64_tr_b16 v[24:25], v6 offset:57344
    ds_read_b64_tr_b16 v[26:27], v6 offset:58368
    ds_read_b64_tr_b16 v[28:29], v6 offset:59392
    ds_read_b64_tr_b16 v[30:31], v6 offset:60416
    v_cvt_pk_f16_f32 v36, v40, v41
    v_cvt_pk_f16_f32 v37, v42, v43
    v_cvt_pk_f16_f32 v38, v44, v45
    v_cvt_pk_f16_f32 v39, v46, v47
    s_lshl_b32 s50, s72, s8
    s_add_u32 s50, s50, s56
    s_add_u32 s51, s50, s9
    buffer_store_dwordx4 v[32:35], v1, s[20:23], s50 offen
    buffer_store_dwordx4 v[36:39], v1, s[20:23], s51 offen
    s_add_u32 m0, s52, 16384
    s_add_u32 s49, s67, s76
    buffer_load_dwordx4 v2, s[12:15], s49 offen lds
    s_waitcnt lgkmcnt(4)
    v_mfma_f32_32x32x16_bf16 v[48:63], v[92:95], v[20:23], v[48:63]
    ds_read_b64_tr_b16 v[16:17], v9 offset:49152
    ds_read_b64_tr_b16 v[18:19], v9 offset:50176
    s_add_u32 m0, s52, 17408
    s_add_u32 s49, s67, s76
    s_add_u32 s49, s49, 9216
    buffer_load_dwordx4 v2, s[12:15], s49 offen lds
    s_waitcnt lgkmcnt(4)
    v_mfma_f32_32x32x16_bf16 v[48:63], v[96:99], v[24:27], v[48:63]
    ds_read_b64_tr_b16 v[20:21], v9 offset:51200
    ds_read_b64_tr_b16 v[22:23], v9 offset:52224
    s_waitcnt lgkmcnt(4)
    v_mfma_f32_32x32x16_bf16 v[48:63], v[100:103], v[28:31], v[48:63]
    ds_read_b64_tr_b16 v[24:25], v9 offset:57344
    ds_read_b64_tr_b16 v[26:27], v9 offset:58368
    s_waitcnt lgkmcnt(4)
    v_mfma_f32_32x32x16_bf16 v[48:63], a[16:19], v[16:19], v[48:63]
    ds_read_b64_tr_b16 v[28:29], v9 offset:59392
    ds_read_b64_tr_b16 v[30:31], v9 offset:60416
    s_waitcnt lgkmcnt(4)
    v_mfma_f32_32x32x16_bf16 v[48:63], a[20:23], v[20:23], v[48:63]
    ds_read_b64_tr_b16 v[16:17], v7 offset:0
    ds_read_b64_tr_b16 v[18:19], v7 offset:1024
    s_waitcnt vmcnt(4)
.sp_9:
    v_readfirstlane_b32 s50, v13
    s_add_u32 s50, s50, s100
    s_cmp_ge_u32 s50, 4
    s_cbranch_scc1 .ok_10
    s_sub_u32 s82, s82, 1
    s_cmp_lt_i32 s82, 1
    s_cbranch_scc1 .ok_10
    buffer_load_dword v13, off, s[16:19], s43 sc1
    s_waitcnt vmcnt(0)
    s_branch .sp_9

.ok_10:
    s_lshl_b32 s50, s73, s8
    s_add_u32 s50, s50, s56
    s_add_u32 s51, s50, s9
    buffer_load_dwordx4 v[64:67], v1, s[20:23], s50 offen sc1
    buffer_load_dwordx4 v[68:71], v1, s[20:23], s51 offen sc1
    s_waitcnt lgkmcnt(4)
    v_mfma_f32_32x32x16_bf16 v[48:63], a[24:27], v[24:27], v[48:63]
    ds_read_b64_tr_b16 v[20:21], v7 offset:2048
    ds_read_b64_tr_b16 v[22:23], v7 offset:3072
    v_mov_b32 v14, 3
    s_waitcnt vmcnt(4)
    s_mov_b64 exec, 1
    buffer_store_dword v14, off, s[16:19], s42
    s_mov_b64 exec, -1
    s_waitcnt lgkmcnt(4)
    v_mfma_f32_32x32x16_bf16 v[48:63], a[28:31], v[28:31], v[48:63]
    s_barrier
    s_waitcnt lgkmcnt(2)
    v_mfma_f32_32x32x16_bf16 v[48:63], v[104:107], v[16:19], v[48:63]
    ds_read_b64_tr_b16 v[24:25], v7 offset:8192
    ds_read_b64_tr_b16 v[26:27], v7 offset:9216
    ds_read_b64_tr_b16 v[28:29], v7 offset:10240
    ds_read_b64_tr_b16 v[30:31], v7 offset:11264
    s_add_u32 m0, s52, 49152
    s_add_u32 s49, s68, s76
    buffer_load_dwordx4 v2, s[12:15], s49 offen lds
    s_waitcnt lgkmcnt(4)
    v_mfma_f32_32x32x16_bf16 v[48:63], v[108:111], v[20:23], v[48:63]
    ds_read_b64_tr_b16 v[16:17], v10 offset:0
    ds_read_b64_tr_b16 v[18:19], v10 offset:1024
    s_add_u32 m0, s52, 50176
    s_add_u32 s49, s68, s76
    s_add_u32 s49, s49, 9216
    buffer_load_dwordx4 v2, s[12:15], s49 offen lds
    s_waitcnt lgkmcnt(4)
    v_mfma_f32_32x32x16_bf16 v[48:63], a[48:51], v[24:27], v[48:63]
    ds_read_b64_tr_b16 v[20:21], v10 offset:2048
    ds_read_b64_tr_b16 v[22:23], v10 offset:3072
    s_waitcnt lgkmcnt(4)
    v_mfma_f32_32x32x16_bf16 v[48:63], a[52:55], v[28:31], v[48:63]
    ds_read_b64_tr_b16 v[24:25], v10 offset:8192
    ds_read_b64_tr_b16 v[26:27], v10 offset:9216
    s_waitcnt lgkmcnt(4)
    v_mfma_f32_32x32x16_bf16 v[48:63], a[32:35], v[16:19], v[48:63]
    ds_read_b64_tr_b16 v[28:29], v10 offset:10240
    ds_read_b64_tr_b16 v[30:31], v10 offset:11264
    s_waitcnt lgkmcnt(4)
    v_mfma_f32_32x32x16_bf16 v[48:63], a[36:39], v[20:23], v[48:63]
    ds_read_b64_tr_b16 v[16:17], v7 offset:16384
    ds_read_b64_tr_b16 v[18:19], v7 offset:17408
    s_waitcnt lgkmcnt(4)
    v_mfma_f32_32x32x16_bf16 v[48:63], a[40:43], v[24:27], v[48:63]
    ds_read_b64_tr_b16 v[20:21], v7 offset:18432
    ds_read_b64_tr_b16 v[22:23], v7 offset:19456
    s_waitcnt lgkmcnt(4)
    v_mfma_f32_32x32x16_bf16 v[48:63], a[44:47], v[28:31], v[48:63]
    s_barrier
    s_waitcnt lgkmcnt(2)
    v_mfma_f32_32x32x16_bf16 v[32:47], v[72:75], v[16:19], 0
    ds_read_b64_tr_b16 v[24:25], v7 offset:24576
    ds_read_b64_tr_b16 v[26:27], v7 offset:25600
    ds_read_b64_tr_b16 v[28:29], v7 offset:26624
    ds_read_b64_tr_b16 v[30:31], v7 offset:27648
    s_add_u32 m0, s52, 65536
    s_add_u32 s49, s69, s76
    buffer_load_dwordx4 v2, s[12:15], s49 offen lds
    s_waitcnt lgkmcnt(4)
    v_mfma_f32_32x32x16_bf16 v[32:47], v[76:79], v[20:23], v[32:47]
    ds_read_b64_tr_b16 v[16:17], v10 offset:16384
    ds_read_b64_tr_b16 v[18:19], v10 offset:17408
    s_add_u32 m0, s52, 66560
    s_add_u32 s49, s69, s76
    s_add_u32 s49, s49, 9216
    buffer_load_dwordx4 v2, s[12:15], s49 offen lds
    s_waitcnt lgkmcnt(4)
    v_mfma_f32_32x32x16_bf16 v[32:47], v[80:83], v[24:27], v[32:47]
    ds_read_b64_tr_b16 v[20:21], v10 offset:18432
    ds_read_b64_tr_b16 v[22:23], v10 offset:19456
    s_waitcnt vmcnt(5)
    v_fma_mix_f32 v48, v64, 1.0, v48 op_sel:[0,0,0] op_sel_hi:[1,0,0]
    v_fma_mix_f32 v49, v64, 1.0, v49 op_sel:[1,0,0] op_sel_hi:[1,0,0]
    v_fma_mix_f32 v50, v65, 1.0, v50 op_sel:[0,0,0] op_sel_hi:[1,0,0]
    s_waitcnt lgkmcnt(4)
    v_mfma_f32_32x32x16_bf16 v[32:47], v[84:87], v[28:31], v[32:47]
    ds_read_b64_tr_b16 v[24:25], v10 offset:24576
    ds_read_b64_tr_b16 v[26:27], v10 offset:25600
    v_fma_mix_f32 v51, v65, 1.0, v51 op_sel:[1,0,0] op_sel_hi:[1,0,0]
    v_fma_mix_f32 v52, v66, 1.0, v52 op_sel:[0,0,0] op_sel_hi:[1,0,0]
    v_fma_mix_f32 v53, v66, 1.0, v53 op_sel:[1,0,0] op_sel_hi:[1,0,0]
    v_fma_mix_f32 v54, v67, 1.0, v54 op_sel:[0,0,0] op_sel_hi:[1,0,0]
    s_waitcnt lgkmcnt(4)
    v_mfma_f32_32x32x16_bf16 v[32:47], a[0:3], v[16:19], v[32:47]
    ds_read_b64_tr_b16 v[28:29], v10 offset:26624
    ds_read_b64_tr_b16 v[30:31], v10 offset:27648
    v_fma_mix_f32 v55, v67, 1.0, v55 op_sel:[1,0,0] op_sel_hi:[1,0,0]
    v_fma_mix_f32 v56, v68, 1.0, v56 op_sel:[0,0,0] op_sel_hi:[1,0,0]
    v_fma_mix_f32 v57, v68, 1.0, v57 op_sel:[1,0,0] op_sel_hi:[1,0,0]
    v_fma_mix_f32 v58, v69, 1.0, v58 op_sel:[0,0,0] op_sel_hi:[1,0,0]
    s_waitcnt lgkmcnt(4)
    v_mfma_f32_32x32x16_bf16 v[32:47], a[4:7], v[20:23], v[32:47]
    ds_read_b64_tr_b16 v[16:17], v7 offset:32768
    ds_read_b64_tr_b16 v[18:19], v7 offset:33792
    v_fma_mix_f32 v59, v69, 1.0, v59 op_sel:[1,0,0] op_sel_hi:[1,0,0]
    v_fma_mix_f32 v60, v70, 1.0, v60 op_sel:[0,0,0] op_sel_hi:[1,0,0]
    v_fma_mix_f32 v61, v70, 1.0, v61 op_sel:[1,0,0] op_sel_hi:[1,0,0]
    v_fma_mix_f32 v62, v71, 1.0, v62 op_sel:[0,0,0] op_sel_hi:[1,0,0]
    v_fma_mix_f32 v63, v71, 1.0, v63 op_sel:[1,0,0] op_sel_hi:[1,0,0]
    buffer_load_dword v13, off, s[16:19], s43 sc1
    s_waitcnt lgkmcnt(4)
    v_mfma_f32_32x32x16_bf16 v[32:47], a[8:11], v[24:27], v[32:47]
    ds_read_b64_tr_b16 v[20:21], v7 offset:34816
    ds_read_b64_tr_b16 v[22:23], v7 offset:35840
    v_cvt_pk_f16_f32 v48, v48, v49
    v_cvt_pk_f16_f32 v49, v50, v51
    v_cvt_pk_f16_f32 v50, v52, v53
    v_cvt_pk_f16_f32 v51, v54, v55
    s_waitcnt lgkmcnt(4)
    v_mfma_f32_32x32x16_bf16 v[32:47], a[12:15], v[28:31], v[32:47]
    s_barrier
    s_waitcnt lgkmcnt(2)
    v_mfma_f32_32x32x16_bf16 v[32:47], v[88:91], v[16:19], v[32:47]
    ds_read_b64_tr_b16 v[24:25], v7 offset:40960
    ds_read_b64_tr_b16 v[26:27], v7 offset:41984
    ds_read_b64_tr_b16 v[28:29], v7 offset:43008
    ds_read_b64_tr_b16 v[30:31], v7 offset:44032
    v_cvt_pk_f16_f32 v52, v56, v57
    v_cvt_pk_f16_f32 v53, v58, v59
    v_cvt_pk_f16_f32 v54, v60, v61
    v_cvt_pk_f16_f32 v55, v62, v63
    s_lshl_b32 s50, s73, s8
    s_add_u32 s50, s50, s56
    s_add_u32 s51, s50, s9
    buffer_store_dwordx4 v[48:51], v1, s[20:23], s50 offen
    buffer_store_dwordx4 v[52:55], v1, s[20:23], s51 offen
    s_add_u32 m0, s52, 81920
    s_add_u32 s49, s67, s77
    buffer_load_dwordx4 v2, s[12:15], s49 offen lds
    s_waitcnt lgkmcnt(4)
    v_mfma_f32_32x32x16_bf16 v[32:47], v[92:95], v[20:23], v[32:47]
    ds_read_b64_tr_b16 v[16:17], v10 offset:32768
    ds_read_b64_tr_b16 v[18:19], v10 offset:33792
    s_add_u32 m0, s52, 82944
    s_add_u32 s49, s67, s77
    s_add_u32 s49, s49, 9216
    buffer_load_dwordx4 v2, s[12:15], s49 offen lds
    s_waitcnt lgkmcnt(4)
    v_mfma_f32_32x32x16_bf16 v[32:47], v[96:99], v[24:27], v[32:47]
    ds_read_b64_tr_b16 v[20:21], v10 offset:34816
    ds_read_b64_tr_b16 v[22:23], v10 offset:35840
    s_waitcnt lgkmcnt(4)
    v_mfma_f32_32x32x16_bf16 v[32:47], v[100:103], v[28:31], v[32:47]
    ds_read_b64_tr_b16 v[24:25], v10 offset:40960
    ds_read_b64_tr_b16 v[26:27], v10 offset:41984
    s_waitcnt lgkmcnt(4)
    v_mfma_f32_32x32x16_bf16 v[32:47], a[16:19], v[16:19], v[32:47]
    ds_read_b64_tr_b16 v[28:29], v10 offset:43008
    ds_read_b64_tr_b16 v[30:31], v10 offset:44032
    s_waitcnt lgkmcnt(4)
    v_mfma_f32_32x32x16_bf16 v[32:47], a[20:23], v[20:23], v[32:47]
    ds_read_b64_tr_b16 v[16:17], v7 offset:49152
    ds_read_b64_tr_b16 v[18:19], v7 offset:50176
    s_waitcnt vmcnt(4)
.sp_11:
    v_readfirstlane_b32 s50, v13
    s_add_u32 s50, s50, s100
    s_cmp_ge_u32 s50, 5
    s_cbranch_scc1 .ok_12
    s_sub_u32 s82, s82, 1
    s_cmp_lt_i32 s82, 1
    s_cbranch_scc1 .ok_12
    buffer_load_dword v13, off, s[16:19], s43 sc1
    s_waitcnt vmcnt(0)
    s_branch .sp_11

.ok_12:
    s_lshl_b32 s50, s74, s8
    s_add_u32 s50, s50, s56
    s_add_u32 s51, s50, s9
    buffer_load_dwordx4 v[64:67], v1, s[20:23], s50 offen sc1
    buffer_load_dwordx4 v[68:71], v1, s[20:23], s51 offen sc1
    s_waitcnt lgkmcnt(4)
    v_mfma_f32_32x32x16_bf16 v[32:47], a[24:27], v[24:27], v[32:47]
    ds_read_b64_tr_b16 v[20:21], v7 offset:51200
    ds_read_b64_tr_b16 v[22:23], v7 offset:52224
    v_mov_b32 v14, 4
    s_waitcnt vmcnt(4)
    s_mov_b64 exec, 1
    buffer_store_dword v14, off, s[16:19], s42
    s_mov_b64 exec, -1
    s_waitcnt lgkmcnt(4)
    v_mfma_f32_32x32x16_bf16 v[32:47], a[28:31], v[28:31], v[32:47]
    s_barrier
    s_waitcnt lgkmcnt(2)
    v_mfma_f32_32x32x16_bf16 v[32:47], v[104:107], v[16:19], v[32:47]
    ds_read_b64_tr_b16 v[24:25], v7 offset:57344
    ds_read_b64_tr_b16 v[26:27], v7 offset:58368
    ds_read_b64_tr_b16 v[28:29], v7 offset:59392
    ds_read_b64_tr_b16 v[30:31], v7 offset:60416
    s_add_u32 m0, s52, 98304
    s_add_u32 s49, s68, s77
    buffer_load_dwordx4 v2, s[12:15], s49 offen lds
    s_waitcnt lgkmcnt(4)
    v_mfma_f32_32x32x16_bf16 v[32:47], v[108:111], v[20:23], v[32:47]
    ds_read_b64_tr_b16 v[16:17], v10 offset:49152
    ds_read_b64_tr_b16 v[18:19], v10 offset:50176
    s_add_u32 m0, s52, 99328
    s_add_u32 s49, s68, s77
    s_add_u32 s49, s49, 9216
    buffer_load_dwordx4 v2, s[12:15], s49 offen lds
    s_waitcnt lgkmcnt(4)
    v_mfma_f32_32x32x16_bf16 v[32:47], a[48:51], v[24:27], v[32:47]
    ds_read_b64_tr_b16 v[20:21], v10 offset:51200
    ds_read_b64_tr_b16 v[22:23], v10 offset:52224
    s_waitcnt lgkmcnt(4)
    v_mfma_f32_32x32x16_bf16 v[32:47], a[52:55], v[28:31], v[32:47]
    ds_read_b64_tr_b16 v[24:25], v10 offset:57344
    ds_read_b64_tr_b16 v[26:27], v10 offset:58368
    s_waitcnt lgkmcnt(4)
    v_mfma_f32_32x32x16_bf16 v[32:47], a[32:35], v[16:19], v[32:47]
    ds_read_b64_tr_b16 v[28:29], v10 offset:59392
    ds_read_b64_tr_b16 v[30:31], v10 offset:60416
    s_waitcnt lgkmcnt(4)
    v_mfma_f32_32x32x16_bf16 v[32:47], a[36:39], v[20:23], v[32:47]
    ds_read_b64_tr_b16 v[16:17], v6 offset:32768
    ds_read_b64_tr_b16 v[18:19], v6 offset:33792
    s_waitcnt lgkmcnt(4)
    v_mfma_f32_32x32x16_bf16 v[32:47], a[40:43], v[24:27], v[32:47]
    ds_read_b64_tr_b16 v[20:21], v6 offset:34816
    ds_read_b64_tr_b16 v[22:23], v6 offset:35840
    s_waitcnt lgkmcnt(4)
    v_mfma_f32_32x32x16_bf16 v[32:47], a[44:47], v[28:31], v[32:47]
    s_barrier
    s_waitcnt lgkmcnt(2)
    v_mfma_f32_32x32x16_bf16 v[48:63], v[72:75], v[16:19], 0
    ds_read_b64_tr_b16 v[24:25], v6 offset:40960
    ds_read_b64_tr_b16 v[26:27], v6 offset:41984
    ds_read_b64_tr_b16 v[28:29], v6 offset:43008
    ds_read_b64_tr_b16 v[30:31], v6 offset:44032
    s_add_u32 m0, s52, 114688
    s_add_u32 s49, s69, s77
    buffer_load_dwordx4 v2, s[12:15], s49 offen lds
    s_waitcnt lgkmcnt(4)
    v_mfma_f32_32x32x16_bf16 v[48:63], v[76:79], v[20:23], v[48:63]
    ds_read_b64_tr_b16 v[16:17], v9 offset:32768
    ds_read_b64_tr_b16 v[18:19], v9 offset:33792
    s_add_u32 m0, s52, 115712
    s_add_u32 s49, s69, s77
    s_add_u32 s49, s49, 9216
    buffer_load_dwordx4 v2, s[12:15], s49 offen lds
    s_waitcnt lgkmcnt(4)
    v_mfma_f32_32x32x16_bf16 v[48:63], v[80:83], v[24:27], v[48:63]
    ds_read_b64_tr_b16 v[20:21], v9 offset:34816
    ds_read_b64_tr_b16 v[22:23], v9 offset:35840
    s_waitcnt vmcnt(5)
    v_fma_mix_f32 v32, v64, 1.0, v32 op_sel:[0,0,0] op_sel_hi:[1,0,0]
    v_fma_mix_f32 v33, v64, 1.0, v33 op_sel:[1,0,0] op_sel_hi:[1,0,0]
    v_fma_mix_f32 v34, v65, 1.0, v34 op_sel:[0,0,0] op_sel_hi:[1,0,0]
    s_waitcnt lgkmcnt(4)
    v_mfma_f32_32x32x16_bf16 v[48:63], v[84:87], v[28:31], v[48:63]
    ds_read_b64_tr_b16 v[24:25], v9 offset:40960
    ds_read_b64_tr_b16 v[26:27], v9 offset:41984
    v_fma_mix_f32 v35, v65, 1.0, v35 op_sel:[1,0,0] op_sel_hi:[1,0,0]
    v_fma_mix_f32 v36, v66, 1.0, v36 op_sel:[0,0,0] op_sel_hi:[1,0,0]
    v_fma_mix_f32 v37, v66, 1.0, v37 op_sel:[1,0,0] op_sel_hi:[1,0,0]
    v_fma_mix_f32 v38, v67, 1.0, v38 op_sel:[0,0,0] op_sel_hi:[1,0,0]
    s_waitcnt lgkmcnt(4)
    v_mfma_f32_32x32x16_bf16 v[48:63], a[0:3], v[16:19], v[48:63]
    ds_read_b64_tr_b16 v[28:29], v9 offset:43008
    ds_read_b64_tr_b16 v[30:31], v9 offset:44032
    v_fma_mix_f32 v39, v67, 1.0, v39 op_sel:[1,0,0] op_sel_hi:[1,0,0]
    v_fma_mix_f32 v40, v68, 1.0, v40 op_sel:[0,0,0] op_sel_hi:[1,0,0]
    v_fma_mix_f32 v41, v68, 1.0, v41 op_sel:[1,0,0] op_sel_hi:[1,0,0]
    v_fma_mix_f32 v42, v69, 1.0, v42 op_sel:[0,0,0] op_sel_hi:[1,0,0]
    s_waitcnt lgkmcnt(4)
    v_mfma_f32_32x32x16_bf16 v[48:63], a[4:7], v[20:23], v[48:63]
    ds_read_b64_tr_b16 v[16:17], v6 offset:0
    ds_read_b64_tr_b16 v[18:19], v6 offset:1024
    v_fma_mix_f32 v43, v69, 1.0, v43 op_sel:[1,0,0] op_sel_hi:[1,0,0]
    v_fma_mix_f32 v44, v70, 1.0, v44 op_sel:[0,0,0] op_sel_hi:[1,0,0]
    v_fma_mix_f32 v45, v70, 1.0, v45 op_sel:[1,0,0] op_sel_hi:[1,0,0]
    v_fma_mix_f32 v46, v71, 1.0, v46 op_sel:[0,0,0] op_sel_hi:[1,0,0]
    v_fma_mix_f32 v47, v71, 1.0, v47 op_sel:[1,0,0] op_sel_hi:[1,0,0]
    buffer_load_dword v13, off, s[16:19], s43 sc1
    s_waitcnt lgkmcnt(4)
    v_mfma_f32_32x32x16_bf16 v[48:63], a[8:11], v[24:27], v[48:63]
    ds_read_b64_tr_b16 v[20:21], v6 offset:2048
    ds_read_b64_tr_b16 v[22:23], v6 offset:3072
    v_cvt_pk_f16_f32 v32, v32, v33
    v_cvt_pk_f16_f32 v33, v34, v35
    v_cvt_pk_f16_f32 v34, v36, v37
    v_cvt_pk_f16_f32 v35, v38, v39
    s_waitcnt lgkmcnt(4)
    v_mfma_f32_32x32x16_bf16 v[48:63], a[12:15], v[28:31], v[48:63]
    s_barrier
    s_waitcnt lgkmcnt(2)
    v_mfma_f32_32x32x16_bf16 v[48:63], v[88:91], v[16:19], v[48:63]
    ds_read_b64_tr_b16 v[24:25], v6 offset:8192
    ds_read_b64_tr_b16 v[26:27], v6 offset:9216
    ds_read_b64_tr_b16 v[28:29], v6 offset:10240
    ds_read_b64_tr_b16 v[30:31], v6 offset:11264
    v_cvt_pk_f16_f32 v36, v40, v41
    v_cvt_pk_f16_f32 v37, v42, v43
    v_cvt_pk_f16_f32 v38, v44, v45
    v_cvt_pk_f16_f32 v39, v46, v47
    s_lshl_b32 s50, s74, s8
    s_add_u32 s50, s50, s56
    s_add_u32 s51, s50, s9
    buffer_store_dwordx4 v[32:35], v1, s[20:23], s50 offen
    buffer_store_dwordx4 v[36:39], v1, s[20:23], s51 offen
    s_add_u32 m0, s52, 32768
    s_add_u32 s49, s67, s78
    buffer_load_dwordx4 v2, s[12:15], s49 offen lds
    s_waitcnt lgkmcnt(4)
    v_mfma_f32_32x32x16_bf16 v[48:63], v[92:95], v[20:23], v[48:63]
    ds_read_b64_tr_b16 v[16:17], v9 offset:0
    ds_read_b64_tr_b16 v[18:19], v9 offset:1024
    s_add_u32 m0, s52, 33792
    s_add_u32 s49, s67, s78
    s_add_u32 s49, s49, 9216
    buffer_load_dwordx4 v2, s[12:15], s49 offen lds
    s_waitcnt lgkmcnt(4)
    v_mfma_f32_32x32x16_bf16 v[48:63], v[96:99], v[24:27], v[48:63]
    ds_read_b64_tr_b16 v[20:21], v9 offset:2048
    ds_read_b64_tr_b16 v[22:23], v9 offset:3072
    s_waitcnt lgkmcnt(4)
    v_mfma_f32_32x32x16_bf16 v[48:63], v[100:103], v[28:31], v[48:63]
    ds_read_b64_tr_b16 v[24:25], v9 offset:8192
    ds_read_b64_tr_b16 v[26:27], v9 offset:9216
    s_waitcnt lgkmcnt(4)
    v_mfma_f32_32x32x16_bf16 v[48:63], a[16:19], v[16:19], v[48:63]
    ds_read_b64_tr_b16 v[28:29], v9 offset:10240
    ds_read_b64_tr_b16 v[30:31], v9 offset:11264
    s_waitcnt lgkmcnt(4)
    v_mfma_f32_32x32x16_bf16 v[48:63], a[20:23], v[20:23], v[48:63]
    ds_read_b64_tr_b16 v[16:17], v8 offset:0
    ds_read_b64_tr_b16 v[18:19], v8 offset:1024
    s_waitcnt vmcnt(4)
.sp_13:
    v_readfirstlane_b32 s50, v13
    s_add_u32 s50, s50, s100
    s_cmp_ge_u32 s50, 6
    s_cbranch_scc1 .ok_14
    s_sub_u32 s82, s82, 1
    s_cmp_lt_i32 s82, 1
    s_cbranch_scc1 .ok_14
    buffer_load_dword v13, off, s[16:19], s43 sc1
    s_waitcnt vmcnt(0)
    s_branch .sp_13

.ok_14:
    s_lshl_b32 s50, s75, s8
    s_add_u32 s50, s50, s56
    s_add_u32 s51, s50, s9
    buffer_load_dwordx4 v[64:67], v1, s[20:23], s50 offen sc1
    buffer_load_dwordx4 v[68:71], v1, s[20:23], s51 offen sc1
    s_waitcnt lgkmcnt(4)
    v_mfma_f32_32x32x16_bf16 v[48:63], a[24:27], v[24:27], v[48:63]
    ds_read_b64_tr_b16 v[20:21], v8 offset:2048
    ds_read_b64_tr_b16 v[22:23], v8 offset:3072
    v_mov_b32 v14, 5
    s_waitcnt vmcnt(4)
    s_mov_b64 exec, 1
    buffer_store_dword v14, off, s[16:19], s42
    s_mov_b64 exec, -1
    s_waitcnt lgkmcnt(4)
    v_mfma_f32_32x32x16_bf16 v[48:63], a[28:31], v[28:31], v[48:63]
    s_barrier
    s_waitcnt lgkmcnt(2)
    v_mfma_f32_32x32x16_bf16 v[48:63], v[104:107], v[16:19], v[48:63]
    ds_read_b64_tr_b16 v[24:25], v8 offset:8192
    ds_read_b64_tr_b16 v[26:27], v8 offset:9216
    ds_read_b64_tr_b16 v[28:29], v8 offset:10240
    ds_read_b64_tr_b16 v[30:31], v8 offset:11264
    s_add_u32 m0, s52, 0
    s_add_u32 s49, s68, s78
    buffer_load_dwordx4 v2, s[12:15], s49 offen lds
    s_waitcnt lgkmcnt(4)
    v_mfma_f32_32x32x16_bf16 v[48:63], v[108:111], v[20:23], v[48:63]
    ds_read_b64_tr_b16 v[16:17], v11 offset:0
    ds_read_b64_tr_b16 v[18:19], v11 offset:1024
    s_add_u32 m0, s52, 1024
    s_add_u32 s49, s68, s78
    s_add_u32 s49, s49, 9216
    buffer_load_dwordx4 v2, s[12:15], s49 offen lds
    s_waitcnt lgkmcnt(4)
    v_mfma_f32_32x32x16_bf16 v[48:63], a[48:51], v[24:27], v[48:63]
    ds_read_b64_tr_b16 v[20:21], v11 offset:2048
    ds_read_b64_tr_b16 v[22:23], v11 offset:3072
    s_waitcnt lgkmcnt(4)
    v_mfma_f32_32x32x16_bf16 v[48:63], a[52:55], v[28:31], v[48:63]
    ds_read_b64_tr_b16 v[24:25], v11 offset:8192
    ds_read_b64_tr_b16 v[26:27], v11 offset:9216
    s_waitcnt lgkmcnt(4)
    v_mfma_f32_32x32x16_bf16 v[48:63], a[32:35], v[16:19], v[48:63]
    ds_read_b64_tr_b16 v[28:29], v11 offset:10240
    ds_read_b64_tr_b16 v[30:31], v11 offset:11264
    s_waitcnt lgkmcnt(4)
    v_mfma_f32_32x32x16_bf16 v[48:63], a[36:39], v[20:23], v[48:63]
    ds_read_b64_tr_b16 v[16:17], v6 offset:16384
    ds_read_b64_tr_b16 v[18:19], v6 offset:17408
    s_waitcnt lgkmcnt(4)
    v_mfma_f32_32x32x16_bf16 v[48:63], a[40:43], v[24:27], v[48:63]
    ds_read_b64_tr_b16 v[20:21], v6 offset:18432
    ds_read_b64_tr_b16 v[22:23], v6 offset:19456
    s_waitcnt lgkmcnt(4)
    v_mfma_f32_32x32x16_bf16 v[48:63], a[44:47], v[28:31], v[48:63]
    s_barrier
    s_waitcnt lgkmcnt(2)
    v_mfma_f32_32x32x16_bf16 v[32:47], v[72:75], v[16:19], 0
    ds_read_b64_tr_b16 v[24:25], v6 offset:24576
    ds_read_b64_tr_b16 v[26:27], v6 offset:25600
    ds_read_b64_tr_b16 v[28:29], v6 offset:26624
    ds_read_b64_tr_b16 v[30:31], v6 offset:27648
    s_add_u32 m0, s52, 131072
    s_add_u32 s49, s69, s78
    buffer_load_dwordx4 v2, s[12:15], s49 offen lds
    s_waitcnt lgkmcnt(4)
    v_mfma_f32_32x32x16_bf16 v[32:47], v[76:79], v[20:23], v[32:47]
    ds_read_b64_tr_b16 v[16:17], v9 offset:16384
    ds_read_b64_tr_b16 v[18:19], v9 offset:17408
    s_add_u32 m0, s52, 132096
    s_add_u32 s49, s69, s78
    s_add_u32 s49, s49, 9216
    buffer_load_dwordx4 v2, s[12:15], s49 offen lds
    s_waitcnt lgkmcnt(4)
    v_mfma_f32_32x32x16_bf16 v[32:47], v[80:83], v[24:27], v[32:47]
    ds_read_b64_tr_b16 v[20:21], v9 offset:18432
    ds_read_b64_tr_b16 v[22:23], v9 offset:19456
    s_waitcnt vmcnt(5)
    v_fma_mix_f32 v48, v64, 1.0, v48 op_sel:[0,0,0] op_sel_hi:[1,0,0]
    v_fma_mix_f32 v49, v64, 1.0, v49 op_sel:[1,0,0] op_sel_hi:[1,0,0]
    v_fma_mix_f32 v50, v65, 1.0, v50 op_sel:[0,0,0] op_sel_hi:[1,0,0]
    s_waitcnt lgkmcnt(4)
    v_mfma_f32_32x32x16_bf16 v[32:47], v[84:87], v[28:31], v[32:47]
    ds_read_b64_tr_b16 v[24:25], v9 offset:24576
    ds_read_b64_tr_b16 v[26:27], v9 offset:25600
    v_fma_mix_f32 v51, v65, 1.0, v51 op_sel:[1,0,0] op_sel_hi:[1,0,0]
    v_fma_mix_f32 v52, v66, 1.0, v52 op_sel:[0,0,0] op_sel_hi:[1,0,0]
    v_fma_mix_f32 v53, v66, 1.0, v53 op_sel:[1,0,0] op_sel_hi:[1,0,0]
    v_fma_mix_f32 v54, v67, 1.0, v54 op_sel:[0,0,0] op_sel_hi:[1,0,0]
    s_waitcnt lgkmcnt(4)
    v_mfma_f32_32x32x16_bf16 v[32:47], a[0:3], v[16:19], v[32:47]
    ds_read_b64_tr_b16 v[28:29], v9 offset:26624
    ds_read_b64_tr_b16 v[30:31], v9 offset:27648
    v_fma_mix_f32 v55, v67, 1.0, v55 op_sel:[1,0,0] op_sel_hi:[1,0,0]
    v_fma_mix_f32 v56, v68, 1.0, v56 op_sel:[0,0,0] op_sel_hi:[1,0,0]
    v_fma_mix_f32 v57, v68, 1.0, v57 op_sel:[1,0,0] op_sel_hi:[1,0,0]
    v_fma_mix_f32 v58, v69, 1.0, v58 op_sel:[0,0,0] op_sel_hi:[1,0,0]
    s_waitcnt lgkmcnt(4)
    v_mfma_f32_32x32x16_bf16 v[32:47], a[4:7], v[20:23], v[32:47]
    ds_read_b64_tr_b16 v[16:17], v6 offset:49152
    ds_read_b64_tr_b16 v[18:19], v6 offset:50176
    v_fma_mix_f32 v59, v69, 1.0, v59 op_sel:[1,0,0] op_sel_hi:[1,0,0]
    v_fma_mix_f32 v60, v70, 1.0, v60 op_sel:[0,0,0] op_sel_hi:[1,0,0]
    v_fma_mix_f32 v61, v70, 1.0, v61 op_sel:[1,0,0] op_sel_hi:[1,0,0]
    v_fma_mix_f32 v62, v71, 1.0, v62 op_sel:[0,0,0] op_sel_hi:[1,0,0]
    v_fma_mix_f32 v63, v71, 1.0, v63 op_sel:[1,0,0] op_sel_hi:[1,0,0]
    buffer_load_dword v13, off, s[16:19], s43 sc1
    s_waitcnt lgkmcnt(4)
    v_mfma_f32_32x32x16_bf16 v[32:47], a[8:11], v[24:27], v[32:47]
    ds_read_b64_tr_b16 v[20:21], v6 offset:51200
    ds_read_b64_tr_b16 v[22:23], v6 offset:52224
    v_cvt_pk_f16_f32 v48, v48, v49
    v_cvt_pk_f16_f32 v49, v50, v51
    v_cvt_pk_f16_f32 v50, v52, v53
    v_cvt_pk_f16_f32 v51, v54, v55
    s_waitcnt lgkmcnt(4)
    v_mfma_f32_32x32x16_bf16 v[32:47], a[12:15], v[28:31], v[32:47]
    s_barrier
    s_waitcnt lgkmcnt(2)
    v_mfma_f32_32x32x16_bf16 v[32:47], v[88:91], v[16:19], v[32:47]
    ds_read_b64_tr_b16 v[24:25], v6 offset:57344
    ds_read_b64_tr_b16 v[26:27], v6 offset:58368
    ds_read_b64_tr_b16 v[28:29], v6 offset:59392
    ds_read_b64_tr_b16 v[30:31], v6 offset:60416
    v_cvt_pk_f16_f32 v52, v56, v57
    v_cvt_pk_f16_f32 v53, v58, v59
    v_cvt_pk_f16_f32 v54, v60, v61
    v_cvt_pk_f16_f32 v55, v62, v63
    s_lshl_b32 s50, s75, s8
    s_add_u32 s50, s50, s56
    s_add_u32 s51, s50, s9
    buffer_store_dwordx4 v[48:51], v1, s[20:23], s50 offen
    buffer_store_dwordx4 v[52:55], v1, s[20:23], s51 offen
    s_waitcnt lgkmcnt(4)
    v_mfma_f32_32x32x16_bf16 v[32:47], v[92:95], v[20:23], v[32:47]
    ds_read_b64_tr_b16 v[16:17], v9 offset:49152
    ds_read_b64_tr_b16 v[18:19], v9 offset:50176
    s_waitcnt lgkmcnt(4)
    v_mfma_f32_32x32x16_bf16 v[32:47], v[96:99], v[24:27], v[32:47]
    ds_read_b64_tr_b16 v[20:21], v9 offset:51200
    ds_read_b64_tr_b16 v[22:23], v9 offset:52224
    s_waitcnt lgkmcnt(4)
    v_mfma_f32_32x32x16_bf16 v[32:47], v[100:103], v[28:31], v[32:47]
    ds_read_b64_tr_b16 v[24:25], v9 offset:57344
    ds_read_b64_tr_b16 v[26:27], v9 offset:58368
    s_waitcnt lgkmcnt(4)
    v_mfma_f32_32x32x16_bf16 v[32:47], a[16:19], v[16:19], v[32:47]
    ds_read_b64_tr_b16 v[28:29], v9 offset:59392
    ds_read_b64_tr_b16 v[30:31], v9 offset:60416
    s_waitcnt lgkmcnt(4)
    v_mfma_f32_32x32x16_bf16 v[32:47], a[20:23], v[20:23], v[32:47]
    ds_read_b64_tr_b16 v[16:17], v7 offset:0
    ds_read_b64_tr_b16 v[18:19], v7 offset:1024
    s_waitcnt vmcnt(2)
.sp_15:
    v_readfirstlane_b32 s50, v13
    s_add_u32 s50, s50, s100
    s_cmp_ge_u32 s50, 7
    s_cbranch_scc1 .ok_16
    s_sub_u32 s82, s82, 1
    s_cmp_lt_i32 s82, 1
    s_cbranch_scc1 .ok_16
    buffer_load_dword v13, off, s[16:19], s43 sc1
    s_waitcnt vmcnt(0)
    s_branch .sp_15

.ok_16:
    s_lshl_b32 s50, s76, s8
    s_add_u32 s50, s50, s56
    s_add_u32 s51, s50, s9
    buffer_load_dwordx4 v[64:67], v1, s[20:23], s50 offen sc1
    buffer_load_dwordx4 v[68:71], v1, s[20:23], s51 offen sc1
    s_waitcnt lgkmcnt(4)
    v_mfma_f32_32x32x16_bf16 v[32:47], a[24:27], v[24:27], v[32:47]
    ds_read_b64_tr_b16 v[20:21], v7 offset:2048
    ds_read_b64_tr_b16 v[22:23], v7 offset:3072
    v_mov_b32 v14, 6
    s_waitcnt vmcnt(2)
    s_mov_b64 exec, 1
    buffer_store_dword v14, off, s[16:19], s42
    s_mov_b64 exec, -1
    v_lshrrev_b32 v4, 8, v12
    v_bfe_u32 v3, v12, 4, 4
    v_lshlrev_b32 v3, 1, v3
    v_lshlrev_b32 v0, 6, v4
    v_mul_u32_u24 v4, 9216, v4
    v_add_u32 v4, v4, v3
    v_lshlrev_b32 v5, 1, v4
    s_lshr_b32 s49, s48, 2
    s_lshr_b32 s51, s48, 3
    s_lshl_b32 s50, s45, 3
    s_add_u32 s50, s50, s51
    s_lshl_b32 s51, s50, 5
    s_add_u32 s51, s51, 153600
    v_add_u32 v0, s51, v0
    s_lshl_b32 s51, s47, 5
    s_add_u32 s50, s50, s51
    s_mul_i32 s64, s50, 4608
    s_lshl_b32 s63, s46, 6
    s_and_b32 s51, s49, 1
    s_lshl_b32 s51, s51, 5
    s_add_u32 s63, s63, s51
    s_add_u32 s64, s64, s63
    s_mul_i32 s65, s47, 147456
    s_lshl_b32 s50, s44, 11
    s_add_u32 s65, s65, s50
    s_lshl_b32 s50, s49, 8
    s_add_u32 s65, s65, s50
    s_add_u32 s65, s65, 4718592
    s_lshl_b32 s49, s49, 2
    s_sub_u32 s62, s42, s49

    ds_read_b128 a[96:99], v0
    ds_read_b128 a[100:103], v0 offset:16
    s_waitcnt lgkmcnt(6)
    v_mfma_f32_32x32x16_bf16 v[32:47], a[28:31], v[28:31], v[32:47]
    s_barrier
    s_waitcnt lgkmcnt(4)
    v_mfma_f32_32x32x16_bf16 v[32:47], v[104:107], v[16:19], v[32:47]
    ds_read_b64_tr_b16 v[24:25], v7 offset:8192
    ds_read_b64_tr_b16 v[26:27], v7 offset:9216
    ds_read_b64_tr_b16 v[28:29], v7 offset:10240
    ds_read_b64_tr_b16 v[30:31], v7 offset:11264
    s_add_u32 s50, s76, s64
    buffer_load_ushort a80, v4, s[4:7], s50 offen offset:0
    buffer_load_ushort a81, v4, s[4:7], s50 offen offset:1152
    buffer_load_ushort a82, v4, s[4:7], s50 offen offset:2304
    buffer_load_ushort a83, v4, s[4:7], s50 offen offset:3456
    s_add_u32 s50, s76, s63
    buffer_load_ushort a84, v3, s[24:27], s50 offen
    s_add_u32 s50, s77, s64
    buffer_load_ushort a85, v4, s[4:7], s50 offen offset:0
    buffer_load_ushort a86, v4, s[4:7], s50 offen offset:1152
    buffer_load_ushort a87, v4, s[4:7], s50 offen offset:2304
    buffer_load_ushort a88, v4, s[4:7], s50 offen offset:3456
    s_add_u32 s50, s77, s63
    buffer_load_ushort a89, v3, s[24:27], s50 offen
    s_waitcnt lgkmcnt(6)
    v_mfma_f32_32x32x16_bf16 v[32:47], v[108:111], v[20:23], v[32:47]
    ds_read_b64_tr_b16 v[16:17], v10 offset:0
    ds_read_b64_tr_b16 v[18:19], v10 offset:1024
    s_add_u32 s50, s78, s64
    buffer_load_ushort a90, v4, s[4:7], s50 offen offset:0
    buffer_load_ushort a91, v4, s[4:7], s50 offen offset:1152
    buffer_load_ushort a92, v4, s[4:7], s50 offen offset:2304
    buffer_load_ushort a93, v4, s[4:7], s50 offen offset:3456
    s_add_u32 s50, s78, s63
    buffer_load_ushort a94, v3, s[24:27], s50 offen
    s_waitcnt lgkmcnt(4)
    v_mfma_f32_32x32x16_bf16 v[32:47], a[48:51], v[24:27], v[32:47]
    ds_read_b64_tr_b16 v[20:21], v10 offset:2048
    ds_read_b64_tr_b16 v[22:23], v10 offset:3072
    s_waitcnt lgkmcnt(4)
    v_mfma_f32_32x32x16_bf16 v[32:47], a[52:55], v[28:31], v[32:47]
    ds_read_b64_tr_b16 v[24:25], v10 offset:8192
    ds_read_b64_tr_b16 v[26:27], v10 offset:9216
    s_waitcnt lgkmcnt(4)
    v_mfma_f32_32x32x16_bf16 v[32:47], a[32:35], v[16:19], v[32:47]
    ds_read_b64_tr_b16 v[28:29], v10 offset:10240
    ds_read_b64_tr_b16 v[30:31], v10 offset:11264
    s_waitcnt lgkmcnt(4)
    v_mfma_f32_32x32x16_bf16 v[32:47], a[36:39], v[20:23], v[32:47]
    ds_read_b64_tr_b16 v[16:17], v7 offset:16384
    ds_read_b64_tr_b16 v[18:19], v7 offset:17408
    s_waitcnt lgkmcnt(4)
    v_mfma_f32_32x32x16_bf16 v[32:47], a[40:43], v[24:27], v[32:47]
    ds_read_b64_tr_b16 v[20:21], v7 offset:18432
    ds_read_b64_tr_b16 v[22:23], v7 offset:19456
    s_waitcnt lgkmcnt(4)
    v_mfma_f32_32x32x16_bf16 v[32:47], a[44:47], v[28:31], v[32:47]
    s_barrier
    s_waitcnt lgkmcnt(2)
    v_mfma_f32_32x32x16_bf16 v[48:63], v[72:75], v[16:19], 0
    ds_read_b64_tr_b16 v[24:25], v7 offset:24576
    ds_read_b64_tr_b16 v[26:27], v7 offset:25600
    ds_read_b64_tr_b16 v[28:29], v7 offset:26624
    ds_read_b64_tr_b16 v[30:31], v7 offset:27648
    s_waitcnt lgkmcnt(4)
    v_mfma_f32_32x32x16_bf16 v[48:63], v[76:79], v[20:23], v[48:63]
    ds_read_b64_tr_b16 v[16:17], v10 offset:16384
    ds_read_b64_tr_b16 v[18:19], v10 offset:17408
    s_waitcnt lgkmcnt(4)
    v_mfma_f32_32x32x16_bf16 v[48:63], v[80:83], v[24:27], v[48:63]
    ds_read_b64_tr_b16 v[20:21], v10 offset:18432
    ds_read_b64_tr_b16 v[22:23], v10 offset:19456
    s_waitcnt vmcnt(16)
    v_fma_mix_f32 v32, v64, 1.0, v32 op_sel:[0,0,0] op_sel_hi:[1,0,0]
    v_fma_mix_f32 v33, v64, 1.0, v33 op_sel:[1,0,0] op_sel_hi:[1,0,0]
    v_fma_mix_f32 v34, v65, 1.0, v34 op_sel:[0,0,0] op_sel_hi:[1,0,0]
    s_waitcnt lgkmcnt(4)
    v_mfma_f32_32x32x16_bf16 v[48:63], v[84:87], v[28:31], v[48:63]
    ds_read_b64_tr_b16 v[24:25], v10 offset:24576
    ds_read_b64_tr_b16 v[26:27], v10 offset:25600
    v_fma_mix_f32 v35, v65, 1.0, v35 op_sel:[1,0,0] op_sel_hi:[1,0,0]
    v_fma_mix_f32 v36, v66, 1.0, v36 op_sel:[0,0,0] op_sel_hi:[1,0,0]
    v_fma_mix_f32 v37, v66, 1.0, v37 op_sel:[1,0,0] op_sel_hi:[1,0,0]
    v_fma_mix_f32 v38, v67, 1.0, v38 op_sel:[0,0,0] op_sel_hi:[1,0,0]
    s_waitcnt lgkmcnt(4)
    v_mfma_f32_32x32x16_bf16 v[48:63], a[0:3], v[16:19], v[48:63]
    ds_read_b64_tr_b16 v[28:29], v10 offset:26624
    ds_read_b64_tr_b16 v[30:31], v10 offset:27648
    v_fma_mix_f32 v39, v67, 1.0, v39 op_sel:[1,0,0] op_sel_hi:[1,0,0]
    v_fma_mix_f32 v40, v68, 1.0, v40 op_sel:[0,0,0] op_sel_hi:[1,0,0]
    v_fma_mix_f32 v41, v68, 1.0, v41 op_sel:[1,0,0] op_sel_hi:[1,0,0]
    v_fma_mix_f32 v42, v69, 1.0, v42 op_sel:[0,0,0] op_sel_hi:[1,0,0]
    s_waitcnt lgkmcnt(4)
    v_mfma_f32_32x32x16_bf16 v[48:63], a[4:7], v[20:23], v[48:63]
    ds_read_b64_tr_b16 v[16:17], v7 offset:32768
    ds_read_b64_tr_b16 v[18:19], v7 offset:33792
    v_fma_mix_f32 v43, v69, 1.0, v43 op_sel:[1,0,0] op_sel_hi:[1,0,0]
    v_fma_mix_f32 v44, v70, 1.0, v44 op_sel:[0,0,0] op_sel_hi:[1,0,0]
    v_fma_mix_f32 v45, v70, 1.0, v45 op_sel:[1,0,0] op_sel_hi:[1,0,0]
    v_fma_mix_f32 v46, v71, 1.0, v46 op_sel:[0,0,0] op_sel_hi:[1,0,0]
    v_fma_mix_f32 v47, v71, 1.0, v47 op_sel:[1,0,0] op_sel_hi:[1,0,0]
    buffer_load_dword v13, off, s[16:19], s43 sc1
    s_waitcnt lgkmcnt(4)
    v_mfma_f32_32x32x16_bf16 v[48:63], a[8:11], v[24:27], v[48:63]
    ds_read_b64_tr_b16 v[20:21], v7 offset:34816
    ds_read_b64_tr_b16 v[22:23], v7 offset:35840
    v_cvt_pk_f16_f32 v32, v32, v33
    v_cvt_pk_f16_f32 v33, v34, v35
    v_cvt_pk_f16_f32 v34, v36, v37
    v_cvt_pk_f16_f32 v35, v38, v39
    s_waitcnt lgkmcnt(4)
    v_mfma_f32_32x32x16_bf16 v[48:63], a[12:15], v[28:31], v[48:63]
    s_barrier
    s_waitcnt lgkmcnt(2)
    v_mfma_f32_32x32x16_bf16 v[48:63], v[88:91], v[16:19], v[48:63]
    ds_read_b64_tr_b16 v[24:25], v7 offset:40960
    ds_read_b64_tr_b16 v[26:27], v7 offset:41984
    ds_read_b64_tr_b16 v[28:29], v7 offset:43008
    ds_read_b64_tr_b16 v[30:31], v7 offset:44032
    v_cvt_pk_f16_f32 v36, v40, v41
    v_cvt_pk_f16_f32 v37, v42, v43
    v_cvt_pk_f16_f32 v38, v44, v45
    v_cvt_pk_f16_f32 v39, v46, v47
    s_lshl_b32 s50, s76, s8
    s_add_u32 s50, s50, s56
    s_add_u32 s51, s50, s9
    buffer_store_dwordx4 v[32:35], v1, s[20:23], s50 offen
    buffer_store_dwordx4 v[36:39], v1, s[20:23], s51 offen
    s_waitcnt lgkmcnt(4)
    v_mfma_f32_32x32x16_bf16 v[48:63], v[92:95], v[20:23], v[48:63]
    ds_read_b64_tr_b16 v[16:17], v10 offset:32768
    ds_read_b64_tr_b16 v[18:19], v10 offset:33792
    s_waitcnt lgkmcnt(4)
    v_mfma_f32_32x32x16_bf16 v[48:63], v[96:99], v[24:27], v[48:63]
    ds_read_b64_tr_b16 v[20:21], v10 offset:34816
    ds_read_b64_tr_b16 v[22:23], v10 offset:35840
    s_waitcnt lgkmcnt(4)
    v_mfma_f32_32x32x16_bf16 v[48:63], v[100:103], v[28:31], v[48:63]
    ds_read_b64_tr_b16 v[24:25], v10 offset:40960
    ds_read_b64_tr_b16 v[26:27], v10 offset:41984
    s_waitcnt lgkmcnt(4)
    v_mfma_f32_32x32x16_bf16 v[48:63], a[16:19], v[16:19], v[48:63]
    ds_read_b64_tr_b16 v[28:29], v10 offset:43008
    ds_read_b64_tr_b16 v[30:31], v10 offset:44032
    s_waitcnt lgkmcnt(4)
    v_mfma_f32_32x32x16_bf16 v[48:63], a[20:23], v[20:23], v[48:63]
    ds_read_b64_tr_b16 v[16:17], v7 offset:49152
    ds_read_b64_tr_b16 v[18:19], v7 offset:50176
    s_waitcnt vmcnt(2)
.sp_17:
    v_readfirstlane_b32 s50, v13
    s_add_u32 s50, s50, s100
    s_cmp_ge_u32 s50, 8
    s_cbranch_scc1 .ok_18
    s_sub_u32 s82, s82, 1
    s_cmp_lt_i32 s82, 1
    s_cbranch_scc1 .ok_18
    buffer_load_dword v13, off, s[16:19], s43 sc1
    s_waitcnt vmcnt(0)
    s_branch .sp_17

.ok_18:
    s_lshl_b32 s50, s77, s8
    s_add_u32 s50, s50, s56
    s_add_u32 s51, s50, s9
    buffer_load_dwordx4 v[64:67], v1, s[20:23], s50 offen sc1
    buffer_load_dwordx4 v[68:71], v1, s[20:23], s51 offen sc1
    s_waitcnt lgkmcnt(4)
    v_mfma_f32_32x32x16_bf16 v[48:63], a[24:27], v[24:27], v[48:63]
    ds_read_b64_tr_b16 v[20:21], v7 offset:51200
    ds_read_b64_tr_b16 v[22:23], v7 offset:52224
    v_mov_b32 v14, 7
    s_waitcnt vmcnt(2)
    s_mov_b64 exec, 1
    buffer_store_dword v14, off, s[16:19], s42
    s_mov_b64 exec, -1
    s_waitcnt lgkmcnt(4)
    v_mfma_f32_32x32x16_bf16 v[48:63], a[28:31], v[28:31], v[48:63]
    s_barrier
    s_waitcnt lgkmcnt(2)
    v_mfma_f32_32x32x16_bf16 v[48:63], v[104:107], v[16:19], v[48:63]
    ds_read_b64_tr_b16 v[24:25], v7 offset:57344
    ds_read_b64_tr_b16 v[26:27], v7 offset:58368
    ds_read_b64_tr_b16 v[28:29], v7 offset:59392
    ds_read_b64_tr_b16 v[30:31], v7 offset:60416
    s_waitcnt lgkmcnt(4)
    v_mfma_f32_32x32x16_bf16 v[48:63], v[108:111], v[20:23], v[48:63]
    ds_read_b64_tr_b16 v[16:17], v10 offset:49152
    ds_read_b64_tr_b16 v[18:19], v10 offset:50176
    s_waitcnt lgkmcnt(4)
    v_mfma_f32_32x32x16_bf16 v[48:63], a[48:51], v[24:27], v[48:63]
    ds_read_b64_tr_b16 v[20:21], v10 offset:51200
    ds_read_b64_tr_b16 v[22:23], v10 offset:52224
    s_waitcnt lgkmcnt(4)
    v_mfma_f32_32x32x16_bf16 v[48:63], a[52:55], v[28:31], v[48:63]
    ds_read_b64_tr_b16 v[24:25], v10 offset:57344
    ds_read_b64_tr_b16 v[26:27], v10 offset:58368
    s_waitcnt lgkmcnt(4)
    v_mfma_f32_32x32x16_bf16 v[48:63], a[32:35], v[16:19], v[48:63]
    ds_read_b64_tr_b16 v[28:29], v10 offset:59392
    ds_read_b64_tr_b16 v[30:31], v10 offset:60416
    s_waitcnt lgkmcnt(4)
    v_mfma_f32_32x32x16_bf16 v[48:63], a[36:39], v[20:23], v[48:63]
    ds_read_b64_tr_b16 v[16:17], v6 offset:32768
    ds_read_b64_tr_b16 v[18:19], v6 offset:33792
    s_waitcnt lgkmcnt(4)
    v_mfma_f32_32x32x16_bf16 v[48:63], a[40:43], v[24:27], v[48:63]
    ds_read_b64_tr_b16 v[20:21], v6 offset:34816
    ds_read_b64_tr_b16 v[22:23], v6 offset:35840
    s_waitcnt lgkmcnt(4)
    v_mfma_f32_32x32x16_bf16 v[48:63], a[44:47], v[28:31], v[48:63]
    s_barrier
    s_waitcnt lgkmcnt(2)
    v_mfma_f32_32x32x16_bf16 v[32:47], v[72:75], v[16:19], 0
    ds_read_b64_tr_b16 v[24:25], v6 offset:40960
    ds_read_b64_tr_b16 v[26:27], v6 offset:41984
    ds_read_b64_tr_b16 v[28:29], v6 offset:43008
    ds_read_b64_tr_b16 v[30:31], v6 offset:44032
    s_waitcnt lgkmcnt(4)
    v_mfma_f32_32x32x16_bf16 v[32:47], v[76:79], v[20:23], v[32:47]
    ds_read_b64_tr_b16 v[16:17], v9 offset:32768
    ds_read_b64_tr_b16 v[18:19], v9 offset:33792
    s_waitcnt lgkmcnt(4)
    v_mfma_f32_32x32x16_bf16 v[32:47], v[80:83], v[24:27], v[32:47]
    ds_read_b64_tr_b16 v[20:21], v9 offset:34816
    ds_read_b64_tr_b16 v[22:23], v9 offset:35840
    s_waitcnt vmcnt(1)
    v_fma_mix_f32 v48, v64, 1.0, v48 op_sel:[0,0,0] op_sel_hi:[1,0,0]
    v_fma_mix_f32 v49, v64, 1.0, v49 op_sel:[1,0,0] op_sel_hi:[1,0,0]
    v_fma_mix_f32 v50, v65, 1.0, v50 op_sel:[0,0,0] op_sel_hi:[1,0,0]
    s_waitcnt lgkmcnt(4)
    v_mfma_f32_32x32x16_bf16 v[32:47], v[84:87], v[28:31], v[32:47]
    ds_read_b64_tr_b16 v[24:25], v9 offset:40960
    ds_read_b64_tr_b16 v[26:27], v9 offset:41984
    v_fma_mix_f32 v51, v65, 1.0, v51 op_sel:[1,0,0] op_sel_hi:[1,0,0]
    v_fma_mix_f32 v52, v66, 1.0, v52 op_sel:[0,0,0] op_sel_hi:[1,0,0]
    v_fma_mix_f32 v53, v66, 1.0, v53 op_sel:[1,0,0] op_sel_hi:[1,0,0]
    v_fma_mix_f32 v54, v67, 1.0, v54 op_sel:[0,0,0] op_sel_hi:[1,0,0]
    s_waitcnt lgkmcnt(4)
    v_mfma_f32_32x32x16_bf16 v[32:47], a[0:3], v[16:19], v[32:47]
    ds_read_b64_tr_b16 v[28:29], v9 offset:43008
    ds_read_b64_tr_b16 v[30:31], v9 offset:44032
    v_fma_mix_f32 v55, v67, 1.0, v55 op_sel:[1,0,0] op_sel_hi:[1,0,0]
    v_fma_mix_f32 v56, v68, 1.0, v56 op_sel:[0,0,0] op_sel_hi:[1,0,0]
    v_fma_mix_f32 v57, v68, 1.0, v57 op_sel:[1,0,0] op_sel_hi:[1,0,0]
    v_fma_mix_f32 v58, v69, 1.0, v58 op_sel:[0,0,0] op_sel_hi:[1,0,0]
    s_waitcnt lgkmcnt(4)
    v_mfma_f32_32x32x16_bf16 v[32:47], a[4:7], v[20:23], v[32:47]
    ds_read_b64_tr_b16 v[16:17], v6 offset:0
    ds_read_b64_tr_b16 v[18:19], v6 offset:1024
    v_fma_mix_f32 v59, v69, 1.0, v59 op_sel:[1,0,0] op_sel_hi:[1,0,0]
    v_fma_mix_f32 v60, v70, 1.0, v60 op_sel:[0,0,0] op_sel_hi:[1,0,0]
    v_fma_mix_f32 v61, v70, 1.0, v61 op_sel:[1,0,0] op_sel_hi:[1,0,0]
    v_fma_mix_f32 v62, v71, 1.0, v62 op_sel:[0,0,0] op_sel_hi:[1,0,0]
    v_fma_mix_f32 v63, v71, 1.0, v63 op_sel:[1,0,0] op_sel_hi:[1,0,0]
    buffer_load_dword v13, off, s[16:19], s43 sc1
    s_waitcnt lgkmcnt(4)
    v_mfma_f32_32x32x16_bf16 v[32:47], a[8:11], v[24:27], v[32:47]
    ds_read_b64_tr_b16 v[20:21], v6 offset:2048
    ds_read_b64_tr_b16 v[22:23], v6 offset:3072
    v_cvt_pk_f16_f32 v48, v48, v49
    v_cvt_pk_f16_f32 v49, v50, v51
    v_cvt_pk_f16_f32 v50, v52, v53
    v_cvt_pk_f16_f32 v51, v54, v55
    s_waitcnt lgkmcnt(4)
    v_mfma_f32_32x32x16_bf16 v[32:47], a[12:15], v[28:31], v[32:47]
    s_barrier
    s_waitcnt lgkmcnt(2)
    v_mfma_f32_32x32x16_bf16 v[32:47], v[88:91], v[16:19], v[32:47]
    ds_read_b64_tr_b16 v[24:25], v6 offset:8192
    ds_read_b64_tr_b16 v[26:27], v6 offset:9216
    ds_read_b64_tr_b16 v[28:29], v6 offset:10240
    ds_read_b64_tr_b16 v[30:31], v6 offset:11264
    v_cvt_pk_f16_f32 v52, v56, v57
    v_cvt_pk_f16_f32 v53, v58, v59
    v_cvt_pk_f16_f32 v54, v60, v61
    v_cvt_pk_f16_f32 v55, v62, v63
    s_lshl_b32 s50, s77, s8
    s_add_u32 s50, s50, s56
    s_add_u32 s51, s50, s9
    buffer_store_dwordx4 v[48:51], v1, s[20:23], s50 offen
    buffer_store_dwordx4 v[52:55], v1, s[20:23], s51 offen
    s_waitcnt lgkmcnt(4)
    v_mfma_f32_32x32x16_bf16 v[32:47], v[92:95], v[20:23], v[32:47]
    ds_read_b64_tr_b16 v[16:17], v9 offset:0
    ds_read_b64_tr_b16 v[18:19], v9 offset:1024
    s_waitcnt lgkmcnt(4)
    v_mfma_f32_32x32x16_bf16 v[32:47], v[96:99], v[24:27], v[32:47]
    ds_read_b64_tr_b16 v[20:21], v9 offset:2048
    ds_read_b64_tr_b16 v[22:23], v9 offset:3072
    s_waitcnt lgkmcnt(4)
    v_mfma_f32_32x32x16_bf16 v[32:47], v[100:103], v[28:31], v[32:47]
    ds_read_b64_tr_b16 v[24:25], v9 offset:8192
    ds_read_b64_tr_b16 v[26:27], v9 offset:9216
    s_waitcnt lgkmcnt(4)
    v_mfma_f32_32x32x16_bf16 v[32:47], a[16:19], v[16:19], v[32:47]
    ds_read_b64_tr_b16 v[28:29], v9 offset:10240
    ds_read_b64_tr_b16 v[30:31], v9 offset:11264
    s_waitcnt lgkmcnt(4)
    v_mfma_f32_32x32x16_bf16 v[32:47], a[20:23], v[20:23], v[32:47]
    ds_read_b64_tr_b16 v[16:17], v8 offset:0
    ds_read_b64_tr_b16 v[18:19], v8 offset:1024
    s_waitcnt vmcnt(2)
.sp_19:
    v_readfirstlane_b32 s50, v13
    s_add_u32 s50, s50, s100
    s_cmp_ge_u32 s50, 9
    s_cbranch_scc1 .ok_20
    s_sub_u32 s82, s82, 1
    s_cmp_lt_i32 s82, 1
    s_cbranch_scc1 .ok_20
    buffer_load_dword v13, off, s[16:19], s43 sc1
    s_waitcnt vmcnt(0)
    s_branch .sp_19

.ok_20:
    s_lshl_b32 s50, s78, s8
    s_add_u32 s50, s50, s56
    s_add_u32 s51, s50, s9
    buffer_load_dwordx4 v[64:67], v1, s[20:23], s50 offen sc1
    buffer_load_dwordx4 v[68:71], v1, s[20:23], s51 offen sc1
    s_waitcnt lgkmcnt(4)
    v_mfma_f32_32x32x16_bf16 v[32:47], a[24:27], v[24:27], v[32:47]
    ds_read_b64_tr_b16 v[20:21], v8 offset:2048
    ds_read_b64_tr_b16 v[22:23], v8 offset:3072
    v_mov_b32 v14, 8
    s_waitcnt vmcnt(2)
    s_mov_b64 exec, 1
    buffer_store_dword v14, off, s[16:19], s42
    s_mov_b64 exec, -1
    s_waitcnt lgkmcnt(4)
    v_mfma_f32_32x32x16_bf16 v[32:47], a[28:31], v[28:31], v[32:47]
    s_barrier
    s_waitcnt lgkmcnt(2)
    v_mfma_f32_32x32x16_bf16 v[32:47], v[104:107], v[16:19], v[32:47]
    ds_read_b64_tr_b16 v[24:25], v8 offset:8192
    ds_read_b64_tr_b16 v[26:27], v8 offset:9216
    ds_read_b64_tr_b16 v[28:29], v8 offset:10240
    ds_read_b64_tr_b16 v[30:31], v8 offset:11264
    s_waitcnt lgkmcnt(4)
    v_mfma_f32_32x32x16_bf16 v[32:47], v[108:111], v[20:23], v[32:47]
    ds_read_b64_tr_b16 v[16:17], v11 offset:0
    ds_read_b64_tr_b16 v[18:19], v11 offset:1024
    s_waitcnt lgkmcnt(4)
    v_mfma_f32_32x32x16_bf16 v[32:47], a[48:51], v[24:27], v[32:47]
    ds_read_b64_tr_b16 v[20:21], v11 offset:2048
    ds_read_b64_tr_b16 v[22:23], v11 offset:3072
    s_waitcnt lgkmcnt(4)
    v_mfma_f32_32x32x16_bf16 v[32:47], a[52:55], v[28:31], v[32:47]
    ds_read_b64_tr_b16 v[24:25], v11 offset:8192
    ds_read_b64_tr_b16 v[26:27], v11 offset:9216
    s_waitcnt lgkmcnt(4)
    v_mfma_f32_32x32x16_bf16 v[32:47], a[32:35], v[16:19], v[32:47]
    ds_read_b64_tr_b16 v[28:29], v11 offset:10240
    ds_read_b64_tr_b16 v[30:31], v11 offset:11264
    s_waitcnt lgkmcnt(4)
    v_mfma_f32_32x32x16_bf16 v[32:47], a[36:39], v[20:23], v[32:47]
    s_waitcnt lgkmcnt(2)
    v_mfma_f32_32x32x16_bf16 v[32:47], a[40:43], v[24:27], v[32:47]
    s_waitcnt lgkmcnt(0)
    v_mfma_f32_32x32x16_bf16 v[32:47], a[44:47], v[28:31], v[32:47]
    s_barrier
    s_nop 7
    s_nop 7
    s_waitcnt vmcnt(1)
    v_fma_mix_f32 v32, v64, 1.0, v32 op_sel:[0,0,0] op_sel_hi:[1,0,0]
    v_fma_mix_f32 v33, v64, 1.0, v33 op_sel:[1,0,0] op_sel_hi:[1,0,0]
    v_fma_mix_f32 v34, v65, 1.0, v34 op_sel:[0,0,0] op_sel_hi:[1,0,0]
    v_fma_mix_f32 v35, v65, 1.0, v35 op_sel:[1,0,0] op_sel_hi:[1,0,0]
    v_fma_mix_f32 v36, v66, 1.0, v36 op_sel:[0,0,0] op_sel_hi:[1,0,0]
    v_fma_mix_f32 v37, v66, 1.0, v37 op_sel:[1,0,0] op_sel_hi:[1,0,0]
    v_fma_mix_f32 v38, v67, 1.0, v38 op_sel:[0,0,0] op_sel_hi:[1,0,0]
    v_fma_mix_f32 v39, v67, 1.0, v39 op_sel:[1,0,0] op_sel_hi:[1,0,0]
    v_fma_mix_f32 v40, v68, 1.0, v40 op_sel:[0,0,0] op_sel_hi:[1,0,0]
    v_fma_mix_f32 v41, v68, 1.0, v41 op_sel:[1,0,0] op_sel_hi:[1,0,0]
    v_fma_mix_f32 v42, v69, 1.0, v42 op_sel:[0,0,0] op_sel_hi:[1,0,0]
    v_fma_mix_f32 v43, v69, 1.0, v43 op_sel:[1,0,0] op_sel_hi:[1,0,0]
    v_fma_mix_f32 v44, v70, 1.0, v44 op_sel:[0,0,0] op_sel_hi:[1,0,0]
    v_fma_mix_f32 v45, v70, 1.0, v45 op_sel:[1,0,0] op_sel_hi:[1,0,0]
    v_fma_mix_f32 v46, v71, 1.0, v46 op_sel:[0,0,0] op_sel_hi:[1,0,0]
    v_fma_mix_f32 v47, v71, 1.0, v47 op_sel:[1,0,0] op_sel_hi:[1,0,0]
    v_cvt_pk_f16_f32 v32, v32, v33
    v_cvt_pk_f16_f32 v33, v34, v35
    v_cvt_pk_f16_f32 v34, v36, v37
    v_cvt_pk_f16_f32 v35, v38, v39
    v_cvt_pk_f16_f32 v36, v40, v41
    v_cvt_pk_f16_f32 v37, v42, v43
    v_cvt_pk_f16_f32 v38, v44, v45
    v_cvt_pk_f16_f32 v39, v46, v47
    s_lshl_b32 s50, s78, s8
    s_add_u32 s50, s50, s56
    s_add_u32 s51, s50, s9
    buffer_store_dwordx4 v[32:35], v1, s[20:23], s50 offen
    buffer_store_dwordx4 v[36:39], v1, s[20:23], s51 offen
    v_bfe_u32 v17, v12, 4, 2
    v_lshlrev_b32 v17, 2, v17
    buffer_load_dword v16, v17, s[16:19], s62 offen sc1
    v_lshrrev_b32 v8, 9, v12
    v_bfe_u32 v9, v12, 8, 1
    v_lshlrev_b32 v9, 3, v9
    v_and_b32 v7, 0xf0, v12
    v_lshl_add_u32 v7, v8, 10, v7
    v_add_u32 v7, v7, v9
    v_bfe_u32 v6, v12, 6, 2
    v_lshl_add_u32 v6, v8, 3, v6
    v_mul_u32_u24 v6, 2304, v6
    v_and_b32 v8, 0x30, v12
    v_add3_u32 v6, v6, v8, v9

    v_accvgpr_read_b32 v88, a96
    v_accvgpr_read_b32 v89, a97
    v_accvgpr_read_b32 v90, a98
    v_accvgpr_read_b32 v91, a99
    v_accvgpr_read_b32 v92, a100
    v_accvgpr_read_b32 v93, a101
    v_accvgpr_read_b32 v94, a102
    v_accvgpr_read_b32 v95, a103
    v_accvgpr_read_b32 v64, a80
    v_accvgpr_read_b32 v65, a81
    v_accvgpr_read_b32 v66, a82
    v_accvgpr_read_b32 v67, a83
    v_accvgpr_read_b32 v96, a84
    v_lshlrev_b32 v64, 16, v64
    v_lshlrev_b32 v65, 16, v65
    v_lshlrev_b32 v66, 16, v66
    v_lshlrev_b32 v67, 16, v67
    v_lshlrev_b32 v96, 16, v96
    v_fma_f32 v76, v64, v88, v89
    v_fma_f32 v77, v65, v90, v91
    v_fma_f32 v78, v66, v92, v93
    v_fma_f32 v79, v67, v94, v95
    v_cvt_pk_bf16_f32 v77, v76, v77
    v_cvt_pk_bf16_f32 v79, v78, v79
    v_lshlrev_b32 v76, 16, v77
    v_lshlrev_b32 v78, 16, v79
    v_and_b32 v77, s99, v77
    v_and_b32 v79, s99, v79
    v_mul_f32 v76, v76, v96
    v_mul_f32 v77, v77, v96
    v_mul_f32 v78, v78, v96
    v_mul_f32 v79, v79, v96
    v_cvt_pk_bf16_f32 v77, v76, v77
    v_cvt_pk_bf16_f32 v79, v78, v79
    v_lshlrev_b32 v76, 16, v77
    v_lshlrev_b32 v78, 16, v79
    v_and_b32 v77, s99, v77
    v_and_b32 v79, s99, v79
    v_accvgpr_read_b32 v68, a85
    v_accvgpr_read_b32 v69, a86
    v_accvgpr_read_b32 v70, a87
    v_accvgpr_read_b32 v71, a88
    v_accvgpr_read_b32 v97, a89
    v_lshlrev_b32 v68, 16, v68
    v_lshlrev_b32 v69, 16, v69
    v_lshlrev_b32 v70, 16, v70
    v_lshlrev_b32 v71, 16, v71
    v_lshlrev_b32 v97, 16, v97
    v_fma_f32 v80, v68, v88, v89
    v_fma_f32 v81, v69, v90, v91
    v_fma_f32 v82, v70, v92, v93
    v_fma_f32 v83, v71, v94, v95
    v_cvt_pk_bf16_f32 v81, v80, v81
    v_cvt_pk_bf16_f32 v83, v82, v83
    v_lshlrev_b32 v80, 16, v81
    v_lshlrev_b32 v82, 16, v83
    v_and_b32 v81, s99, v81
    v_and_b32 v83, s99, v83
    v_mul_f32 v80, v80, v97
    v_mul_f32 v81, v81, v97
    v_mul_f32 v82, v82, v97
    v_mul_f32 v83, v83, v97
    v_cvt_pk_bf16_f32 v81, v80, v81
    v_cvt_pk_bf16_f32 v83, v82, v83
    v_lshlrev_b32 v80, 16, v81
    v_lshlrev_b32 v82, 16, v83
    v_and_b32 v81, s99, v81
    v_and_b32 v83, s99, v83
    v_accvgpr_read_b32 v72, a90
    v_accvgpr_read_b32 v73, a91
    v_accvgpr_read_b32 v74, a92
    v_accvgpr_read_b32 v75, a93
    v_accvgpr_read_b32 v98, a94
    v_lshlrev_b32 v72, 16, v72
    v_lshlrev_b32 v73, 16, v73
    v_lshlrev_b32 v74, 16, v74
    v_lshlrev_b32 v75, 16, v75
    v_lshlrev_b32 v98, 16, v98
    v_fma_f32 v84, v72, v88, v89
    v_fma_f32 v85, v73, v90, v91
    v_fma_f32 v86, v74, v92, v93
    v_fma_f32 v87, v75, v94, v95
    v_cvt_pk_bf16_f32 v85, v84, v85
    v_cvt_pk_bf16_f32 v87, v86, v87
    v_lshlrev_b32 v84, 16, v85
    v_lshlrev_b32 v86, 16, v87
    v_and_b32 v85, s99, v85
    v_and_b32 v87, s99, v87
    v_mul_f32 v84, v84, v98
    v_mul_f32 v85, v85, v98
    v_mul_f32 v86, v86, v98
    v_mul_f32 v87, v87, v98
    v_cvt_pk_bf16_f32 v85, v84, v85
    v_cvt_pk_bf16_f32 v87, v86, v87
    v_lshlrev_b32 v84, 16, v85
    v_lshlrev_b32 v86, 16, v87
    v_and_b32 v85, s99, v85
    v_and_b32 v87, s99, v87
    v_mov_b32 v19, 9
    s_waitcnt vmcnt(1)
    s_mov_b64 exec, 1
    buffer_store_dword v19, off, s[16:19], s42
    s_mov_b64 exec, -1
    s_lshr_b32 s49, s48, 2
    s_lshl_b32 s49, 1, s49
    s_waitcnt vmcnt(0)
    v_cmp_gt_u32 vcc, 9, v16
    s_andn2_b32 s49, vcc_lo, s49
    s_and_b32 s49, s49, 15
    s_cbranch_scc0 .batch_21

    s_branch .f1_24
.fp_22:
    buffer_load_dword v16, v17, s[16:19], s62 offen sc1
.f1_24:
    s_waitcnt vmcnt(0)
    v_cmp_gt_u32 vcc, 8, v16
    s_cbranch_vccz .fg_23
    s_sub_u32 s82, s82, 1
    s_cmp_lt_i32 s82, 1
    s_cbranch_scc0 .fp_22

.fg_23:
    s_and_b32 s49, s48, 3
    s_cmp_eq_u32 s49, 3
    s_cselect_b64 exec, -1, 0
    s_lshl_b32 s50, s76, 7
    s_add_u32 s50, s50, s65
    s_add_u32 s51, s76, s64
    s_lshl_b32 s51, s51, 1
    buffer_load_dwordx2 v[96:97], v6, s[32:35], s51 offen sc1
    s_add_u32 s51, s51, 36864
    buffer_load_dwordx2 v[98:99], v6, s[32:35], s51 offen sc1
    buffer_load_dwordx2 v[100:101], v7, s[16:19], s50 offen sc1
    s_add_u32 s50, s50, 2359296
    buffer_load_dwordx2 v[20:21], v7, s[16:19], s50 offen sc1
    s_mov_b64 exec, -1
    s_lshl_b32 s50, s77, 7
    s_add_u32 s50, s50, s65
    s_add_u32 s51, s77, s64
    s_lshl_b32 s51, s51, 1
    buffer_load_dwordx2 v[102:103], v6, s[32:35], s51 offen sc1
    s_add_u32 s51, s51, 36864
    buffer_load_dwordx2 v[104:105], v6, s[32:35], s51 offen sc1
    buffer_load_dwordx2 v[106:107], v7, s[16:19], s50 offen sc1
    s_add_u32 s50, s50, 2359296
    buffer_load_dwordx2 v[22:23], v7, s[16:19], s50 offen sc1
    s_waitcnt vmcnt(0)
    v_fma_mix_f32 v32, v96, 1.0, v98 op_sel:[0,0,0] op_sel_hi:[1,0,1]
    v_fma_mix_f32 v33, v96, 1.0, v98 op_sel:[1,0,1] op_sel_hi:[1,0,1]
    v_fma_mix_f32 v34, v97, 1.0, v99 op_sel:[0,0,0] op_sel_hi:[1,0,1]
    v_fma_mix_f32 v35, v97, 1.0, v99 op_sel:[1,0,1] op_sel_hi:[1,0,1]
    v_fma_mix_f32 v36, v102, 1.0, v104 op_sel:[0,0,0] op_sel_hi:[1,0,1]
    v_fma_mix_f32 v37, v102, 1.0, v104 op_sel:[1,0,1] op_sel_hi:[1,0,1]
    v_fma_mix_f32 v38, v103, 1.0, v105 op_sel:[0,0,0] op_sel_hi:[1,0,1]
    v_fma_mix_f32 v39, v103, 1.0, v105 op_sel:[1,0,1] op_sel_hi:[1,0,1]
    v_fma_mix_f32 v32, v100, 1.0, v32 op_sel:[0,0,0] op_sel_hi:[1,0,0]
    v_fma_mix_f32 v33, v100, 1.0, v33 op_sel:[1,0,0] op_sel_hi:[1,0,0]
    v_fma_mix_f32 v34, v101, 1.0, v34 op_sel:[0,0,0] op_sel_hi:[1,0,0]
    v_fma_mix_f32 v35, v101, 1.0, v35 op_sel:[1,0,0] op_sel_hi:[1,0,0]
    v_fma_mix_f32 v36, v106, 1.0, v36 op_sel:[0,0,0] op_sel_hi:[1,0,0]
    v_fma_mix_f32 v37, v106, 1.0, v37 op_sel:[1,0,0] op_sel_hi:[1,0,0]
    v_fma_mix_f32 v38, v107, 1.0, v38 op_sel:[0,0,0] op_sel_hi:[1,0,0]
    v_fma_mix_f32 v39, v107, 1.0, v39 op_sel:[1,0,0] op_sel_hi:[1,0,0]
    v_fma_mix_f32 v44, v20, 1.0, v76 op_sel:[0,0,0] op_sel_hi:[1,0,0]
    v_fma_mix_f32 v45, v20, 1.0, v77 op_sel:[1,0,0] op_sel_hi:[1,0,0]
    v_fma_mix_f32 v46, v21, 1.0, v78 op_sel:[0,0,0] op_sel_hi:[1,0,0]
    v_fma_mix_f32 v47, v21, 1.0, v79 op_sel:[1,0,0] op_sel_hi:[1,0,0]
    v_fma_mix_f32 v48, v22, 1.0, v80 op_sel:[0,0,0] op_sel_hi:[1,0,0]
    v_fma_mix_f32 v49, v22, 1.0, v81 op_sel:[1,0,0] op_sel_hi:[1,0,0]
    v_fma_mix_f32 v50, v23, 1.0, v82 op_sel:[0,0,0] op_sel_hi:[1,0,0]
    v_fma_mix_f32 v51, v23, 1.0, v83 op_sel:[1,0,0] op_sel_hi:[1,0,0]
    v_cvt_pk_bf16_f32 v33, v32, v33
    v_cvt_pk_bf16_f32 v35, v34, v35
    v_lshlrev_b32 v32, 16, v33
    v_lshlrev_b32 v34, 16, v35
    v_and_b32 v33, s99, v33
    v_and_b32 v35, s99, v35
    v_cvt_pk_bf16_f32 v37, v36, v37
    v_cvt_pk_bf16_f32 v39, v38, v39
    v_lshlrev_b32 v36, 16, v37
    v_lshlrev_b32 v38, 16, v39
    v_and_b32 v37, s99, v37
    v_and_b32 v39, s99, v39
    v_mul_f32 v96, s98, v32
    v_mul_f32 v97, s98, v33
    v_mul_f32 v98, s98, v34
    v_mul_f32 v99, s98, v35
    v_mul_f32 v100, s98, v36
    v_mul_f32 v101, s98, v37
    v_mul_f32 v102, s98, v38
    v_mul_f32 v103, s98, v39
    v_exp_f32 v96, -v96
    v_exp_f32 v97, -v97
    v_exp_f32 v98, -v98
    v_exp_f32 v99, -v99
    v_exp_f32 v100, -v100
    v_exp_f32 v101, -v101
    v_exp_f32 v102, -v102
    v_exp_f32 v103, -v103
    v_add_f32 v96, 1.0, v96
    v_add_f32 v97, 1.0, v97
    v_add_f32 v98, 1.0, v98
    v_add_f32 v99, 1.0, v99
    v_add_f32 v100, 1.0, v100
    v_add_f32 v101, 1.0, v101
    v_add_f32 v102, 1.0, v102
    v_add_f32 v103, 1.0, v103
    v_rcp_f32 v96, v96
    v_rcp_f32 v97, v97
    v_rcp_f32 v98, v98
    v_rcp_f32 v99, v99
    v_rcp_f32 v100, v100
    v_rcp_f32 v101, v101
    v_rcp_f32 v102, v102
    v_rcp_f32 v103, v103
    v_mul_f32 v32, v32, v96
    v_mul_f32 v33, v33, v97
    v_mul_f32 v34, v34, v98
    v_mul_f32 v35, v35, v99
    v_mul_f32 v36, v36, v100
    v_mul_f32 v37, v37, v101
    v_mul_f32 v38, v38, v102
    v_mul_f32 v39, v39, v103
    v_cvt_pk_bf16_f32 v33, v32, v33
    v_cvt_pk_bf16_f32 v35, v34, v35
    v_lshlrev_b32 v32, 16, v33
    v_lshlrev_b32 v34, 16, v35
    v_and_b32 v33, s99, v33
    v_and_b32 v35, s99, v35
    v_cvt_pk_bf16_f32 v37, v36, v37
    v_cvt_pk_bf16_f32 v39, v38, v39
    v_lshlrev_b32 v36, 16, v37
    v_lshlrev_b32 v38, 16, v39
    v_and_b32 v37, s99, v37
    v_and_b32 v39, s99, v39
    v_fmac_f32 v64, v44, v32
    v_fmac_f32 v65, v45, v33
    v_fmac_f32 v66, v46, v34
    v_fmac_f32 v67, v47, v35
    v_fmac_f32 v68, v48, v36
    v_fmac_f32 v69, v49, v37
    v_fmac_f32 v70, v50, v38
    v_fmac_f32 v71, v51, v39
    s_and_b32 s49, s48, 3
    s_cmp_eq_u32 s49, 3
    s_cselect_b64 exec, -1, 0
    s_add_u32 s50, s76, s64
    s_lshl_b32 s50, s50, 1
    s_add_u32 s51, s50, 4608
    buffer_store_dword v64, v5, s[32:35], s50 offen offset:0
    buffer_store_dword v65, v5, s[32:35], s50 offen offset:2304
    buffer_store_dword v66, v5, s[32:35], s51 offen offset:0
    buffer_store_dword v67, v5, s[32:35], s51 offen offset:2304
    s_mov_b64 exec, -1
    s_add_u32 s50, s77, s64
    s_lshl_b32 s50, s50, 1
    s_add_u32 s51, s50, 4608
    buffer_store_dword v68, v5, s[32:35], s50 offen offset:0
    buffer_store_dword v69, v5, s[32:35], s50 offen offset:2304
    buffer_store_dword v70, v5, s[32:35], s51 offen offset:0
    buffer_store_dword v71, v5, s[32:35], s51 offen offset:2304
.fp_25:
    buffer_load_dword v16, v17, s[16:19], s62 offen sc1
.f1_27:
    s_waitcnt vmcnt(0)
    v_cmp_gt_u32 vcc, 9, v16
    s_cbranch_vccz .fg_26
    s_sub_u32 s82, s82, 1
    s_cmp_lt_i32 s82, 1
    s_cbranch_scc0 .fp_25

.fg_26:
    s_lshl_b32 s50, s78, 7
    s_add_u32 s50, s50, s65
    s_add_u32 s51, s78, s64
    s_lshl_b32 s51, s51, 1
    buffer_load_dwordx2 v[26:27], v6, s[32:35], s51 offen sc1
    s_add_u32 s51, s51, 36864
    buffer_load_dwordx2 v[28:29], v6, s[32:35], s51 offen sc1
    buffer_load_dwordx2 v[30:31], v7, s[16:19], s50 offen sc1
    s_add_u32 s50, s50, 2359296
    buffer_load_dwordx2 v[24:25], v7, s[16:19], s50 offen sc1
    s_waitcnt vmcnt(0)
    v_fma_mix_f32 v40, v26, 1.0, v28 op_sel:[0,0,0] op_sel_hi:[1,0,1]
    v_fma_mix_f32 v41, v26, 1.0, v28 op_sel:[1,0,1] op_sel_hi:[1,0,1]
    v_fma_mix_f32 v42, v27, 1.0, v29 op_sel:[0,0,0] op_sel_hi:[1,0,1]
    v_fma_mix_f32 v43, v27, 1.0, v29 op_sel:[1,0,1] op_sel_hi:[1,0,1]
    v_fma_mix_f32 v40, v30, 1.0, v40 op_sel:[0,0,0] op_sel_hi:[1,0,0]
    v_fma_mix_f32 v41, v30, 1.0, v41 op_sel:[1,0,0] op_sel_hi:[1,0,0]
    v_fma_mix_f32 v42, v31, 1.0, v42 op_sel:[0,0,0] op_sel_hi:[1,0,0]
    v_fma_mix_f32 v43, v31, 1.0, v43 op_sel:[1,0,0] op_sel_hi:[1,0,0]
    v_fma_mix_f32 v52, v24, 1.0, v84 op_sel:[0,0,0] op_sel_hi:[1,0,0]
    v_fma_mix_f32 v53, v24, 1.0, v85 op_sel:[1,0,0] op_sel_hi:[1,0,0]
    v_fma_mix_f32 v54, v25, 1.0, v86 op_sel:[0,0,0] op_sel_hi:[1,0,0]
    v_fma_mix_f32 v55, v25, 1.0, v87 op_sel:[1,0,0] op_sel_hi:[1,0,0]
    v_cvt_pk_bf16_f32 v41, v40, v41
    v_cvt_pk_bf16_f32 v43, v42, v43
    v_lshlrev_b32 v40, 16, v41
    v_lshlrev_b32 v42, 16, v43
    v_and_b32 v41, s99, v41
    v_and_b32 v43, s99, v43
    v_mul_f32 v104, s98, v40
    v_mul_f32 v105, s98, v41
    v_mul_f32 v106, s98, v42
    v_mul_f32 v107, s98, v43
    v_exp_f32 v104, -v104
    v_exp_f32 v105, -v105
    v_exp_f32 v106, -v106
    v_exp_f32 v107, -v107
    v_add_f32 v104, 1.0, v104
    v_add_f32 v105, 1.0, v105
    v_add_f32 v106, 1.0, v106
    v_add_f32 v107, 1.0, v107
    v_rcp_f32 v104, v104
    v_rcp_f32 v105, v105
    v_rcp_f32 v106, v106
    v_rcp_f32 v107, v107
    v_mul_f32 v40, v40, v104
    v_mul_f32 v41, v41, v105
    v_mul_f32 v42, v42, v106
    v_mul_f32 v43, v43, v107
    v_cvt_pk_bf16_f32 v41, v40, v41
    v_cvt_pk_bf16_f32 v43, v42, v43
    v_lshlrev_b32 v40, 16, v41
    v_lshlrev_b32 v42, 16, v43
    v_and_b32 v41, s99, v41
    v_and_b32 v43, s99, v43
    v_fmac_f32 v72, v52, v40
    v_fmac_f32 v73, v53, v41
    v_fmac_f32 v74, v54, v42
    v_fmac_f32 v75, v55, v43
    s_add_u32 s50, s78, s64
    s_lshl_b32 s50, s50, 1
    s_add_u32 s51, s50, 4608
    buffer_store_dword v72, v5, s[32:35], s50 offen offset:0
    buffer_store_dword v73, v5, s[32:35], s50 offen offset:2304
    buffer_store_dword v74, v5, s[32:35], s51 offen offset:0
    buffer_store_dword v75, v5, s[32:35], s51 offen offset:2304
    s_endpgm
.batch_21:
    s_and_b32 s49, s48, 3
    s_cmp_eq_u32 s49, 3
    s_cselect_b64 exec, -1, 0
    s_lshl_b32 s50, s76, 7
    s_add_u32 s50, s50, s65
    s_add_u32 s51, s76, s64
    s_lshl_b32 s51, s51, 1
    buffer_load_dwordx2 v[96:97], v6, s[32:35], s51 offen sc1
    s_add_u32 s51, s51, 36864
    buffer_load_dwordx2 v[98:99], v6, s[32:35], s51 offen sc1
    buffer_load_dwordx2 v[100:101], v7, s[16:19], s50 offen sc1
    s_add_u32 s50, s50, 2359296
    buffer_load_dwordx2 v[20:21], v7, s[16:19], s50 offen sc1
    s_mov_b64 exec, -1
    s_lshl_b32 s50, s77, 7
    s_add_u32 s50, s50, s65
    s_add_u32 s51, s77, s64
    s_lshl_b32 s51, s51, 1
    buffer_load_dwordx2 v[102:103], v6, s[32:35], s51 offen sc1
    s_add_u32 s51, s51, 36864
    buffer_load_dwordx2 v[104:105], v6, s[32:35], s51 offen sc1
    buffer_load_dwordx2 v[106:107], v7, s[16:19], s50 offen sc1
    s_add_u32 s50, s50, 2359296
    buffer_load_dwordx2 v[22:23], v7, s[16:19], s50 offen sc1
    s_lshl_b32 s50, s78, 7
    s_add_u32 s50, s50, s65
    s_add_u32 s51, s78, s64
    s_lshl_b32 s51, s51, 1
    buffer_load_dwordx2 v[26:27], v6, s[32:35], s51 offen sc1
    s_add_u32 s51, s51, 36864
    buffer_load_dwordx2 v[28:29], v6, s[32:35], s51 offen sc1
    buffer_load_dwordx2 v[30:31], v7, s[16:19], s50 offen sc1
    s_add_u32 s50, s50, 2359296
    buffer_load_dwordx2 v[24:25], v7, s[16:19], s50 offen sc1
    s_waitcnt vmcnt(0)
    v_fma_mix_f32 v32, v96, 1.0, v98 op_sel:[0,0,0] op_sel_hi:[1,0,1]
    v_fma_mix_f32 v33, v96, 1.0, v98 op_sel:[1,0,1] op_sel_hi:[1,0,1]
    v_fma_mix_f32 v34, v97, 1.0, v99 op_sel:[0,0,0] op_sel_hi:[1,0,1]
    v_fma_mix_f32 v35, v97, 1.0, v99 op_sel:[1,0,1] op_sel_hi:[1,0,1]
    v_fma_mix_f32 v36, v102, 1.0, v104 op_sel:[0,0,0] op_sel_hi:[1,0,1]
    v_fma_mix_f32 v37, v102, 1.0, v104 op_sel:[1,0,1] op_sel_hi:[1,0,1]
    v_fma_mix_f32 v38, v103, 1.0, v105 op_sel:[0,0,0] op_sel_hi:[1,0,1]
    v_fma_mix_f32 v39, v103, 1.0, v105 op_sel:[1,0,1] op_sel_hi:[1,0,1]
    v_fma_mix_f32 v40, v26, 1.0, v28 op_sel:[0,0,0] op_sel_hi:[1,0,1]
    v_fma_mix_f32 v41, v26, 1.0, v28 op_sel:[1,0,1] op_sel_hi:[1,0,1]
    v_fma_mix_f32 v42, v27, 1.0, v29 op_sel:[0,0,0] op_sel_hi:[1,0,1]
    v_fma_mix_f32 v43, v27, 1.0, v29 op_sel:[1,0,1] op_sel_hi:[1,0,1]
    v_fma_mix_f32 v32, v100, 1.0, v32 op_sel:[0,0,0] op_sel_hi:[1,0,0]
    v_fma_mix_f32 v33, v100, 1.0, v33 op_sel:[1,0,0] op_sel_hi:[1,0,0]
    v_fma_mix_f32 v34, v101, 1.0, v34 op_sel:[0,0,0] op_sel_hi:[1,0,0]
    v_fma_mix_f32 v35, v101, 1.0, v35 op_sel:[1,0,0] op_sel_hi:[1,0,0]
    v_fma_mix_f32 v36, v106, 1.0, v36 op_sel:[0,0,0] op_sel_hi:[1,0,0]
    v_fma_mix_f32 v37, v106, 1.0, v37 op_sel:[1,0,0] op_sel_hi:[1,0,0]
    v_fma_mix_f32 v38, v107, 1.0, v38 op_sel:[0,0,0] op_sel_hi:[1,0,0]
    v_fma_mix_f32 v39, v107, 1.0, v39 op_sel:[1,0,0] op_sel_hi:[1,0,0]
    v_fma_mix_f32 v40, v30, 1.0, v40 op_sel:[0,0,0] op_sel_hi:[1,0,0]
    v_fma_mix_f32 v41, v30, 1.0, v41 op_sel:[1,0,0] op_sel_hi:[1,0,0]
    v_fma_mix_f32 v42, v31, 1.0, v42 op_sel:[0,0,0] op_sel_hi:[1,0,0]
    v_fma_mix_f32 v43, v31, 1.0, v43 op_sel:[1,0,0] op_sel_hi:[1,0,0]
    v_fma_mix_f32 v44, v20, 1.0, v76 op_sel:[0,0,0] op_sel_hi:[1,0,0]
    v_fma_mix_f32 v45, v20, 1.0, v77 op_sel:[1,0,0] op_sel_hi:[1,0,0]
    v_fma_mix_f32 v46, v21, 1.0, v78 op_sel:[0,0,0] op_sel_hi:[1,0,0]
    v_fma_mix_f32 v47, v21, 1.0, v79 op_sel:[1,0,0] op_sel_hi:[1,0,0]
    v_fma_mix_f32 v48, v22, 1.0, v80 op_sel:[0,0,0] op_sel_hi:[1,0,0]
    v_fma_mix_f32 v49, v22, 1.0, v81 op_sel:[1,0,0] op_sel_hi:[1,0,0]
    v_fma_mix_f32 v50, v23, 1.0, v82 op_sel:[0,0,0] op_sel_hi:[1,0,0]
    v_fma_mix_f32 v51, v23, 1.0, v83 op_sel:[1,0,0] op_sel_hi:[1,0,0]
    v_fma_mix_f32 v52, v24, 1.0, v84 op_sel:[0,0,0] op_sel_hi:[1,0,0]
    v_fma_mix_f32 v53, v24, 1.0, v85 op_sel:[1,0,0] op_sel_hi:[1,0,0]
    v_fma_mix_f32 v54, v25, 1.0, v86 op_sel:[0,0,0] op_sel_hi:[1,0,0]
    v_fma_mix_f32 v55, v25, 1.0, v87 op_sel:[1,0,0] op_sel_hi:[1,0,0]
    v_cvt_pk_bf16_f32 v33, v32, v33
    v_cvt_pk_bf16_f32 v35, v34, v35
    v_lshlrev_b32 v32, 16, v33
    v_lshlrev_b32 v34, 16, v35
    v_and_b32 v33, s99, v33
    v_and_b32 v35, s99, v35
    v_cvt_pk_bf16_f32 v37, v36, v37
    v_cvt_pk_bf16_f32 v39, v38, v39
    v_lshlrev_b32 v36, 16, v37
    v_lshlrev_b32 v38, 16, v39
    v_and_b32 v37, s99, v37
    v_and_b32 v39, s99, v39
    v_cvt_pk_bf16_f32 v41, v40, v41
    v_cvt_pk_bf16_f32 v43, v42, v43
    v_lshlrev_b32 v40, 16, v41
    v_lshlrev_b32 v42, 16, v43
    v_and_b32 v41, s99, v41
    v_and_b32 v43, s99, v43
    v_mul_f32 v96, s98, v32
    v_mul_f32 v97, s98, v33
    v_mul_f32 v98, s98, v34
    v_mul_f32 v99, s98, v35
    v_mul_f32 v100, s98, v36
    v_mul_f32 v101, s98, v37
    v_mul_f32 v102, s98, v38
    v_mul_f32 v103, s98, v39
    v_mul_f32 v104, s98, v40
    v_mul_f32 v105, s98, v41
    v_mul_f32 v106, s98, v42
    v_mul_f32 v107, s98, v43
    v_exp_f32 v96, -v96
    v_exp_f32 v97, -v97
    v_exp_f32 v98, -v98
    v_exp_f32 v99, -v99
    v_exp_f32 v100, -v100
    v_exp_f32 v101, -v101
    v_exp_f32 v102, -v102
    v_exp_f32 v103, -v103
    v_exp_f32 v104, -v104
    v_exp_f32 v105, -v105
    v_exp_f32 v106, -v106
    v_exp_f32 v107, -v107
    v_add_f32 v96, 1.0, v96
    v_add_f32 v97, 1.0, v97
    v_add_f32 v98, 1.0, v98
    v_add_f32 v99, 1.0, v99
    v_add_f32 v100, 1.0, v100
    v_add_f32 v101, 1.0, v101
    v_add_f32 v102, 1.0, v102
    v_add_f32 v103, 1.0, v103
    v_add_f32 v104, 1.0, v104
    v_add_f32 v105, 1.0, v105
    v_add_f32 v106, 1.0, v106
    v_add_f32 v107, 1.0, v107
    v_rcp_f32 v96, v96
    v_rcp_f32 v97, v97
    v_rcp_f32 v98, v98
    v_rcp_f32 v99, v99
    v_rcp_f32 v100, v100
    v_rcp_f32 v101, v101
    v_rcp_f32 v102, v102
    v_rcp_f32 v103, v103
    v_rcp_f32 v104, v104
    v_rcp_f32 v105, v105
    v_rcp_f32 v106, v106
    v_rcp_f32 v107, v107
    v_mul_f32 v32, v32, v96
    v_mul_f32 v33, v33, v97
    v_mul_f32 v34, v34, v98
    v_mul_f32 v35, v35, v99
    v_mul_f32 v36, v36, v100
    v_mul_f32 v37, v37, v101
    v_mul_f32 v38, v38, v102
    v_mul_f32 v39, v39, v103
    v_mul_f32 v40, v40, v104
    v_mul_f32 v41, v41, v105
    v_mul_f32 v42, v42, v106
    v_mul_f32 v43, v43, v107
    v_cvt_pk_bf16_f32 v33, v32, v33
    v_cvt_pk_bf16_f32 v35, v34, v35
    v_lshlrev_b32 v32, 16, v33
    v_lshlrev_b32 v34, 16, v35
    v_and_b32 v33, s99, v33
    v_and_b32 v35, s99, v35
    v_cvt_pk_bf16_f32 v37, v36, v37
    v_cvt_pk_bf16_f32 v39, v38, v39
    v_lshlrev_b32 v36, 16, v37
    v_lshlrev_b32 v38, 16, v39
    v_and_b32 v37, s99, v37
    v_and_b32 v39, s99, v39
    v_cvt_pk_bf16_f32 v41, v40, v41
    v_cvt_pk_bf16_f32 v43, v42, v43
    v_lshlrev_b32 v40, 16, v41
    v_lshlrev_b32 v42, 16, v43
    v_and_b32 v41, s99, v41
    v_and_b32 v43, s99, v43
    v_fmac_f32 v64, v44, v32
    v_fmac_f32 v65, v45, v33
    v_fmac_f32 v66, v46, v34
    v_fmac_f32 v67, v47, v35
    v_fmac_f32 v68, v48, v36
    v_fmac_f32 v69, v49, v37
    v_fmac_f32 v70, v50, v38
    v_fmac_f32 v71, v51, v39
    v_fmac_f32 v72, v52, v40
    v_fmac_f32 v73, v53, v41
    v_fmac_f32 v74, v54, v42
    v_fmac_f32 v75, v55, v43
    s_and_b32 s49, s48, 3
    s_cmp_eq_u32 s49, 3
    s_cselect_b64 exec, -1, 0
    s_add_u32 s50, s76, s64
    s_lshl_b32 s50, s50, 1
    s_add_u32 s51, s50, 4608
    buffer_store_dword v64, v5, s[32:35], s50 offen offset:0
    buffer_store_dword v65, v5, s[32:35], s50 offen offset:2304
    buffer_store_dword v66, v5, s[32:35], s51 offen offset:0
    buffer_store_dword v67, v5, s[32:35], s51 offen offset:2304
    s_mov_b64 exec, -1
    s_add_u32 s50, s77, s64
    s_lshl_b32 s50, s50, 1
    s_add_u32 s51, s50, 4608
    buffer_store_dword v68, v5, s[32:35], s50 offen offset:0
    buffer_store_dword v69, v5, s[32:35], s50 offen offset:2304
    buffer_store_dword v70, v5, s[32:35], s51 offen offset:0
    buffer_store_dword v71, v5, s[32:35], s51 offen offset:2304
    s_add_u32 s50, s78, s64
    s_lshl_b32 s50, s50, 1
    s_add_u32 s51, s50, 4608
    buffer_store_dword v72, v5, s[32:35], s50 offen offset:0
    buffer_store_dword v73, v5, s[32:35], s50 offen offset:2304
    buffer_store_dword v74, v5, s[32:35], s51 offen offset:0
    buffer_store_dword v75, v5, s[32:35], s51 offen offset:2304
    s_endpgm
.slow_6:
    v_mfma_f32_32x32x16_bf16 v[32:47], v[72:75], v[16:19], 0
    ds_read_b64_tr_b16 v[28:29], v8 offset:10240
    ds_read_b64_tr_b16 v[30:31], v8 offset:11264
    ds_read_b128 a[32:35], v15 offset:0
    ds_read_b128 a[36:39], v15 offset:1024
    s_add_u32 m0, s52, 32768
    s_add_u32 s49, s67, s72
    buffer_load_dwordx4 v2, s[12:15], s49 offen lds
    v_mfma_f32_32x32x16_bf16 v[32:47], v[76:79], v[20:23], v[32:47]
    ds_read_b64_tr_b16 v[16:17], v6 offset:49152
    ds_read_b64_tr_b16 v[18:19], v6 offset:50176
    s_lshr_b32 s49, s48, 2
    s_lshl_b32 s50, s47, 3
    s_lshl_b32 s51, s45, 1
    s_add_u32 s50, s50, s51
    s_add_u32 s50, s50, s49
    s_mul_i32 s50, s50, 36864
    s_lshl_b32 s51, s46, 7
    s_add_u32 s50, s50, s51
    v_lshrrev_b32 v0, 9, v12
    v_bfe_u32 v13, v12, 6, 2
    v_lshl_add_u32 v0, v0, 2, v13
    v_mul_u32_u24 v0, 2304, v0
    v_bfe_u32 v13, v12, 8, 1
    v_lshl_add_u32 v0, v13, 6, v0
    v_and_b32 v13, 0x30, v12
    v_add_u32 v0, v0, v13
    s_movk_i32 s51, 1024
    s_cmp_lt_u32 s49, 2
    s_cselect_b32 s56, s50, s56
    s_cselect_b32 s20, s32, s16
    s_cselect_b32 s21, s33, s17
    s_cselect_b32 s22, s34, s18
    s_cselect_b32 s8, 1, 7
    s_cselect_b32 s9, 18432, s51
    s_cselect_b64 vcc, -1, 0
    s_nop 1
    v_cndmask_b32 v1, v12, v0, vcc

    s_add_u32 m0, s52, 33792
    s_add_u32 s49, s67, s72
    s_add_u32 s49, s49, 9216
    buffer_load_dwordx4 v2, s[12:15], s49 offen lds
    s_waitcnt lgkmcnt(6)
    v_mfma_f32_32x32x16_bf16 v[32:47], v[80:83], v[24:27], v[32:47]
    ds_read_b64_tr_b16 v[20:21], v6 offset:51200
    ds_read_b64_tr_b16 v[22:23], v6 offset:52224
    v_mul_f32 v64, s98, v48
    v_mul_f32 v66, s98, v49
    v_mul_f32 v68, s98, v50
    v_mul_f32 v70, s98, v51
    v_exp_f32 v64, v64
    v_exp_f32 v66, v66
    v_exp_f32 v68, v68
    v_exp_f32 v70, v70
    v_fmaak_f32 v65, -0.5, v64, 0xbf800000
    s_waitcnt lgkmcnt(6)
    v_mfma_f32_32x32x16_bf16 v[32:47], v[84:87], v[28:31], v[32:47]
    ds_read_b64_tr_b16 v[24:25], v6 offset:57344
    ds_read_b64_tr_b16 v[26:27], v6 offset:58368
    v_fmaak_f32 v67, -0.5, v66, 0xbf800000
    v_fmaak_f32 v69, -0.5, v68, 0xbf800000
    v_fmaak_f32 v71, -0.5, v70, 0xbf800000
    v_fmaak_f32 v65, v64, v65, 0xbf800000
    v_fmaak_f32 v67, v66, v67, 0xbf800000
    v_fmaak_f32 v69, v68, v69, 0xbf800000
    v_fmaak_f32 v71, v70, v71, 0xbf800000
    v_rcp_f32 v65, v65
    s_waitcnt lgkmcnt(4)
    v_mfma_f32_32x32x16_bf16 v[32:47], v[88:91], v[16:19], v[32:47]
    ds_read_b64_tr_b16 v[28:29], v6 offset:59392
    ds_read_b64_tr_b16 v[30:31], v6 offset:60416
    v_rcp_f32 v67, v67
    v_rcp_f32 v69, v69
    v_rcp_f32 v71, v71
    v_fmac_f32 v48, v48, v65
    v_fmac_f32 v49, v49, v67
    v_fmac_f32 v50, v50, v69
    v_fmac_f32 v51, v51, v71
    v_cvt_pk_bf16_f32 v48, v48, v49
    v_cvt_pk_bf16_f32 v49, v50, v51
    s_waitcnt lgkmcnt(4)
    v_mfma_f32_32x32x16_bf16 v[32:47], v[92:95], v[20:23], v[32:47]
    ds_read_b64_tr_b16 v[16:17], v7 offset:0
    ds_read_b64_tr_b16 v[18:19], v7 offset:1024
    v_mul_f32 v64, s98, v52
    v_mul_f32 v66, s98, v53
    v_mul_f32 v68, s98, v54
    v_mul_f32 v70, s98, v55
    v_exp_f32 v64, v64
    v_exp_f32 v66, v66
    v_exp_f32 v68, v68
    v_exp_f32 v70, v70
    v_fmaak_f32 v65, -0.5, v64, 0xbf800000
    s_waitcnt lgkmcnt(4)
    v_mfma_f32_32x32x16_bf16 v[32:47], v[96:99], v[24:27], v[32:47]
    ds_read_b64_tr_b16 v[20:21], v7 offset:2048
    ds_read_b64_tr_b16 v[22:23], v7 offset:3072
    v_fmaak_f32 v67, -0.5, v66, 0xbf800000
    v_fmaak_f32 v69, -0.5, v68, 0xbf800000
    v_fmaak_f32 v71, -0.5, v70, 0xbf800000
    v_fmaak_f32 v65, v64, v65, 0xbf800000
    v_fmaak_f32 v67, v66, v67, 0xbf800000
    v_fmaak_f32 v69, v68, v69, 0xbf800000
    v_fmaak_f32 v71, v70, v71, 0xbf800000
    v_rcp_f32 v65, v65
    s_waitcnt lgkmcnt(4)
    v_mfma_f32_32x32x16_bf16 v[32:47], v[100:103], v[28:31], v[32:47]
    s_barrier
    s_waitcnt lgkmcnt(2)
    v_mfma_f32_32x32x16_bf16 v[32:47], v[104:107], v[16:19], v[32:47]
    ds_read_b64_tr_b16 v[24:25], v11 offset:0
    ds_read_b64_tr_b16 v[26:27], v11 offset:1024
    ds_read_b64_tr_b16 v[28:29], v11 offset:2048
    ds_read_b64_tr_b16 v[30:31], v11 offset:3072
    v_rcp_f32 v67, v67
    v_rcp_f32 v69, v69
    v_rcp_f32 v71, v71
    v_fmac_f32 v52, v52, v65
    v_fmac_f32 v53, v53, v67
    v_fmac_f32 v54, v54, v69
    v_fmac_f32 v55, v55, v71
    v_cvt_pk_bf16_f32 v50, v52, v53
    v_cvt_pk_bf16_f32 v51, v54, v55
    v_mul_f32 v64, s98, v56
    v_mul_f32 v66, s98, v57
    v_mul_f32 v68, s98, v58
    v_mul_f32 v70, s98, v59
    v_exp_f32 v64, v64
    v_exp_f32 v66, v66
    v_exp_f32 v68, v68
    v_exp_f32 v70, v70
    v_fmaak_f32 v65, -0.5, v64, 0xbf800000
    s_add_u32 m0, s52, 0
    s_add_u32 s49, s68, s72
    buffer_load_dwordx4 v2, s[12:15], s49 offen lds
    s_waitcnt lgkmcnt(4)
    v_mfma_f32_32x32x16_bf16 v[32:47], v[108:111], v[20:23], v[32:47]
    ds_read_b64_tr_b16 v[16:17], v11 offset:8192
    ds_read_b64_tr_b16 v[18:19], v11 offset:9216
    v_fmaak_f32 v67, -0.5, v66, 0xbf800000
    v_fmaak_f32 v69, -0.5, v68, 0xbf800000
    v_fmaak_f32 v71, -0.5, v70, 0xbf800000
    v_fmaak_f32 v65, v64, v65, 0xbf800000
    v_fmaak_f32 v67, v66, v67, 0xbf800000
    v_fmaak_f32 v69, v68, v69, 0xbf800000
    v_fmaak_f32 v71, v70, v71, 0xbf800000
    v_rcp_f32 v65, v65
    s_add_u32 m0, s52, 1024
    s_add_u32 s49, s68, s72
    s_add_u32 s49, s49, 9216
    buffer_load_dwordx4 v2, s[12:15], s49 offen lds
    s_waitcnt lgkmcnt(4)
    v_mfma_f32_32x32x16_bf16 v[32:47], a[0:3], v[24:27], v[32:47]
    ds_read_b64_tr_b16 v[20:21], v11 offset:10240
    ds_read_b64_tr_b16 v[22:23], v11 offset:11264
    v_rcp_f32 v67, v67
    v_rcp_f32 v69, v69
    v_rcp_f32 v71, v71
    v_fmac_f32 v56, v56, v65
    v_fmac_f32 v57, v57, v67
    v_fmac_f32 v58, v58, v69
    v_fmac_f32 v59, v59, v71
    v_cvt_pk_bf16_f32 v52, v56, v57
    v_cvt_pk_bf16_f32 v53, v58, v59
    s_waitcnt lgkmcnt(4)
    v_mfma_f32_32x32x16_bf16 v[32:47], a[4:7], v[28:31], v[32:47]
    ds_read_b64_tr_b16 v[24:25], v9 offset:49152
    ds_read_b64_tr_b16 v[26:27], v9 offset:50176
    v_mul_f32 v64, s98, v60
    v_mul_f32 v66, s98, v61
    v_mul_f32 v68, s98, v62
    v_mul_f32 v70, s98, v63
    v_exp_f32 v64, v64
    v_exp_f32 v66, v66
    v_exp_f32 v68, v68
    v_exp_f32 v70, v70
    v_fmaak_f32 v65, -0.5, v64, 0xbf800000
    s_waitcnt lgkmcnt(4)
    v_mfma_f32_32x32x16_bf16 v[32:47], a[8:11], v[16:19], v[32:47]
    ds_read_b64_tr_b16 v[28:29], v9 offset:51200
    ds_read_b64_tr_b16 v[30:31], v9 offset:52224
    v_fmaak_f32 v67, -0.5, v66, 0xbf800000
    v_fmaak_f32 v69, -0.5, v68, 0xbf800000
    v_fmaak_f32 v71, -0.5, v70, 0xbf800000
    v_fmaak_f32 v65, v64, v65, 0xbf800000
    v_fmaak_f32 v67, v66, v67, 0xbf800000
    v_fmaak_f32 v69, v68, v69, 0xbf800000
    v_fmaak_f32 v71, v70, v71, 0xbf800000
    v_rcp_f32 v65, v65
    s_waitcnt lgkmcnt(4)
    v_mfma_f32_32x32x16_bf16 v[32:47], a[12:15], v[20:23], v[32:47]
    ds_read_b64_tr_b16 v[16:17], v9 offset:57344
    ds_read_b64_tr_b16 v[18:19], v9 offset:58368
    v_rcp_f32 v67, v67
    v_rcp_f32 v69, v69
    v_rcp_f32 v71, v71
    v_fmac_f32 v60, v60, v65
    v_fmac_f32 v61, v61, v67
    v_fmac_f32 v62, v62, v69
    v_fmac_f32 v63, v63, v71
    v_cvt_pk_bf16_f32 v54, v60, v61
    v_cvt_pk_bf16_f32 v55, v62, v63
    s_waitcnt lgkmcnt(4)
    v_mfma_f32_32x32x16_bf16 v[32:47], a[16:19], v[24:27], v[32:47]
    ds_read_b64_tr_b16 v[20:21], v9 offset:59392
    ds_read_b64_tr_b16 v[22:23], v9 offset:60416
    ds_write_b128 v14, v[48:51] offset:16384
    ds_write_b128 v14, v[52:55] offset:17408
    s_waitcnt lgkmcnt(6)
    v_mfma_f32_32x32x16_bf16 v[32:47], a[20:23], v[28:31], v[32:47]
    s_waitcnt vmcnt(8) lgkmcnt(0)
    s_barrier
    v_mfma_f32_32x32x16_bf16 v[32:47], a[24:27], v[16:19], v[32:47]
    ds_read_b64_tr_b16 v[24:25], v10 offset:0
    ds_read_b64_tr_b16 v[26:27], v10 offset:1024
    ds_read_b64_tr_b16 v[28:29], v10 offset:2048
    ds_read_b64_tr_b16 v[30:31], v10 offset:3072
    ds_read_b128 a[40:43], v15 offset:16384
    ds_read_b128 a[44:47], v15 offset:17408
    ds_read_b128 a[48:51], v14 offset:16384
    ds_read_b128 a[52:55], v14 offset:17408
    s_add_u32 m0, s52, 131072
    s_add_u32 s49, s69, s72
    buffer_load_dwordx4 v2, s[12:15], s49 offen lds
    v_mfma_f32_32x32x16_bf16 v[32:47], a[28:31], v[20:23], v[32:47]
    ds_read_b64_tr_b16 v[16:17], v7 offset:8192
    ds_read_b64_tr_b16 v[18:19], v7 offset:9216
    s_add_u32 m0, s52, 132096
    s_add_u32 s49, s69, s72
    s_add_u32 s49, s49, 9216
    buffer_load_dwordx4 v2, s[12:15], s49 offen lds
    s_waitcnt lgkmcnt(8)
    v_mfma_f32_32x32x16_bf16 v[32:47], a[32:35], v[24:27], v[32:47]
    ds_read_b64_tr_b16 v[20:21], v7 offset:10240
    ds_read_b64_tr_b16 v[22:23], v7 offset:11264
    s_waitcnt lgkmcnt(8)
    v_mfma_f32_32x32x16_bf16 v[32:47], a[36:39], v[28:31], v[32:47]
    ds_read_b64_tr_b16 v[24:25], v10 offset:8192
    ds_read_b64_tr_b16 v[26:27], v10 offset:9216
    s_waitcnt lgkmcnt(4)
    v_mfma_f32_32x32x16_bf16 v[32:47], a[48:51], v[16:19], v[32:47]
    ds_read_b64_tr_b16 v[28:29], v10 offset:10240
    ds_read_b64_tr_b16 v[30:31], v10 offset:11264
    s_waitcnt lgkmcnt(4)
    v_mfma_f32_32x32x16_bf16 v[32:47], a[52:55], v[20:23], v[32:47]
    ds_read_b64_tr_b16 v[16:17], v7 offset:16384
    ds_read_b64_tr_b16 v[18:19], v7 offset:17408
    s_waitcnt lgkmcnt(4)
    v_mfma_f32_32x32x16_bf16 v[32:47], a[40:43], v[24:27], v[32:47]
    ds_read_b64_tr_b16 v[20:21], v7 offset:18432
    ds_read_b64_tr_b16 v[22:23], v7 offset:19456
    s_waitcnt lgkmcnt(4)
    v_mfma_f32_32x32x16_bf16 v[32:47], a[44:47], v[28:31], v[32:47]
    s_waitcnt vmcnt(8)
    s_barrier
    s_waitcnt lgkmcnt(2)
    v_mfma_f32_32x32x16_bf16 v[48:63], v[72:75], v[16:19], 0
    ds_read_b64_tr_b16 v[24:25], v7 offset:24576
    ds_read_b64_tr_b16 v[26:27], v7 offset:25600
    ds_read_b64_tr_b16 v[28:29], v7 offset:26624
    ds_read_b64_tr_b16 v[30:31], v7 offset:27648
    s_add_u32 m0, s52, 16384
    s_add_u32 s49, s67, s73
    buffer_load_dwordx4 v2, s[12:15], s49 offen lds
    s_waitcnt lgkmcnt(4)
    v_mfma_f32_32x32x16_bf16 v[48:63], v[76:79], v[20:23], v[48:63]
    ds_read_b64_tr_b16 v[16:17], v10 offset:16384
    ds_read_b64_tr_b16 v[18:19], v10 offset:17408
    s_add_u32 m0, s52, 17408
    s_add_u32 s49, s67, s73
    s_add_u32 s49, s49, 9216
    buffer_load_dwordx4 v2, s[12:15], s49 offen lds
    s_waitcnt lgkmcnt(4)
    v_mfma_f32_32x32x16_bf16 v[48:63], v[80:83], v[24:27], v[48:63]
    ds_read_b64_tr_b16 v[20:21], v10 offset:18432
    ds_read_b64_tr_b16 v[22:23], v10 offset:19456
    v_cvt_pk_f16_f32 v32, v32, v33
    v_cvt_pk_f16_f32 v33, v34, v35
    v_cvt_pk_f16_f32 v34, v36, v37
    s_add_u32 m0, s52, 49152
    s_add_u32 s49, s68, s73
    buffer_load_dwordx4 v2, s[12:15], s49 offen lds
    s_waitcnt lgkmcnt(4)
    v_mfma_f32_32x32x16_bf16 v[48:63], v[84:87], v[28:31], v[48:63]
    ds_read_b64_tr_b16 v[24:25], v10 offset:24576
    ds_read_b64_tr_b16 v[26:27], v10 offset:25600
    v_cvt_pk_f16_f32 v35, v38, v39
    v_cvt_pk_f16_f32 v36, v40, v41
    s_add_u32 m0, s52, 50176
    s_add_u32 s49, s68, s73
    s_add_u32 s49, s49, 9216
    buffer_load_dwordx4 v2, s[12:15], s49 offen lds
    s_waitcnt lgkmcnt(4)
    v_mfma_f32_32x32x16_bf16 v[48:63], a[0:3], v[16:19], v[48:63]
    ds_read_b64_tr_b16 v[28:29], v10 offset:26624
    ds_read_b64_tr_b16 v[30:31], v10 offset:27648
    v_cvt_pk_f16_f32 v37, v42, v43
    v_cvt_pk_f16_f32 v38, v44, v45
    v_cvt_pk_f16_f32 v39, v46, v47
    s_waitcnt lgkmcnt(4)
    v_mfma_f32_32x32x16_bf16 v[48:63], a[4:7], v[20:23], v[48:63]
    ds_read_b64_tr_b16 v[16:17], v7 offset:32768
    ds_read_b64_tr_b16 v[18:19], v7 offset:33792
    v_mov_b32 v64, 0
    v_mov_b32 v65, 0
    v_mov_b32 v66, 0
    v_mov_b32 v67, 0
    v_mov_b32 v68, 0
    v_mov_b32 v69, 0
    v_mov_b32 v70, 0
    v_mov_b32 v71, 0
    s_mov_b32 s82, 30000
    s_lshl_b32 s50, s70, s8
    s_add_u32 s50, s50, s56
    s_add_u32 s51, s50, s9
    buffer_store_dwordx4 v[32:35], v1, s[20:23], s50 offen sc0 sc1
    buffer_store_dwordx4 v[36:39], v1, s[20:23], s51 offen sc0 sc1
    s_waitcnt lgkmcnt(4)
    v_mfma_f32_32x32x16_bf16 v[48:63], a[8:11], v[24:27], v[48:63]
    ds_read_b64_tr_b16 v[20:21], v7 offset:34816
    ds_read_b64_tr_b16 v[22:23], v7 offset:35840
    s_waitcnt lgkmcnt(4)
    v_mfma_f32_32x32x16_bf16 v[48:63], a[12:15], v[28:31], v[48:63]
    s_waitcnt vmcnt(12)
    s_barrier
    s_waitcnt lgkmcnt(2)
    v_mfma_f32_32x32x16_bf16 v[48:63], v[88:91], v[16:19], v[48:63]
    ds_read_b64_tr_b16 v[24:25], v7 offset:40960
    ds_read_b64_tr_b16 v[26:27], v7 offset:41984
    ds_read_b64_tr_b16 v[28:29], v7 offset:43008
    ds_read_b64_tr_b16 v[30:31], v7 offset:44032
    s_add_u32 m0, s52, 65536
    s_add_u32 s49, s69, s73
    buffer_load_dwordx4 v2, s[12:15], s49 offen lds
    s_waitcnt lgkmcnt(4)
    v_mfma_f32_32x32x16_bf16 v[48:63], v[92:95], v[20:23], v[48:63]
    ds_read_b64_tr_b16 v[16:17], v10 offset:32768
    ds_read_b64_tr_b16 v[18:19], v10 offset:33792
    s_add_u32 m0, s52, 66560
    s_add_u32 s49, s69, s73
    s_add_u32 s49, s49, 9216
    buffer_load_dwordx4 v2, s[12:15], s49 offen lds
    s_waitcnt lgkmcnt(4)
    v_mfma_f32_32x32x16_bf16 v[48:63], v[96:99], v[24:27], v[48:63]
    ds_read_b64_tr_b16 v[20:21], v10 offset:34816
    ds_read_b64_tr_b16 v[22:23], v10 offset:35840
    s_add_u32 m0, s52, 81920
    s_add_u32 s49, s67, s74
    buffer_load_dwordx4 v2, s[12:15], s49 offen lds
    s_waitcnt lgkmcnt(4)
    v_mfma_f32_32x32x16_bf16 v[48:63], v[100:103], v[28:31], v[48:63]
    ds_read_b64_tr_b16 v[24:25], v10 offset:40960
    ds_read_b64_tr_b16 v[26:27], v10 offset:41984
    s_add_u32 m0, s52, 82944
    s_add_u32 s49, s67, s74
    s_add_u32 s49, s49, 9216
    buffer_load_dwordx4 v2, s[12:15], s49 offen lds
    s_waitcnt lgkmcnt(4)
    v_mfma_f32_32x32x16_bf16 v[48:63], a[16:19], v[16:19], v[48:63]
    ds_read_b64_tr_b16 v[28:29], v10 offset:43008
    ds_read_b64_tr_b16 v[30:31], v10 offset:44032
    s_waitcnt lgkmcnt(4)
    v_mfma_f32_32x32x16_bf16 v[48:63], a[20:23], v[20:23], v[48:63]
    ds_read_b64_tr_b16 v[16:17], v7 offset:49152
    ds_read_b64_tr_b16 v[18:19], v7 offset:50176
    s_waitcnt lgkmcnt(4)
    v_mfma_f32_32x32x16_bf16 v[48:63], a[24:27], v[24:27], v[48:63]
    ds_read_b64_tr_b16 v[20:21], v7 offset:51200
    ds_read_b64_tr_b16 v[22:23], v7 offset:52224
    v_mov_b32 v14, 1
    s_waitcnt vmcnt(4)
    s_mov_b64 exec, 1
    buffer_store_dword v14, off, s[16:19], s42 sc0 sc1
    s_mov_b64 exec, -1
    s_waitcnt lgkmcnt(4)
    v_mfma_f32_32x32x16_bf16 v[48:63], a[28:31], v[28:31], v[48:63]
    s_barrier
    s_waitcnt lgkmcnt(2)
    v_mfma_f32_32x32x16_bf16 v[48:63], v[104:107], v[16:19], v[48:63]
    ds_read_b64_tr_b16 v[24:25], v7 offset:57344
    ds_read_b64_tr_b16 v[26:27], v7 offset:58368
    ds_read_b64_tr_b16 v[28:29], v7 offset:59392
    ds_read_b64_tr_b16 v[30:31], v7 offset:60416
    s_add_u32 m0, s52, 98304
    s_add_u32 s49, s68, s74
    buffer_load_dwordx4 v2, s[12:15], s49 offen lds
    s_waitcnt lgkmcnt(4)
    v_mfma_f32_32x32x16_bf16 v[48:63], v[108:111], v[20:23], v[48:63]
    ds_read_b64_tr_b16 v[16:17], v10 offset:49152
    ds_read_b64_tr_b16 v[18:19], v10 offset:50176
    s_add_u32 m0, s52, 99328
    s_add_u32 s49, s68, s74
    s_add_u32 s49, s49, 9216
    buffer_load_dwordx4 v2, s[12:15], s49 offen lds
    s_waitcnt lgkmcnt(4)
    v_mfma_f32_32x32x16_bf16 v[48:63], a[48:51], v[24:27], v[48:63]
    ds_read_b64_tr_b16 v[20:21], v10 offset:51200
    ds_read_b64_tr_b16 v[22:23], v10 offset:52224
    s_waitcnt lgkmcnt(4)
    v_mfma_f32_32x32x16_bf16 v[48:63], a[52:55], v[28:31], v[48:63]
    ds_read_b64_tr_b16 v[24:25], v10 offset:57344
    ds_read_b64_tr_b16 v[26:27], v10 offset:58368
    s_waitcnt lgkmcnt(4)
    v_mfma_f32_32x32x16_bf16 v[48:63], a[32:35], v[16:19], v[48:63]
    ds_read_b64_tr_b16 v[28:29], v10 offset:59392
    ds_read_b64_tr_b16 v[30:31], v10 offset:60416
    s_waitcnt lgkmcnt(4)
    v_mfma_f32_32x32x16_bf16 v[48:63], a[36:39], v[20:23], v[48:63]
    ds_read_b64_tr_b16 v[16:17], v6 offset:32768
    ds_read_b64_tr_b16 v[18:19], v6 offset:33792
    s_waitcnt lgkmcnt(4)
    v_mfma_f32_32x32x16_bf16 v[48:63], a[40:43], v[24:27], v[48:63]
    ds_read_b64_tr_b16 v[20:21], v6 offset:34816
    ds_read_b64_tr_b16 v[22:23], v6 offset:35840
    s_waitcnt lgkmcnt(4)
    v_mfma_f32_32x32x16_bf16 v[48:63], a[44:47], v[28:31], v[48:63]
    s_barrier
    s_waitcnt lgkmcnt(2)
    v_mfma_f32_32x32x16_bf16 v[32:47], v[72:75], v[16:19], 0
    ds_read_b64_tr_b16 v[24:25], v6 offset:40960
    ds_read_b64_tr_b16 v[26:27], v6 offset:41984
    ds_read_b64_tr_b16 v[28:29], v6 offset:43008
    ds_read_b64_tr_b16 v[30:31], v6 offset:44032
    s_add_u32 m0, s52, 114688
    s_add_u32 s49, s69, s74
    buffer_load_dwordx4 v2, s[12:15], s49 offen lds
    s_waitcnt lgkmcnt(4)
    v_mfma_f32_32x32x16_bf16 v[32:47], v[76:79], v[20:23], v[32:47]
    ds_read_b64_tr_b16 v[16:17], v9 offset:32768
    ds_read_b64_tr_b16 v[18:19], v9 offset:33792
    s_add_u32 m0, s52, 115712
    s_add_u32 s49, s69, s74
    s_add_u32 s49, s49, 9216
    buffer_load_dwordx4 v2, s[12:15], s49 offen lds
    s_waitcnt lgkmcnt(4)
    v_mfma_f32_32x32x16_bf16 v[32:47], v[80:83], v[24:27], v[32:47]
    ds_read_b64_tr_b16 v[20:21], v9 offset:34816
    ds_read_b64_tr_b16 v[22:23], v9 offset:35840
    v_cvt_pk_f16_f32 v48, v48, v49
    v_cvt_pk_f16_f32 v49, v50, v51
    v_cvt_pk_f16_f32 v50, v52, v53
    s_waitcnt lgkmcnt(4)
    v_mfma_f32_32x32x16_bf16 v[32:47], v[84:87], v[28:31], v[32:47]
    ds_read_b64_tr_b16 v[24:25], v9 offset:40960
    ds_read_b64_tr_b16 v[26:27], v9 offset:41984
    v_cvt_pk_f16_f32 v51, v54, v55
    v_cvt_pk_f16_f32 v52, v56, v57
    s_waitcnt lgkmcnt(4)
    v_mfma_f32_32x32x16_bf16 v[32:47], a[0:3], v[16:19], v[32:47]
    ds_read_b64_tr_b16 v[28:29], v9 offset:43008
    ds_read_b64_tr_b16 v[30:31], v9 offset:44032
    v_cvt_pk_f16_f32 v53, v58, v59
    v_cvt_pk_f16_f32 v54, v60, v61
    v_cvt_pk_f16_f32 v55, v62, v63
    s_waitcnt lgkmcnt(4)
    v_mfma_f32_32x32x16_bf16 v[32:47], a[4:7], v[20:23], v[32:47]
    ds_read_b64_tr_b16 v[16:17], v6 offset:0
    ds_read_b64_tr_b16 v[18:19], v6 offset:1024
    s_lshl_b32 s50, s71, s8
    s_add_u32 s50, s50, s56
    s_add_u32 s51, s50, s9
    buffer_store_dwordx4 v[48:51], v1, s[20:23], s50 offen sc0 sc1
    buffer_store_dwordx4 v[52:55], v1, s[20:23], s51 offen sc0 sc1
    buffer_load_dword v13, off, s[16:19], s43 sc0 sc1
    s_waitcnt lgkmcnt(4)
    v_mfma_f32_32x32x16_bf16 v[32:47], a[8:11], v[24:27], v[32:47]
    ds_read_b64_tr_b16 v[20:21], v6 offset:2048
    ds_read_b64_tr_b16 v[22:23], v6 offset:3072
    s_waitcnt lgkmcnt(4)
    v_mfma_f32_32x32x16_bf16 v[32:47], a[12:15], v[28:31], v[32:47]
    s_barrier
    s_waitcnt lgkmcnt(2)
    v_mfma_f32_32x32x16_bf16 v[32:47], v[88:91], v[16:19], v[32:47]
    ds_read_b64_tr_b16 v[24:25], v6 offset:8192
    ds_read_b64_tr_b16 v[26:27], v6 offset:9216
    ds_read_b64_tr_b16 v[28:29], v6 offset:10240
    ds_read_b64_tr_b16 v[30:31], v6 offset:11264
    s_add_u32 m0, s52, 32768
    s_add_u32 s49, s67, s75
    buffer_load_dwordx4 v2, s[12:15], s49 offen lds
    s_waitcnt lgkmcnt(4)
    v_mfma_f32_32x32x16_bf16 v[32:47], v[92:95], v[20:23], v[32:47]
    ds_read_b64_tr_b16 v[16:17], v9 offset:0
    ds_read_b64_tr_b16 v[18:19], v9 offset:1024
    s_add_u32 m0, s52, 33792
    s_add_u32 s49, s67, s75
    s_add_u32 s49, s49, 9216
    buffer_load_dwordx4 v2, s[12:15], s49 offen lds
    s_waitcnt lgkmcnt(4)
    v_mfma_f32_32x32x16_bf16 v[32:47], v[96:99], v[24:27], v[32:47]
    ds_read_b64_tr_b16 v[20:21], v9 offset:2048
    ds_read_b64_tr_b16 v[22:23], v9 offset:3072
    s_waitcnt lgkmcnt(4)
    v_mfma_f32_32x32x16_bf16 v[32:47], v[100:103], v[28:31], v[32:47]
    ds_read_b64_tr_b16 v[24:25], v9 offset:8192
    ds_read_b64_tr_b16 v[26:27], v9 offset:9216
    s_waitcnt lgkmcnt(4)
    v_mfma_f32_32x32x16_bf16 v[32:47], a[16:19], v[16:19], v[32:47]
    ds_read_b64_tr_b16 v[28:29], v9 offset:10240
    ds_read_b64_tr_b16 v[30:31], v9 offset:11264
    s_waitcnt lgkmcnt(4)
    v_mfma_f32_32x32x16_bf16 v[32:47], a[20:23], v[20:23], v[32:47]
    ds_read_b64_tr_b16 v[16:17], v8 offset:0
    ds_read_b64_tr_b16 v[18:19], v8 offset:1024
    s_waitcnt vmcnt(2)
.sp_28:
    v_readfirstlane_b32 s50, v13
    s_add_u32 s50, s50, s100
    s_cmp_ge_u32 s50, 3
    s_cbranch_scc1 .ok_29
    s_sub_u32 s82, s82, 1
    s_cmp_lt_i32 s82, 1
    s_cbranch_scc1 .ok_29
    buffer_load_dword v13, off, s[16:19], s43 sc0 sc1
    s_waitcnt vmcnt(0)
    s_branch .sp_28

.ok_29:
    s_lshl_b32 s50, s72, s8
    s_add_u32 s50, s50, s56
    s_add_u32 s51, s50, s9
    s_cmp_eq_u32 s100, 2
    s_cselect_b64 exec, -1, 0
    buffer_load_dwordx4 v[64:67], v1, s[20:23], s50 offen sc0 sc1
    buffer_load_dwordx4 v[68:71], v1, s[20:23], s51 offen sc0 sc1
    s_mov_b64 exec, -1
    s_waitcnt lgkmcnt(4)
    v_mfma_f32_32x32x16_bf16 v[32:47], a[24:27], v[24:27], v[32:47]
    ds_read_b64_tr_b16 v[20:21], v8 offset:2048
    ds_read_b64_tr_b16 v[22:23], v8 offset:3072
    v_mov_b32 v14, 2
    s_mov_b64 exec, 1
    buffer_store_dword v14, off, s[16:19], s42 sc0 sc1
    s_mov_b64 exec, -1
    s_waitcnt lgkmcnt(4)
    v_mfma_f32_32x32x16_bf16 v[32:47], a[28:31], v[28:31], v[32:47]
    s_barrier
    s_waitcnt lgkmcnt(2)
    v_mfma_f32_32x32x16_bf16 v[32:47], v[104:107], v[16:19], v[32:47]
    ds_read_b64_tr_b16 v[24:25], v8 offset:8192
    ds_read_b64_tr_b16 v[26:27], v8 offset:9216
    ds_read_b64_tr_b16 v[28:29], v8 offset:10240
    ds_read_b64_tr_b16 v[30:31], v8 offset:11264
    s_add_u32 m0, s52, 0
    s_add_u32 s49, s68, s75
    buffer_load_dwordx4 v2, s[12:15], s49 offen lds
    s_waitcnt lgkmcnt(4)
    v_mfma_f32_32x32x16_bf16 v[32:47], v[108:111], v[20:23], v[32:47]
    ds_read_b64_tr_b16 v[16:17], v11 offset:0
    ds_read_b64_tr_b16 v[18:19], v11 offset:1024
    s_add_u32 m0, s52, 1024
    s_add_u32 s49, s68, s75
    s_add_u32 s49, s49, 9216
    buffer_load_dwordx4 v2, s[12:15], s49 offen lds
    s_waitcnt lgkmcnt(4)
    v_mfma_f32_32x32x16_bf16 v[32:47], a[48:51], v[24:27], v[32:47]
    ds_read_b64_tr_b16 v[20:21], v11 offset:2048
    ds_read_b64_tr_b16 v[22:23], v11 offset:3072
    s_waitcnt lgkmcnt(4)
    v_mfma_f32_32x32x16_bf16 v[32:47], a[52:55], v[28:31], v[32:47]
    ds_read_b64_tr_b16 v[24:25], v11 offset:8192
    ds_read_b64_tr_b16 v[26:27], v11 offset:9216
    s_waitcnt lgkmcnt(4)
    v_mfma_f32_32x32x16_bf16 v[32:47], a[32:35], v[16:19], v[32:47]
    ds_read_b64_tr_b16 v[28:29], v11 offset:10240
    ds_read_b64_tr_b16 v[30:31], v11 offset:11264
    s_waitcnt lgkmcnt(4)
    v_mfma_f32_32x32x16_bf16 v[32:47], a[36:39], v[20:23], v[32:47]
    ds_read_b64_tr_b16 v[16:17], v6 offset:16384
    ds_read_b64_tr_b16 v[18:19], v6 offset:17408
    s_waitcnt lgkmcnt(4)
    v_mfma_f32_32x32x16_bf16 v[32:47], a[40:43], v[24:27], v[32:47]
    ds_read_b64_tr_b16 v[20:21], v6 offset:18432
    ds_read_b64_tr_b16 v[22:23], v6 offset:19456
    s_waitcnt lgkmcnt(4)
    v_mfma_f32_32x32x16_bf16 v[32:47], a[44:47], v[28:31], v[32:47]
    s_barrier
    s_waitcnt lgkmcnt(2)
    v_mfma_f32_32x32x16_bf16 v[48:63], v[72:75], v[16:19], 0
    ds_read_b64_tr_b16 v[24:25], v6 offset:24576
    ds_read_b64_tr_b16 v[26:27], v6 offset:25600
    ds_read_b64_tr_b16 v[28:29], v6 offset:26624
    ds_read_b64_tr_b16 v[30:31], v6 offset:27648
    s_add_u32 m0, s52, 131072
    s_add_u32 s49, s69, s75
    buffer_load_dwordx4 v2, s[12:15], s49 offen lds
    s_waitcnt lgkmcnt(4)
    v_mfma_f32_32x32x16_bf16 v[48:63], v[76:79], v[20:23], v[48:63]
    ds_read_b64_tr_b16 v[16:17], v9 offset:16384
    ds_read_b64_tr_b16 v[18:19], v9 offset:17408
    s_add_u32 m0, s52, 132096
    s_add_u32 s49, s69, s75
    s_add_u32 s49, s49, 9216
    buffer_load_dwordx4 v2, s[12:15], s49 offen lds
    s_waitcnt lgkmcnt(4)
    v_mfma_f32_32x32x16_bf16 v[48:63], v[80:83], v[24:27], v[48:63]
    ds_read_b64_tr_b16 v[20:21], v9 offset:18432
    ds_read_b64_tr_b16 v[22:23], v9 offset:19456
    s_waitcnt vmcnt(5)
    v_fma_mix_f32 v32, v64, 1.0, v32 op_sel:[0,0,0] op_sel_hi:[1,0,0]
    v_fma_mix_f32 v33, v64, 1.0, v33 op_sel:[1,0,0] op_sel_hi:[1,0,0]
    v_fma_mix_f32 v34, v65, 1.0, v34 op_sel:[0,0,0] op_sel_hi:[1,0,0]
    s_waitcnt lgkmcnt(4)
    v_mfma_f32_32x32x16_bf16 v[48:63], v[84:87], v[28:31], v[48:63]
    ds_read_b64_tr_b16 v[24:25], v9 offset:24576
    ds_read_b64_tr_b16 v[26:27], v9 offset:25600
    v_fma_mix_f32 v35, v65, 1.0, v35 op_sel:[1,0,0] op_sel_hi:[1,0,0]
    v_fma_mix_f32 v36, v66, 1.0, v36 op_sel:[0,0,0] op_sel_hi:[1,0,0]
    v_fma_mix_f32 v37, v66, 1.0, v37 op_sel:[1,0,0] op_sel_hi:[1,0,0]
    v_fma_mix_f32 v38, v67, 1.0, v38 op_sel:[0,0,0] op_sel_hi:[1,0,0]
    s_waitcnt lgkmcnt(4)
    v_mfma_f32_32x32x16_bf16 v[48:63], a[0:3], v[16:19], v[48:63]
    ds_read_b64_tr_b16 v[28:29], v9 offset:26624
    ds_read_b64_tr_b16 v[30:31], v9 offset:27648
    v_fma_mix_f32 v39, v67, 1.0, v39 op_sel:[1,0,0] op_sel_hi:[1,0,0]
    v_fma_mix_f32 v40, v68, 1.0, v40 op_sel:[0,0,0] op_sel_hi:[1,0,0]
    v_fma_mix_f32 v41, v68, 1.0, v41 op_sel:[1,0,0] op_sel_hi:[1,0,0]
    v_fma_mix_f32 v42, v69, 1.0, v42 op_sel:[0,0,0] op_sel_hi:[1,0,0]
    s_waitcnt lgkmcnt(4)
    v_mfma_f32_32x32x16_bf16 v[48:63], a[4:7], v[20:23], v[48:63]
    ds_read_b64_tr_b16 v[16:17], v6 offset:49152
    ds_read_b64_tr_b16 v[18:19], v6 offset:50176
    v_fma_mix_f32 v43, v69, 1.0, v43 op_sel:[1,0,0] op_sel_hi:[1,0,0]
    v_fma_mix_f32 v44, v70, 1.0, v44 op_sel:[0,0,0] op_sel_hi:[1,0,0]
    v_fma_mix_f32 v45, v70, 1.0, v45 op_sel:[1,0,0] op_sel_hi:[1,0,0]
    v_fma_mix_f32 v46, v71, 1.0, v46 op_sel:[0,0,0] op_sel_hi:[1,0,0]
    v_fma_mix_f32 v47, v71, 1.0, v47 op_sel:[1,0,0] op_sel_hi:[1,0,0]
    buffer_load_dword v13, off, s[16:19], s43 sc0 sc1
    s_waitcnt lgkmcnt(4)
    v_mfma_f32_32x32x16_bf16 v[48:63], a[8:11], v[24:27], v[48:63]
    ds_read_b64_tr_b16 v[20:21], v6 offset:51200
    ds_read_b64_tr_b16 v[22:23], v6 offset:52224
    v_cvt_pk_f16_f32 v32, v32, v33
    v_cvt_pk_f16_f32 v33, v34, v35
    v_cvt_pk_f16_f32 v34, v36, v37
    v_cvt_pk_f16_f32 v35, v38, v39
    s_waitcnt lgkmcnt(4)
    v_mfma_f32_32x32x16_bf16 v[48:63], a[12:15], v[28:31], v[48:63]
    s_barrier
    s_waitcnt lgkmcnt(2)
    v_mfma_f32_32x32x16_bf16 v[48:63], v[88:91], v[16:19], v[48:63]
    ds_read_b64_tr_b16 v[24:25], v6 offset:57344
    ds_read_b64_tr_b16 v[26:27], v6 offset:58368
    ds_read_b64_tr_b16 v[28:29], v6 offset:59392
    ds_read_b64_tr_b16 v[30:31], v6 offset:60416
    v_cvt_pk_f16_f32 v36, v40, v41
    v_cvt_pk_f16_f32 v37, v42, v43
    v_cvt_pk_f16_f32 v38, v44, v45
    v_cvt_pk_f16_f32 v39, v46, v47
    s_lshl_b32 s50, s72, s8
    s_add_u32 s50, s50, s56
    s_add_u32 s51, s50, s9
    buffer_store_dwordx4 v[32:35], v1, s[20:23], s50 offen sc0 sc1
    buffer_store_dwordx4 v[36:39], v1, s[20:23], s51 offen sc0 sc1
    s_add_u32 m0, s52, 16384
    s_add_u32 s49, s67, s76
    buffer_load_dwordx4 v2, s[12:15], s49 offen lds
    s_waitcnt lgkmcnt(4)
    v_mfma_f32_32x32x16_bf16 v[48:63], v[92:95], v[20:23], v[48:63]
    ds_read_b64_tr_b16 v[16:17], v9 offset:49152
    ds_read_b64_tr_b16 v[18:19], v9 offset:50176
    s_add_u32 m0, s52, 17408
    s_add_u32 s49, s67, s76
    s_add_u32 s49, s49, 9216
    buffer_load_dwordx4 v2, s[12:15], s49 offen lds
    s_waitcnt lgkmcnt(4)
    v_mfma_f32_32x32x16_bf16 v[48:63], v[96:99], v[24:27], v[48:63]
    ds_read_b64_tr_b16 v[20:21], v9 offset:51200
    ds_read_b64_tr_b16 v[22:23], v9 offset:52224
    s_waitcnt lgkmcnt(4)
    v_mfma_f32_32x32x16_bf16 v[48:63], v[100:103], v[28:31], v[48:63]
    ds_read_b64_tr_b16 v[24:25], v9 offset:57344
    ds_read_b64_tr_b16 v[26:27], v9 offset:58368
    s_waitcnt lgkmcnt(4)
    v_mfma_f32_32x32x16_bf16 v[48:63], a[16:19], v[16:19], v[48:63]
    ds_read_b64_tr_b16 v[28:29], v9 offset:59392
    ds_read_b64_tr_b16 v[30:31], v9 offset:60416
    s_waitcnt lgkmcnt(4)
    v_mfma_f32_32x32x16_bf16 v[48:63], a[20:23], v[20:23], v[48:63]
    ds_read_b64_tr_b16 v[16:17], v7 offset:0
    ds_read_b64_tr_b16 v[18:19], v7 offset:1024
    s_waitcnt vmcnt(4)
.sp_30:
    v_readfirstlane_b32 s50, v13
    s_add_u32 s50, s50, s100
    s_cmp_ge_u32 s50, 4
    s_cbranch_scc1 .ok_31
    s_sub_u32 s82, s82, 1
    s_cmp_lt_i32 s82, 1
    s_cbranch_scc1 .ok_31
    buffer_load_dword v13, off, s[16:19], s43 sc0 sc1
    s_waitcnt vmcnt(0)
    s_branch .sp_30

.ok_31:
    s_lshl_b32 s50, s73, s8
    s_add_u32 s50, s50, s56
    s_add_u32 s51, s50, s9
    buffer_load_dwordx4 v[64:67], v1, s[20:23], s50 offen sc0 sc1
    buffer_load_dwordx4 v[68:71], v1, s[20:23], s51 offen sc0 sc1
    s_waitcnt lgkmcnt(4)
    v_mfma_f32_32x32x16_bf16 v[48:63], a[24:27], v[24:27], v[48:63]
    ds_read_b64_tr_b16 v[20:21], v7 offset:2048
    ds_read_b64_tr_b16 v[22:23], v7 offset:3072
    v_mov_b32 v14, 3
    s_waitcnt vmcnt(4)
    s_mov_b64 exec, 1
    buffer_store_dword v14, off, s[16:19], s42 sc0 sc1
    s_mov_b64 exec, -1
    s_waitcnt lgkmcnt(4)
    v_mfma_f32_32x32x16_bf16 v[48:63], a[28:31], v[28:31], v[48:63]
    s_barrier
    s_waitcnt lgkmcnt(2)
    v_mfma_f32_32x32x16_bf16 v[48:63], v[104:107], v[16:19], v[48:63]
    ds_read_b64_tr_b16 v[24:25], v7 offset:8192
    ds_read_b64_tr_b16 v[26:27], v7 offset:9216
    ds_read_b64_tr_b16 v[28:29], v7 offset:10240
    ds_read_b64_tr_b16 v[30:31], v7 offset:11264
    s_add_u32 m0, s52, 49152
    s_add_u32 s49, s68, s76
    buffer_load_dwordx4 v2, s[12:15], s49 offen lds
    s_waitcnt lgkmcnt(4)
    v_mfma_f32_32x32x16_bf16 v[48:63], v[108:111], v[20:23], v[48:63]
    ds_read_b64_tr_b16 v[16:17], v10 offset:0
    ds_read_b64_tr_b16 v[18:19], v10 offset:1024
    s_add_u32 m0, s52, 50176
    s_add_u32 s49, s68, s76
    s_add_u32 s49, s49, 9216
    buffer_load_dwordx4 v2, s[12:15], s49 offen lds
    s_waitcnt lgkmcnt(4)
    v_mfma_f32_32x32x16_bf16 v[48:63], a[48:51], v[24:27], v[48:63]
    ds_read_b64_tr_b16 v[20:21], v10 offset:2048
    ds_read_b64_tr_b16 v[22:23], v10 offset:3072
    s_waitcnt lgkmcnt(4)
    v_mfma_f32_32x32x16_bf16 v[48:63], a[52:55], v[28:31], v[48:63]
    ds_read_b64_tr_b16 v[24:25], v10 offset:8192
    ds_read_b64_tr_b16 v[26:27], v10 offset:9216
    s_waitcnt lgkmcnt(4)
    v_mfma_f32_32x32x16_bf16 v[48:63], a[32:35], v[16:19], v[48:63]
    ds_read_b64_tr_b16 v[28:29], v10 offset:10240
    ds_read_b64_tr_b16 v[30:31], v10 offset:11264
    s_waitcnt lgkmcnt(4)
    v_mfma_f32_32x32x16_bf16 v[48:63], a[36:39], v[20:23], v[48:63]
    ds_read_b64_tr_b16 v[16:17], v7 offset:16384
    ds_read_b64_tr_b16 v[18:19], v7 offset:17408
    s_waitcnt lgkmcnt(4)
    v_mfma_f32_32x32x16_bf16 v[48:63], a[40:43], v[24:27], v[48:63]
    ds_read_b64_tr_b16 v[20:21], v7 offset:18432
    ds_read_b64_tr_b16 v[22:23], v7 offset:19456
    s_waitcnt lgkmcnt(4)
    v_mfma_f32_32x32x16_bf16 v[48:63], a[44:47], v[28:31], v[48:63]
    s_barrier
    s_waitcnt lgkmcnt(2)
    v_mfma_f32_32x32x16_bf16 v[32:47], v[72:75], v[16:19], 0
    ds_read_b64_tr_b16 v[24:25], v7 offset:24576
    ds_read_b64_tr_b16 v[26:27], v7 offset:25600
    ds_read_b64_tr_b16 v[28:29], v7 offset:26624
    ds_read_b64_tr_b16 v[30:31], v7 offset:27648
    s_add_u32 m0, s52, 65536
    s_add_u32 s49, s69, s76
    buffer_load_dwordx4 v2, s[12:15], s49 offen lds
    s_waitcnt lgkmcnt(4)
    v_mfma_f32_32x32x16_bf16 v[32:47], v[76:79], v[20:23], v[32:47]
    ds_read_b64_tr_b16 v[16:17], v10 offset:16384
    ds_read_b64_tr_b16 v[18:19], v10 offset:17408
    s_add_u32 m0, s52, 66560
    s_add_u32 s49, s69, s76
    s_add_u32 s49, s49, 9216
    buffer_load_dwordx4 v2, s[12:15], s49 offen lds
    s_waitcnt lgkmcnt(4)
    v_mfma_f32_32x32x16_bf16 v[32:47], v[80:83], v[24:27], v[32:47]
    ds_read_b64_tr_b16 v[20:21], v10 offset:18432
    ds_read_b64_tr_b16 v[22:23], v10 offset:19456
    s_waitcnt vmcnt(5)
    v_fma_mix_f32 v48, v64, 1.0, v48 op_sel:[0,0,0] op_sel_hi:[1,0,0]
    v_fma_mix_f32 v49, v64, 1.0, v49 op_sel:[1,0,0] op_sel_hi:[1,0,0]
    v_fma_mix_f32 v50, v65, 1.0, v50 op_sel:[0,0,0] op_sel_hi:[1,0,0]
    s_waitcnt lgkmcnt(4)
    v_mfma_f32_32x32x16_bf16 v[32:47], v[84:87], v[28:31], v[32:47]
    ds_read_b64_tr_b16 v[24:25], v10 offset:24576
    ds_read_b64_tr_b16 v[26:27], v10 offset:25600
    v_fma_mix_f32 v51, v65, 1.0, v51 op_sel:[1,0,0] op_sel_hi:[1,0,0]
    v_fma_mix_f32 v52, v66, 1.0, v52 op_sel:[0,0,0] op_sel_hi:[1,0,0]
    v_fma_mix_f32 v53, v66, 1.0, v53 op_sel:[1,0,0] op_sel_hi:[1,0,0]
    v_fma_mix_f32 v54, v67, 1.0, v54 op_sel:[0,0,0] op_sel_hi:[1,0,0]
    s_waitcnt lgkmcnt(4)
    v_mfma_f32_32x32x16_bf16 v[32:47], a[0:3], v[16:19], v[32:47]
    ds_read_b64_tr_b16 v[28:29], v10 offset:26624
    ds_read_b64_tr_b16 v[30:31], v10 offset:27648
    v_fma_mix_f32 v55, v67, 1.0, v55 op_sel:[1,0,0] op_sel_hi:[1,0,0]
    v_fma_mix_f32 v56, v68, 1.0, v56 op_sel:[0,0,0] op_sel_hi:[1,0,0]
    v_fma_mix_f32 v57, v68, 1.0, v57 op_sel:[1,0,0] op_sel_hi:[1,0,0]
    v_fma_mix_f32 v58, v69, 1.0, v58 op_sel:[0,0,0] op_sel_hi:[1,0,0]
    s_waitcnt lgkmcnt(4)
    v_mfma_f32_32x32x16_bf16 v[32:47], a[4:7], v[20:23], v[32:47]
    ds_read_b64_tr_b16 v[16:17], v7 offset:32768
    ds_read_b64_tr_b16 v[18:19], v7 offset:33792
    v_fma_mix_f32 v59, v69, 1.0, v59 op_sel:[1,0,0] op_sel_hi:[1,0,0]
    v_fma_mix_f32 v60, v70, 1.0, v60 op_sel:[0,0,0] op_sel_hi:[1,0,0]
    v_fma_mix_f32 v61, v70, 1.0, v61 op_sel:[1,0,0] op_sel_hi:[1,0,0]
    v_fma_mix_f32 v62, v71, 1.0, v62 op_sel:[0,0,0] op_sel_hi:[1,0,0]
    v_fma_mix_f32 v63, v71, 1.0, v63 op_sel:[1,0,0] op_sel_hi:[1,0,0]
    buffer_load_dword v13, off, s[16:19], s43 sc0 sc1
    s_waitcnt lgkmcnt(4)
    v_mfma_f32_32x32x16_bf16 v[32:47], a[8:11], v[24:27], v[32:47]
    ds_read_b64_tr_b16 v[20:21], v7 offset:34816
    ds_read_b64_tr_b16 v[22:23], v7 offset:35840
    v_cvt_pk_f16_f32 v48, v48, v49
    v_cvt_pk_f16_f32 v49, v50, v51
    v_cvt_pk_f16_f32 v50, v52, v53
    v_cvt_pk_f16_f32 v51, v54, v55
    s_waitcnt lgkmcnt(4)
    v_mfma_f32_32x32x16_bf16 v[32:47], a[12:15], v[28:31], v[32:47]
    s_barrier
    s_waitcnt lgkmcnt(2)
    v_mfma_f32_32x32x16_bf16 v[32:47], v[88:91], v[16:19], v[32:47]
    ds_read_b64_tr_b16 v[24:25], v7 offset:40960
    ds_read_b64_tr_b16 v[26:27], v7 offset:41984
    ds_read_b64_tr_b16 v[28:29], v7 offset:43008
    ds_read_b64_tr_b16 v[30:31], v7 offset:44032
    v_cvt_pk_f16_f32 v52, v56, v57
    v_cvt_pk_f16_f32 v53, v58, v59
    v_cvt_pk_f16_f32 v54, v60, v61
    v_cvt_pk_f16_f32 v55, v62, v63
    s_lshl_b32 s50, s73, s8
    s_add_u32 s50, s50, s56
    s_add_u32 s51, s50, s9
    buffer_store_dwordx4 v[48:51], v1, s[20:23], s50 offen sc0 sc1
    buffer_store_dwordx4 v[52:55], v1, s[20:23], s51 offen sc0 sc1
    s_add_u32 m0, s52, 81920
    s_add_u32 s49, s67, s77
    buffer_load_dwordx4 v2, s[12:15], s49 offen lds
    s_waitcnt lgkmcnt(4)
    v_mfma_f32_32x32x16_bf16 v[32:47], v[92:95], v[20:23], v[32:47]
    ds_read_b64_tr_b16 v[16:17], v10 offset:32768
    ds_read_b64_tr_b16 v[18:19], v10 offset:33792
    s_add_u32 m0, s52, 82944
    s_add_u32 s49, s67, s77
    s_add_u32 s49, s49, 9216
    buffer_load_dwordx4 v2, s[12:15], s49 offen lds
    s_waitcnt lgkmcnt(4)
    v_mfma_f32_32x32x16_bf16 v[32:47], v[96:99], v[24:27], v[32:47]
    ds_read_b64_tr_b16 v[20:21], v10 offset:34816
    ds_read_b64_tr_b16 v[22:23], v10 offset:35840
    s_waitcnt lgkmcnt(4)
    v_mfma_f32_32x32x16_bf16 v[32:47], v[100:103], v[28:31], v[32:47]
    ds_read_b64_tr_b16 v[24:25], v10 offset:40960
    ds_read_b64_tr_b16 v[26:27], v10 offset:41984
    s_waitcnt lgkmcnt(4)
    v_mfma_f32_32x32x16_bf16 v[32:47], a[16:19], v[16:19], v[32:47]
    ds_read_b64_tr_b16 v[28:29], v10 offset:43008
    ds_read_b64_tr_b16 v[30:31], v10 offset:44032
    s_waitcnt lgkmcnt(4)
    v_mfma_f32_32x32x16_bf16 v[32:47], a[20:23], v[20:23], v[32:47]
    ds_read_b64_tr_b16 v[16:17], v7 offset:49152
    ds_read_b64_tr_b16 v[18:19], v7 offset:50176
    s_waitcnt vmcnt(4)
.sp_32:
    v_readfirstlane_b32 s50, v13
    s_add_u32 s50, s50, s100
    s_cmp_ge_u32 s50, 5
    s_cbranch_scc1 .ok_33
    s_sub_u32 s82, s82, 1
    s_cmp_lt_i32 s82, 1
    s_cbranch_scc1 .ok_33
    buffer_load_dword v13, off, s[16:19], s43 sc0 sc1
    s_waitcnt vmcnt(0)
    s_branch .sp_32

.ok_33:
    s_lshl_b32 s50, s74, s8
    s_add_u32 s50, s50, s56
    s_add_u32 s51, s50, s9
    buffer_load_dwordx4 v[64:67], v1, s[20:23], s50 offen sc0 sc1
    buffer_load_dwordx4 v[68:71], v1, s[20:23], s51 offen sc0 sc1
    s_waitcnt lgkmcnt(4)
    v_mfma_f32_32x32x16_bf16 v[32:47], a[24:27], v[24:27], v[32:47]
    ds_read_b64_tr_b16 v[20:21], v7 offset:51200
    ds_read_b64_tr_b16 v[22:23], v7 offset:52224
    v_mov_b32 v14, 4
    s_waitcnt vmcnt(4)
    s_mov_b64 exec, 1
    buffer_store_dword v14, off, s[16:19], s42 sc0 sc1
    s_mov_b64 exec, -1
    s_waitcnt lgkmcnt(4)
    v_mfma_f32_32x32x16_bf16 v[32:47], a[28:31], v[28:31], v[32:47]
    s_barrier
    s_waitcnt lgkmcnt(2)
    v_mfma_f32_32x32x16_bf16 v[32:47], v[104:107], v[16:19], v[32:47]
    ds_read_b64_tr_b16 v[24:25], v7 offset:57344
    ds_read_b64_tr_b16 v[26:27], v7 offset:58368
    ds_read_b64_tr_b16 v[28:29], v7 offset:59392
    ds_read_b64_tr_b16 v[30:31], v7 offset:60416
    s_add_u32 m0, s52, 98304
    s_add_u32 s49, s68, s77
    buffer_load_dwordx4 v2, s[12:15], s49 offen lds
    s_waitcnt lgkmcnt(4)
    v_mfma_f32_32x32x16_bf16 v[32:47], v[108:111], v[20:23], v[32:47]
    ds_read_b64_tr_b16 v[16:17], v10 offset:49152
    ds_read_b64_tr_b16 v[18:19], v10 offset:50176
    s_add_u32 m0, s52, 99328
    s_add_u32 s49, s68, s77
    s_add_u32 s49, s49, 9216
    buffer_load_dwordx4 v2, s[12:15], s49 offen lds
    s_waitcnt lgkmcnt(4)
    v_mfma_f32_32x32x16_bf16 v[32:47], a[48:51], v[24:27], v[32:47]
    ds_read_b64_tr_b16 v[20:21], v10 offset:51200
    ds_read_b64_tr_b16 v[22:23], v10 offset:52224
    s_waitcnt lgkmcnt(4)
    v_mfma_f32_32x32x16_bf16 v[32:47], a[52:55], v[28:31], v[32:47]
    ds_read_b64_tr_b16 v[24:25], v10 offset:57344
    ds_read_b64_tr_b16 v[26:27], v10 offset:58368
    s_waitcnt lgkmcnt(4)
    v_mfma_f32_32x32x16_bf16 v[32:47], a[32:35], v[16:19], v[32:47]
    ds_read_b64_tr_b16 v[28:29], v10 offset:59392
    ds_read_b64_tr_b16 v[30:31], v10 offset:60416
    s_waitcnt lgkmcnt(4)
    v_mfma_f32_32x32x16_bf16 v[32:47], a[36:39], v[20:23], v[32:47]
    ds_read_b64_tr_b16 v[16:17], v6 offset:32768
    ds_read_b64_tr_b16 v[18:19], v6 offset:33792
    s_waitcnt lgkmcnt(4)
    v_mfma_f32_32x32x16_bf16 v[32:47], a[40:43], v[24:27], v[32:47]
    ds_read_b64_tr_b16 v[20:21], v6 offset:34816
    ds_read_b64_tr_b16 v[22:23], v6 offset:35840
    s_waitcnt lgkmcnt(4)
    v_mfma_f32_32x32x16_bf16 v[32:47], a[44:47], v[28:31], v[32:47]
    s_barrier
    s_waitcnt lgkmcnt(2)
    v_mfma_f32_32x32x16_bf16 v[48:63], v[72:75], v[16:19], 0
    ds_read_b64_tr_b16 v[24:25], v6 offset:40960
    ds_read_b64_tr_b16 v[26:27], v6 offset:41984
    ds_read_b64_tr_b16 v[28:29], v6 offset:43008
    ds_read_b64_tr_b16 v[30:31], v6 offset:44032
    s_add_u32 m0, s52, 114688
    s_add_u32 s49, s69, s77
    buffer_load_dwordx4 v2, s[12:15], s49 offen lds
    s_waitcnt lgkmcnt(4)
    v_mfma_f32_32x32x16_bf16 v[48:63], v[76:79], v[20:23], v[48:63]
    ds_read_b64_tr_b16 v[16:17], v9 offset:32768
    ds_read_b64_tr_b16 v[18:19], v9 offset:33792
    s_add_u32 m0, s52, 115712
    s_add_u32 s49, s69, s77
    s_add_u32 s49, s49, 9216
    buffer_load_dwordx4 v2, s[12:15], s49 offen lds
    s_waitcnt lgkmcnt(4)
    v_mfma_f32_32x32x16_bf16 v[48:63], v[80:83], v[24:27], v[48:63]
    ds_read_b64_tr_b16 v[20:21], v9 offset:34816
    ds_read_b64_tr_b16 v[22:23], v9 offset:35840
    s_waitcnt vmcnt(5)
    v_fma_mix_f32 v32, v64, 1.0, v32 op_sel:[0,0,0] op_sel_hi:[1,0,0]
    v_fma_mix_f32 v33, v64, 1.0, v33 op_sel:[1,0,0] op_sel_hi:[1,0,0]
    v_fma_mix_f32 v34, v65, 1.0, v34 op_sel:[0,0,0] op_sel_hi:[1,0,0]
    s_waitcnt lgkmcnt(4)
    v_mfma_f32_32x32x16_bf16 v[48:63], v[84:87], v[28:31], v[48:63]
    ds_read_b64_tr_b16 v[24:25], v9 offset:40960
    ds_read_b64_tr_b16 v[26:27], v9 offset:41984
    v_fma_mix_f32 v35, v65, 1.0, v35 op_sel:[1,0,0] op_sel_hi:[1,0,0]
    v_fma_mix_f32 v36, v66, 1.0, v36 op_sel:[0,0,0] op_sel_hi:[1,0,0]
    v_fma_mix_f32 v37, v66, 1.0, v37 op_sel:[1,0,0] op_sel_hi:[1,0,0]
    v_fma_mix_f32 v38, v67, 1.0, v38 op_sel:[0,0,0] op_sel_hi:[1,0,0]
    s_waitcnt lgkmcnt(4)
    v_mfma_f32_32x32x16_bf16 v[48:63], a[0:3], v[16:19], v[48:63]
    ds_read_b64_tr_b16 v[28:29], v9 offset:43008
    ds_read_b64_tr_b16 v[30:31], v9 offset:44032
    v_fma_mix_f32 v39, v67, 1.0, v39 op_sel:[1,0,0] op_sel_hi:[1,0,0]
    v_fma_mix_f32 v40, v68, 1.0, v40 op_sel:[0,0,0] op_sel_hi:[1,0,0]
    v_fma_mix_f32 v41, v68, 1.0, v41 op_sel:[1,0,0] op_sel_hi:[1,0,0]
    v_fma_mix_f32 v42, v69, 1.0, v42 op_sel:[0,0,0] op_sel_hi:[1,0,0]
    s_waitcnt lgkmcnt(4)
    v_mfma_f32_32x32x16_bf16 v[48:63], a[4:7], v[20:23], v[48:63]
    ds_read_b64_tr_b16 v[16:17], v6 offset:0
    ds_read_b64_tr_b16 v[18:19], v6 offset:1024
    v_fma_mix_f32 v43, v69, 1.0, v43 op_sel:[1,0,0] op_sel_hi:[1,0,0]
    v_fma_mix_f32 v44, v70, 1.0, v44 op_sel:[0,0,0] op_sel_hi:[1,0,0]
    v_fma_mix_f32 v45, v70, 1.0, v45 op_sel:[1,0,0] op_sel_hi:[1,0,0]
    v_fma_mix_f32 v46, v71, 1.0, v46 op_sel:[0,0,0] op_sel_hi:[1,0,0]
    v_fma_mix_f32 v47, v71, 1.0, v47 op_sel:[1,0,0] op_sel_hi:[1,0,0]
    buffer_load_dword v13, off, s[16:19], s43 sc0 sc1
    s_waitcnt lgkmcnt(4)
    v_mfma_f32_32x32x16_bf16 v[48:63], a[8:11], v[24:27], v[48:63]
    ds_read_b64_tr_b16 v[20:21], v6 offset:2048
    ds_read_b64_tr_b16 v[22:23], v6 offset:3072
    v_cvt_pk_f16_f32 v32, v32, v33
    v_cvt_pk_f16_f32 v33, v34, v35
    v_cvt_pk_f16_f32 v34, v36, v37
    v_cvt_pk_f16_f32 v35, v38, v39
    s_waitcnt lgkmcnt(4)
    v_mfma_f32_32x32x16_bf16 v[48:63], a[12:15], v[28:31], v[48:63]
    s_barrier
    s_waitcnt lgkmcnt(2)
    v_mfma_f32_32x32x16_bf16 v[48:63], v[88:91], v[16:19], v[48:63]
    ds_read_b64_tr_b16 v[24:25], v6 offset:8192
    ds_read_b64_tr_b16 v[26:27], v6 offset:9216
    ds_read_b64_tr_b16 v[28:29], v6 offset:10240
    ds_read_b64_tr_b16 v[30:31], v6 offset:11264
    v_cvt_pk_f16_f32 v36, v40, v41
    v_cvt_pk_f16_f32 v37, v42, v43
    v_cvt_pk_f16_f32 v38, v44, v45
    v_cvt_pk_f16_f32 v39, v46, v47
    s_lshl_b32 s50, s74, s8
    s_add_u32 s50, s50, s56
    s_add_u32 s51, s50, s9
    buffer_store_dwordx4 v[32:35], v1, s[20:23], s50 offen sc0 sc1
    buffer_store_dwordx4 v[36:39], v1, s[20:23], s51 offen sc0 sc1
    s_add_u32 m0, s52, 32768
    s_add_u32 s49, s67, s78
    buffer_load_dwordx4 v2, s[12:15], s49 offen lds
    s_waitcnt lgkmcnt(4)
    v_mfma_f32_32x32x16_bf16 v[48:63], v[92:95], v[20:23], v[48:63]
    ds_read_b64_tr_b16 v[16:17], v9 offset:0
    ds_read_b64_tr_b16 v[18:19], v9 offset:1024
    s_add_u32 m0, s52, 33792
    s_add_u32 s49, s67, s78
    s_add_u32 s49, s49, 9216
    buffer_load_dwordx4 v2, s[12:15], s49 offen lds
    s_waitcnt lgkmcnt(4)
    v_mfma_f32_32x32x16_bf16 v[48:63], v[96:99], v[24:27], v[48:63]
    ds_read_b64_tr_b16 v[20:21], v9 offset:2048
    ds_read_b64_tr_b16 v[22:23], v9 offset:3072
    s_waitcnt lgkmcnt(4)
    v_mfma_f32_32x32x16_bf16 v[48:63], v[100:103], v[28:31], v[48:63]
    ds_read_b64_tr_b16 v[24:25], v9 offset:8192
    ds_read_b64_tr_b16 v[26:27], v9 offset:9216
    s_waitcnt lgkmcnt(4)
    v_mfma_f32_32x32x16_bf16 v[48:63], a[16:19], v[16:19], v[48:63]
    ds_read_b64_tr_b16 v[28:29], v9 offset:10240
    ds_read_b64_tr_b16 v[30:31], v9 offset:11264
    s_waitcnt lgkmcnt(4)
    v_mfma_f32_32x32x16_bf16 v[48:63], a[20:23], v[20:23], v[48:63]
    ds_read_b64_tr_b16 v[16:17], v8 offset:0
    ds_read_b64_tr_b16 v[18:19], v8 offset:1024
    s_waitcnt vmcnt(4)
.sp_34:
    v_readfirstlane_b32 s50, v13
    s_add_u32 s50, s50, s100
    s_cmp_ge_u32 s50, 6
    s_cbranch_scc1 .ok_35
    s_sub_u32 s82, s82, 1
    s_cmp_lt_i32 s82, 1
    s_cbranch_scc1 .ok_35
    buffer_load_dword v13, off, s[16:19], s43 sc0 sc1
    s_waitcnt vmcnt(0)
    s_branch .sp_34

.ok_35:
    s_lshl_b32 s50, s75, s8
    s_add_u32 s50, s50, s56
    s_add_u32 s51, s50, s9
    buffer_load_dwordx4 v[64:67], v1, s[20:23], s50 offen sc0 sc1
    buffer_load_dwordx4 v[68:71], v1, s[20:23], s51 offen sc0 sc1
    s_waitcnt lgkmcnt(4)
    v_mfma_f32_32x32x16_bf16 v[48:63], a[24:27], v[24:27], v[48:63]
    ds_read_b64_tr_b16 v[20:21], v8 offset:2048
    ds_read_b64_tr_b16 v[22:23], v8 offset:3072
    v_mov_b32 v14, 5
    s_waitcnt vmcnt(4)
    s_mov_b64 exec, 1
    buffer_store_dword v14, off, s[16:19], s42 sc0 sc1
    s_mov_b64 exec, -1
    s_waitcnt lgkmcnt(4)
    v_mfma_f32_32x32x16_bf16 v[48:63], a[28:31], v[28:31], v[48:63]
    s_barrier
    s_waitcnt lgkmcnt(2)
    v_mfma_f32_32x32x16_bf16 v[48:63], v[104:107], v[16:19], v[48:63]
    ds_read_b64_tr_b16 v[24:25], v8 offset:8192
    ds_read_b64_tr_b16 v[26:27], v8 offset:9216
    ds_read_b64_tr_b16 v[28:29], v8 offset:10240
    ds_read_b64_tr_b16 v[30:31], v8 offset:11264
    s_add_u32 m0, s52, 0
    s_add_u32 s49, s68, s78
    buffer_load_dwordx4 v2, s[12:15], s49 offen lds
    s_waitcnt lgkmcnt(4)
    v_mfma_f32_32x32x16_bf16 v[48:63], v[108:111], v[20:23], v[48:63]
    ds_read_b64_tr_b16 v[16:17], v11 offset:0
    ds_read_b64_tr_b16 v[18:19], v11 offset:1024
    s_add_u32 m0, s52, 1024
    s_add_u32 s49, s68, s78
    s_add_u32 s49, s49, 9216
    buffer_load_dwordx4 v2, s[12:15], s49 offen lds
    s_waitcnt lgkmcnt(4)
    v_mfma_f32_32x32x16_bf16 v[48:63], a[48:51], v[24:27], v[48:63]
    ds_read_b64_tr_b16 v[20:21], v11 offset:2048
    ds_read_b64_tr_b16 v[22:23], v11 offset:3072
    s_waitcnt lgkmcnt(4)
    v_mfma_f32_32x32x16_bf16 v[48:63], a[52:55], v[28:31], v[48:63]
    ds_read_b64_tr_b16 v[24:25], v11 offset:8192
    ds_read_b64_tr_b16 v[26:27], v11 offset:9216
    s_waitcnt lgkmcnt(4)
    v_mfma_f32_32x32x16_bf16 v[48:63], a[32:35], v[16:19], v[48:63]
    ds_read_b64_tr_b16 v[28:29], v11 offset:10240
    ds_read_b64_tr_b16 v[30:31], v11 offset:11264
    s_waitcnt lgkmcnt(4)
    v_mfma_f32_32x32x16_bf16 v[48:63], a[36:39], v[20:23], v[48:63]
    ds_read_b64_tr_b16 v[16:17], v6 offset:16384
    ds_read_b64_tr_b16 v[18:19], v6 offset:17408
    s_waitcnt lgkmcnt(4)
    v_mfma_f32_32x32x16_bf16 v[48:63], a[40:43], v[24:27], v[48:63]
    ds_read_b64_tr_b16 v[20:21], v6 offset:18432
    ds_read_b64_tr_b16 v[22:23], v6 offset:19456
    s_waitcnt lgkmcnt(4)
    v_mfma_f32_32x32x16_bf16 v[48:63], a[44:47], v[28:31], v[48:63]
    s_barrier
    s_waitcnt lgkmcnt(2)
    v_mfma_f32_32x32x16_bf16 v[32:47], v[72:75], v[16:19], 0
    ds_read_b64_tr_b16 v[24:25], v6 offset:24576
    ds_read_b64_tr_b16 v[26:27], v6 offset:25600
    ds_read_b64_tr_b16 v[28:29], v6 offset:26624
    ds_read_b64_tr_b16 v[30:31], v6 offset:27648
    s_add_u32 m0, s52, 131072
    s_add_u32 s49, s69, s78
    buffer_load_dwordx4 v2, s[12:15], s49 offen lds
    s_waitcnt lgkmcnt(4)
    v_mfma_f32_32x32x16_bf16 v[32:47], v[76:79], v[20:23], v[32:47]
    ds_read_b64_tr_b16 v[16:17], v9 offset:16384
    ds_read_b64_tr_b16 v[18:19], v9 offset:17408
    s_add_u32 m0, s52, 132096
    s_add_u32 s49, s69, s78
    s_add_u32 s49, s49, 9216
    buffer_load_dwordx4 v2, s[12:15], s49 offen lds
    s_waitcnt lgkmcnt(4)
    v_mfma_f32_32x32x16_bf16 v[32:47], v[80:83], v[24:27], v[32:47]
    ds_read_b64_tr_b16 v[20:21], v9 offset:18432
    ds_read_b64_tr_b16 v[22:23], v9 offset:19456
    s_waitcnt vmcnt(5)
    v_fma_mix_f32 v48, v64, 1.0, v48 op_sel:[0,0,0] op_sel_hi:[1,0,0]
    v_fma_mix_f32 v49, v64, 1.0, v49 op_sel:[1,0,0] op_sel_hi:[1,0,0]
    v_fma_mix_f32 v50, v65, 1.0, v50 op_sel:[0,0,0] op_sel_hi:[1,0,0]
    s_waitcnt lgkmcnt(4)
    v_mfma_f32_32x32x16_bf16 v[32:47], v[84:87], v[28:31], v[32:47]
    ds_read_b64_tr_b16 v[24:25], v9 offset:24576
    ds_read_b64_tr_b16 v[26:27], v9 offset:25600
    v_fma_mix_f32 v51, v65, 1.0, v51 op_sel:[1,0,0] op_sel_hi:[1,0,0]
    v_fma_mix_f32 v52, v66, 1.0, v52 op_sel:[0,0,0] op_sel_hi:[1,0,0]
    v_fma_mix_f32 v53, v66, 1.0, v53 op_sel:[1,0,0] op_sel_hi:[1,0,0]
    v_fma_mix_f32 v54, v67, 1.0, v54 op_sel:[0,0,0] op_sel_hi:[1,0,0]
    s_waitcnt lgkmcnt(4)
    v_mfma_f32_32x32x16_bf16 v[32:47], a[0:3], v[16:19], v[32:47]
    ds_read_b64_tr_b16 v[28:29], v9 offset:26624
    ds_read_b64_tr_b16 v[30:31], v9 offset:27648
    v_fma_mix_f32 v55, v67, 1.0, v55 op_sel:[1,0,0] op_sel_hi:[1,0,0]
    v_fma_mix_f32 v56, v68, 1.0, v56 op_sel:[0,0,0] op_sel_hi:[1,0,0]
    v_fma_mix_f32 v57, v68, 1.0, v57 op_sel:[1,0,0] op_sel_hi:[1,0,0]
    v_fma_mix_f32 v58, v69, 1.0, v58 op_sel:[0,0,0] op_sel_hi:[1,0,0]
    s_waitcnt lgkmcnt(4)
    v_mfma_f32_32x32x16_bf16 v[32:47], a[4:7], v[20:23], v[32:47]
    ds_read_b64_tr_b16 v[16:17], v6 offset:49152
    ds_read_b64_tr_b16 v[18:19], v6 offset:50176
    v_fma_mix_f32 v59, v69, 1.0, v59 op_sel:[1,0,0] op_sel_hi:[1,0,0]
    v_fma_mix_f32 v60, v70, 1.0, v60 op_sel:[0,0,0] op_sel_hi:[1,0,0]
    v_fma_mix_f32 v61, v70, 1.0, v61 op_sel:[1,0,0] op_sel_hi:[1,0,0]
    v_fma_mix_f32 v62, v71, 1.0, v62 op_sel:[0,0,0] op_sel_hi:[1,0,0]
    v_fma_mix_f32 v63, v71, 1.0, v63 op_sel:[1,0,0] op_sel_hi:[1,0,0]
    buffer_load_dword v13, off, s[16:19], s43 sc0 sc1
    s_waitcnt lgkmcnt(4)
    v_mfma_f32_32x32x16_bf16 v[32:47], a[8:11], v[24:27], v[32:47]
    ds_read_b64_tr_b16 v[20:21], v6 offset:51200
    ds_read_b64_tr_b16 v[22:23], v6 offset:52224
    v_cvt_pk_f16_f32 v48, v48, v49
    v_cvt_pk_f16_f32 v49, v50, v51
    v_cvt_pk_f16_f32 v50, v52, v53
    v_cvt_pk_f16_f32 v51, v54, v55
    s_waitcnt lgkmcnt(4)
    v_mfma_f32_32x32x16_bf16 v[32:47], a[12:15], v[28:31], v[32:47]
    s_barrier
    s_waitcnt lgkmcnt(2)
    v_mfma_f32_32x32x16_bf16 v[32:47], v[88:91], v[16:19], v[32:47]
    ds_read_b64_tr_b16 v[24:25], v6 offset:57344
    ds_read_b64_tr_b16 v[26:27], v6 offset:58368
    ds_read_b64_tr_b16 v[28:29], v6 offset:59392
    ds_read_b64_tr_b16 v[30:31], v6 offset:60416
    v_cvt_pk_f16_f32 v52, v56, v57
    v_cvt_pk_f16_f32 v53, v58, v59
    v_cvt_pk_f16_f32 v54, v60, v61
    v_cvt_pk_f16_f32 v55, v62, v63
    s_lshl_b32 s50, s75, s8
    s_add_u32 s50, s50, s56
    s_add_u32 s51, s50, s9
    buffer_store_dwordx4 v[48:51], v1, s[20:23], s50 offen sc0 sc1
    buffer_store_dwordx4 v[52:55], v1, s[20:23], s51 offen sc0 sc1
    s_waitcnt lgkmcnt(4)
    v_mfma_f32_32x32x16_bf16 v[32:47], v[92:95], v[20:23], v[32:47]
    ds_read_b64_tr_b16 v[16:17], v9 offset:49152
    ds_read_b64_tr_b16 v[18:19], v9 offset:50176
    s_waitcnt lgkmcnt(4)
    v_mfma_f32_32x32x16_bf16 v[32:47], v[96:99], v[24:27], v[32:47]
    ds_read_b64_tr_b16 v[20:21], v9 offset:51200
    ds_read_b64_tr_b16 v[22:23], v9 offset:52224
    s_waitcnt lgkmcnt(4)
    v_mfma_f32_32x32x16_bf16 v[32:47], v[100:103], v[28:31], v[32:47]
    ds_read_b64_tr_b16 v[24:25], v9 offset:57344
    ds_read_b64_tr_b16 v[26:27], v9 offset:58368
    s_waitcnt lgkmcnt(4)
    v_mfma_f32_32x32x16_bf16 v[32:47], a[16:19], v[16:19], v[32:47]
    ds_read_b64_tr_b16 v[28:29], v9 offset:59392
    ds_read_b64_tr_b16 v[30:31], v9 offset:60416
    s_waitcnt lgkmcnt(4)
    v_mfma_f32_32x32x16_bf16 v[32:47], a[20:23], v[20:23], v[32:47]
    ds_read_b64_tr_b16 v[16:17], v7 offset:0
    ds_read_b64_tr_b16 v[18:19], v7 offset:1024
    s_waitcnt vmcnt(2)
.sp_36:
    v_readfirstlane_b32 s50, v13
    s_add_u32 s50, s50, s100
    s_cmp_ge_u32 s50, 7
    s_cbranch_scc1 .ok_37
    s_sub_u32 s82, s82, 1
    s_cmp_lt_i32 s82, 1
    s_cbranch_scc1 .ok_37
    buffer_load_dword v13, off, s[16:19], s43 sc0 sc1
    s_waitcnt vmcnt(0)
    s_branch .sp_36

.ok_37:
    s_lshl_b32 s50, s76, s8
    s_add_u32 s50, s50, s56
    s_add_u32 s51, s50, s9
    buffer_load_dwordx4 v[64:67], v1, s[20:23], s50 offen sc0 sc1
    buffer_load_dwordx4 v[68:71], v1, s[20:23], s51 offen sc0 sc1
    s_waitcnt lgkmcnt(4)
    v_mfma_f32_32x32x16_bf16 v[32:47], a[24:27], v[24:27], v[32:47]
    ds_read_b64_tr_b16 v[20:21], v7 offset:2048
    ds_read_b64_tr_b16 v[22:23], v7 offset:3072
    v_mov_b32 v14, 6
    s_waitcnt vmcnt(2)
    s_mov_b64 exec, 1
    buffer_store_dword v14, off, s[16:19], s42 sc0 sc1
    s_mov_b64 exec, -1
    v_lshrrev_b32 v4, 8, v12
    v_bfe_u32 v3, v12, 4, 4
    v_lshlrev_b32 v3, 1, v3
    v_lshlrev_b32 v0, 6, v4
    v_mul_u32_u24 v4, 9216, v4
    v_add_u32 v4, v4, v3
    v_lshlrev_b32 v5, 1, v4
    s_lshr_b32 s49, s48, 2
    s_lshr_b32 s51, s48, 3
    s_lshl_b32 s50, s45, 3
    s_add_u32 s50, s50, s51
    s_lshl_b32 s51, s50, 5
    s_add_u32 s51, s51, 153600
    v_add_u32 v0, s51, v0
    s_lshl_b32 s51, s47, 5
    s_add_u32 s50, s50, s51
    s_mul_i32 s64, s50, 4608
    s_lshl_b32 s63, s46, 6
    s_and_b32 s51, s49, 1
    s_lshl_b32 s51, s51, 5
    s_add_u32 s63, s63, s51
    s_add_u32 s64, s64, s63
    s_mul_i32 s65, s47, 147456
    s_lshl_b32 s50, s44, 11
    s_add_u32 s65, s65, s50
    s_lshl_b32 s50, s49, 8
    s_add_u32 s65, s65, s50
    s_add_u32 s65, s65, 4718592
    s_lshl_b32 s49, s49, 2
    s_sub_u32 s62, s42, s49

    ds_read_b128 a[96:99], v0
    ds_read_b128 a[100:103], v0 offset:16
    s_waitcnt lgkmcnt(6)
    v_mfma_f32_32x32x16_bf16 v[32:47], a[28:31], v[28:31], v[32:47]
    s_barrier
    s_waitcnt lgkmcnt(4)
    v_mfma_f32_32x32x16_bf16 v[32:47], v[104:107], v[16:19], v[32:47]
    ds_read_b64_tr_b16 v[24:25], v7 offset:8192
    ds_read_b64_tr_b16 v[26:27], v7 offset:9216
    ds_read_b64_tr_b16 v[28:29], v7 offset:10240
    ds_read_b64_tr_b16 v[30:31], v7 offset:11264
    s_add_u32 s50, s76, s64
    buffer_load_ushort a80, v4, s[4:7], s50 offen offset:0
    buffer_load_ushort a81, v4, s[4:7], s50 offen offset:1152
    buffer_load_ushort a82, v4, s[4:7], s50 offen offset:2304
    buffer_load_ushort a83, v4, s[4:7], s50 offen offset:3456
    s_add_u32 s50, s76, s63
    buffer_load_ushort a84, v3, s[24:27], s50 offen
    s_add_u32 s50, s77, s64
    buffer_load_ushort a85, v4, s[4:7], s50 offen offset:0
    buffer_load_ushort a86, v4, s[4:7], s50 offen offset:1152
    buffer_load_ushort a87, v4, s[4:7], s50 offen offset:2304
    buffer_load_ushort a88, v4, s[4:7], s50 offen offset:3456
    s_add_u32 s50, s77, s63
    buffer_load_ushort a89, v3, s[24:27], s50 offen
    s_waitcnt lgkmcnt(6)
    v_mfma_f32_32x32x16_bf16 v[32:47], v[108:111], v[20:23], v[32:47]
    ds_read_b64_tr_b16 v[16:17], v10 offset:0
    ds_read_b64_tr_b16 v[18:19], v10 offset:1024
    s_add_u32 s50, s78, s64
    buffer_load_ushort a90, v4, s[4:7], s50 offen offset:0
    buffer_load_ushort a91, v4, s[4:7], s50 offen offset:1152
    buffer_load_ushort a92, v4, s[4:7], s50 offen offset:2304
    buffer_load_ushort a93, v4, s[4:7], s50 offen offset:3456
    s_add_u32 s50, s78, s63
    buffer_load_ushort a94, v3, s[24:27], s50 offen
    s_waitcnt lgkmcnt(4)
    v_mfma_f32_32x32x16_bf16 v[32:47], a[48:51], v[24:27], v[32:47]
    ds_read_b64_tr_b16 v[20:21], v10 offset:2048
    ds_read_b64_tr_b16 v[22:23], v10 offset:3072
    s_waitcnt lgkmcnt(4)
    v_mfma_f32_32x32x16_bf16 v[32:47], a[52:55], v[28:31], v[32:47]
    ds_read_b64_tr_b16 v[24:25], v10 offset:8192
    ds_read_b64_tr_b16 v[26:27], v10 offset:9216
    s_waitcnt lgkmcnt(4)
    v_mfma_f32_32x32x16_bf16 v[32:47], a[32:35], v[16:19], v[32:47]
    ds_read_b64_tr_b16 v[28:29], v10 offset:10240
    ds_read_b64_tr_b16 v[30:31], v10 offset:11264
    s_waitcnt lgkmcnt(4)
    v_mfma_f32_32x32x16_bf16 v[32:47], a[36:39], v[20:23], v[32:47]
    ds_read_b64_tr_b16 v[16:17], v7 offset:16384
    ds_read_b64_tr_b16 v[18:19], v7 offset:17408
    s_waitcnt lgkmcnt(4)
    v_mfma_f32_32x32x16_bf16 v[32:47], a[40:43], v[24:27], v[32:47]
    ds_read_b64_tr_b16 v[20:21], v7 offset:18432
    ds_read_b64_tr_b16 v[22:23], v7 offset:19456
    s_waitcnt lgkmcnt(4)
    v_mfma_f32_32x32x16_bf16 v[32:47], a[44:47], v[28:31], v[32:47]
    s_barrier
    s_waitcnt lgkmcnt(2)
    v_mfma_f32_32x32x16_bf16 v[48:63], v[72:75], v[16:19], 0
    ds_read_b64_tr_b16 v[24:25], v7 offset:24576
    ds_read_b64_tr_b16 v[26:27], v7 offset:25600
    ds_read_b64_tr_b16 v[28:29], v7 offset:26624
    ds_read_b64_tr_b16 v[30:31], v7 offset:27648
    s_waitcnt lgkmcnt(4)
    v_mfma_f32_32x32x16_bf16 v[48:63], v[76:79], v[20:23], v[48:63]
    ds_read_b64_tr_b16 v[16:17], v10 offset:16384
    ds_read_b64_tr_b16 v[18:19], v10 offset:17408
    s_waitcnt lgkmcnt(4)
    v_mfma_f32_32x32x16_bf16 v[48:63], v[80:83], v[24:27], v[48:63]
    ds_read_b64_tr_b16 v[20:21], v10 offset:18432
    ds_read_b64_tr_b16 v[22:23], v10 offset:19456
    s_waitcnt vmcnt(16)
    v_fma_mix_f32 v32, v64, 1.0, v32 op_sel:[0,0,0] op_sel_hi:[1,0,0]
    v_fma_mix_f32 v33, v64, 1.0, v33 op_sel:[1,0,0] op_sel_hi:[1,0,0]
    v_fma_mix_f32 v34, v65, 1.0, v34 op_sel:[0,0,0] op_sel_hi:[1,0,0]
    s_waitcnt lgkmcnt(4)
    v_mfma_f32_32x32x16_bf16 v[48:63], v[84:87], v[28:31], v[48:63]
    ds_read_b64_tr_b16 v[24:25], v10 offset:24576
    ds_read_b64_tr_b16 v[26:27], v10 offset:25600
    v_fma_mix_f32 v35, v65, 1.0, v35 op_sel:[1,0,0] op_sel_hi:[1,0,0]
    v_fma_mix_f32 v36, v66, 1.0, v36 op_sel:[0,0,0] op_sel_hi:[1,0,0]
    v_fma_mix_f32 v37, v66, 1.0, v37 op_sel:[1,0,0] op_sel_hi:[1,0,0]
    v_fma_mix_f32 v38, v67, 1.0, v38 op_sel:[0,0,0] op_sel_hi:[1,0,0]
    s_waitcnt lgkmcnt(4)
    v_mfma_f32_32x32x16_bf16 v[48:63], a[0:3], v[16:19], v[48:63]
    ds_read_b64_tr_b16 v[28:29], v10 offset:26624
    ds_read_b64_tr_b16 v[30:31], v10 offset:27648
    v_fma_mix_f32 v39, v67, 1.0, v39 op_sel:[1,0,0] op_sel_hi:[1,0,0]
    v_fma_mix_f32 v40, v68, 1.0, v40 op_sel:[0,0,0] op_sel_hi:[1,0,0]
    v_fma_mix_f32 v41, v68, 1.0, v41 op_sel:[1,0,0] op_sel_hi:[1,0,0]
    v_fma_mix_f32 v42, v69, 1.0, v42 op_sel:[0,0,0] op_sel_hi:[1,0,0]
    s_waitcnt lgkmcnt(4)
    v_mfma_f32_32x32x16_bf16 v[48:63], a[4:7], v[20:23], v[48:63]
    ds_read_b64_tr_b16 v[16:17], v7 offset:32768
    ds_read_b64_tr_b16 v[18:19], v7 offset:33792
    v_fma_mix_f32 v43, v69, 1.0, v43 op_sel:[1,0,0] op_sel_hi:[1,0,0]
    v_fma_mix_f32 v44, v70, 1.0, v44 op_sel:[0,0,0] op_sel_hi:[1,0,0]
    v_fma_mix_f32 v45, v70, 1.0, v45 op_sel:[1,0,0] op_sel_hi:[1,0,0]
    v_fma_mix_f32 v46, v71, 1.0, v46 op_sel:[0,0,0] op_sel_hi:[1,0,0]
    v_fma_mix_f32 v47, v71, 1.0, v47 op_sel:[1,0,0] op_sel_hi:[1,0,0]
    buffer_load_dword v13, off, s[16:19], s43 sc0 sc1
    s_waitcnt lgkmcnt(4)
    v_mfma_f32_32x32x16_bf16 v[48:63], a[8:11], v[24:27], v[48:63]
    ds_read_b64_tr_b16 v[20:21], v7 offset:34816
    ds_read_b64_tr_b16 v[22:23], v7 offset:35840
    v_cvt_pk_f16_f32 v32, v32, v33
    v_cvt_pk_f16_f32 v33, v34, v35
    v_cvt_pk_f16_f32 v34, v36, v37
    v_cvt_pk_f16_f32 v35, v38, v39
    s_waitcnt lgkmcnt(4)
    v_mfma_f32_32x32x16_bf16 v[48:63], a[12:15], v[28:31], v[48:63]
    s_barrier
    s_waitcnt lgkmcnt(2)
    v_mfma_f32_32x32x16_bf16 v[48:63], v[88:91], v[16:19], v[48:63]
    ds_read_b64_tr_b16 v[24:25], v7 offset:40960
    ds_read_b64_tr_b16 v[26:27], v7 offset:41984
    ds_read_b64_tr_b16 v[28:29], v7 offset:43008
    ds_read_b64_tr_b16 v[30:31], v7 offset:44032
    v_cvt_pk_f16_f32 v36, v40, v41
    v_cvt_pk_f16_f32 v37, v42, v43
    v_cvt_pk_f16_f32 v38, v44, v45
    v_cvt_pk_f16_f32 v39, v46, v47
    s_lshl_b32 s50, s76, s8
    s_add_u32 s50, s50, s56
    s_add_u32 s51, s50, s9
    buffer_store_dwordx4 v[32:35], v1, s[20:23], s50 offen sc0 sc1
    buffer_store_dwordx4 v[36:39], v1, s[20:23], s51 offen sc0 sc1
    s_waitcnt lgkmcnt(4)
    v_mfma_f32_32x32x16_bf16 v[48:63], v[92:95], v[20:23], v[48:63]
    ds_read_b64_tr_b16 v[16:17], v10 offset:32768
    ds_read_b64_tr_b16 v[18:19], v10 offset:33792
    s_waitcnt lgkmcnt(4)
    v_mfma_f32_32x32x16_bf16 v[48:63], v[96:99], v[24:27], v[48:63]
    ds_read_b64_tr_b16 v[20:21], v10 offset:34816
    ds_read_b64_tr_b16 v[22:23], v10 offset:35840
    s_waitcnt lgkmcnt(4)
    v_mfma_f32_32x32x16_bf16 v[48:63], v[100:103], v[28:31], v[48:63]
    ds_read_b64_tr_b16 v[24:25], v10 offset:40960
    ds_read_b64_tr_b16 v[26:27], v10 offset:41984
    s_waitcnt lgkmcnt(4)
    v_mfma_f32_32x32x16_bf16 v[48:63], a[16:19], v[16:19], v[48:63]
    ds_read_b64_tr_b16 v[28:29], v10 offset:43008
    ds_read_b64_tr_b16 v[30:31], v10 offset:44032
    s_waitcnt lgkmcnt(4)
    v_mfma_f32_32x32x16_bf16 v[48:63], a[20:23], v[20:23], v[48:63]
    ds_read_b64_tr_b16 v[16:17], v7 offset:49152
    ds_read_b64_tr_b16 v[18:19], v7 offset:50176
    s_waitcnt vmcnt(2)
.sp_38:
    v_readfirstlane_b32 s50, v13
    s_add_u32 s50, s50, s100
    s_cmp_ge_u32 s50, 8
    s_cbranch_scc1 .ok_39
    s_sub_u32 s82, s82, 1
    s_cmp_lt_i32 s82, 1
    s_cbranch_scc1 .ok_39
    buffer_load_dword v13, off, s[16:19], s43 sc0 sc1
    s_waitcnt vmcnt(0)
    s_branch .sp_38

.ok_39:
    s_lshl_b32 s50, s77, s8
    s_add_u32 s50, s50, s56
    s_add_u32 s51, s50, s9
    buffer_load_dwordx4 v[64:67], v1, s[20:23], s50 offen sc0 sc1
    buffer_load_dwordx4 v[68:71], v1, s[20:23], s51 offen sc0 sc1
    s_waitcnt lgkmcnt(4)
    v_mfma_f32_32x32x16_bf16 v[48:63], a[24:27], v[24:27], v[48:63]
    ds_read_b64_tr_b16 v[20:21], v7 offset:51200
    ds_read_b64_tr_b16 v[22:23], v7 offset:52224
    v_mov_b32 v14, 7
    s_waitcnt vmcnt(2)
    s_mov_b64 exec, 1
    buffer_store_dword v14, off, s[16:19], s42 sc0 sc1
    s_mov_b64 exec, -1
    s_waitcnt lgkmcnt(4)
    v_mfma_f32_32x32x16_bf16 v[48:63], a[28:31], v[28:31], v[48:63]
    s_barrier
    s_waitcnt lgkmcnt(2)
    v_mfma_f32_32x32x16_bf16 v[48:63], v[104:107], v[16:19], v[48:63]
    ds_read_b64_tr_b16 v[24:25], v7 offset:57344
    ds_read_b64_tr_b16 v[26:27], v7 offset:58368
    ds_read_b64_tr_b16 v[28:29], v7 offset:59392
    ds_read_b64_tr_b16 v[30:31], v7 offset:60416
    s_waitcnt lgkmcnt(4)
    v_mfma_f32_32x32x16_bf16 v[48:63], v[108:111], v[20:23], v[48:63]
    ds_read_b64_tr_b16 v[16:17], v10 offset:49152
    ds_read_b64_tr_b16 v[18:19], v10 offset:50176
    s_waitcnt lgkmcnt(4)
    v_mfma_f32_32x32x16_bf16 v[48:63], a[48:51], v[24:27], v[48:63]
    ds_read_b64_tr_b16 v[20:21], v10 offset:51200
    ds_read_b64_tr_b16 v[22:23], v10 offset:52224
    s_waitcnt lgkmcnt(4)
    v_mfma_f32_32x32x16_bf16 v[48:63], a[52:55], v[28:31], v[48:63]
    ds_read_b64_tr_b16 v[24:25], v10 offset:57344
    ds_read_b64_tr_b16 v[26:27], v10 offset:58368
    s_waitcnt lgkmcnt(4)
    v_mfma_f32_32x32x16_bf16 v[48:63], a[32:35], v[16:19], v[48:63]
    ds_read_b64_tr_b16 v[28:29], v10 offset:59392
    ds_read_b64_tr_b16 v[30:31], v10 offset:60416
    s_waitcnt lgkmcnt(4)
    v_mfma_f32_32x32x16_bf16 v[48:63], a[36:39], v[20:23], v[48:63]
    ds_read_b64_tr_b16 v[16:17], v6 offset:32768
    ds_read_b64_tr_b16 v[18:19], v6 offset:33792
    s_waitcnt lgkmcnt(4)
    v_mfma_f32_32x32x16_bf16 v[48:63], a[40:43], v[24:27], v[48:63]
    ds_read_b64_tr_b16 v[20:21], v6 offset:34816
    ds_read_b64_tr_b16 v[22:23], v6 offset:35840
    s_waitcnt lgkmcnt(4)
    v_mfma_f32_32x32x16_bf16 v[48:63], a[44:47], v[28:31], v[48:63]
    s_barrier
    s_waitcnt lgkmcnt(2)
    v_mfma_f32_32x32x16_bf16 v[32:47], v[72:75], v[16:19], 0
    ds_read_b64_tr_b16 v[24:25], v6 offset:40960
    ds_read_b64_tr_b16 v[26:27], v6 offset:41984
    ds_read_b64_tr_b16 v[28:29], v6 offset:43008
    ds_read_b64_tr_b16 v[30:31], v6 offset:44032
    s_waitcnt lgkmcnt(4)
    v_mfma_f32_32x32x16_bf16 v[32:47], v[76:79], v[20:23], v[32:47]
    ds_read_b64_tr_b16 v[16:17], v9 offset:32768
    ds_read_b64_tr_b16 v[18:19], v9 offset:33792
    s_waitcnt lgkmcnt(4)
    v_mfma_f32_32x32x16_bf16 v[32:47], v[80:83], v[24:27], v[32:47]
    ds_read_b64_tr_b16 v[20:21], v9 offset:34816
    ds_read_b64_tr_b16 v[22:23], v9 offset:35840
    s_waitcnt vmcnt(1)
    v_fma_mix_f32 v48, v64, 1.0, v48 op_sel:[0,0,0] op_sel_hi:[1,0,0]
    v_fma_mix_f32 v49, v64, 1.0, v49 op_sel:[1,0,0] op_sel_hi:[1,0,0]
    v_fma_mix_f32 v50, v65, 1.0, v50 op_sel:[0,0,0] op_sel_hi:[1,0,0]
    s_waitcnt lgkmcnt(4)
    v_mfma_f32_32x32x16_bf16 v[32:47], v[84:87], v[28:31], v[32:47]
    ds_read_b64_tr_b16 v[24:25], v9 offset:40960
    ds_read_b64_tr_b16 v[26:27], v9 offset:41984
    v_fma_mix_f32 v51, v65, 1.0, v51 op_sel:[1,0,0] op_sel_hi:[1,0,0]
    v_fma_mix_f32 v52, v66, 1.0, v52 op_sel:[0,0,0] op_sel_hi:[1,0,0]
    v_fma_mix_f32 v53, v66, 1.0, v53 op_sel:[1,0,0] op_sel_hi:[1,0,0]
    v_fma_mix_f32 v54, v67, 1.0, v54 op_sel:[0,0,0] op_sel_hi:[1,0,0]
    s_waitcnt lgkmcnt(4)
    v_mfma_f32_32x32x16_bf16 v[32:47], a[0:3], v[16:19], v[32:47]
    ds_read_b64_tr_b16 v[28:29], v9 offset:43008
    ds_read_b64_tr_b16 v[30:31], v9 offset:44032
    v_fma_mix_f32 v55, v67, 1.0, v55 op_sel:[1,0,0] op_sel_hi:[1,0,0]
    v_fma_mix_f32 v56, v68, 1.0, v56 op_sel:[0,0,0] op_sel_hi:[1,0,0]
    v_fma_mix_f32 v57, v68, 1.0, v57 op_sel:[1,0,0] op_sel_hi:[1,0,0]
    v_fma_mix_f32 v58, v69, 1.0, v58 op_sel:[0,0,0] op_sel_hi:[1,0,0]
    s_waitcnt lgkmcnt(4)
    v_mfma_f32_32x32x16_bf16 v[32:47], a[4:7], v[20:23], v[32:47]
    ds_read_b64_tr_b16 v[16:17], v6 offset:0
    ds_read_b64_tr_b16 v[18:19], v6 offset:1024
    v_fma_mix_f32 v59, v69, 1.0, v59 op_sel:[1,0,0] op_sel_hi:[1,0,0]
    v_fma_mix_f32 v60, v70, 1.0, v60 op_sel:[0,0,0] op_sel_hi:[1,0,0]
    v_fma_mix_f32 v61, v70, 1.0, v61 op_sel:[1,0,0] op_sel_hi:[1,0,0]
    v_fma_mix_f32 v62, v71, 1.0, v62 op_sel:[0,0,0] op_sel_hi:[1,0,0]
    v_fma_mix_f32 v63, v71, 1.0, v63 op_sel:[1,0,0] op_sel_hi:[1,0,0]
    buffer_load_dword v13, off, s[16:19], s43 sc0 sc1
    s_waitcnt lgkmcnt(4)
    v_mfma_f32_32x32x16_bf16 v[32:47], a[8:11], v[24:27], v[32:47]
    ds_read_b64_tr_b16 v[20:21], v6 offset:2048
    ds_read_b64_tr_b16 v[22:23], v6 offset:3072
    v_cvt_pk_f16_f32 v48, v48, v49
    v_cvt_pk_f16_f32 v49, v50, v51
    v_cvt_pk_f16_f32 v50, v52, v53
    v_cvt_pk_f16_f32 v51, v54, v55
    s_waitcnt lgkmcnt(4)
    v_mfma_f32_32x32x16_bf16 v[32:47], a[12:15], v[28:31], v[32:47]
    s_barrier
    s_waitcnt lgkmcnt(2)
    v_mfma_f32_32x32x16_bf16 v[32:47], v[88:91], v[16:19], v[32:47]
    ds_read_b64_tr_b16 v[24:25], v6 offset:8192
    ds_read_b64_tr_b16 v[26:27], v6 offset:9216
    ds_read_b64_tr_b16 v[28:29], v6 offset:10240
    ds_read_b64_tr_b16 v[30:31], v6 offset:11264
    v_cvt_pk_f16_f32 v52, v56, v57
    v_cvt_pk_f16_f32 v53, v58, v59
    v_cvt_pk_f16_f32 v54, v60, v61
    v_cvt_pk_f16_f32 v55, v62, v63
    s_lshl_b32 s50, s77, s8
    s_add_u32 s50, s50, s56
    s_add_u32 s51, s50, s9
    buffer_store_dwordx4 v[48:51], v1, s[20:23], s50 offen sc0 sc1
    buffer_store_dwordx4 v[52:55], v1, s[20:23], s51 offen sc0 sc1
    s_waitcnt lgkmcnt(4)
    v_mfma_f32_32x32x16_bf16 v[32:47], v[92:95], v[20:23], v[32:47]
    ds_read_b64_tr_b16 v[16:17], v9 offset:0
    ds_read_b64_tr_b16 v[18:19], v9 offset:1024
    s_waitcnt lgkmcnt(4)
    v_mfma_f32_32x32x16_bf16 v[32:47], v[96:99], v[24:27], v[32:47]
    ds_read_b64_tr_b16 v[20:21], v9 offset:2048
    ds_read_b64_tr_b16 v[22:23], v9 offset:3072
    s_waitcnt lgkmcnt(4)
    v_mfma_f32_32x32x16_bf16 v[32:47], v[100:103], v[28:31], v[32:47]
    ds_read_b64_tr_b16 v[24:25], v9 offset:8192
    ds_read_b64_tr_b16 v[26:27], v9 offset:9216
    s_waitcnt lgkmcnt(4)
    v_mfma_f32_32x32x16_bf16 v[32:47], a[16:19], v[16:19], v[32:47]
    ds_read_b64_tr_b16 v[28:29], v9 offset:10240
    ds_read_b64_tr_b16 v[30:31], v9 offset:11264
    s_waitcnt lgkmcnt(4)
    v_mfma_f32_32x32x16_bf16 v[32:47], a[20:23], v[20:23], v[32:47]
    ds_read_b64_tr_b16 v[16:17], v8 offset:0
    ds_read_b64_tr_b16 v[18:19], v8 offset:1024
    s_waitcnt vmcnt(2)
.sp_40:
    v_readfirstlane_b32 s50, v13
    s_add_u32 s50, s50, s100
    s_cmp_ge_u32 s50, 9
    s_cbranch_scc1 .ok_41
    s_sub_u32 s82, s82, 1
    s_cmp_lt_i32 s82, 1
    s_cbranch_scc1 .ok_41
    buffer_load_dword v13, off, s[16:19], s43 sc0 sc1
    s_waitcnt vmcnt(0)
    s_branch .sp_40

.ok_41:
    s_lshl_b32 s50, s78, s8
    s_add_u32 s50, s50, s56
    s_add_u32 s51, s50, s9
    buffer_load_dwordx4 v[64:67], v1, s[20:23], s50 offen sc0 sc1
    buffer_load_dwordx4 v[68:71], v1, s[20:23], s51 offen sc0 sc1
    s_waitcnt lgkmcnt(4)
    v_mfma_f32_32x32x16_bf16 v[32:47], a[24:27], v[24:27], v[32:47]
    ds_read_b64_tr_b16 v[20:21], v8 offset:2048
    ds_read_b64_tr_b16 v[22:23], v8 offset:3072
    v_mov_b32 v14, 8
    s_waitcnt vmcnt(2)
    s_mov_b64 exec, 1
    buffer_store_dword v14, off, s[16:19], s42 sc0 sc1
    s_mov_b64 exec, -1
    s_waitcnt lgkmcnt(4)
    v_mfma_f32_32x32x16_bf16 v[32:47], a[28:31], v[28:31], v[32:47]
    s_barrier
    s_waitcnt lgkmcnt(2)
    v_mfma_f32_32x32x16_bf16 v[32:47], v[104:107], v[16:19], v[32:47]
    ds_read_b64_tr_b16 v[24:25], v8 offset:8192
    ds_read_b64_tr_b16 v[26:27], v8 offset:9216
    ds_read_b64_tr_b16 v[28:29], v8 offset:10240
    ds_read_b64_tr_b16 v[30:31], v8 offset:11264
    s_waitcnt lgkmcnt(4)
    v_mfma_f32_32x32x16_bf16 v[32:47], v[108:111], v[20:23], v[32:47]
    ds_read_b64_tr_b16 v[16:17], v11 offset:0
    ds_read_b64_tr_b16 v[18:19], v11 offset:1024
    s_waitcnt lgkmcnt(4)
    v_mfma_f32_32x32x16_bf16 v[32:47], a[48:51], v[24:27], v[32:47]
    ds_read_b64_tr_b16 v[20:21], v11 offset:2048
    ds_read_b64_tr_b16 v[22:23], v11 offset:3072
    s_waitcnt lgkmcnt(4)
    v_mfma_f32_32x32x16_bf16 v[32:47], a[52:55], v[28:31], v[32:47]
    ds_read_b64_tr_b16 v[24:25], v11 offset:8192
    ds_read_b64_tr_b16 v[26:27], v11 offset:9216
    s_waitcnt lgkmcnt(4)
    v_mfma_f32_32x32x16_bf16 v[32:47], a[32:35], v[16:19], v[32:47]
    ds_read_b64_tr_b16 v[28:29], v11 offset:10240
    ds_read_b64_tr_b16 v[30:31], v11 offset:11264
    s_waitcnt lgkmcnt(4)
    v_mfma_f32_32x32x16_bf16 v[32:47], a[36:39], v[20:23], v[32:47]
    s_waitcnt lgkmcnt(2)
    v_mfma_f32_32x32x16_bf16 v[32:47], a[40:43], v[24:27], v[32:47]
    s_waitcnt lgkmcnt(0)
    v_mfma_f32_32x32x16_bf16 v[32:47], a[44:47], v[28:31], v[32:47]
    s_barrier
    s_nop 7
    s_nop 7
    s_waitcnt vmcnt(1)
    v_fma_mix_f32 v32, v64, 1.0, v32 op_sel:[0,0,0] op_sel_hi:[1,0,0]
    v_fma_mix_f32 v33, v64, 1.0, v33 op_sel:[1,0,0] op_sel_hi:[1,0,0]
    v_fma_mix_f32 v34, v65, 1.0, v34 op_sel:[0,0,0] op_sel_hi:[1,0,0]
    v_fma_mix_f32 v35, v65, 1.0, v35 op_sel:[1,0,0] op_sel_hi:[1,0,0]
    v_fma_mix_f32 v36, v66, 1.0, v36 op_sel:[0,0,0] op_sel_hi:[1,0,0]
    v_fma_mix_f32 v37, v66, 1.0, v37 op_sel:[1,0,0] op_sel_hi:[1,0,0]
    v_fma_mix_f32 v38, v67, 1.0, v38 op_sel:[0,0,0] op_sel_hi:[1,0,0]
    v_fma_mix_f32 v39, v67, 1.0, v39 op_sel:[1,0,0] op_sel_hi:[1,0,0]
    v_fma_mix_f32 v40, v68, 1.0, v40 op_sel:[0,0,0] op_sel_hi:[1,0,0]
    v_fma_mix_f32 v41, v68, 1.0, v41 op_sel:[1,0,0] op_sel_hi:[1,0,0]
    v_fma_mix_f32 v42, v69, 1.0, v42 op_sel:[0,0,0] op_sel_hi:[1,0,0]
    v_fma_mix_f32 v43, v69, 1.0, v43 op_sel:[1,0,0] op_sel_hi:[1,0,0]
    v_fma_mix_f32 v44, v70, 1.0, v44 op_sel:[0,0,0] op_sel_hi:[1,0,0]
    v_fma_mix_f32 v45, v70, 1.0, v45 op_sel:[1,0,0] op_sel_hi:[1,0,0]
    v_fma_mix_f32 v46, v71, 1.0, v46 op_sel:[0,0,0] op_sel_hi:[1,0,0]
    v_fma_mix_f32 v47, v71, 1.0, v47 op_sel:[1,0,0] op_sel_hi:[1,0,0]
    v_cvt_pk_f16_f32 v32, v32, v33
    v_cvt_pk_f16_f32 v33, v34, v35
    v_cvt_pk_f16_f32 v34, v36, v37
    v_cvt_pk_f16_f32 v35, v38, v39
    v_cvt_pk_f16_f32 v36, v40, v41
    v_cvt_pk_f16_f32 v37, v42, v43
    v_cvt_pk_f16_f32 v38, v44, v45
    v_cvt_pk_f16_f32 v39, v46, v47
    s_lshl_b32 s50, s78, s8
    s_add_u32 s50, s50, s56
    s_add_u32 s51, s50, s9
    buffer_store_dwordx4 v[32:35], v1, s[20:23], s50 offen sc0 sc1
    buffer_store_dwordx4 v[36:39], v1, s[20:23], s51 offen sc0 sc1
    v_bfe_u32 v17, v12, 4, 2
    v_lshlrev_b32 v17, 2, v17
    buffer_load_dword v16, v17, s[16:19], s62 offen sc0 sc1
    v_lshrrev_b32 v8, 9, v12
    v_bfe_u32 v9, v12, 8, 1
    v_lshlrev_b32 v9, 3, v9
    v_and_b32 v7, 0xf0, v12
    v_lshl_add_u32 v7, v8, 10, v7
    v_add_u32 v7, v7, v9
    v_bfe_u32 v6, v12, 6, 2
    v_lshl_add_u32 v6, v8, 3, v6
    v_mul_u32_u24 v6, 2304, v6
    v_and_b32 v8, 0x30, v12
    v_add3_u32 v6, v6, v8, v9

    v_accvgpr_read_b32 v88, a96
    v_accvgpr_read_b32 v89, a97
    v_accvgpr_read_b32 v90, a98
    v_accvgpr_read_b32 v91, a99
    v_accvgpr_read_b32 v92, a100
    v_accvgpr_read_b32 v93, a101
    v_accvgpr_read_b32 v94, a102
    v_accvgpr_read_b32 v95, a103
    v_accvgpr_read_b32 v64, a80
    v_accvgpr_read_b32 v65, a81
    v_accvgpr_read_b32 v66, a82
    v_accvgpr_read_b32 v67, a83
    v_accvgpr_read_b32 v96, a84
    v_lshlrev_b32 v64, 16, v64
    v_lshlrev_b32 v65, 16, v65
    v_lshlrev_b32 v66, 16, v66
    v_lshlrev_b32 v67, 16, v67
    v_lshlrev_b32 v96, 16, v96
    v_fma_f32 v76, v64, v88, v89
    v_fma_f32 v77, v65, v90, v91
    v_fma_f32 v78, v66, v92, v93
    v_fma_f32 v79, v67, v94, v95
    v_cvt_pk_bf16_f32 v77, v76, v77
    v_cvt_pk_bf16_f32 v79, v78, v79
    v_lshlrev_b32 v76, 16, v77
    v_lshlrev_b32 v78, 16, v79
    v_and_b32 v77, s99, v77
    v_and_b32 v79, s99, v79
    v_mul_f32 v76, v76, v96
    v_mul_f32 v77, v77, v96
    v_mul_f32 v78, v78, v96
    v_mul_f32 v79, v79, v96
    v_cvt_pk_bf16_f32 v77, v76, v77
    v_cvt_pk_bf16_f32 v79, v78, v79
    v_lshlrev_b32 v76, 16, v77
    v_lshlrev_b32 v78, 16, v79
    v_and_b32 v77, s99, v77
    v_and_b32 v79, s99, v79
    v_accvgpr_read_b32 v68, a85
    v_accvgpr_read_b32 v69, a86
    v_accvgpr_read_b32 v70, a87
    v_accvgpr_read_b32 v71, a88
    v_accvgpr_read_b32 v97, a89
    v_lshlrev_b32 v68, 16, v68
    v_lshlrev_b32 v69, 16, v69
    v_lshlrev_b32 v70, 16, v70
    v_lshlrev_b32 v71, 16, v71
    v_lshlrev_b32 v97, 16, v97
    v_fma_f32 v80, v68, v88, v89
    v_fma_f32 v81, v69, v90, v91
    v_fma_f32 v82, v70, v92, v93
    v_fma_f32 v83, v71, v94, v95
    v_cvt_pk_bf16_f32 v81, v80, v81
    v_cvt_pk_bf16_f32 v83, v82, v83
    v_lshlrev_b32 v80, 16, v81
    v_lshlrev_b32 v82, 16, v83
    v_and_b32 v81, s99, v81
    v_and_b32 v83, s99, v83
    v_mul_f32 v80, v80, v97
    v_mul_f32 v81, v81, v97
    v_mul_f32 v82, v82, v97
    v_mul_f32 v83, v83, v97
    v_cvt_pk_bf16_f32 v81, v80, v81
    v_cvt_pk_bf16_f32 v83, v82, v83
    v_lshlrev_b32 v80, 16, v81
    v_lshlrev_b32 v82, 16, v83
    v_and_b32 v81, s99, v81
    v_and_b32 v83, s99, v83
    v_accvgpr_read_b32 v72, a90
    v_accvgpr_read_b32 v73, a91
    v_accvgpr_read_b32 v74, a92
    v_accvgpr_read_b32 v75, a93
    v_accvgpr_read_b32 v98, a94
    v_lshlrev_b32 v72, 16, v72
    v_lshlrev_b32 v73, 16, v73
    v_lshlrev_b32 v74, 16, v74
    v_lshlrev_b32 v75, 16, v75
    v_lshlrev_b32 v98, 16, v98
    v_fma_f32 v84, v72, v88, v89
    v_fma_f32 v85, v73, v90, v91
    v_fma_f32 v86, v74, v92, v93
    v_fma_f32 v87, v75, v94, v95
    v_cvt_pk_bf16_f32 v85, v84, v85
    v_cvt_pk_bf16_f32 v87, v86, v87
    v_lshlrev_b32 v84, 16, v85
    v_lshlrev_b32 v86, 16, v87
    v_and_b32 v85, s99, v85
    v_and_b32 v87, s99, v87
    v_mul_f32 v84, v84, v98
    v_mul_f32 v85, v85, v98
    v_mul_f32 v86, v86, v98
    v_mul_f32 v87, v87, v98
    v_cvt_pk_bf16_f32 v85, v84, v85
    v_cvt_pk_bf16_f32 v87, v86, v87
    v_lshlrev_b32 v84, 16, v85
    v_lshlrev_b32 v86, 16, v87
    v_and_b32 v85, s99, v85
    v_and_b32 v87, s99, v87
    v_mov_b32 v19, 9
    s_waitcnt vmcnt(1)
    s_mov_b64 exec, 1
    buffer_store_dword v19, off, s[16:19], s42 sc0 sc1
    s_mov_b64 exec, -1
    s_lshr_b32 s49, s48, 2
    s_lshl_b32 s49, 1, s49
    s_waitcnt vmcnt(0)
    v_cmp_gt_u32 vcc, 9, v16
    s_andn2_b32 s49, vcc_lo, s49
    s_and_b32 s49, s49, 15
    s_cbranch_scc0 .batch_42

    s_branch .f1_45
.fp_43:
    buffer_load_dword v16, v17, s[16:19], s62 offen sc0 sc1
.f1_45:
    s_waitcnt vmcnt(0)
    v_cmp_gt_u32 vcc, 8, v16
    s_cbranch_vccz .fg_44
    s_sub_u32 s82, s82, 1
    s_cmp_lt_i32 s82, 1
    s_cbranch_scc0 .fp_43

.fg_44:
    s_and_b32 s49, s48, 3
    s_cmp_eq_u32 s49, 3
    s_cselect_b64 exec, -1, 0
    s_lshl_b32 s50, s76, 7
    s_add_u32 s50, s50, s65
    s_add_u32 s51, s76, s64
    s_lshl_b32 s51, s51, 1
    buffer_load_dwordx2 v[96:97], v6, s[32:35], s51 offen sc0 sc1
    s_add_u32 s51, s51, 36864
    buffer_load_dwordx2 v[98:99], v6, s[32:35], s51 offen sc0 sc1
    buffer_load_dwordx2 v[100:101], v7, s[16:19], s50 offen sc0 sc1
    s_add_u32 s50, s50, 2359296
    buffer_load_dwordx2 v[20:21], v7, s[16:19], s50 offen sc0 sc1
    s_mov_b64 exec, -1
    s_lshl_b32 s50, s77, 7
    s_add_u32 s50, s50, s65
    s_add_u32 s51, s77, s64
    s_lshl_b32 s51, s51, 1
    buffer_load_dwordx2 v[102:103], v6, s[32:35], s51 offen sc0 sc1
    s_add_u32 s51, s51, 36864
    buffer_load_dwordx2 v[104:105], v6, s[32:35], s51 offen sc0 sc1
    buffer_load_dwordx2 v[106:107], v7, s[16:19], s50 offen sc0 sc1
    s_add_u32 s50, s50, 2359296
    buffer_load_dwordx2 v[22:23], v7, s[16:19], s50 offen sc0 sc1
    s_waitcnt vmcnt(0)
    v_fma_mix_f32 v32, v96, 1.0, v98 op_sel:[0,0,0] op_sel_hi:[1,0,1]
    v_fma_mix_f32 v33, v96, 1.0, v98 op_sel:[1,0,1] op_sel_hi:[1,0,1]
    v_fma_mix_f32 v34, v97, 1.0, v99 op_sel:[0,0,0] op_sel_hi:[1,0,1]
    v_fma_mix_f32 v35, v97, 1.0, v99 op_sel:[1,0,1] op_sel_hi:[1,0,1]
    v_fma_mix_f32 v36, v102, 1.0, v104 op_sel:[0,0,0] op_sel_hi:[1,0,1]
    v_fma_mix_f32 v37, v102, 1.0, v104 op_sel:[1,0,1] op_sel_hi:[1,0,1]
    v_fma_mix_f32 v38, v103, 1.0, v105 op_sel:[0,0,0] op_sel_hi:[1,0,1]
    v_fma_mix_f32 v39, v103, 1.0, v105 op_sel:[1,0,1] op_sel_hi:[1,0,1]
    v_fma_mix_f32 v32, v100, 1.0, v32 op_sel:[0,0,0] op_sel_hi:[1,0,0]
    v_fma_mix_f32 v33, v100, 1.0, v33 op_sel:[1,0,0] op_sel_hi:[1,0,0]
    v_fma_mix_f32 v34, v101, 1.0, v34 op_sel:[0,0,0] op_sel_hi:[1,0,0]
    v_fma_mix_f32 v35, v101, 1.0, v35 op_sel:[1,0,0] op_sel_hi:[1,0,0]
    v_fma_mix_f32 v36, v106, 1.0, v36 op_sel:[0,0,0] op_sel_hi:[1,0,0]
    v_fma_mix_f32 v37, v106, 1.0, v37 op_sel:[1,0,0] op_sel_hi:[1,0,0]
    v_fma_mix_f32 v38, v107, 1.0, v38 op_sel:[0,0,0] op_sel_hi:[1,0,0]
    v_fma_mix_f32 v39, v107, 1.0, v39 op_sel:[1,0,0] op_sel_hi:[1,0,0]
    v_fma_mix_f32 v44, v20, 1.0, v76 op_sel:[0,0,0] op_sel_hi:[1,0,0]
    v_fma_mix_f32 v45, v20, 1.0, v77 op_sel:[1,0,0] op_sel_hi:[1,0,0]
    v_fma_mix_f32 v46, v21, 1.0, v78 op_sel:[0,0,0] op_sel_hi:[1,0,0]
    v_fma_mix_f32 v47, v21, 1.0, v79 op_sel:[1,0,0] op_sel_hi:[1,0,0]
    v_fma_mix_f32 v48, v22, 1.0, v80 op_sel:[0,0,0] op_sel_hi:[1,0,0]
    v_fma_mix_f32 v49, v22, 1.0, v81 op_sel:[1,0,0] op_sel_hi:[1,0,0]
    v_fma_mix_f32 v50, v23, 1.0, v82 op_sel:[0,0,0] op_sel_hi:[1,0,0]
    v_fma_mix_f32 v51, v23, 1.0, v83 op_sel:[1,0,0] op_sel_hi:[1,0,0]
    v_cvt_pk_bf16_f32 v33, v32, v33
    v_cvt_pk_bf16_f32 v35, v34, v35
    v_lshlrev_b32 v32, 16, v33
    v_lshlrev_b32 v34, 16, v35
    v_and_b32 v33, s99, v33
    v_and_b32 v35, s99, v35
    v_cvt_pk_bf16_f32 v37, v36, v37
    v_cvt_pk_bf16_f32 v39, v38, v39
    v_lshlrev_b32 v36, 16, v37
    v_lshlrev_b32 v38, 16, v39
    v_and_b32 v37, s99, v37
    v_and_b32 v39, s99, v39
    v_mul_f32 v96, s98, v32
    v_mul_f32 v97, s98, v33
    v_mul_f32 v98, s98, v34
    v_mul_f32 v99, s98, v35
    v_mul_f32 v100, s98, v36
    v_mul_f32 v101, s98, v37
    v_mul_f32 v102, s98, v38
    v_mul_f32 v103, s98, v39
    v_exp_f32 v96, -v96
    v_exp_f32 v97, -v97
    v_exp_f32 v98, -v98
    v_exp_f32 v99, -v99
    v_exp_f32 v100, -v100
    v_exp_f32 v101, -v101
    v_exp_f32 v102, -v102
    v_exp_f32 v103, -v103
    v_add_f32 v96, 1.0, v96
    v_add_f32 v97, 1.0, v97
    v_add_f32 v98, 1.0, v98
    v_add_f32 v99, 1.0, v99
    v_add_f32 v100, 1.0, v100
    v_add_f32 v101, 1.0, v101
    v_add_f32 v102, 1.0, v102
    v_add_f32 v103, 1.0, v103
    v_rcp_f32 v96, v96
    v_rcp_f32 v97, v97
    v_rcp_f32 v98, v98
    v_rcp_f32 v99, v99
    v_rcp_f32 v100, v100
    v_rcp_f32 v101, v101
    v_rcp_f32 v102, v102
    v_rcp_f32 v103, v103
    v_mul_f32 v32, v32, v96
    v_mul_f32 v33, v33, v97
    v_mul_f32 v34, v34, v98
    v_mul_f32 v35, v35, v99
    v_mul_f32 v36, v36, v100
    v_mul_f32 v37, v37, v101
    v_mul_f32 v38, v38, v102
    v_mul_f32 v39, v39, v103
    v_cvt_pk_bf16_f32 v33, v32, v33
    v_cvt_pk_bf16_f32 v35, v34, v35
    v_lshlrev_b32 v32, 16, v33
    v_lshlrev_b32 v34, 16, v35
    v_and_b32 v33, s99, v33
    v_and_b32 v35, s99, v35
    v_cvt_pk_bf16_f32 v37, v36, v37
    v_cvt_pk_bf16_f32 v39, v38, v39
    v_lshlrev_b32 v36, 16, v37
    v_lshlrev_b32 v38, 16, v39
    v_and_b32 v37, s99, v37
    v_and_b32 v39, s99, v39
    v_fmac_f32 v64, v44, v32
    v_fmac_f32 v65, v45, v33
    v_fmac_f32 v66, v46, v34
    v_fmac_f32 v67, v47, v35
    v_fmac_f32 v68, v48, v36
    v_fmac_f32 v69, v49, v37
    v_fmac_f32 v70, v50, v38
    v_fmac_f32 v71, v51, v39
    s_and_b32 s49, s48, 3
    s_cmp_eq_u32 s49, 3
    s_cselect_b64 exec, -1, 0
    s_add_u32 s50, s76, s64
    s_lshl_b32 s50, s50, 1
    s_add_u32 s51, s50, 4608
    buffer_store_dword v64, v5, s[32:35], s50 offen offset:0
    buffer_store_dword v65, v5, s[32:35], s50 offen offset:2304
    buffer_store_dword v66, v5, s[32:35], s51 offen offset:0
    buffer_store_dword v67, v5, s[32:35], s51 offen offset:2304
    s_mov_b64 exec, -1
    s_add_u32 s50, s77, s64
    s_lshl_b32 s50, s50, 1
    s_add_u32 s51, s50, 4608
    buffer_store_dword v68, v5, s[32:35], s50 offen offset:0
    buffer_store_dword v69, v5, s[32:35], s50 offen offset:2304
    buffer_store_dword v70, v5, s[32:35], s51 offen offset:0
    buffer_store_dword v71, v5, s[32:35], s51 offen offset:2304
.fp_46:
    buffer_load_dword v16, v17, s[16:19], s62 offen sc0 sc1
.f1_48:
    s_waitcnt vmcnt(0)
    v_cmp_gt_u32 vcc, 9, v16
    s_cbranch_vccz .fg_47
    s_sub_u32 s82, s82, 1
    s_cmp_lt_i32 s82, 1
    s_cbranch_scc0 .fp_46

.fg_47:
    s_lshl_b32 s50, s78, 7
    s_add_u32 s50, s50, s65
    s_add_u32 s51, s78, s64
    s_lshl_b32 s51, s51, 1
    buffer_load_dwordx2 v[26:27], v6, s[32:35], s51 offen sc0 sc1
    s_add_u32 s51, s51, 36864
    buffer_load_dwordx2 v[28:29], v6, s[32:35], s51 offen sc0 sc1
    buffer_load_dwordx2 v[30:31], v7, s[16:19], s50 offen sc0 sc1
    s_add_u32 s50, s50, 2359296
    buffer_load_dwordx2 v[24:25], v7, s[16:19], s50 offen sc0 sc1
    s_waitcnt vmcnt(0)
    v_fma_mix_f32 v40, v26, 1.0, v28 op_sel:[0,0,0] op_sel_hi:[1,0,1]
    v_fma_mix_f32 v41, v26, 1.0, v28 op_sel:[1,0,1] op_sel_hi:[1,0,1]
    v_fma_mix_f32 v42, v27, 1.0, v29 op_sel:[0,0,0] op_sel_hi:[1,0,1]
    v_fma_mix_f32 v43, v27, 1.0, v29 op_sel:[1,0,1] op_sel_hi:[1,0,1]
    v_fma_mix_f32 v40, v30, 1.0, v40 op_sel:[0,0,0] op_sel_hi:[1,0,0]
    v_fma_mix_f32 v41, v30, 1.0, v41 op_sel:[1,0,0] op_sel_hi:[1,0,0]
    v_fma_mix_f32 v42, v31, 1.0, v42 op_sel:[0,0,0] op_sel_hi:[1,0,0]
    v_fma_mix_f32 v43, v31, 1.0, v43 op_sel:[1,0,0] op_sel_hi:[1,0,0]
    v_fma_mix_f32 v52, v24, 1.0, v84 op_sel:[0,0,0] op_sel_hi:[1,0,0]
    v_fma_mix_f32 v53, v24, 1.0, v85 op_sel:[1,0,0] op_sel_hi:[1,0,0]
    v_fma_mix_f32 v54, v25, 1.0, v86 op_sel:[0,0,0] op_sel_hi:[1,0,0]
    v_fma_mix_f32 v55, v25, 1.0, v87 op_sel:[1,0,0] op_sel_hi:[1,0,0]
    v_cvt_pk_bf16_f32 v41, v40, v41
    v_cvt_pk_bf16_f32 v43, v42, v43
    v_lshlrev_b32 v40, 16, v41
    v_lshlrev_b32 v42, 16, v43
    v_and_b32 v41, s99, v41
    v_and_b32 v43, s99, v43
    v_mul_f32 v104, s98, v40
    v_mul_f32 v105, s98, v41
    v_mul_f32 v106, s98, v42
    v_mul_f32 v107, s98, v43
    v_exp_f32 v104, -v104
    v_exp_f32 v105, -v105
    v_exp_f32 v106, -v106
    v_exp_f32 v107, -v107
    v_add_f32 v104, 1.0, v104
    v_add_f32 v105, 1.0, v105
    v_add_f32 v106, 1.0, v106
    v_add_f32 v107, 1.0, v107
    v_rcp_f32 v104, v104
    v_rcp_f32 v105, v105
    v_rcp_f32 v106, v106
    v_rcp_f32 v107, v107
    v_mul_f32 v40, v40, v104
    v_mul_f32 v41, v41, v105
    v_mul_f32 v42, v42, v106
    v_mul_f32 v43, v43, v107
    v_cvt_pk_bf16_f32 v41, v40, v41
    v_cvt_pk_bf16_f32 v43, v42, v43
    v_lshlrev_b32 v40, 16, v41
    v_lshlrev_b32 v42, 16, v43
    v_and_b32 v41, s99, v41
    v_and_b32 v43, s99, v43
    v_fmac_f32 v72, v52, v40
    v_fmac_f32 v73, v53, v41
    v_fmac_f32 v74, v54, v42
    v_fmac_f32 v75, v55, v43
    s_add_u32 s50, s78, s64
    s_lshl_b32 s50, s50, 1
    s_add_u32 s51, s50, 4608
    buffer_store_dword v72, v5, s[32:35], s50 offen offset:0
    buffer_store_dword v73, v5, s[32:35], s50 offen offset:2304
    buffer_store_dword v74, v5, s[32:35], s51 offen offset:0
    buffer_store_dword v75, v5, s[32:35], s51 offen offset:2304
    s_endpgm
.batch_42:
    s_and_b32 s49, s48, 3
    s_cmp_eq_u32 s49, 3
    s_cselect_b64 exec, -1, 0
    s_lshl_b32 s50, s76, 7
    s_add_u32 s50, s50, s65
    s_add_u32 s51, s76, s64
    s_lshl_b32 s51, s51, 1
    buffer_load_dwordx2 v[96:97], v6, s[32:35], s51 offen sc0 sc1
    s_add_u32 s51, s51, 36864
    buffer_load_dwordx2 v[98:99], v6, s[32:35], s51 offen sc0 sc1
    buffer_load_dwordx2 v[100:101], v7, s[16:19], s50 offen sc0 sc1
    s_add_u32 s50, s50, 2359296
    buffer_load_dwordx2 v[20:21], v7, s[16:19], s50 offen sc0 sc1
    s_mov_b64 exec, -1
    s_lshl_b32 s50, s77, 7
    s_add_u32 s50, s50, s65
    s_add_u32 s51, s77, s64
    s_lshl_b32 s51, s51, 1
    buffer_load_dwordx2 v[102:103], v6, s[32:35], s51 offen sc0 sc1
    s_add_u32 s51, s51, 36864
    buffer_load_dwordx2 v[104:105], v6, s[32:35], s51 offen sc0 sc1
    buffer_load_dwordx2 v[106:107], v7, s[16:19], s50 offen sc0 sc1
    s_add_u32 s50, s50, 2359296
    buffer_load_dwordx2 v[22:23], v7, s[16:19], s50 offen sc0 sc1
    s_lshl_b32 s50, s78, 7
    s_add_u32 s50, s50, s65
    s_add_u32 s51, s78, s64
    s_lshl_b32 s51, s51, 1
    buffer_load_dwordx2 v[26:27], v6, s[32:35], s51 offen sc0 sc1
    s_add_u32 s51, s51, 36864
    buffer_load_dwordx2 v[28:29], v6, s[32:35], s51 offen sc0 sc1
    buffer_load_dwordx2 v[30:31], v7, s[16:19], s50 offen sc0 sc1
    s_add_u32 s50, s50, 2359296
    buffer_load_dwordx2 v[24:25], v7, s[16:19], s50 offen sc0 sc1
    s_waitcnt vmcnt(0)
    v_fma_mix_f32 v32, v96, 1.0, v98 op_sel:[0,0,0] op_sel_hi:[1,0,1]
    v_fma_mix_f32 v33, v96, 1.0, v98 op_sel:[1,0,1] op_sel_hi:[1,0,1]
    v_fma_mix_f32 v34, v97, 1.0, v99 op_sel:[0,0,0] op_sel_hi:[1,0,1]
    v_fma_mix_f32 v35, v97, 1.0, v99 op_sel:[1,0,1] op_sel_hi:[1,0,1]
    v_fma_mix_f32 v36, v102, 1.0, v104 op_sel:[0,0,0] op_sel_hi:[1,0,1]
    v_fma_mix_f32 v37, v102, 1.0, v104 op_sel:[1,0,1] op_sel_hi:[1,0,1]
    v_fma_mix_f32 v38, v103, 1.0, v105 op_sel:[0,0,0] op_sel_hi:[1,0,1]
    v_fma_mix_f32 v39, v103, 1.0, v105 op_sel:[1,0,1] op_sel_hi:[1,0,1]
    v_fma_mix_f32 v40, v26, 1.0, v28 op_sel:[0,0,0] op_sel_hi:[1,0,1]
    v_fma_mix_f32 v41, v26, 1.0, v28 op_sel:[1,0,1] op_sel_hi:[1,0,1]
    v_fma_mix_f32 v42, v27, 1.0, v29 op_sel:[0,0,0] op_sel_hi:[1,0,1]
    v_fma_mix_f32 v43, v27, 1.0, v29 op_sel:[1,0,1] op_sel_hi:[1,0,1]
    v_fma_mix_f32 v32, v100, 1.0, v32 op_sel:[0,0,0] op_sel_hi:[1,0,0]
    v_fma_mix_f32 v33, v100, 1.0, v33 op_sel:[1,0,0] op_sel_hi:[1,0,0]
    v_fma_mix_f32 v34, v101, 1.0, v34 op_sel:[0,0,0] op_sel_hi:[1,0,0]
    v_fma_mix_f32 v35, v101, 1.0, v35 op_sel:[1,0,0] op_sel_hi:[1,0,0]
    v_fma_mix_f32 v36, v106, 1.0, v36 op_sel:[0,0,0] op_sel_hi:[1,0,0]
    v_fma_mix_f32 v37, v106, 1.0, v37 op_sel:[1,0,0] op_sel_hi:[1,0,0]
    v_fma_mix_f32 v38, v107, 1.0, v38 op_sel:[0,0,0] op_sel_hi:[1,0,0]
    v_fma_mix_f32 v39, v107, 1.0, v39 op_sel:[1,0,0] op_sel_hi:[1,0,0]
    v_fma_mix_f32 v40, v30, 1.0, v40 op_sel:[0,0,0] op_sel_hi:[1,0,0]
    v_fma_mix_f32 v41, v30, 1.0, v41 op_sel:[1,0,0] op_sel_hi:[1,0,0]
    v_fma_mix_f32 v42, v31, 1.0, v42 op_sel:[0,0,0] op_sel_hi:[1,0,0]
    v_fma_mix_f32 v43, v31, 1.0, v43 op_sel:[1,0,0] op_sel_hi:[1,0,0]
    v_fma_mix_f32 v44, v20, 1.0, v76 op_sel:[0,0,0] op_sel_hi:[1,0,0]
    v_fma_mix_f32 v45, v20, 1.0, v77 op_sel:[1,0,0] op_sel_hi:[1,0,0]
    v_fma_mix_f32 v46, v21, 1.0, v78 op_sel:[0,0,0] op_sel_hi:[1,0,0]
    v_fma_mix_f32 v47, v21, 1.0, v79 op_sel:[1,0,0] op_sel_hi:[1,0,0]
    v_fma_mix_f32 v48, v22, 1.0, v80 op_sel:[0,0,0] op_sel_hi:[1,0,0]
    v_fma_mix_f32 v49, v22, 1.0, v81 op_sel:[1,0,0] op_sel_hi:[1,0,0]
    v_fma_mix_f32 v50, v23, 1.0, v82 op_sel:[0,0,0] op_sel_hi:[1,0,0]
    v_fma_mix_f32 v51, v23, 1.0, v83 op_sel:[1,0,0] op_sel_hi:[1,0,0]
    v_fma_mix_f32 v52, v24, 1.0, v84 op_sel:[0,0,0] op_sel_hi:[1,0,0]
    v_fma_mix_f32 v53, v24, 1.0, v85 op_sel:[1,0,0] op_sel_hi:[1,0,0]
    v_fma_mix_f32 v54, v25, 1.0, v86 op_sel:[0,0,0] op_sel_hi:[1,0,0]
    v_fma_mix_f32 v55, v25, 1.0, v87 op_sel:[1,0,0] op_sel_hi:[1,0,0]
    v_cvt_pk_bf16_f32 v33, v32, v33
    v_cvt_pk_bf16_f32 v35, v34, v35
    v_lshlrev_b32 v32, 16, v33
    v_lshlrev_b32 v34, 16, v35
    v_and_b32 v33, s99, v33
    v_and_b32 v35, s99, v35
    v_cvt_pk_bf16_f32 v37, v36, v37
    v_cvt_pk_bf16_f32 v39, v38, v39
    v_lshlrev_b32 v36, 16, v37
    v_lshlrev_b32 v38, 16, v39
    v_and_b32 v37, s99, v37
    v_and_b32 v39, s99, v39
    v_cvt_pk_bf16_f32 v41, v40, v41
    v_cvt_pk_bf16_f32 v43, v42, v43
    v_lshlrev_b32 v40, 16, v41
    v_lshlrev_b32 v42, 16, v43
    v_and_b32 v41, s99, v41
    v_and_b32 v43, s99, v43
    v_mul_f32 v96, s98, v32
    v_mul_f32 v97, s98, v33
    v_mul_f32 v98, s98, v34
    v_mul_f32 v99, s98, v35
    v_mul_f32 v100, s98, v36
    v_mul_f32 v101, s98, v37
    v_mul_f32 v102, s98, v38
    v_mul_f32 v103, s98, v39
    v_mul_f32 v104, s98, v40
    v_mul_f32 v105, s98, v41
    v_mul_f32 v106, s98, v42
    v_mul_f32 v107, s98, v43
    v_exp_f32 v96, -v96
    v_exp_f32 v97, -v97
    v_exp_f32 v98, -v98
    v_exp_f32 v99, -v99
    v_exp_f32 v100, -v100
    v_exp_f32 v101, -v101
    v_exp_f32 v102, -v102
    v_exp_f32 v103, -v103
    v_exp_f32 v104, -v104
    v_exp_f32 v105, -v105
    v_exp_f32 v106, -v106
    v_exp_f32 v107, -v107
    v_add_f32 v96, 1.0, v96
    v_add_f32 v97, 1.0, v97
    v_add_f32 v98, 1.0, v98
    v_add_f32 v99, 1.0, v99
    v_add_f32 v100, 1.0, v100
    v_add_f32 v101, 1.0, v101
    v_add_f32 v102, 1.0, v102
    v_add_f32 v103, 1.0, v103
    v_add_f32 v104, 1.0, v104
    v_add_f32 v105, 1.0, v105
    v_add_f32 v106, 1.0, v106
    v_add_f32 v107, 1.0, v107
    v_rcp_f32 v96, v96
    v_rcp_f32 v97, v97
    v_rcp_f32 v98, v98
    v_rcp_f32 v99, v99
    v_rcp_f32 v100, v100
    v_rcp_f32 v101, v101
    v_rcp_f32 v102, v102
    v_rcp_f32 v103, v103
    v_rcp_f32 v104, v104
    v_rcp_f32 v105, v105
    v_rcp_f32 v106, v106
    v_rcp_f32 v107, v107
    v_mul_f32 v32, v32, v96
    v_mul_f32 v33, v33, v97
    v_mul_f32 v34, v34, v98
    v_mul_f32 v35, v35, v99
    v_mul_f32 v36, v36, v100
    v_mul_f32 v37, v37, v101
    v_mul_f32 v38, v38, v102
    v_mul_f32 v39, v39, v103
    v_mul_f32 v40, v40, v104
    v_mul_f32 v41, v41, v105
    v_mul_f32 v42, v42, v106
    v_mul_f32 v43, v43, v107
    v_cvt_pk_bf16_f32 v33, v32, v33
    v_cvt_pk_bf16_f32 v35, v34, v35
    v_lshlrev_b32 v32, 16, v33
    v_lshlrev_b32 v34, 16, v35
    v_and_b32 v33, s99, v33
    v_and_b32 v35, s99, v35
    v_cvt_pk_bf16_f32 v37, v36, v37
    v_cvt_pk_bf16_f32 v39, v38, v39
    v_lshlrev_b32 v36, 16, v37
    v_lshlrev_b32 v38, 16, v39
    v_and_b32 v37, s99, v37
    v_and_b32 v39, s99, v39
    v_cvt_pk_bf16_f32 v41, v40, v41
    v_cvt_pk_bf16_f32 v43, v42, v43
    v_lshlrev_b32 v40, 16, v41
    v_lshlrev_b32 v42, 16, v43
    v_and_b32 v41, s99, v41
    v_and_b32 v43, s99, v43
    v_fmac_f32 v64, v44, v32
    v_fmac_f32 v65, v45, v33
    v_fmac_f32 v66, v46, v34
    v_fmac_f32 v67, v47, v35
    v_fmac_f32 v68, v48, v36
    v_fmac_f32 v69, v49, v37
    v_fmac_f32 v70, v50, v38
    v_fmac_f32 v71, v51, v39
    v_fmac_f32 v72, v52, v40
    v_fmac_f32 v73, v53, v41
    v_fmac_f32 v74, v54, v42
    v_fmac_f32 v75, v55, v43
    s_and_b32 s49, s48, 3
    s_cmp_eq_u32 s49, 3
    s_cselect_b64 exec, -1, 0
    s_add_u32 s50, s76, s64
    s_lshl_b32 s50, s50, 1
    s_add_u32 s51, s50, 4608
    buffer_store_dword v64, v5, s[32:35], s50 offen offset:0
    buffer_store_dword v65, v5, s[32:35], s50 offen offset:2304
    buffer_store_dword v66, v5, s[32:35], s51 offen offset:0
    buffer_store_dword v67, v5, s[32:35], s51 offen offset:2304
    s_mov_b64 exec, -1
    s_add_u32 s50, s77, s64
    s_lshl_b32 s50, s50, 1
    s_add_u32 s51, s50, 4608
    buffer_store_dword v68, v5, s[32:35], s50 offen offset:0
    buffer_store_dword v69, v5, s[32:35], s50 offen offset:2304
    buffer_store_dword v70, v5, s[32:35], s51 offen offset:0
    buffer_store_dword v71, v5, s[32:35], s51 offen offset:2304
    s_add_u32 s50, s78, s64
    s_lshl_b32 s50, s50, 1
    s_add_u32 s51, s50, 4608
    buffer_store_dword v72, v5, s[32:35], s50 offen offset:0
    buffer_store_dword v73, v5, s[32:35], s50 offen offset:2304
    buffer_store_dword v74, v5, s[32:35], s51 offen offset:0
    buffer_store_dword v75, v5, s[32:35], s51 offen offset:2304
    s_endpgm
.Lexit:
    s_endpgm
.Lssm:
    v_lshrrev_b32 v104, 3, v0
    v_and_b32 v105, 7, v0
    v_mul_u32_u24 v106, 1152, v104
    v_lshl_add_u32 v106, v105, 4, v106
    s_mul_i32 s49, s47, 147456
    s_mul_i32 s50, s44, 9216
    s_add_u32 s49, s49, s50
    s_add_u32 s50, s49, 73728

    s_load_dwordx2 s[4:5], s[0:1], 0
    s_load_dwordx2 s[16:17], s[0:1], 120
    s_load_dwordx2 s[8:9], s[0:1], 24
    s_load_dwordx2 s[12:13], s[0:1], 32
    s_load_dwordx2 s[20:21], s[0:1], 40
    s_load_dwordx2 s[24:25], s[0:1], 48
    s_load_dwordx2 s[32:33], s[0:1], 8
    s_load_dwordx2 s[36:37], s[0:1], 16
    s_load_dwordx2 s[40:41], s[0:1], 56
    s_load_dwordx2 s[28:29], s[0:1], 112
    s_load_dwordx2 s[80:81], s[0:1], 104
    s_sub_u32 s57, s48, 12
    s_waitcnt lgkmcnt(0)
    s_bitcmp1_b32 s44, 0
    s_cselect_b32 s8, s12, s8
    s_cselect_b32 s9, s13, s9
    s_mov_b64 s[12:13], s[80:81]

    s_mov_b32 s14, 4718592
    s_mov_b32 s15, 0x00020000
    s_mov_b32 s10, 663552
    s_mov_b32 s11, 0x00020000
    s_mov_b32 s22, 663552
    s_mov_b32 s23, 0x00020000
    s_mov_b32 s26, 663552
    s_mov_b32 s27, 0x00020000
    s_mov_b32 s34, 1152
    s_mov_b32 s35, 0x00020000
    s_mov_b32 s38, 1152
    s_mov_b32 s39, 0x00020000
    s_mov_b32 s42, 1152
    s_mov_b32 s43, 0x00020000
    s_mov_b32 s30, 256
    s_mov_b32 s31, 0x00020000
    buffer_load_dwordx4 v[16:19], v106, s[4:7], s49 offen offset:0
    buffer_load_dwordx4 v[20:23], v106, s[4:7], s49 offen offset:128
    buffer_load_dwordx4 v[24:27], v106, s[4:7], s49 offen offset:256
    buffer_load_dwordx4 v[28:31], v106, s[4:7], s49 offen offset:384
    buffer_load_dwordx4 v[32:35], v106, s[4:7], s49 offen offset:512
    buffer_load_dwordx4 v[36:39], v106, s[4:7], s49 offen offset:640
    buffer_load_dwordx4 v[40:43], v106, s[4:7], s49 offen offset:768
    buffer_load_dwordx4 v[44:47], v106, s[4:7], s49 offen offset:896
    buffer_load_dwordx4 v[48:51], v106, s[4:7], s49 offen offset:1024
    buffer_load_dwordx4 v[52:55], v106, s[4:7], s50 offen offset:0
    buffer_load_dwordx4 v[56:59], v106, s[4:7], s50 offen offset:128
    buffer_load_dwordx4 v[60:63], v106, s[4:7], s50 offen offset:256
    buffer_load_dwordx4 v[64:67], v106, s[4:7], s50 offen offset:384
    buffer_load_dwordx4 v[68:71], v106, s[4:7], s50 offen offset:512
    buffer_load_dwordx4 v[72:75], v106, s[4:7], s50 offen offset:640
    buffer_load_dwordx4 v[76:79], v106, s[4:7], s50 offen offset:768
    buffer_load_dwordx4 v[80:83], v106, s[4:7], s50 offen offset:896
    buffer_load_dwordx4 v[84:87], v106, s[4:7], s50 offen offset:1024
    v_lshrrev_b32 v108, 3, v0
    v_mul_u32_u24 v109, 1152, v108
    v_lshrrev_b32 v108, 4, v0
    v_xor_b32 v108, v108, v0
    v_and_b32 v108, 7, v108
    v_lshl_add_u32 v1, v108, 4, v109
    v_xor_b32 v110, 64, v1
    v_add_u32 v2, 9216, v110
    v_lshrrev_b32 v108, 1, v0
    v_mul_u32_u24 v109, 1152, v108
    v_xor_b32 v108, s44, v0
    v_and_b32 v108, 1, v108
    v_lshl_add_u32 v15, v108, 4, v109
    s_lshl_b32 s52, s44, 11
    s_lshl_b32 s53, s44, 8
    s_add_u32 s53, s53, 16384

    s_mul_i32 s54, s57, 147456
    s_mul_i32 s49, s46, 73728
    s_add_u32 s54, s54, s49
    s_bfe_u32 s49, s44, 0x10001
    s_mul_i32 s50, s49, 17408
    s_add_u32 s55, s54, s50
    s_lshl_b32 s49, s49, 7
    s_add_u32 s54, s54, s49
    s_lshl_b32 s50, s57, 8
    s_add_u32 s59, s49, s50
    s_mul_i32 s49, s46, 36864
    s_add_u32 s59, s59, s49
    s_and_b32 s49, s44, 1
    s_mul_i32 s49, s49, 18432
    s_add_u32 s59, s59, s49
    s_mul_i32 s58, s57, 18432
    s_add_u32 s58, s58, 589824
    s_lshr_b32 s49, s44, 1
    s_lshl_b32 s49, s49, 7
    s_add_u32 s58, s58, s49
    s_mul_i32 s60, s44, 9216
    s_lshl_b32 s49, s57, 5
    s_add_u32 s60, s60, s49
    s_add_u32 s60, s60, 1024

    s_cmp_ge_u32 s83, 9
    s_cselect_b32 s49, 9, 0
    s_sub_u32 s49, s83, s49

    s_lshl_b32 s70, s49, 7
    s_mul_i32 s84, s49, 73728
    s_add_u32 s49, s49, 1
    s_cmp_ge_u32 s49, 9
    s_cselect_b32 s49, 0, s49
    s_lshl_b32 s71, s49, 7
    s_mul_i32 s85, s49, 73728
    s_add_u32 s49, s49, 1
    s_cmp_ge_u32 s49, 9
    s_cselect_b32 s49, 0, s49
    s_lshl_b32 s72, s49, 7
    s_mul_i32 s86, s49, 73728
    s_add_u32 s49, s49, 1
    s_cmp_ge_u32 s49, 9
    s_cselect_b32 s49, 0, s49
    s_lshl_b32 s73, s49, 7
    s_mul_i32 s87, s49, 73728
    s_add_u32 s49, s49, 1
    s_cmp_ge_u32 s49, 9
    s_cselect_b32 s49, 0, s49
    s_lshl_b32 s74, s49, 7
    s_mul_i32 s88, s49, 73728
    s_add_u32 s49, s49, 1
    s_cmp_ge_u32 s49, 9
    s_cselect_b32 s49, 0, s49
    s_lshl_b32 s75, s49, 7
    s_mul_i32 s89, s49, 73728
    s_add_u32 s49, s49, 1
    s_cmp_ge_u32 s49, 9
    s_cselect_b32 s49, 0, s49
    s_lshl_b32 s76, s49, 7
    s_mul_i32 s90, s49, 73728
    s_add_u32 s49, s49, 1
    s_cmp_ge_u32 s49, 9
    s_cselect_b32 s49, 0, s49
    s_lshl_b32 s77, s49, 7
    s_mul_i32 s91, s49, 73728
    s_add_u32 s49, s49, 1
    s_cmp_ge_u32 s49, 9
    s_cselect_b32 s49, 0, s49
    s_lshl_b32 s78, s49, 7
    s_mul_i32 s92, s49, 73728
    s_add_u32 s49, s49, 1
    s_cmp_ge_u32 s49, 9
    s_cselect_b32 s49, 0, s49
    s_lshr_b32 s56, s48, 2
    s_mul_i32 s56, s56, 2359296
    s_mul_i32 s49, s47, 147456
    s_add_u32 s56, s56, s49
    s_lshl_b32 s49, s44, 11
    s_add_u32 s56, s56, s49
    v_lshlrev_b32 v12, 4, v0

    s_add_u32 m0, s52, 0
    s_add_u32 s49, s54, 0
    buffer_load_dwordx4 v1, s[8:11], s49 offen lds
    s_add_u32 m0, s52, 1024
    s_add_u32 s49, s54, 0
    buffer_load_dwordx4 v2, s[8:11], s49 offen lds
    s_add_u32 m0, s52, 18432
    s_add_u32 s49, s54, 256
    buffer_load_dwordx4 v1, s[8:11], s49 offen lds
    s_add_u32 m0, s52, 19456
    s_add_u32 s49, s54, 256
    buffer_load_dwordx4 v2, s[8:11], s49 offen lds
    s_add_u32 m0, s52, 36864
    s_add_u32 s49, s54, 512
    buffer_load_dwordx4 v1, s[8:11], s49 offen lds
    s_add_u32 m0, s52, 37888
    s_add_u32 s49, s54, 512
    buffer_load_dwordx4 v2, s[8:11], s49 offen lds
    s_lshl_b32 s49, s44, 6
    v_add_u32 v100, s49, v0
    v_min_u32 v100, 143, v100
    s_lshl_b32 s49, s57, 7
    s_lshl_b32 s50, s57, 4
    s_add_u32 s50, s50, 384
    v_add_u32 v101, s49, v100
    v_add_u32 v102, s50, v100
    v_cmp_gt_u32 vcc, 128, v100
    v_lshlrev_b32 v100, 5, v100
    v_add_u32 v100, 147456, v100
    v_cndmask_b32 v101, v102, v101, vcc
    v_lshlrev_b32 v101, 1, v101

    buffer_load_ushort v88, v101, s[32:35], 0 offen
    buffer_load_ushort v89, v101, s[36:39], 0 offen
    buffer_load_ushort v90, v101, s[40:43], 0 offen
    v_bfe_u32 v108, v0, 3, 1
    v_lshlrev_b32 v108, 10, v108
    v_and_b32 v109, 7, v0
    v_lshl_add_u32 v108, v109, 7, v108
    v_bfe_u32 v109, v0, 1, 3
    v_lshrrev_b32 v110, 4, v0
    v_xor_b32 v109, v109, v110
    v_lshl_add_u32 v108, v109, 4, v108
    s_lshl_b32 s49, s46, 13
    v_add_u32 v3, s49, v108
    v_add_u32 v4, 0x10000, v3
    v_xor_b32 v6, 64, v3
    v_xor_b32 v7, 64, v4

    v_mul_u32_u24 v108, 1152, v110
    v_and_b32 v109, 15, v0
    v_lshl_add_u32 v108, v109, 3, v108
    s_mul_i32 s49, s45, 4608
    s_lshl_b32 s50, s46, 9
    s_add_u32 s49, s49, s50
    s_add_u32 s49, s49, 129024
    v_add_u32 v13, s49, v108
    s_lshl_b32 s50, s46, 11
    s_add_u32 s50, s50, 147456
    v_lshlrev_b32 v109, 5, v109
    v_add_u32 v14, s50, v109

    s_waitcnt vmcnt(0)
    v_mov_b32 v96, 0
    s_and_b32 s49, s48, 3
    s_cmp_eq_u32 s49, 0
    s_cselect_b32 s100, 3, 2
    s_lshl_b32 s42, s47, 9
    s_lshl_b32 s50, s44, 4
    s_add_u32 s42, s42, s50
    s_and_b32 s50, s48, 12
    s_add_u32 s42, s42, s50
    s_add_u32 s42, s42, 37748736
    s_add_u32 s50, s49, 3
    s_and_b32 s50, s50, 3
    s_lshl_b32 s50, s50, 7
    s_add_u32 s43, s42, s50
    s_lshl_b32 s49, s49, 7
    s_add_u32 s42, s42, s49
    s_getreg_b32 s93, hwreg(HW_REG_XCC_ID, 0, 4)
    s_or_b32 s93, s93, 0x80
    s_mov_b64 exec, 1

    buffer_store_dword v96, off, s[16:19], s42 sc0 sc1
    s_mov_b64 exec, -1
    s_mov_b32 s98, 0x3fb8aa3b
    s_mov_b32 s99, 0xffff0000
    v_lshlrev_b32 v88, 16, v88
    v_lshlrev_b32 v89, 16, v89
    v_lshlrev_b32 v90, 16, v90
    v_mul_f32 v90, 0x3fb8aa3b, v90
    v_exp_f32 v90, v90
    s_nop 0
    v_cvt_pk_bf16_f32 v90, v90, v90
    v_lshlrev_b32 v90, 16, v90
    v_mul_f32 v110, v90, v88
    v_mul_f32 v111, v90, v89

    v_mul_f32 v106, 0x3fb8aa3b, v110
    v_mul_f32 v107, 0x3e22f983, v111
    v_exp_f32 v106, v106
    v_cos_f32 v108, v107
    v_sin_f32 v109, v107
    s_nop 0
    v_mul_f32 v92, v106, v108
    v_mul_f32 v93, v106, v109

    v_mul_f32 v106, 0x4138aa3b, v110
    v_mul_f32 v107, 0x3fa2f983, v111
    v_exp_f32 v106, v106
    v_cos_f32 v108, v107
    v_sin_f32 v109, v107
    s_nop 0
    v_mul_f32 v96, v106, v108
    v_mul_f32 v97, v106, v109

    v_add_f32 v106, -1.0, v92
    v_mul_f32 v107, v88, v88
    v_fma_f32 v107, v89, v89, v107
    v_rcp_f32 v107, v107
    v_mul_f32 v108, v106, v88
    v_fma_f32 v108, v93, v89, v108
    v_mul_f32 v109, v93, v88
    v_fma_f32 v109, -v106, v89, v109
    v_add_f32 v107, v107, v107
    v_mul_f32 v94, v108, v107
    v_mul_f32 v95, v109, v107

    ds_write_b128 v100, v[92:95]
    ds_write_b64 v100, v[96:97] offset:16
    s_mul_i32 s49, s44, 9344
    s_add_u32 s49, s49, 65536
    v_mul_u32_u24 v106, 1168, v104
    v_lshl_add_u32 v106, v105, 4, v106
    v_add_u32 v106, s49, v106
    s_and_b32 s49, s45, 1
    s_mul_i32 s49, s49, 37376
    s_add_u32 s49, s49, 65536

    v_bfe_u32 v107, v0, 2, 2
    v_lshlrev_b32 v107, 3, v107
    v_and_b32 v108, 3, v0
    v_add_u32 v107, v107, v108
    v_mul_u32_u24 v107, 1168, v107
    v_lshrrev_b32 v108, 4, v0
    v_lshl_add_u32 v107, v108, 4, v107
    v_add_u32 v107, s49, v107

    s_waitcnt lgkmcnt(0)
    v_mov_b32 v90, 0x3f803f80
    v_mov_b32 v88, 0
    v_mov_b32 v89, 0
    v_mov_b32 v91, 0
    v_mov_b32 v92, 0
    v_dot2_f32_bf16 v88, v16, v90, v88
    v_dot2_f32_bf16 v89, v16, v16, v89
    v_dot2_f32_bf16 v91, v17, v90, v91
    v_dot2_f32_bf16 v92, v17, v17, v92
    v_dot2_f32_bf16 v88, v18, v90, v88
    v_dot2_f32_bf16 v89, v18, v18, v89
    v_dot2_f32_bf16 v91, v19, v90, v91
    v_dot2_f32_bf16 v92, v19, v19, v92
    v_dot2_f32_bf16 v88, v20, v90, v88
    v_dot2_f32_bf16 v89, v20, v20, v89
    v_dot2_f32_bf16 v91, v21, v90, v91
    v_dot2_f32_bf16 v92, v21, v21, v92
    v_dot2_f32_bf16 v88, v22, v90, v88
    v_dot2_f32_bf16 v89, v22, v22, v89
    v_dot2_f32_bf16 v91, v23, v90, v91
    v_dot2_f32_bf16 v92, v23, v23, v92
    v_dot2_f32_bf16 v88, v24, v90, v88
    v_dot2_f32_bf16 v89, v24, v24, v89
    v_dot2_f32_bf16 v91, v25, v90, v91
    v_dot2_f32_bf16 v92, v25, v25, v92
    v_dot2_f32_bf16 v88, v26, v90, v88
    v_dot2_f32_bf16 v89, v26, v26, v89
    v_dot2_f32_bf16 v91, v27, v90, v91
    v_dot2_f32_bf16 v92, v27, v27, v92
    v_dot2_f32_bf16 v88, v28, v90, v88
    v_dot2_f32_bf16 v89, v28, v28, v89
    v_dot2_f32_bf16 v91, v29, v90, v91
    v_dot2_f32_bf16 v92, v29, v29, v92
    v_dot2_f32_bf16 v88, v30, v90, v88
    v_dot2_f32_bf16 v89, v30, v30, v89
    v_dot2_f32_bf16 v91, v31, v90, v91
    v_dot2_f32_bf16 v92, v31, v31, v92
    v_dot2_f32_bf16 v88, v32, v90, v88
    v_dot2_f32_bf16 v89, v32, v32, v89
    v_dot2_f32_bf16 v91, v33, v90, v91
    v_dot2_f32_bf16 v92, v33, v33, v92
    v_dot2_f32_bf16 v88, v34, v90, v88
    v_dot2_f32_bf16 v89, v34, v34, v89
    v_dot2_f32_bf16 v91, v35, v90, v91
    v_dot2_f32_bf16 v92, v35, v35, v92
    v_dot2_f32_bf16 v88, v36, v90, v88
    v_dot2_f32_bf16 v89, v36, v36, v89
    v_dot2_f32_bf16 v91, v37, v90, v91
    v_dot2_f32_bf16 v92, v37, v37, v92
    v_dot2_f32_bf16 v88, v38, v90, v88
    v_dot2_f32_bf16 v89, v38, v38, v89
    v_dot2_f32_bf16 v91, v39, v90, v91
    v_dot2_f32_bf16 v92, v39, v39, v92
    v_dot2_f32_bf16 v88, v40, v90, v88
    v_dot2_f32_bf16 v89, v40, v40, v89
    v_dot2_f32_bf16 v91, v41, v90, v91
    v_dot2_f32_bf16 v92, v41, v41, v92
    v_dot2_f32_bf16 v88, v42, v90, v88
    v_dot2_f32_bf16 v89, v42, v42, v89
    v_dot2_f32_bf16 v91, v43, v90, v91
    v_dot2_f32_bf16 v92, v43, v43, v92
    v_dot2_f32_bf16 v88, v44, v90, v88
    v_dot2_f32_bf16 v89, v44, v44, v89
    v_dot2_f32_bf16 v91, v45, v90, v91
    v_dot2_f32_bf16 v92, v45, v45, v92
    v_dot2_f32_bf16 v88, v46, v90, v88
    v_dot2_f32_bf16 v89, v46, v46, v89
    v_dot2_f32_bf16 v91, v47, v90, v91
    v_dot2_f32_bf16 v92, v47, v47, v92
    v_dot2_f32_bf16 v88, v48, v90, v88
    v_dot2_f32_bf16 v89, v48, v48, v89
    v_dot2_f32_bf16 v91, v49, v90, v91
    v_dot2_f32_bf16 v92, v49, v49, v92
    v_dot2_f32_bf16 v88, v50, v90, v88
    v_dot2_f32_bf16 v89, v50, v50, v89
    v_dot2_f32_bf16 v91, v51, v90, v91
    v_dot2_f32_bf16 v92, v51, v51, v92
    s_nop 3
    v_add_f32 v88, v88, v91
    v_add_f32 v89, v89, v92
    s_nop 1
    v_add_f32_dpp v88, v88, v88 quad_perm:[1,0,3,2] row_mask:0xf bank_mask:0xf
    v_add_f32_dpp v89, v89, v89 quad_perm:[1,0,3,2] row_mask:0xf bank_mask:0xf
    s_nop 1
    v_add_f32_dpp v88, v88, v88 quad_perm:[2,3,0,1] row_mask:0xf bank_mask:0xf
    v_add_f32_dpp v89, v89, v89 quad_perm:[2,3,0,1] row_mask:0xf bank_mask:0xf
    s_nop 1
    v_add_f32_dpp v88, v88, v88 row_half_mirror row_mask:0xf bank_mask:0xf
    v_add_f32_dpp v89, v89, v89 row_half_mirror row_mask:0xf bank_mask:0xf
    v_mul_f32 v88, 0x3ae38e39, v88
    v_mul_f32 v89, 0x3ae38e39, v89
    v_fma_f32 v89, -v88, v88, v89
    v_max_f32 v89, 0, v89
    v_cvt_pk_bf16_f32 v90, v88, v89
    v_lshlrev_b32 v88, 16, v90
    v_and_b32 v89, 0xffff0000, v90
    v_add_f32 v89, 0x3727c5ac, v89
    v_cvt_pk_bf16_f32 v90, v89, v89
    v_lshlrev_b32 v89, 16, v90
    v_sqrt_f32 v89, v89
    s_nop 0
    v_cvt_pk_bf16_f32 v90, v89, v89
    v_lshlrev_b32 v89, 16, v90
    v_rcp_f32 v92, v89
    s_nop 0
    v_mul_f32 v94, v88, v92
    v_sub_f32 v94, 0, v94

    s_lshl_b32 s49, s44, 6
    s_add_u32 s49, s49, 153600
    v_lshlrev_b32 v96, 3, v104
    v_add_u32 v96, s49, v96

    ds_write2_b32 v96, v92, v94 offset0:0 offset1:1
    v_lshlrev_b32 v96, 16, v16
    v_and_b32 v97, 0xffff0000, v16
    v_pk_fma_f32 v[96:97], v[96:97], v[92:93], v[94:95] op_sel_hi:[1,0,0]
    v_cvt_pk_bf16_f32 v16, v96, v97
    v_lshlrev_b32 v98, 16, v17
    v_and_b32 v99, 0xffff0000, v17
    v_pk_fma_f32 v[98:99], v[98:99], v[92:93], v[94:95] op_sel_hi:[1,0,0]
    v_cvt_pk_bf16_f32 v17, v98, v99
    v_lshlrev_b32 v100, 16, v18
    v_and_b32 v101, 0xffff0000, v18
    v_pk_fma_f32 v[100:101], v[100:101], v[92:93], v[94:95] op_sel_hi:[1,0,0]
    v_cvt_pk_bf16_f32 v18, v100, v101
    v_lshlrev_b32 v102, 16, v19
    v_and_b32 v103, 0xffff0000, v19
    v_pk_fma_f32 v[102:103], v[102:103], v[92:93], v[94:95] op_sel_hi:[1,0,0]
    v_cvt_pk_bf16_f32 v19, v102, v103
    v_lshlrev_b32 v96, 16, v20
    v_and_b32 v97, 0xffff0000, v20
    v_pk_fma_f32 v[96:97], v[96:97], v[92:93], v[94:95] op_sel_hi:[1,0,0]
    v_cvt_pk_bf16_f32 v20, v96, v97
    v_lshlrev_b32 v98, 16, v21
    v_and_b32 v99, 0xffff0000, v21
    v_pk_fma_f32 v[98:99], v[98:99], v[92:93], v[94:95] op_sel_hi:[1,0,0]
    v_cvt_pk_bf16_f32 v21, v98, v99
    v_lshlrev_b32 v100, 16, v22
    v_and_b32 v101, 0xffff0000, v22
    v_pk_fma_f32 v[100:101], v[100:101], v[92:93], v[94:95] op_sel_hi:[1,0,0]
    v_cvt_pk_bf16_f32 v22, v100, v101
    v_lshlrev_b32 v102, 16, v23
    v_and_b32 v103, 0xffff0000, v23
    v_pk_fma_f32 v[102:103], v[102:103], v[92:93], v[94:95] op_sel_hi:[1,0,0]
    v_cvt_pk_bf16_f32 v23, v102, v103
    v_lshlrev_b32 v96, 16, v24
    v_and_b32 v97, 0xffff0000, v24
    v_pk_fma_f32 v[96:97], v[96:97], v[92:93], v[94:95] op_sel_hi:[1,0,0]
    v_cvt_pk_bf16_f32 v24, v96, v97
    v_lshlrev_b32 v98, 16, v25
    v_and_b32 v99, 0xffff0000, v25
    v_pk_fma_f32 v[98:99], v[98:99], v[92:93], v[94:95] op_sel_hi:[1,0,0]
    v_cvt_pk_bf16_f32 v25, v98, v99
    v_lshlrev_b32 v100, 16, v26
    v_and_b32 v101, 0xffff0000, v26
    v_pk_fma_f32 v[100:101], v[100:101], v[92:93], v[94:95] op_sel_hi:[1,0,0]
    v_cvt_pk_bf16_f32 v26, v100, v101
    v_lshlrev_b32 v102, 16, v27
    v_and_b32 v103, 0xffff0000, v27
    v_pk_fma_f32 v[102:103], v[102:103], v[92:93], v[94:95] op_sel_hi:[1,0,0]
    v_cvt_pk_bf16_f32 v27, v102, v103
    v_lshlrev_b32 v96, 16, v28
    v_and_b32 v97, 0xffff0000, v28
    v_pk_fma_f32 v[96:97], v[96:97], v[92:93], v[94:95] op_sel_hi:[1,0,0]
    v_cvt_pk_bf16_f32 v28, v96, v97
    v_lshlrev_b32 v98, 16, v29
    v_and_b32 v99, 0xffff0000, v29
    v_pk_fma_f32 v[98:99], v[98:99], v[92:93], v[94:95] op_sel_hi:[1,0,0]
    v_cvt_pk_bf16_f32 v29, v98, v99
    v_lshlrev_b32 v100, 16, v30
    v_and_b32 v101, 0xffff0000, v30
    v_pk_fma_f32 v[100:101], v[100:101], v[92:93], v[94:95] op_sel_hi:[1,0,0]
    v_cvt_pk_bf16_f32 v30, v100, v101
    v_lshlrev_b32 v102, 16, v31
    v_and_b32 v103, 0xffff0000, v31
    v_pk_fma_f32 v[102:103], v[102:103], v[92:93], v[94:95] op_sel_hi:[1,0,0]
    v_cvt_pk_bf16_f32 v31, v102, v103
    v_lshlrev_b32 v96, 16, v32
    v_and_b32 v97, 0xffff0000, v32
    v_pk_fma_f32 v[96:97], v[96:97], v[92:93], v[94:95] op_sel_hi:[1,0,0]
    v_cvt_pk_bf16_f32 v32, v96, v97
    v_lshlrev_b32 v98, 16, v33
    v_and_b32 v99, 0xffff0000, v33
    v_pk_fma_f32 v[98:99], v[98:99], v[92:93], v[94:95] op_sel_hi:[1,0,0]
    v_cvt_pk_bf16_f32 v33, v98, v99
    v_lshlrev_b32 v100, 16, v34
    v_and_b32 v101, 0xffff0000, v34
    v_pk_fma_f32 v[100:101], v[100:101], v[92:93], v[94:95] op_sel_hi:[1,0,0]
    v_cvt_pk_bf16_f32 v34, v100, v101
    v_lshlrev_b32 v102, 16, v35
    v_and_b32 v103, 0xffff0000, v35
    v_pk_fma_f32 v[102:103], v[102:103], v[92:93], v[94:95] op_sel_hi:[1,0,0]
    v_cvt_pk_bf16_f32 v35, v102, v103
    v_lshlrev_b32 v96, 16, v36
    v_and_b32 v97, 0xffff0000, v36
    v_pk_fma_f32 v[96:97], v[96:97], v[92:93], v[94:95] op_sel_hi:[1,0,0]
    v_cvt_pk_bf16_f32 v36, v96, v97
    v_lshlrev_b32 v98, 16, v37
    v_and_b32 v99, 0xffff0000, v37
    v_pk_fma_f32 v[98:99], v[98:99], v[92:93], v[94:95] op_sel_hi:[1,0,0]
    v_cvt_pk_bf16_f32 v37, v98, v99
    v_lshlrev_b32 v100, 16, v38
    v_and_b32 v101, 0xffff0000, v38
    v_pk_fma_f32 v[100:101], v[100:101], v[92:93], v[94:95] op_sel_hi:[1,0,0]
    v_cvt_pk_bf16_f32 v38, v100, v101
    v_lshlrev_b32 v102, 16, v39
    v_and_b32 v103, 0xffff0000, v39
    v_pk_fma_f32 v[102:103], v[102:103], v[92:93], v[94:95] op_sel_hi:[1,0,0]
    v_cvt_pk_bf16_f32 v39, v102, v103
    v_lshlrev_b32 v96, 16, v40
    v_and_b32 v97, 0xffff0000, v40
    v_pk_fma_f32 v[96:97], v[96:97], v[92:93], v[94:95] op_sel_hi:[1,0,0]
    v_cvt_pk_bf16_f32 v40, v96, v97
    v_lshlrev_b32 v98, 16, v41
    v_and_b32 v99, 0xffff0000, v41
    v_pk_fma_f32 v[98:99], v[98:99], v[92:93], v[94:95] op_sel_hi:[1,0,0]
    v_cvt_pk_bf16_f32 v41, v98, v99
    v_lshlrev_b32 v100, 16, v42
    v_and_b32 v101, 0xffff0000, v42
    v_pk_fma_f32 v[100:101], v[100:101], v[92:93], v[94:95] op_sel_hi:[1,0,0]
    v_cvt_pk_bf16_f32 v42, v100, v101
    v_lshlrev_b32 v102, 16, v43
    v_and_b32 v103, 0xffff0000, v43
    v_pk_fma_f32 v[102:103], v[102:103], v[92:93], v[94:95] op_sel_hi:[1,0,0]
    v_cvt_pk_bf16_f32 v43, v102, v103
    v_lshlrev_b32 v96, 16, v44
    v_and_b32 v97, 0xffff0000, v44
    v_pk_fma_f32 v[96:97], v[96:97], v[92:93], v[94:95] op_sel_hi:[1,0,0]
    v_cvt_pk_bf16_f32 v44, v96, v97
    v_lshlrev_b32 v98, 16, v45
    v_and_b32 v99, 0xffff0000, v45
    v_pk_fma_f32 v[98:99], v[98:99], v[92:93], v[94:95] op_sel_hi:[1,0,0]
    v_cvt_pk_bf16_f32 v45, v98, v99
    v_lshlrev_b32 v100, 16, v46
    v_and_b32 v101, 0xffff0000, v46
    v_pk_fma_f32 v[100:101], v[100:101], v[92:93], v[94:95] op_sel_hi:[1,0,0]
    v_cvt_pk_bf16_f32 v46, v100, v101
    v_lshlrev_b32 v102, 16, v47
    v_and_b32 v103, 0xffff0000, v47
    v_pk_fma_f32 v[102:103], v[102:103], v[92:93], v[94:95] op_sel_hi:[1,0,0]
    v_cvt_pk_bf16_f32 v47, v102, v103
    v_lshlrev_b32 v96, 16, v48
    v_and_b32 v97, 0xffff0000, v48
    v_pk_fma_f32 v[96:97], v[96:97], v[92:93], v[94:95] op_sel_hi:[1,0,0]
    v_cvt_pk_bf16_f32 v48, v96, v97
    v_lshlrev_b32 v98, 16, v49
    v_and_b32 v99, 0xffff0000, v49
    v_pk_fma_f32 v[98:99], v[98:99], v[92:93], v[94:95] op_sel_hi:[1,0,0]
    v_cvt_pk_bf16_f32 v49, v98, v99
    v_lshlrev_b32 v100, 16, v50
    v_and_b32 v101, 0xffff0000, v50
    v_pk_fma_f32 v[100:101], v[100:101], v[92:93], v[94:95] op_sel_hi:[1,0,0]
    v_cvt_pk_bf16_f32 v50, v100, v101
    v_lshlrev_b32 v102, 16, v51
    v_and_b32 v103, 0xffff0000, v51
    v_pk_fma_f32 v[102:103], v[102:103], v[92:93], v[94:95] op_sel_hi:[1,0,0]
    v_cvt_pk_bf16_f32 v51, v102, v103
    ds_write_b128 v106, v[16:19] offset:0
    ds_write_b128 v106, v[20:23] offset:128
    ds_write_b128 v106, v[24:27] offset:256
    ds_write_b128 v106, v[28:31] offset:384
    ds_write_b128 v106, v[32:35] offset:512
    ds_write_b128 v106, v[36:39] offset:640
    ds_write_b128 v106, v[40:43] offset:768
    ds_write_b128 v106, v[44:47] offset:896
    ds_write_b128 v106, v[48:51] offset:1024
    s_waitcnt lgkmcnt(0)
    s_barrier
    s_lshr_b32 s49, s45, 1
    s_cmp_lg_u32 s49, 0
    s_cbranch_scc1 .xr_49
    ds_read_b128 a[0:3], v107 offset:0
    ds_read_b128 a[4:7], v107 offset:4672
    ds_read_b128 a[8:11], v107 offset:64
    ds_read_b128 a[12:15], v107 offset:4736
    ds_read_b128 a[16:19], v107 offset:128
    ds_read_b128 a[20:23], v107 offset:4800
    ds_read_b128 a[24:27], v107 offset:192
    ds_read_b128 a[28:31], v107 offset:4864
    ds_read_b128 a[32:35], v107 offset:256
    ds_read_b128 a[36:39], v107 offset:4928
    ds_read_b128 a[40:43], v107 offset:320
    ds_read_b128 a[44:47], v107 offset:4992
    ds_read_b128 a[48:51], v107 offset:384
    ds_read_b128 a[52:55], v107 offset:5056
    ds_read_b128 a[56:59], v107 offset:448
    ds_read_b128 a[60:63], v107 offset:5120
    ds_read_b128 a[64:67], v107 offset:512
    ds_read_b128 a[68:71], v107 offset:5184
    ds_read_b128 a[72:75], v107 offset:576
    ds_read_b128 a[76:79], v107 offset:5248
    ds_read_b128 a[80:83], v107 offset:640
    ds_read_b128 a[84:87], v107 offset:5312
    ds_read_b128 a[88:91], v107 offset:704
    ds_read_b128 a[92:95], v107 offset:5376
    ds_read_b128 a[96:99], v107 offset:768
    ds_read_b128 a[100:103], v107 offset:5440
    ds_read_b128 a[104:107], v107 offset:832
    ds_read_b128 a[108:111], v107 offset:5504
    ds_read_b128 a[112:115], v107 offset:896
    ds_read_b128 a[116:119], v107 offset:5568
    ds_read_b128 a[120:123], v107 offset:960
    ds_read_b128 a[124:127], v107 offset:5632
    ds_read_b128 a[128:131], v107 offset:1024
    ds_read_b128 a[132:135], v107 offset:5696
    ds_read_b128 a[136:139], v107 offset:1088
    ds_read_b128 a[140:143], v107 offset:5760
.xr_49:
    v_mov_b32 v90, 0x3f803f80
    v_mov_b32 v88, 0
    v_mov_b32 v89, 0
    v_mov_b32 v91, 0
    v_mov_b32 v92, 0
    v_dot2_f32_bf16 v88, v52, v90, v88
    v_dot2_f32_bf16 v89, v52, v52, v89
    v_dot2_f32_bf16 v91, v53, v90, v91
    v_dot2_f32_bf16 v92, v53, v53, v92
    v_dot2_f32_bf16 v88, v54, v90, v88
    v_dot2_f32_bf16 v89, v54, v54, v89
    v_dot2_f32_bf16 v91, v55, v90, v91
    v_dot2_f32_bf16 v92, v55, v55, v92
    v_dot2_f32_bf16 v88, v56, v90, v88
    v_dot2_f32_bf16 v89, v56, v56, v89
    v_dot2_f32_bf16 v91, v57, v90, v91
    v_dot2_f32_bf16 v92, v57, v57, v92
    v_dot2_f32_bf16 v88, v58, v90, v88
    v_dot2_f32_bf16 v89, v58, v58, v89
    v_dot2_f32_bf16 v91, v59, v90, v91
    v_dot2_f32_bf16 v92, v59, v59, v92
    v_dot2_f32_bf16 v88, v60, v90, v88
    v_dot2_f32_bf16 v89, v60, v60, v89
    v_dot2_f32_bf16 v91, v61, v90, v91
    v_dot2_f32_bf16 v92, v61, v61, v92
    v_dot2_f32_bf16 v88, v62, v90, v88
    v_dot2_f32_bf16 v89, v62, v62, v89
    v_dot2_f32_bf16 v91, v63, v90, v91
    v_dot2_f32_bf16 v92, v63, v63, v92
    v_dot2_f32_bf16 v88, v64, v90, v88
    v_dot2_f32_bf16 v89, v64, v64, v89
    v_dot2_f32_bf16 v91, v65, v90, v91
    v_dot2_f32_bf16 v92, v65, v65, v92
    v_dot2_f32_bf16 v88, v66, v90, v88
    v_dot2_f32_bf16 v89, v66, v66, v89
    v_dot2_f32_bf16 v91, v67, v90, v91
    v_dot2_f32_bf16 v92, v67, v67, v92
    v_dot2_f32_bf16 v88, v68, v90, v88
    v_dot2_f32_bf16 v89, v68, v68, v89
    v_dot2_f32_bf16 v91, v69, v90, v91
    v_dot2_f32_bf16 v92, v69, v69, v92
    v_dot2_f32_bf16 v88, v70, v90, v88
    v_dot2_f32_bf16 v89, v70, v70, v89
    v_dot2_f32_bf16 v91, v71, v90, v91
    v_dot2_f32_bf16 v92, v71, v71, v92
    v_dot2_f32_bf16 v88, v72, v90, v88
    v_dot2_f32_bf16 v89, v72, v72, v89
    v_dot2_f32_bf16 v91, v73, v90, v91
    v_dot2_f32_bf16 v92, v73, v73, v92
    v_dot2_f32_bf16 v88, v74, v90, v88
    v_dot2_f32_bf16 v89, v74, v74, v89
    v_dot2_f32_bf16 v91, v75, v90, v91
    v_dot2_f32_bf16 v92, v75, v75, v92
    v_dot2_f32_bf16 v88, v76, v90, v88
    v_dot2_f32_bf16 v89, v76, v76, v89
    v_dot2_f32_bf16 v91, v77, v90, v91
    v_dot2_f32_bf16 v92, v77, v77, v92
    v_dot2_f32_bf16 v88, v78, v90, v88
    v_dot2_f32_bf16 v89, v78, v78, v89
    v_dot2_f32_bf16 v91, v79, v90, v91
    v_dot2_f32_bf16 v92, v79, v79, v92
    v_dot2_f32_bf16 v88, v80, v90, v88
    v_dot2_f32_bf16 v89, v80, v80, v89
    v_dot2_f32_bf16 v91, v81, v90, v91
    v_dot2_f32_bf16 v92, v81, v81, v92
    v_dot2_f32_bf16 v88, v82, v90, v88
    v_dot2_f32_bf16 v89, v82, v82, v89
    v_dot2_f32_bf16 v91, v83, v90, v91
    v_dot2_f32_bf16 v92, v83, v83, v92
    v_dot2_f32_bf16 v88, v84, v90, v88
    v_dot2_f32_bf16 v89, v84, v84, v89
    v_dot2_f32_bf16 v91, v85, v90, v91
    v_dot2_f32_bf16 v92, v85, v85, v92
    v_dot2_f32_bf16 v88, v86, v90, v88
    v_dot2_f32_bf16 v89, v86, v86, v89
    v_dot2_f32_bf16 v91, v87, v90, v91
    v_dot2_f32_bf16 v92, v87, v87, v92
    s_nop 3
    v_add_f32 v88, v88, v91
    v_add_f32 v89, v89, v92
    s_nop 1
    v_add_f32_dpp v88, v88, v88 quad_perm:[1,0,3,2] row_mask:0xf bank_mask:0xf
    v_add_f32_dpp v89, v89, v89 quad_perm:[1,0,3,2] row_mask:0xf bank_mask:0xf
    s_nop 1
    v_add_f32_dpp v88, v88, v88 quad_perm:[2,3,0,1] row_mask:0xf bank_mask:0xf
    v_add_f32_dpp v89, v89, v89 quad_perm:[2,3,0,1] row_mask:0xf bank_mask:0xf
    s_nop 1
    v_add_f32_dpp v88, v88, v88 row_half_mirror row_mask:0xf bank_mask:0xf
    v_add_f32_dpp v89, v89, v89 row_half_mirror row_mask:0xf bank_mask:0xf
    v_mul_f32 v88, 0x3ae38e39, v88
    v_mul_f32 v89, 0x3ae38e39, v89
    v_fma_f32 v89, -v88, v88, v89
    v_max_f32 v89, 0, v89
    v_cvt_pk_bf16_f32 v90, v88, v89
    v_lshlrev_b32 v88, 16, v90
    v_and_b32 v89, 0xffff0000, v90
    v_add_f32 v89, 0x3727c5ac, v89
    v_cvt_pk_bf16_f32 v90, v89, v89
    v_lshlrev_b32 v89, 16, v90
    v_sqrt_f32 v89, v89
    s_nop 0
    v_cvt_pk_bf16_f32 v90, v89, v89
    v_lshlrev_b32 v89, 16, v90
    v_rcp_f32 v92, v89
    s_nop 0
    v_mul_f32 v94, v88, v92
    v_sub_f32 v94, 0, v94

    s_lshl_b32 s49, s44, 6
    s_add_u32 s49, s49, 154112
    v_lshlrev_b32 v96, 3, v104
    v_add_u32 v96, s49, v96

    ds_write2_b32 v96, v92, v94 offset0:0 offset1:1
    v_lshlrev_b32 v96, 16, v52
    v_and_b32 v97, 0xffff0000, v52
    v_pk_fma_f32 v[96:97], v[96:97], v[92:93], v[94:95] op_sel_hi:[1,0,0]
    v_cvt_pk_bf16_f32 v52, v96, v97
    v_lshlrev_b32 v98, 16, v53
    v_and_b32 v99, 0xffff0000, v53
    v_pk_fma_f32 v[98:99], v[98:99], v[92:93], v[94:95] op_sel_hi:[1,0,0]
    v_cvt_pk_bf16_f32 v53, v98, v99
    v_lshlrev_b32 v100, 16, v54
    v_and_b32 v101, 0xffff0000, v54
    v_pk_fma_f32 v[100:101], v[100:101], v[92:93], v[94:95] op_sel_hi:[1,0,0]
    v_cvt_pk_bf16_f32 v54, v100, v101
    v_lshlrev_b32 v102, 16, v55
    v_and_b32 v103, 0xffff0000, v55
    v_pk_fma_f32 v[102:103], v[102:103], v[92:93], v[94:95] op_sel_hi:[1,0,0]
    v_cvt_pk_bf16_f32 v55, v102, v103
    v_lshlrev_b32 v96, 16, v56
    v_and_b32 v97, 0xffff0000, v56
    v_pk_fma_f32 v[96:97], v[96:97], v[92:93], v[94:95] op_sel_hi:[1,0,0]
    v_cvt_pk_bf16_f32 v56, v96, v97
    v_lshlrev_b32 v98, 16, v57
    v_and_b32 v99, 0xffff0000, v57
    v_pk_fma_f32 v[98:99], v[98:99], v[92:93], v[94:95] op_sel_hi:[1,0,0]
    v_cvt_pk_bf16_f32 v57, v98, v99
    v_lshlrev_b32 v100, 16, v58
    v_and_b32 v101, 0xffff0000, v58
    v_pk_fma_f32 v[100:101], v[100:101], v[92:93], v[94:95] op_sel_hi:[1,0,0]
    v_cvt_pk_bf16_f32 v58, v100, v101
    v_lshlrev_b32 v102, 16, v59
    v_and_b32 v103, 0xffff0000, v59
    v_pk_fma_f32 v[102:103], v[102:103], v[92:93], v[94:95] op_sel_hi:[1,0,0]
    v_cvt_pk_bf16_f32 v59, v102, v103
    v_lshlrev_b32 v96, 16, v60
    v_and_b32 v97, 0xffff0000, v60
    v_pk_fma_f32 v[96:97], v[96:97], v[92:93], v[94:95] op_sel_hi:[1,0,0]
    v_cvt_pk_bf16_f32 v60, v96, v97
    v_lshlrev_b32 v98, 16, v61
    v_and_b32 v99, 0xffff0000, v61
    v_pk_fma_f32 v[98:99], v[98:99], v[92:93], v[94:95] op_sel_hi:[1,0,0]
    v_cvt_pk_bf16_f32 v61, v98, v99
    v_lshlrev_b32 v100, 16, v62
    v_and_b32 v101, 0xffff0000, v62
    v_pk_fma_f32 v[100:101], v[100:101], v[92:93], v[94:95] op_sel_hi:[1,0,0]
    v_cvt_pk_bf16_f32 v62, v100, v101
    v_lshlrev_b32 v102, 16, v63
    v_and_b32 v103, 0xffff0000, v63
    v_pk_fma_f32 v[102:103], v[102:103], v[92:93], v[94:95] op_sel_hi:[1,0,0]
    v_cvt_pk_bf16_f32 v63, v102, v103
    v_lshlrev_b32 v96, 16, v64
    v_and_b32 v97, 0xffff0000, v64
    v_pk_fma_f32 v[96:97], v[96:97], v[92:93], v[94:95] op_sel_hi:[1,0,0]
    v_cvt_pk_bf16_f32 v64, v96, v97
    v_lshlrev_b32 v98, 16, v65
    v_and_b32 v99, 0xffff0000, v65
    v_pk_fma_f32 v[98:99], v[98:99], v[92:93], v[94:95] op_sel_hi:[1,0,0]
    v_cvt_pk_bf16_f32 v65, v98, v99
    v_lshlrev_b32 v100, 16, v66
    v_and_b32 v101, 0xffff0000, v66
    v_pk_fma_f32 v[100:101], v[100:101], v[92:93], v[94:95] op_sel_hi:[1,0,0]
    v_cvt_pk_bf16_f32 v66, v100, v101
    v_lshlrev_b32 v102, 16, v67
    v_and_b32 v103, 0xffff0000, v67
    v_pk_fma_f32 v[102:103], v[102:103], v[92:93], v[94:95] op_sel_hi:[1,0,0]
    v_cvt_pk_bf16_f32 v67, v102, v103
    v_lshlrev_b32 v96, 16, v68
    v_and_b32 v97, 0xffff0000, v68
    v_pk_fma_f32 v[96:97], v[96:97], v[92:93], v[94:95] op_sel_hi:[1,0,0]
    v_cvt_pk_bf16_f32 v68, v96, v97
    v_lshlrev_b32 v98, 16, v69
    v_and_b32 v99, 0xffff0000, v69
    v_pk_fma_f32 v[98:99], v[98:99], v[92:93], v[94:95] op_sel_hi:[1,0,0]
    v_cvt_pk_bf16_f32 v69, v98, v99
    v_lshlrev_b32 v100, 16, v70
    v_and_b32 v101, 0xffff0000, v70
    v_pk_fma_f32 v[100:101], v[100:101], v[92:93], v[94:95] op_sel_hi:[1,0,0]
    v_cvt_pk_bf16_f32 v70, v100, v101
    v_lshlrev_b32 v102, 16, v71
    v_and_b32 v103, 0xffff0000, v71
    v_pk_fma_f32 v[102:103], v[102:103], v[92:93], v[94:95] op_sel_hi:[1,0,0]
    v_cvt_pk_bf16_f32 v71, v102, v103
    v_lshlrev_b32 v96, 16, v72
    v_and_b32 v97, 0xffff0000, v72
    v_pk_fma_f32 v[96:97], v[96:97], v[92:93], v[94:95] op_sel_hi:[1,0,0]
    v_cvt_pk_bf16_f32 v72, v96, v97
    v_lshlrev_b32 v98, 16, v73
    v_and_b32 v99, 0xffff0000, v73
    v_pk_fma_f32 v[98:99], v[98:99], v[92:93], v[94:95] op_sel_hi:[1,0,0]
    v_cvt_pk_bf16_f32 v73, v98, v99
    v_lshlrev_b32 v100, 16, v74
    v_and_b32 v101, 0xffff0000, v74
    v_pk_fma_f32 v[100:101], v[100:101], v[92:93], v[94:95] op_sel_hi:[1,0,0]
    v_cvt_pk_bf16_f32 v74, v100, v101
    v_lshlrev_b32 v102, 16, v75
    v_and_b32 v103, 0xffff0000, v75
    v_pk_fma_f32 v[102:103], v[102:103], v[92:93], v[94:95] op_sel_hi:[1,0,0]
    v_cvt_pk_bf16_f32 v75, v102, v103
    v_lshlrev_b32 v96, 16, v76
    v_and_b32 v97, 0xffff0000, v76
    v_pk_fma_f32 v[96:97], v[96:97], v[92:93], v[94:95] op_sel_hi:[1,0,0]
    v_cvt_pk_bf16_f32 v76, v96, v97
    v_lshlrev_b32 v98, 16, v77
    v_and_b32 v99, 0xffff0000, v77
    v_pk_fma_f32 v[98:99], v[98:99], v[92:93], v[94:95] op_sel_hi:[1,0,0]
    v_cvt_pk_bf16_f32 v77, v98, v99
    v_lshlrev_b32 v100, 16, v78
    v_and_b32 v101, 0xffff0000, v78
    v_pk_fma_f32 v[100:101], v[100:101], v[92:93], v[94:95] op_sel_hi:[1,0,0]
    v_cvt_pk_bf16_f32 v78, v100, v101
    v_lshlrev_b32 v102, 16, v79
    v_and_b32 v103, 0xffff0000, v79
    v_pk_fma_f32 v[102:103], v[102:103], v[92:93], v[94:95] op_sel_hi:[1,0,0]
    v_cvt_pk_bf16_f32 v79, v102, v103
    v_lshlrev_b32 v96, 16, v80
    v_and_b32 v97, 0xffff0000, v80
    v_pk_fma_f32 v[96:97], v[96:97], v[92:93], v[94:95] op_sel_hi:[1,0,0]
    v_cvt_pk_bf16_f32 v80, v96, v97
    v_lshlrev_b32 v98, 16, v81
    v_and_b32 v99, 0xffff0000, v81
    v_pk_fma_f32 v[98:99], v[98:99], v[92:93], v[94:95] op_sel_hi:[1,0,0]
    v_cvt_pk_bf16_f32 v81, v98, v99
    v_lshlrev_b32 v100, 16, v82
    v_and_b32 v101, 0xffff0000, v82
    v_pk_fma_f32 v[100:101], v[100:101], v[92:93], v[94:95] op_sel_hi:[1,0,0]
    v_cvt_pk_bf16_f32 v82, v100, v101
    v_lshlrev_b32 v102, 16, v83
    v_and_b32 v103, 0xffff0000, v83
    v_pk_fma_f32 v[102:103], v[102:103], v[92:93], v[94:95] op_sel_hi:[1,0,0]
    v_cvt_pk_bf16_f32 v83, v102, v103
    v_lshlrev_b32 v96, 16, v84
    v_and_b32 v97, 0xffff0000, v84
    v_pk_fma_f32 v[96:97], v[96:97], v[92:93], v[94:95] op_sel_hi:[1,0,0]
    v_cvt_pk_bf16_f32 v84, v96, v97
    v_lshlrev_b32 v98, 16, v85
    v_and_b32 v99, 0xffff0000, v85
    v_pk_fma_f32 v[98:99], v[98:99], v[92:93], v[94:95] op_sel_hi:[1,0,0]
    v_cvt_pk_bf16_f32 v85, v98, v99
    v_lshlrev_b32 v100, 16, v86
    v_and_b32 v101, 0xffff0000, v86
    v_pk_fma_f32 v[100:101], v[100:101], v[92:93], v[94:95] op_sel_hi:[1,0,0]
    v_cvt_pk_bf16_f32 v86, v100, v101
    v_lshlrev_b32 v102, 16, v87
    v_and_b32 v103, 0xffff0000, v87
    v_pk_fma_f32 v[102:103], v[102:103], v[92:93], v[94:95] op_sel_hi:[1,0,0]
    v_cvt_pk_bf16_f32 v87, v102, v103
    s_waitcnt lgkmcnt(0)
    s_barrier
    ds_write_b128 v106, v[52:55] offset:0
    ds_write_b128 v106, v[56:59] offset:128
    ds_write_b128 v106, v[60:63] offset:256
    ds_write_b128 v106, v[64:67] offset:384
    ds_write_b128 v106, v[68:71] offset:512
    ds_write_b128 v106, v[72:75] offset:640
    ds_write_b128 v106, v[76:79] offset:768
    ds_write_b128 v106, v[80:83] offset:896
    ds_write_b128 v106, v[84:87] offset:1024
    s_waitcnt lgkmcnt(0)
    s_barrier
    s_lshr_b32 s49, s45, 1
    s_cmp_lg_u32 s49, 1
    s_cbranch_scc1 .xr_50
    ds_read_b128 a[0:3], v107 offset:0
    ds_read_b128 a[4:7], v107 offset:4672
    ds_read_b128 a[8:11], v107 offset:64
    ds_read_b128 a[12:15], v107 offset:4736
    ds_read_b128 a[16:19], v107 offset:128
    ds_read_b128 a[20:23], v107 offset:4800
    ds_read_b128 a[24:27], v107 offset:192
    ds_read_b128 a[28:31], v107 offset:4864
    ds_read_b128 a[32:35], v107 offset:256
    ds_read_b128 a[36:39], v107 offset:4928
    ds_read_b128 a[40:43], v107 offset:320
    ds_read_b128 a[44:47], v107 offset:4992
    ds_read_b128 a[48:51], v107 offset:384
    ds_read_b128 a[52:55], v107 offset:5056
    ds_read_b128 a[56:59], v107 offset:448
    ds_read_b128 a[60:63], v107 offset:5120
    ds_read_b128 a[64:67], v107 offset:512
    ds_read_b128 a[68:71], v107 offset:5184
    ds_read_b128 a[72:75], v107 offset:576
    ds_read_b128 a[76:79], v107 offset:5248
    ds_read_b128 a[80:83], v107 offset:640
    ds_read_b128 a[84:87], v107 offset:5312
    ds_read_b128 a[88:91], v107 offset:704
    ds_read_b128 a[92:95], v107 offset:5376
    ds_read_b128 a[96:99], v107 offset:768
    ds_read_b128 a[100:103], v107 offset:5440
    ds_read_b128 a[104:107], v107 offset:832
    ds_read_b128 a[108:111], v107 offset:5504
    ds_read_b128 a[112:115], v107 offset:896
    ds_read_b128 a[116:119], v107 offset:5568
    ds_read_b128 a[120:123], v107 offset:960
    ds_read_b128 a[124:127], v107 offset:5632
    ds_read_b128 a[128:131], v107 offset:1024
    ds_read_b128 a[132:135], v107 offset:5696
    ds_read_b128 a[136:139], v107 offset:1088
    ds_read_b128 a[140:143], v107 offset:5760
.xr_50:
    s_waitcnt lgkmcnt(0)
    s_barrier
    v_mov_b32 v108, -1
    v_mov_b32 v109, -1
    v_mov_b32 v110, -1
    v_mov_b32 v111, -1
    ds_read_b128 v[16:19], v3 offset:0
    ds_read_b128 v[20:23], v3 offset:2048
    ds_read_b128 v[24:27], v6 offset:0
    s_waitcnt lgkmcnt(2)
    v_mfma_f32_16x16x32_bf16 v[32:35], a[0:3], v[16:19], 0
    ds_read_b128 v[28:31], v6 offset:2048
    v_mfma_f32_16x16x32_bf16 v[36:39], a[4:7], v[16:19], 0
    s_add_u32 m0, s52, 55296
    s_add_u32 s49, s54, 768
    buffer_load_dwordx4 v1, s[8:11], s49 offen lds
    s_waitcnt lgkmcnt(2)
    v_mfma_f32_16x16x32_bf16 v[40:43], a[0:3], v[20:23], 0
    ds_read_b128 v[16:19], v3 offset:4096
    v_mfma_f32_16x16x32_bf16 v[44:47], a[4:7], v[20:23], 0
    s_lshl_b32 s50, s57, 4
    s_add_u32 s50, s50, s47
    s_mul_i32 s50, s50, 1152
    s_mul_i32 s51, s44, 144
    s_add_u32 s50, s50, s51
    s_add_u32 s50, s50, 38797312
    s_mov_b64 exec, 0x1ff

    buffer_store_dwordx4 v[108:111], v12, s[16:19], s50 offen sc0 sc1
    s_mov_b64 exec, -1
    s_add_u32 m0, s52, 56320
    s_add_u32 s49, s54, 768
    buffer_load_dwordx4 v2, s[8:11], s49 offen lds
    s_waitcnt lgkmcnt(2)
    v_mfma_f32_16x16x32_bf16 v[32:35], a[8:11], v[24:27], v[32:35]
    ds_read_b128 v[20:23], v3 offset:6144
    v_mfma_f32_16x16x32_bf16 v[36:39], a[12:15], v[24:27], v[36:39]
    s_add_u32 m0, s52, 73728
    s_add_u32 s49, s55, 1024
    buffer_load_dwordx4 v1, s[8:11], s49 offen lds
    s_waitcnt lgkmcnt(2)
    v_mfma_f32_16x16x32_bf16 v[40:43], a[8:11], v[28:31], v[40:43]
    ds_read_b128 v[24:27], v6 offset:4096
    v_mfma_f32_16x16x32_bf16 v[44:47], a[12:15], v[28:31], v[44:47]
    s_add_u32 m0, s52, 74752
    s_add_u32 s49, s55, 1024
    buffer_load_dwordx4 v2, s[8:11], s49 offen lds
    s_waitcnt lgkmcnt(2)
    v_mfma_f32_16x16x32_bf16 v[32:35], a[16:19], v[16:19], v[32:35]
    ds_read_b128 v[28:31], v6 offset:6144
    v_mfma_f32_16x16x32_bf16 v[36:39], a[20:23], v[16:19], v[36:39]
    s_waitcnt lgkmcnt(2)
    v_mfma_f32_16x16x32_bf16 v[40:43], a[16:19], v[20:23], v[40:43]
    ds_read_b128 v[16:19], v3 offset:18432
    v_mfma_f32_16x16x32_bf16 v[44:47], a[20:23], v[20:23], v[44:47]
    s_waitcnt lgkmcnt(2)
    v_mfma_f32_16x16x32_bf16 v[32:35], a[24:27], v[24:27], v[32:35]
    ds_read_b128 v[20:23], v3 offset:20480
    v_mfma_f32_16x16x32_bf16 v[36:39], a[28:31], v[24:27], v[36:39]
    s_waitcnt lgkmcnt(2)
    v_mfma_f32_16x16x32_bf16 v[40:43], a[24:27], v[28:31], v[40:43]
    v_mfma_f32_16x16x32_bf16 v[44:47], a[28:31], v[28:31], v[44:47]
    s_barrier
    s_waitcnt lgkmcnt(1)
    v_mfma_f32_16x16x32_bf16 v[32:35], a[32:35], v[16:19], v[32:35]
    ds_read_b128 v[24:27], v6 offset:18432
    ds_read_b128 v[28:31], v6 offset:20480
    v_mfma_f32_16x16x32_bf16 v[36:39], a[36:39], v[16:19], v[36:39]
    s_add_u32 m0, s52, 0
    s_add_u32 s49, s54, 18560
    buffer_load_dwordx4 v1, s[8:11], s49 offen lds
    s_waitcnt lgkmcnt(2)
    v_mfma_f32_16x16x32_bf16 v[40:43], a[32:35], v[20:23], v[40:43]
    ds_read_b128 v[16:19], v3 offset:22528
    v_mfma_f32_16x16x32_bf16 v[44:47], a[36:39], v[20:23], v[44:47]
    s_add_u32 m0, s52, 1024
    s_add_u32 s49, s54, 18560
    buffer_load_dwordx4 v2, s[8:11], s49 offen lds
    s_waitcnt lgkmcnt(2)
    v_mfma_f32_16x16x32_bf16 v[32:35], a[40:43], v[24:27], v[32:35]
    ds_read_b128 v[20:23], v3 offset:24576
    v_mfma_f32_16x16x32_bf16 v[36:39], a[44:47], v[24:27], v[36:39]
    s_add_u32 m0, s52, 92160
    s_add_u32 s49, s54, 18816
    buffer_load_dwordx4 v1, s[8:11], s49 offen lds
    s_waitcnt lgkmcnt(2)
    v_mfma_f32_16x16x32_bf16 v[40:43], a[40:43], v[28:31], v[40:43]
    ds_read_b128 v[24:27], v6 offset:22528
    v_mfma_f32_16x16x32_bf16 v[44:47], a[44:47], v[28:31], v[44:47]
    s_add_u32 m0, s52, 93184
    s_add_u32 s49, s54, 18816
    buffer_load_dwordx4 v2, s[8:11], s49 offen lds
    s_waitcnt lgkmcnt(2)
    v_mfma_f32_16x16x32_bf16 v[32:35], a[48:51], v[16:19], v[32:35]
    ds_read_b128 v[28:31], v6 offset:24576
    v_mfma_f32_16x16x32_bf16 v[36:39], a[52:55], v[16:19], v[36:39]
    s_waitcnt lgkmcnt(2)
    v_mfma_f32_16x16x32_bf16 v[40:43], a[48:51], v[20:23], v[40:43]
    ds_read_b128 v[16:19], v3 offset:36864
    v_mfma_f32_16x16x32_bf16 v[44:47], a[52:55], v[20:23], v[44:47]
    s_waitcnt lgkmcnt(2)
    v_mfma_f32_16x16x32_bf16 v[32:35], a[56:59], v[24:27], v[32:35]
    ds_read_b128 v[20:23], v3 offset:38912
    v_mfma_f32_16x16x32_bf16 v[36:39], a[60:63], v[24:27], v[36:39]
    s_waitcnt lgkmcnt(2)
    v_mfma_f32_16x16x32_bf16 v[40:43], a[56:59], v[28:31], v[40:43]
    v_mfma_f32_16x16x32_bf16 v[44:47], a[60:63], v[28:31], v[44:47]
    s_waitcnt vmcnt(6)
    s_barrier
    s_waitcnt lgkmcnt(1)
    v_mfma_f32_16x16x32_bf16 v[32:35], a[64:67], v[16:19], v[32:35]
    ds_read_b128 v[24:27], v6 offset:36864
    ds_read_b128 v[28:31], v6 offset:38912
    v_mfma_f32_16x16x32_bf16 v[36:39], a[68:71], v[16:19], v[36:39]
    s_add_u32 m0, s52, 18432
    s_add_u32 s49, s54, 19072
    buffer_load_dwordx4 v1, s[8:11], s49 offen lds
    s_waitcnt lgkmcnt(2)
    v_mfma_f32_16x16x32_bf16 v[40:43], a[64:67], v[20:23], v[40:43]
    ds_read_b128 v[16:19], v3 offset:40960
    v_mfma_f32_16x16x32_bf16 v[44:47], a[68:71], v[20:23], v[44:47]
    s_add_u32 m0, s52, 19456
    s_add_u32 s49, s54, 19072
    buffer_load_dwordx4 v2, s[8:11], s49 offen lds
    s_waitcnt lgkmcnt(2)
    v_mfma_f32_16x16x32_bf16 v[32:35], a[72:75], v[24:27], v[32:35]
    ds_read_b128 v[20:23], v3 offset:43008
    v_mfma_f32_16x16x32_bf16 v[36:39], a[76:79], v[24:27], v[36:39]
    s_add_u32 m0, s52, 110592
    s_add_u32 s49, s54, 19328
    buffer_load_dwordx4 v1, s[8:11], s49 offen lds
    s_waitcnt lgkmcnt(2)
    v_mfma_f32_16x16x32_bf16 v[40:43], a[72:75], v[28:31], v[40:43]
    ds_read_b128 v[24:27], v6 offset:40960
    v_mfma_f32_16x16x32_bf16 v[44:47], a[76:79], v[28:31], v[44:47]
    s_add_u32 m0, s52, 111616
    s_add_u32 s49, s54, 19328
    buffer_load_dwordx4 v2, s[8:11], s49 offen lds
    s_waitcnt lgkmcnt(2)
    v_mfma_f32_16x16x32_bf16 v[32:35], a[80:83], v[16:19], v[32:35]
    ds_read_b128 v[28:31], v6 offset:43008
    v_mfma_f32_16x16x32_bf16 v[36:39], a[84:87], v[16:19], v[36:39]
    s_waitcnt lgkmcnt(2)
    v_mfma_f32_16x16x32_bf16 v[40:43], a[80:83], v[20:23], v[40:43]
    ds_read_b128 v[16:19], v3 offset:55296
    v_mfma_f32_16x16x32_bf16 v[44:47], a[84:87], v[20:23], v[44:47]
    s_waitcnt lgkmcnt(2)
    v_mfma_f32_16x16x32_bf16 v[32:35], a[88:91], v[24:27], v[32:35]
    ds_read_b128 v[20:23], v3 offset:57344
    v_mfma_f32_16x16x32_bf16 v[36:39], a[92:95], v[24:27], v[36:39]
    s_waitcnt lgkmcnt(2)
    v_mfma_f32_16x16x32_bf16 v[40:43], a[88:91], v[28:31], v[40:43]
    v_mfma_f32_16x16x32_bf16 v[44:47], a[92:95], v[28:31], v[44:47]
    s_waitcnt vmcnt(8)
    s_barrier
    s_waitcnt lgkmcnt(1)
    v_mfma_f32_16x16x32_bf16 v[32:35], a[96:99], v[16:19], v[32:35]
    ds_read_b128 v[24:27], v6 offset:55296
    ds_read_b128 v[28:31], v6 offset:57344
    v_mfma_f32_16x16x32_bf16 v[36:39], a[100:103], v[16:19], v[36:39]
    s_add_u32 m0, s52, 36864
    s_add_u32 s49, s54, 36864
    buffer_load_dwordx4 v1, s[8:11], s49 offen lds
    s_waitcnt lgkmcnt(2)
    v_mfma_f32_16x16x32_bf16 v[40:43], a[96:99], v[20:23], v[40:43]
    ds_read_b128 v[16:19], v3 offset:59392
    v_mfma_f32_16x16x32_bf16 v[44:47], a[100:103], v[20:23], v[44:47]
    s_add_u32 m0, s52, 37888
    s_add_u32 s49, s54, 36864
    buffer_load_dwordx4 v2, s[8:11], s49 offen lds
    s_waitcnt lgkmcnt(2)
    v_mfma_f32_16x16x32_bf16 v[32:35], a[104:107], v[24:27], v[32:35]
    ds_read_b128 v[20:23], v3 offset:61440
    v_mfma_f32_16x16x32_bf16 v[36:39], a[108:111], v[24:27], v[36:39]
    s_waitcnt lgkmcnt(2)
    v_mfma_f32_16x16x32_bf16 v[40:43], a[104:107], v[28:31], v[40:43]
    ds_read_b128 v[24:27], v6 offset:59392
    v_mfma_f32_16x16x32_bf16 v[44:47], a[108:111], v[28:31], v[44:47]
    s_waitcnt lgkmcnt(2)
    v_mfma_f32_16x16x32_bf16 v[32:35], a[112:115], v[16:19], v[32:35]
    ds_read_b128 v[28:31], v6 offset:61440
    v_mfma_f32_16x16x32_bf16 v[36:39], a[116:119], v[16:19], v[36:39]
    s_waitcnt lgkmcnt(2)
    v_mfma_f32_16x16x32_bf16 v[40:43], a[112:115], v[20:23], v[40:43]
    ds_read_b128 v[16:19], v4 offset:8192
    v_mfma_f32_16x16x32_bf16 v[44:47], a[116:119], v[20:23], v[44:47]
    s_waitcnt lgkmcnt(2)
    v_mfma_f32_16x16x32_bf16 v[32:35], a[120:123], v[24:27], v[32:35]
    ds_read_b128 v[20:23], v4 offset:10240
    v_mfma_f32_16x16x32_bf16 v[36:39], a[124:127], v[24:27], v[36:39]
    s_waitcnt lgkmcnt(2)
    v_mfma_f32_16x16x32_bf16 v[40:43], a[120:123], v[28:31], v[40:43]
    v_mfma_f32_16x16x32_bf16 v[44:47], a[124:127], v[28:31], v[44:47]
    s_waitcnt vmcnt(8)
    s_barrier
    s_waitcnt lgkmcnt(1)
    v_mfma_f32_16x16x32_bf16 v[32:35], a[128:131], v[16:19], v[32:35]
    ds_read_b128 v[24:27], v7 offset:8192
    ds_read_b128 v[28:31], v7 offset:10240
    v_mfma_f32_16x16x32_bf16 v[36:39], a[132:135], v[16:19], v[36:39]
    s_add_u32 m0, s52, 55296
    s_add_u32 s49, s54, 37120
    buffer_load_dwordx4 v1, s[8:11], s49 offen lds
    s_waitcnt lgkmcnt(2)
    v_mfma_f32_16x16x32_bf16 v[40:43], a[128:131], v[20:23], v[40:43]
    ds_read_b128 v[16:19], v4 offset:12288
    v_mfma_f32_16x16x32_bf16 v[44:47], a[132:135], v[20:23], v[44:47]
    s_add_u32 m0, s52, 56320
    s_add_u32 s49, s54, 37120
    buffer_load_dwordx4 v2, s[8:11], s49 offen lds
    s_waitcnt lgkmcnt(2)
    v_mfma_f32_16x16x32_bf16 v[32:35], a[136:139], v[24:27], v[32:35]
    ds_read_b128 v[20:23], v4 offset:14336
    v_mfma_f32_16x16x32_bf16 v[36:39], a[140:143], v[24:27], v[36:39]
    s_waitcnt lgkmcnt(2)
    v_mfma_f32_16x16x32_bf16 v[40:43], a[136:139], v[28:31], v[40:43]
    ds_read_b128 v[24:27], v7 offset:12288
    v_mfma_f32_16x16x32_bf16 v[44:47], a[140:143], v[28:31], v[44:47]
    s_waitcnt lgkmcnt(2)
    v_mfma_f32_16x16x32_bf16 v[48:51], a[0:3], v[16:19], 0
    ds_read_b128 v[28:31], v7 offset:14336
    v_mfma_f32_16x16x32_bf16 v[52:55], a[4:7], v[16:19], 0
    s_waitcnt lgkmcnt(2)
    v_mfma_f32_16x16x32_bf16 v[56:59], a[0:3], v[20:23], 0
    ds_read_b128 v[16:19], v3 offset:0
    v_mfma_f32_16x16x32_bf16 v[60:63], a[4:7], v[20:23], 0
    s_waitcnt lgkmcnt(2)
    v_mfma_f32_16x16x32_bf16 v[48:51], a[8:11], v[24:27], v[48:51]
    ds_read_b128 v[20:23], v3 offset:2048
    v_mfma_f32_16x16x32_bf16 v[52:55], a[12:15], v[24:27], v[52:55]
    s_waitcnt lgkmcnt(2)
    v_mfma_f32_16x16x32_bf16 v[56:59], a[8:11], v[28:31], v[56:59]
    v_mfma_f32_16x16x32_bf16 v[60:63], a[12:15], v[28:31], v[60:63]
    s_waitcnt vmcnt(8)
    s_barrier
    s_waitcnt lgkmcnt(1)
    v_mfma_f32_16x16x32_bf16 v[48:51], a[16:19], v[16:19], v[48:51]
    ds_read_b128 v[24:27], v6 offset:0
    ds_read_b128 v[28:31], v6 offset:2048
    v_mfma_f32_16x16x32_bf16 v[52:55], a[20:23], v[16:19], v[52:55]
    s_add_u32 m0, s52, 73728
    s_add_u32 s49, s54, 37376
    buffer_load_dwordx4 v1, s[8:11], s49 offen lds
    s_waitcnt lgkmcnt(2)
    v_mfma_f32_16x16x32_bf16 v[56:59], a[16:19], v[20:23], v[56:59]
    ds_read_b128 v[16:19], v3 offset:4096
    v_mfma_f32_16x16x32_bf16 v[60:63], a[20:23], v[20:23], v[60:63]
    s_add_u32 m0, s52, 74752
    s_add_u32 s49, s54, 37376
    buffer_load_dwordx4 v2, s[8:11], s49 offen lds
    s_waitcnt lgkmcnt(2)
    v_mfma_f32_16x16x32_bf16 v[48:51], a[24:27], v[24:27], v[48:51]
    ds_read_b128 v[20:23], v3 offset:6144
    v_mfma_f32_16x16x32_bf16 v[52:55], a[28:31], v[24:27], v[52:55]
    s_waitcnt lgkmcnt(2)
    v_mfma_f32_16x16x32_bf16 v[56:59], a[24:27], v[28:31], v[56:59]
    ds_read_b128 v[24:27], v6 offset:4096
    v_mfma_f32_16x16x32_bf16 v[60:63], a[28:31], v[28:31], v[60:63]
    s_waitcnt lgkmcnt(2)
    v_mfma_f32_16x16x32_bf16 v[48:51], a[32:35], v[16:19], v[48:51]
    ds_read_b128 v[28:31], v6 offset:6144
    v_mfma_f32_16x16x32_bf16 v[52:55], a[36:39], v[16:19], v[52:55]
    s_waitcnt lgkmcnt(2)
    v_mfma_f32_16x16x32_bf16 v[56:59], a[32:35], v[20:23], v[56:59]
    ds_read_b128 v[16:19], v4 offset:26624
    v_mfma_f32_16x16x32_bf16 v[60:63], a[36:39], v[20:23], v[60:63]
    s_waitcnt lgkmcnt(2)
    v_mfma_f32_16x16x32_bf16 v[48:51], a[40:43], v[24:27], v[48:51]
    ds_read_b128 v[20:23], v4 offset:28672
    v_mfma_f32_16x16x32_bf16 v[52:55], a[44:47], v[24:27], v[52:55]
    s_waitcnt lgkmcnt(2)
    v_mfma_f32_16x16x32_bf16 v[56:59], a[40:43], v[28:31], v[56:59]
    v_mfma_f32_16x16x32_bf16 v[60:63], a[44:47], v[28:31], v[60:63]
    s_waitcnt vmcnt(8)
    s_barrier
    s_waitcnt lgkmcnt(1)
    v_mfma_f32_16x16x32_bf16 v[48:51], a[48:51], v[16:19], v[48:51]
    ds_read_b128 v[24:27], v7 offset:26624
    ds_read_b128 v[28:31], v7 offset:28672
    v_mfma_f32_16x16x32_bf16 v[52:55], a[52:55], v[16:19], v[52:55]
    s_add_u32 m0, s52, 0
    s_add_u32 s49, s54, 37632
    buffer_load_dwordx4 v1, s[8:11], s49 offen lds
    s_waitcnt lgkmcnt(2)
    v_mfma_f32_16x16x32_bf16 v[56:59], a[48:51], v[20:23], v[56:59]
    ds_read_b128 v[16:19], v4 offset:30720
    v_mfma_f32_16x16x32_bf16 v[60:63], a[52:55], v[20:23], v[60:63]
    s_lshl_b32 s50, s47, 4
    s_add_u32 s50, s50, s48
    v_mov_b32 v0, s93
    s_cmp_eq_u32 s44, 0
    s_cselect_b64 exec, 1, 0

    buffer_store_byte v0, off, s[28:31], s50 sc0 sc1
    s_mov_b64 exec, -1
    s_add_u32 m0, s52, 1024
    s_add_u32 s49, s54, 37632
    buffer_load_dwordx4 v2, s[8:11], s49 offen lds
    s_waitcnt lgkmcnt(2)
    v_mfma_f32_16x16x32_bf16 v[48:51], a[56:59], v[24:27], v[48:51]
    ds_read_b128 v[20:23], v4 offset:32768
    v_mfma_f32_16x16x32_bf16 v[52:55], a[60:63], v[24:27], v[52:55]
    s_waitcnt lgkmcnt(2)
    v_mfma_f32_16x16x32_bf16 v[56:59], a[56:59], v[28:31], v[56:59]
    ds_read_b128 v[24:27], v7 offset:30720
    v_mfma_f32_16x16x32_bf16 v[60:63], a[60:63], v[28:31], v[60:63]
    s_waitcnt lgkmcnt(2)
    v_mfma_f32_16x16x32_bf16 v[48:51], a[64:67], v[16:19], v[48:51]
    ds_read_b128 v[28:31], v7 offset:32768
    v_mfma_f32_16x16x32_bf16 v[52:55], a[68:71], v[16:19], v[52:55]
    s_waitcnt lgkmcnt(2)
    v_mfma_f32_16x16x32_bf16 v[56:59], a[64:67], v[20:23], v[56:59]
    ds_read_b128 v[16:19], v3 offset:18432
    v_mfma_f32_16x16x32_bf16 v[60:63], a[68:71], v[20:23], v[60:63]
    s_waitcnt lgkmcnt(2)
    v_mfma_f32_16x16x32_bf16 v[48:51], a[72:75], v[24:27], v[48:51]
    ds_read_b128 v[20:23], v3 offset:20480
    v_mfma_f32_16x16x32_bf16 v[52:55], a[76:79], v[24:27], v[52:55]
    s_waitcnt lgkmcnt(2)
    v_mfma_f32_16x16x32_bf16 v[56:59], a[72:75], v[28:31], v[56:59]
    v_mfma_f32_16x16x32_bf16 v[60:63], a[76:79], v[28:31], v[60:63]
    s_waitcnt vmcnt(9)
    s_barrier
    s_waitcnt lgkmcnt(1)
    v_mfma_f32_16x16x32_bf16 v[48:51], a[80:83], v[16:19], v[48:51]
    ds_read_b128 v[24:27], v6 offset:18432
    ds_read_b128 v[28:31], v6 offset:20480
    v_mfma_f32_16x16x32_bf16 v[52:55], a[84:87], v[16:19], v[52:55]
    s_add_u32 m0, s52, 92160
    s_add_u32 s49, s55, 37888
    buffer_load_dwordx4 v1, s[8:11], s49 offen lds
    s_waitcnt lgkmcnt(2)
    v_mfma_f32_16x16x32_bf16 v[56:59], a[80:83], v[20:23], v[56:59]
    ds_read_b128 v[16:19], v3 offset:22528
    v_mfma_f32_16x16x32_bf16 v[60:63], a[84:87], v[20:23], v[60:63]
    s_add_u32 m0, s52, 93184
    s_add_u32 s49, s55, 37888
    buffer_load_dwordx4 v2, s[8:11], s49 offen lds
    s_waitcnt lgkmcnt(2)
    v_mfma_f32_16x16x32_bf16 v[48:51], a[88:91], v[24:27], v[48:51]
    ds_read_b128 v[20:23], v3 offset:24576
    v_mfma_f32_16x16x32_bf16 v[52:55], a[92:95], v[24:27], v[52:55]
    s_waitcnt lgkmcnt(2)
    v_mfma_f32_16x16x32_bf16 v[56:59], a[88:91], v[28:31], v[56:59]
    ds_read_b128 v[24:27], v6 offset:22528
    v_mfma_f32_16x16x32_bf16 v[60:63], a[92:95], v[28:31], v[60:63]
    s_waitcnt lgkmcnt(2)
    v_mfma_f32_16x16x32_bf16 v[48:51], a[96:99], v[16:19], v[48:51]
    ds_read_b128 v[28:31], v6 offset:24576
    v_mfma_f32_16x16x32_bf16 v[52:55], a[100:103], v[16:19], v[52:55]
    s_waitcnt lgkmcnt(2)
    v_mfma_f32_16x16x32_bf16 v[56:59], a[96:99], v[20:23], v[56:59]
    ds_read_b128 v[16:19], v4 offset:45056
    v_mfma_f32_16x16x32_bf16 v[60:63], a[100:103], v[20:23], v[60:63]
    s_waitcnt lgkmcnt(2)
    v_mfma_f32_16x16x32_bf16 v[48:51], a[104:107], v[24:27], v[48:51]
    ds_read_b128 v[20:23], v4 offset:47104
    v_mfma_f32_16x16x32_bf16 v[52:55], a[108:111], v[24:27], v[52:55]
    s_waitcnt lgkmcnt(2)
    v_mfma_f32_16x16x32_bf16 v[56:59], a[104:107], v[28:31], v[56:59]
    v_mfma_f32_16x16x32_bf16 v[60:63], a[108:111], v[28:31], v[60:63]
    s_waitcnt vmcnt(9)
    s_barrier
    s_waitcnt lgkmcnt(1)
    v_mfma_f32_16x16x32_bf16 v[48:51], a[112:115], v[16:19], v[48:51]
    ds_read_b128 v[24:27], v7 offset:45056
    ds_read_b128 v[28:31], v7 offset:47104
    v_mfma_f32_16x16x32_bf16 v[52:55], a[116:119], v[16:19], v[52:55]
    s_add_u32 m0, s52, 18432
    s_add_u32 s49, s54, 55424
    buffer_load_dwordx4 v1, s[8:11], s49 offen lds
    s_waitcnt lgkmcnt(2)
    v_mfma_f32_16x16x32_bf16 v[56:59], a[112:115], v[20:23], v[56:59]
    ds_read_b128 v[16:19], v4 offset:49152
    v_mfma_f32_16x16x32_bf16 v[60:63], a[116:119], v[20:23], v[60:63]
    s_add_u32 m0, s52, 19456
    s_add_u32 s49, s54, 55424
    buffer_load_dwordx4 v2, s[8:11], s49 offen lds
    s_waitcnt lgkmcnt(2)
    v_mfma_f32_16x16x32_bf16 v[48:51], a[120:123], v[24:27], v[48:51]
    ds_read_b128 v[20:23], v4 offset:51200
    v_mfma_f32_16x16x32_bf16 v[52:55], a[124:127], v[24:27], v[52:55]
    s_waitcnt lgkmcnt(2)
    v_mfma_f32_16x16x32_bf16 v[56:59], a[120:123], v[28:31], v[56:59]
    ds_read_b128 v[24:27], v7 offset:49152
    v_mfma_f32_16x16x32_bf16 v[60:63], a[124:127], v[28:31], v[60:63]
    s_waitcnt lgkmcnt(2)
    v_mfma_f32_16x16x32_bf16 v[48:51], a[128:131], v[16:19], v[48:51]
    ds_read_b128 v[28:31], v7 offset:51200
    v_mfma_f32_16x16x32_bf16 v[52:55], a[132:135], v[16:19], v[52:55]
    s_waitcnt lgkmcnt(2)
    v_mfma_f32_16x16x32_bf16 v[56:59], a[128:131], v[20:23], v[56:59]
    ds_read_b128 v[16:19], v3 offset:36864
    v_mfma_f32_16x16x32_bf16 v[60:63], a[132:135], v[20:23], v[60:63]
    s_waitcnt lgkmcnt(2)
    v_mfma_f32_16x16x32_bf16 v[48:51], a[136:139], v[24:27], v[48:51]
    ds_read_b128 v[20:23], v3 offset:38912
    v_mfma_f32_16x16x32_bf16 v[52:55], a[140:143], v[24:27], v[52:55]
    s_waitcnt lgkmcnt(2)
    v_mfma_f32_16x16x32_bf16 v[56:59], a[136:139], v[28:31], v[56:59]
    v_mfma_f32_16x16x32_bf16 v[60:63], a[140:143], v[28:31], v[60:63]
    s_waitcnt vmcnt(9)
    s_barrier
    s_waitcnt lgkmcnt(1)
    v_mfma_f32_16x16x32_bf16 v[64:67], a[0:3], v[16:19], 0
    ds_read_b128 v[24:27], v6 offset:36864
    ds_read_b128 v[28:31], v6 offset:38912
    v_mfma_f32_16x16x32_bf16 v[68:71], a[4:7], v[16:19], 0
    s_add_u32 m0, s52, 110592
    s_add_u32 s49, s54, 55680
    buffer_load_dwordx4 v1, s[8:11], s49 offen lds
    s_waitcnt lgkmcnt(2)
    v_mfma_f32_16x16x32_bf16 v[72:75], a[0:3], v[20:23], 0
    ds_read_b128 v[16:19], v3 offset:40960
    v_mfma_f32_16x16x32_bf16 v[76:79], a[4:7], v[20:23], 0
    s_add_u32 m0, s52, 111616
    s_add_u32 s49, s54, 55680
    buffer_load_dwordx4 v2, s[8:11], s49 offen lds
    s_waitcnt lgkmcnt(2)
    v_mfma_f32_16x16x32_bf16 v[64:67], a[8:11], v[24:27], v[64:67]
    ds_read_b128 v[20:23], v3 offset:43008
    v_mfma_f32_16x16x32_bf16 v[68:71], a[12:15], v[24:27], v[68:71]
    s_waitcnt lgkmcnt(2)
    v_mfma_f32_16x16x32_bf16 v[72:75], a[8:11], v[28:31], v[72:75]
    ds_read_b128 v[24:27], v6 offset:40960
    v_mfma_f32_16x16x32_bf16 v[76:79], a[12:15], v[28:31], v[76:79]
    s_waitcnt lgkmcnt(2)
    v_mfma_f32_16x16x32_bf16 v[64:67], a[16:19], v[16:19], v[64:67]
    ds_read_b128 v[28:31], v6 offset:43008
    v_mfma_f32_16x16x32_bf16 v[68:71], a[20:23], v[16:19], v[68:71]
    s_waitcnt lgkmcnt(2)
    v_mfma_f32_16x16x32_bf16 v[72:75], a[16:19], v[20:23], v[72:75]
    ds_read_b128 v[16:19], v3 offset:55296
    v_mfma_f32_16x16x32_bf16 v[76:79], a[20:23], v[20:23], v[76:79]
    s_waitcnt lgkmcnt(2)
    v_mfma_f32_16x16x32_bf16 v[64:67], a[24:27], v[24:27], v[64:67]
    ds_read_b128 v[20:23], v3 offset:57344
    v_mfma_f32_16x16x32_bf16 v[68:71], a[28:31], v[24:27], v[68:71]
    s_waitcnt lgkmcnt(2)
    v_mfma_f32_16x16x32_bf16 v[72:75], a[24:27], v[28:31], v[72:75]
    v_mfma_f32_16x16x32_bf16 v[76:79], a[28:31], v[28:31], v[76:79]
    s_waitcnt vmcnt(9)
    s_barrier
    s_waitcnt lgkmcnt(1)
    v_mfma_f32_16x16x32_bf16 v[64:67], a[32:35], v[16:19], v[64:67]
    ds_read_b128 v[24:27], v6 offset:55296
    ds_read_b128 v[28:31], v6 offset:57344
    v_mfma_f32_16x16x32_bf16 v[68:71], a[36:39], v[16:19], v[68:71]
    s_add_u32 m0, s52, 36864
    s_add_u32 s49, s54, 55936
    buffer_load_dwordx4 v1, s[8:11], s49 offen lds
    s_waitcnt lgkmcnt(2)
    v_mfma_f32_16x16x32_bf16 v[72:75], a[32:35], v[20:23], v[72:75]
    ds_read_b128 v[16:19], v3 offset:59392
    v_mfma_f32_16x16x32_bf16 v[76:79], a[36:39], v[20:23], v[76:79]
    s_add_u32 m0, s52, 37888
    s_add_u32 s49, s54, 55936
    buffer_load_dwordx4 v2, s[8:11], s49 offen lds
    s_waitcnt lgkmcnt(2)
    v_mfma_f32_16x16x32_bf16 v[64:67], a[40:43], v[24:27], v[64:67]
    ds_read_b128 v[20:23], v3 offset:61440
    v_mfma_f32_16x16x32_bf16 v[68:71], a[44:47], v[24:27], v[68:71]
    s_waitcnt lgkmcnt(2)
    v_mfma_f32_16x16x32_bf16 v[72:75], a[40:43], v[28:31], v[72:75]
    ds_read_b128 v[24:27], v6 offset:59392
    v_mfma_f32_16x16x32_bf16 v[76:79], a[44:47], v[28:31], v[76:79]
    s_waitcnt lgkmcnt(2)
    v_mfma_f32_16x16x32_bf16 v[64:67], a[48:51], v[16:19], v[64:67]
    ds_read_b128 v[28:31], v6 offset:61440
    v_mfma_f32_16x16x32_bf16 v[68:71], a[52:55], v[16:19], v[68:71]
    s_waitcnt lgkmcnt(2)
    v_mfma_f32_16x16x32_bf16 v[72:75], a[48:51], v[20:23], v[72:75]
    ds_read_b128 v[16:19], v4 offset:8192
    v_mfma_f32_16x16x32_bf16 v[76:79], a[52:55], v[20:23], v[76:79]
    s_waitcnt lgkmcnt(2)
    v_mfma_f32_16x16x32_bf16 v[64:67], a[56:59], v[24:27], v[64:67]
    ds_read_b128 v[20:23], v4 offset:10240
    v_mfma_f32_16x16x32_bf16 v[68:71], a[60:63], v[24:27], v[68:71]
    s_waitcnt lgkmcnt(2)
    v_mfma_f32_16x16x32_bf16 v[72:75], a[56:59], v[28:31], v[72:75]
    v_mfma_f32_16x16x32_bf16 v[76:79], a[60:63], v[28:31], v[76:79]
    s_waitcnt vmcnt(8)
    s_barrier
    s_waitcnt lgkmcnt(1)
    v_mfma_f32_16x16x32_bf16 v[64:67], a[64:67], v[16:19], v[64:67]
    ds_read_b128 v[24:27], v7 offset:8192
    ds_read_b128 v[28:31], v7 offset:10240
    v_mfma_f32_16x16x32_bf16 v[68:71], a[68:71], v[16:19], v[68:71]
    s_add_u32 m0, s52, 55296
    s_add_u32 s49, s54, 56192
    buffer_load_dwordx4 v1, s[8:11], s49 offen lds
    s_waitcnt lgkmcnt(2)
    v_mfma_f32_16x16x32_bf16 v[72:75], a[64:67], v[20:23], v[72:75]
    ds_read_b128 v[16:19], v4 offset:12288
    v_mfma_f32_16x16x32_bf16 v[76:79], a[68:71], v[20:23], v[76:79]
    s_add_u32 m0, s52, 56320
    s_add_u32 s49, s54, 56192
    buffer_load_dwordx4 v2, s[8:11], s49 offen lds
    s_waitcnt lgkmcnt(2)
    v_mfma_f32_16x16x32_bf16 v[64:67], a[72:75], v[24:27], v[64:67]
    ds_read_b128 v[20:23], v4 offset:14336
    v_mfma_f32_16x16x32_bf16 v[68:71], a[76:79], v[24:27], v[68:71]
    s_waitcnt lgkmcnt(2)
    v_mfma_f32_16x16x32_bf16 v[72:75], a[72:75], v[28:31], v[72:75]
    ds_read_b128 v[24:27], v7 offset:12288
    v_mfma_f32_16x16x32_bf16 v[76:79], a[76:79], v[28:31], v[76:79]
    s_waitcnt lgkmcnt(2)
    v_mfma_f32_16x16x32_bf16 v[64:67], a[80:83], v[16:19], v[64:67]
    ds_read_b128 v[28:31], v7 offset:14336
    v_mfma_f32_16x16x32_bf16 v[68:71], a[84:87], v[16:19], v[68:71]
    s_waitcnt lgkmcnt(2)
    v_mfma_f32_16x16x32_bf16 v[72:75], a[80:83], v[20:23], v[72:75]
    ds_read_b128 v[16:19], v3 offset:0
    v_mfma_f32_16x16x32_bf16 v[76:79], a[84:87], v[20:23], v[76:79]
    s_waitcnt lgkmcnt(2)
    v_mfma_f32_16x16x32_bf16 v[64:67], a[88:91], v[24:27], v[64:67]
    ds_read_b128 v[20:23], v3 offset:2048
    v_mfma_f32_16x16x32_bf16 v[68:71], a[92:95], v[24:27], v[68:71]
    s_waitcnt lgkmcnt(2)
    v_mfma_f32_16x16x32_bf16 v[72:75], a[88:91], v[28:31], v[72:75]
    v_mfma_f32_16x16x32_bf16 v[76:79], a[92:95], v[28:31], v[76:79]
    s_waitcnt vmcnt(8)
    s_barrier
    s_waitcnt lgkmcnt(1)
    v_mfma_f32_16x16x32_bf16 v[64:67], a[96:99], v[16:19], v[64:67]
    ds_read_b128 v[24:27], v6 offset:0
    ds_read_b128 v[28:31], v6 offset:2048
    v_mfma_f32_16x16x32_bf16 v[68:71], a[100:103], v[16:19], v[68:71]
    s_add_u32 m0, s52, 73728
    s_add_u32 s49, s58, 0
    buffer_load_dwordx4 v1, s[8:11], s49 offen lds
    s_waitcnt lgkmcnt(2)
    v_mfma_f32_16x16x32_bf16 v[72:75], a[96:99], v[20:23], v[72:75]
    ds_read_b128 v[16:19], v3 offset:4096
    v_mfma_f32_16x16x32_bf16 v[76:79], a[100:103], v[20:23], v[76:79]
    s_add_u32 m0, s52, 74752
    s_add_u32 s49, s58, 0
    buffer_load_dwordx4 v2, s[8:11], s49 offen lds
    s_waitcnt lgkmcnt(2)
    v_mfma_f32_16x16x32_bf16 v[64:67], a[104:107], v[24:27], v[64:67]
    ds_read_b128 v[20:23], v3 offset:6144
    v_mfma_f32_16x16x32_bf16 v[68:71], a[108:111], v[24:27], v[68:71]
    s_waitcnt lgkmcnt(2)
    v_mfma_f32_16x16x32_bf16 v[72:75], a[104:107], v[28:31], v[72:75]
    ds_read_b128 v[24:27], v6 offset:4096
    v_mfma_f32_16x16x32_bf16 v[76:79], a[108:111], v[28:31], v[76:79]
    s_waitcnt lgkmcnt(2)
    v_mfma_f32_16x16x32_bf16 v[64:67], a[112:115], v[16:19], v[64:67]
    ds_read_b128 v[28:31], v6 offset:6144
    v_mfma_f32_16x16x32_bf16 v[68:71], a[116:119], v[16:19], v[68:71]
    s_waitcnt lgkmcnt(2)
    v_mfma_f32_16x16x32_bf16 v[72:75], a[112:115], v[20:23], v[72:75]
    ds_read_b128 v[16:19], v4 offset:26624
    v_mfma_f32_16x16x32_bf16 v[76:79], a[116:119], v[20:23], v[76:79]
    s_waitcnt lgkmcnt(2)
    v_mfma_f32_16x16x32_bf16 v[64:67], a[120:123], v[24:27], v[64:67]
    ds_read_b128 v[20:23], v4 offset:28672
    v_mfma_f32_16x16x32_bf16 v[68:71], a[124:127], v[24:27], v[68:71]
    s_waitcnt lgkmcnt(2)
    v_mfma_f32_16x16x32_bf16 v[72:75], a[120:123], v[28:31], v[72:75]
    v_mfma_f32_16x16x32_bf16 v[76:79], a[124:127], v[28:31], v[76:79]
    s_waitcnt vmcnt(8)
    s_barrier
    s_waitcnt lgkmcnt(1)
    v_mfma_f32_16x16x32_bf16 v[64:67], a[128:131], v[16:19], v[64:67]
    ds_read_b128 v[24:27], v7 offset:26624
    ds_read_b128 v[28:31], v7 offset:28672
    v_mfma_f32_16x16x32_bf16 v[68:71], a[132:135], v[16:19], v[68:71]
    s_add_u32 m0, s52, 0
    s_add_u32 s49, s58, 512
    buffer_load_dwordx4 v1, s[8:11], s49 offen lds
    s_waitcnt lgkmcnt(2)
    v_mfma_f32_16x16x32_bf16 v[72:75], a[128:131], v[20:23], v[72:75]
    ds_read_b128 v[16:19], v4 offset:30720
    v_mfma_f32_16x16x32_bf16 v[76:79], a[132:135], v[20:23], v[76:79]
    s_add_u32 m0, s52, 1024
    s_add_u32 s49, s58, 512
    buffer_load_dwordx4 v2, s[8:11], s49 offen lds
    s_waitcnt lgkmcnt(2)
    v_mfma_f32_16x16x32_bf16 v[64:67], a[136:139], v[24:27], v[64:67]
    ds_read_b128 v[20:23], v4 offset:32768
    v_mfma_f32_16x16x32_bf16 v[68:71], a[140:143], v[24:27], v[68:71]
    s_waitcnt lgkmcnt(2)
    v_mfma_f32_16x16x32_bf16 v[72:75], a[136:139], v[28:31], v[72:75]
    ds_read_b128 v[24:27], v7 offset:30720
    v_mfma_f32_16x16x32_bf16 v[76:79], a[140:143], v[28:31], v[76:79]
    s_waitcnt lgkmcnt(2)
    v_mfma_f32_16x16x32_bf16 v[80:83], a[0:3], v[16:19], 0
    ds_read_b128 v[28:31], v7 offset:32768
    v_mfma_f32_16x16x32_bf16 v[84:87], a[4:7], v[16:19], 0
    s_waitcnt lgkmcnt(2)
    v_mfma_f32_16x16x32_bf16 v[88:91], a[0:3], v[20:23], 0
    ds_read_b128 v[16:19], v3 offset:18432
    v_mfma_f32_16x16x32_bf16 v[92:95], a[4:7], v[20:23], 0
    s_waitcnt lgkmcnt(2)
    v_mfma_f32_16x16x32_bf16 v[80:83], a[8:11], v[24:27], v[80:83]
    ds_read_b128 v[20:23], v3 offset:20480
    v_mfma_f32_16x16x32_bf16 v[84:87], a[12:15], v[24:27], v[84:87]
    s_waitcnt lgkmcnt(2)
    v_mfma_f32_16x16x32_bf16 v[88:91], a[8:11], v[28:31], v[88:91]
    v_mfma_f32_16x16x32_bf16 v[92:95], a[12:15], v[28:31], v[92:95]
    s_waitcnt vmcnt(8)
    s_barrier
    s_waitcnt lgkmcnt(1)
    v_mfma_f32_16x16x32_bf16 v[80:83], a[16:19], v[16:19], v[80:83]
    ds_read_b128 v[24:27], v6 offset:18432
    ds_read_b128 v[28:31], v6 offset:20480
    v_mfma_f32_16x16x32_bf16 v[84:87], a[20:23], v[16:19], v[84:87]
    s_add_u32 m0, s52, 92160
    s_add_u32 s49, s58, 1024
    buffer_load_dwordx4 v1, s[8:11], s49 offen lds
    s_waitcnt lgkmcnt(2)
    v_mfma_f32_16x16x32_bf16 v[88:91], a[16:19], v[20:23], v[88:91]
    ds_read_b128 v[16:19], v3 offset:22528
    v_mfma_f32_16x16x32_bf16 v[92:95], a[20:23], v[20:23], v[92:95]
    s_add_u32 m0, s52, 93184
    s_add_u32 s49, s58, 1024
    buffer_load_dwordx4 v2, s[8:11], s49 offen lds
    s_waitcnt lgkmcnt(2)
    v_mfma_f32_16x16x32_bf16 v[80:83], a[24:27], v[24:27], v[80:83]
    ds_read_b128 v[20:23], v3 offset:24576
    v_mfma_f32_16x16x32_bf16 v[84:87], a[28:31], v[24:27], v[84:87]
    s_waitcnt lgkmcnt(2)
    v_mfma_f32_16x16x32_bf16 v[88:91], a[24:27], v[28:31], v[88:91]
    ds_read_b128 v[24:27], v6 offset:22528
    v_mfma_f32_16x16x32_bf16 v[92:95], a[28:31], v[28:31], v[92:95]
    s_waitcnt lgkmcnt(2)
    v_mfma_f32_16x16x32_bf16 v[80:83], a[32:35], v[16:19], v[80:83]
    ds_read_b128 v[28:31], v6 offset:24576
    v_mfma_f32_16x16x32_bf16 v[84:87], a[36:39], v[16:19], v[84:87]
    s_waitcnt lgkmcnt(2)
    v_mfma_f32_16x16x32_bf16 v[88:91], a[32:35], v[20:23], v[88:91]
    ds_read_b128 v[16:19], v4 offset:45056
    v_mfma_f32_16x16x32_bf16 v[92:95], a[36:39], v[20:23], v[92:95]
    s_waitcnt lgkmcnt(2)
    v_mfma_f32_16x16x32_bf16 v[80:83], a[40:43], v[24:27], v[80:83]
    ds_read_b128 v[20:23], v4 offset:47104
    v_mfma_f32_16x16x32_bf16 v[84:87], a[44:47], v[24:27], v[84:87]
    s_waitcnt lgkmcnt(2)
    v_mfma_f32_16x16x32_bf16 v[88:91], a[40:43], v[28:31], v[88:91]
    v_mfma_f32_16x16x32_bf16 v[92:95], a[44:47], v[28:31], v[92:95]
    s_waitcnt vmcnt(8)
    s_barrier
    s_waitcnt lgkmcnt(1)
    v_mfma_f32_16x16x32_bf16 v[80:83], a[48:51], v[16:19], v[80:83]
    ds_read_b128 v[24:27], v7 offset:45056
    ds_read_b128 v[28:31], v7 offset:47104
    v_mfma_f32_16x16x32_bf16 v[84:87], a[52:55], v[16:19], v[84:87]
    s_add_u32 m0, s52, 18432
    s_add_u32 s49, s59, s84
    buffer_load_dwordx4 v1, s[20:23], s49 offen lds
    s_waitcnt lgkmcnt(2)
    v_mfma_f32_16x16x32_bf16 v[88:91], a[48:51], v[20:23], v[88:91]
    ds_read_b128 v[16:19], v4 offset:49152
    v_mfma_f32_16x16x32_bf16 v[92:95], a[52:55], v[20:23], v[92:95]
    s_add_u32 m0, s52, 19456
    s_add_u32 s49, s59, s84
    buffer_load_dwordx4 v2, s[20:23], s49 offen lds
    s_waitcnt lgkmcnt(2)
    v_mfma_f32_16x16x32_bf16 v[80:83], a[56:59], v[24:27], v[80:83]
    ds_read_b128 v[20:23], v4 offset:51200
    v_mfma_f32_16x16x32_bf16 v[84:87], a[60:63], v[24:27], v[84:87]
    s_add_u32 m0, s53, 18432
    s_add_u32 s49, s60, s84
    s_mov_b64 exec, 0xffff
    buffer_load_dwordx4 v15, s[20:23], s49 offen lds
    s_mov_b64 exec, -1
    s_waitcnt lgkmcnt(2)
    v_mfma_f32_16x16x32_bf16 v[88:91], a[56:59], v[28:31], v[88:91]
    ds_read_b128 v[24:27], v7 offset:49152
    v_mfma_f32_16x16x32_bf16 v[92:95], a[60:63], v[28:31], v[92:95]
    s_waitcnt lgkmcnt(2)
    v_mfma_f32_16x16x32_bf16 v[80:83], a[64:67], v[16:19], v[80:83]
    ds_read_b128 v[28:31], v7 offset:51200
    v_mfma_f32_16x16x32_bf16 v[84:87], a[68:71], v[16:19], v[84:87]
    s_waitcnt lgkmcnt(2)
    v_mfma_f32_16x16x32_bf16 v[88:91], a[64:67], v[20:23], v[88:91]
    ds_read_b128 v[16:19], v3 offset:36864
    v_mfma_f32_16x16x32_bf16 v[92:95], a[68:71], v[20:23], v[92:95]
    s_waitcnt lgkmcnt(2)
    v_mfma_f32_16x16x32_bf16 v[80:83], a[72:75], v[24:27], v[80:83]
    ds_read_b128 v[20:23], v3 offset:38912
    v_mfma_f32_16x16x32_bf16 v[84:87], a[76:79], v[24:27], v[84:87]
    s_waitcnt lgkmcnt(2)
    v_mfma_f32_16x16x32_bf16 v[88:91], a[72:75], v[28:31], v[88:91]
    v_mfma_f32_16x16x32_bf16 v[92:95], a[76:79], v[28:31], v[92:95]
    s_waitcnt vmcnt(9)
    s_barrier
    s_waitcnt lgkmcnt(1)
    v_mfma_f32_16x16x32_bf16 v[80:83], a[80:83], v[16:19], v[80:83]
    ds_read_b128 v[24:27], v6 offset:36864
    ds_read_b128 v[28:31], v6 offset:38912
    v_mfma_f32_16x16x32_bf16 v[84:87], a[84:87], v[16:19], v[84:87]
    s_waitcnt lgkmcnt(2)
    v_mfma_f32_16x16x32_bf16 v[88:91], a[80:83], v[20:23], v[88:91]
    ds_read_b128 v[16:19], v3 offset:40960
    v_mfma_f32_16x16x32_bf16 v[92:95], a[84:87], v[20:23], v[92:95]
    s_waitcnt lgkmcnt(2)
    v_mfma_f32_16x16x32_bf16 v[80:83], a[88:91], v[24:27], v[80:83]
    ds_read_b128 v[20:23], v3 offset:43008
    v_mfma_f32_16x16x32_bf16 v[84:87], a[92:95], v[24:27], v[84:87]
    s_waitcnt lgkmcnt(2)
    v_mfma_f32_16x16x32_bf16 v[88:91], a[88:91], v[28:31], v[88:91]
    ds_read_b128 v[24:27], v6 offset:40960
    v_mfma_f32_16x16x32_bf16 v[92:95], a[92:95], v[28:31], v[92:95]
    s_waitcnt lgkmcnt(2)
    v_mfma_f32_16x16x32_bf16 v[80:83], a[96:99], v[16:19], v[80:83]
    ds_read_b128 v[28:31], v6 offset:43008
    v_mfma_f32_16x16x32_bf16 v[84:87], a[100:103], v[16:19], v[84:87]
    s_waitcnt lgkmcnt(2)
    v_mfma_f32_16x16x32_bf16 v[88:91], a[96:99], v[20:23], v[88:91]
    ds_read_b128 v[16:19], v3 offset:55296
    v_mfma_f32_16x16x32_bf16 v[92:95], a[100:103], v[20:23], v[92:95]
    s_waitcnt lgkmcnt(2)
    v_mfma_f32_16x16x32_bf16 v[80:83], a[104:107], v[24:27], v[80:83]
    ds_read_b128 v[20:23], v3 offset:57344
    v_mfma_f32_16x16x32_bf16 v[84:87], a[108:111], v[24:27], v[84:87]
    s_waitcnt lgkmcnt(2)
    v_mfma_f32_16x16x32_bf16 v[88:91], a[104:107], v[28:31], v[88:91]
    v_mfma_f32_16x16x32_bf16 v[92:95], a[108:111], v[28:31], v[92:95]
    s_waitcnt vmcnt(7)
    s_barrier
    s_waitcnt lgkmcnt(1)
    v_mfma_f32_16x16x32_bf16 v[80:83], a[112:115], v[16:19], v[80:83]
    ds_read_b128 v[24:27], v6 offset:55296
    ds_read_b128 v[28:31], v6 offset:57344
    v_mfma_f32_16x16x32_bf16 v[84:87], a[116:119], v[16:19], v[84:87]
    s_add_u32 m0, s52, 36864
    s_add_u32 s49, s59, s84
    buffer_load_dwordx4 v1, s[24:27], s49 offen lds
    s_waitcnt lgkmcnt(2)
    v_mfma_f32_16x16x32_bf16 v[88:91], a[112:115], v[20:23], v[88:91]
    ds_read_b128 v[16:19], v3 offset:59392
    v_mfma_f32_16x16x32_bf16 v[92:95], a[116:119], v[20:23], v[92:95]
    s_add_u32 m0, s52, 37888
    s_add_u32 s49, s59, s84
    buffer_load_dwordx4 v2, s[24:27], s49 offen lds
    s_waitcnt lgkmcnt(2)
    v_mfma_f32_16x16x32_bf16 v[80:83], a[120:123], v[24:27], v[80:83]
    ds_read_b128 v[20:23], v3 offset:61440
    v_mfma_f32_16x16x32_bf16 v[84:87], a[124:127], v[24:27], v[84:87]
    s_add_u32 m0, s53, 36864
    s_add_u32 s49, s60, s84
    s_mov_b64 exec, 0xffff
    buffer_load_dwordx4 v15, s[24:27], s49 offen lds
    s_mov_b64 exec, -1
    s_waitcnt lgkmcnt(2)
    v_mfma_f32_16x16x32_bf16 v[88:91], a[120:123], v[28:31], v[88:91]
    ds_read_b128 v[24:27], v6 offset:59392
    v_mfma_f32_16x16x32_bf16 v[92:95], a[124:127], v[28:31], v[92:95]
    s_waitcnt lgkmcnt(2)
    v_mfma_f32_16x16x32_bf16 v[80:83], a[128:131], v[16:19], v[80:83]
    ds_read_b128 v[28:31], v6 offset:61440
    v_mfma_f32_16x16x32_bf16 v[84:87], a[132:135], v[16:19], v[84:87]
    s_waitcnt lgkmcnt(2)
    v_mfma_f32_16x16x32_bf16 v[88:91], a[128:131], v[20:23], v[88:91]
    v_mfma_f32_16x16x32_bf16 v[92:95], a[132:135], v[20:23], v[92:95]
    s_waitcnt lgkmcnt(1)
    v_mfma_f32_16x16x32_bf16 v[80:83], a[136:139], v[24:27], v[80:83]
    v_mfma_f32_16x16x32_bf16 v[84:87], a[140:143], v[24:27], v[84:87]
    s_waitcnt lgkmcnt(0)
    v_mfma_f32_16x16x32_bf16 v[88:91], a[136:139], v[28:31], v[88:91]
    v_mfma_f32_16x16x32_bf16 v[92:95], a[140:143], v[28:31], v[92:95]
    s_waitcnt vmcnt(8)
    s_barrier
    s_add_u32 s50, s57, 12
    buffer_load_ubyte v8, v12, s[28:31], s50 offen sc0 sc1
    s_cmp_lg_u32 s46, 0
    s_cbranch_scc1 .varB_51
    ds_read_b128 v[16:19], v4 offset:8192
    ds_read_b128 v[20:23], v4 offset:10240
    ds_read_b128 v[24:27], v7 offset:8192
    s_waitcnt lgkmcnt(2)
    v_mfma_f32_16x16x32_bf16 v[96:99], a[0:3], v[16:19], 0
    ds_read_b128 v[28:31], v7 offset:10240
    v_mfma_f32_16x16x32_bf16 v[100:103], a[4:7], v[16:19], 0
    s_waitcnt lgkmcnt(2)
    v_mfma_f32_16x16x32_bf16 v[104:107], a[0:3], v[20:23], 0
    ds_read_b128 v[16:19], v4 offset:12288
    v_mfma_f32_16x16x32_bf16 v[108:111], a[4:7], v[20:23], 0
    s_waitcnt lgkmcnt(2)
    v_mfma_f32_16x16x32_bf16 v[96:99], a[8:11], v[24:27], v[96:99]
    ds_read_b128 v[20:23], v4 offset:14336
    v_mfma_f32_16x16x32_bf16 v[100:103], a[12:15], v[24:27], v[100:103]
    s_waitcnt lgkmcnt(2)
    v_mfma_f32_16x16x32_bf16 v[104:107], a[8:11], v[28:31], v[104:107]
    ds_read_b128 v[24:27], v7 offset:12288
    v_mfma_f32_16x16x32_bf16 v[108:111], a[12:15], v[28:31], v[108:111]
    s_waitcnt lgkmcnt(2)
    v_mfma_f32_16x16x32_bf16 v[96:99], a[16:19], v[16:19], v[96:99]
    ds_read_b128 v[28:31], v7 offset:14336
    v_mfma_f32_16x16x32_bf16 v[100:103], a[20:23], v[16:19], v[100:103]
    s_waitcnt lgkmcnt(2)
    v_mfma_f32_16x16x32_bf16 v[104:107], a[16:19], v[20:23], v[104:107]
    ds_read_b128 v[16:19], v4 offset:16384
    v_mfma_f32_16x16x32_bf16 v[108:111], a[20:23], v[20:23], v[108:111]
    s_waitcnt lgkmcnt(2)
    v_mfma_f32_16x16x32_bf16 v[96:99], a[24:27], v[24:27], v[96:99]
    ds_read_b128 v[20:23], v4 offset:18432
    v_mfma_f32_16x16x32_bf16 v[100:103], a[28:31], v[24:27], v[100:103]
    s_waitcnt lgkmcnt(2)
    v_mfma_f32_16x16x32_bf16 v[104:107], a[24:27], v[28:31], v[104:107]
    ds_read_b128 v[24:27], v7 offset:16384
    v_mfma_f32_16x16x32_bf16 v[108:111], a[28:31], v[28:31], v[108:111]
    s_waitcnt lgkmcnt(2)
    v_mfma_f32_16x16x32_bf16 v[96:99], a[32:35], v[16:19], v[96:99]
    ds_read_b128 v[28:31], v7 offset:18432
    v_mfma_f32_16x16x32_bf16 v[100:103], a[36:39], v[16:19], v[100:103]
    s_waitcnt lgkmcnt(2)
    v_mfma_f32_16x16x32_bf16 v[104:107], a[32:35], v[20:23], v[104:107]
    ds_read_b128 v[16:19], v4 offset:20480
    v_mfma_f32_16x16x32_bf16 v[108:111], a[36:39], v[20:23], v[108:111]
    s_waitcnt lgkmcnt(2)
    v_mfma_f32_16x16x32_bf16 v[96:99], a[40:43], v[24:27], v[96:99]
    ds_read_b128 v[20:23], v4 offset:22528
    v_mfma_f32_16x16x32_bf16 v[100:103], a[44:47], v[24:27], v[100:103]
    s_waitcnt lgkmcnt(2)
    v_mfma_f32_16x16x32_bf16 v[104:107], a[40:43], v[28:31], v[104:107]
    ds_read_b128 v[24:27], v7 offset:20480
    v_mfma_f32_16x16x32_bf16 v[108:111], a[44:47], v[28:31], v[108:111]
    s_waitcnt lgkmcnt(2)
    v_mfma_f32_16x16x32_bf16 v[96:99], a[48:51], v[16:19], v[96:99]
    ds_read_b128 v[28:31], v7 offset:22528
    v_mfma_f32_16x16x32_bf16 v[100:103], a[52:55], v[16:19], v[100:103]
    s_waitcnt lgkmcnt(2)
    v_mfma_f32_16x16x32_bf16 v[104:107], a[48:51], v[20:23], v[104:107]
    ds_read_b128 v[16:19], v3 offset:0
    v_mfma_f32_16x16x32_bf16 v[108:111], a[52:55], v[20:23], v[108:111]
    s_waitcnt lgkmcnt(2)
    v_mfma_f32_16x16x32_bf16 v[96:99], a[56:59], v[24:27], v[96:99]
    ds_read_b128 v[20:23], v3 offset:2048
    v_mfma_f32_16x16x32_bf16 v[100:103], a[60:63], v[24:27], v[100:103]
    s_waitcnt lgkmcnt(2)
    v_mfma_f32_16x16x32_bf16 v[104:107], a[56:59], v[28:31], v[104:107]
    v_mfma_f32_16x16x32_bf16 v[108:111], a[60:63], v[28:31], v[108:111]
    s_waitcnt vmcnt(7)
    s_barrier
    s_waitcnt lgkmcnt(1)
    v_mfma_f32_16x16x32_bf16 v[96:99], a[64:67], v[16:19], v[96:99]
    ds_read_b128 v[24:27], v6 offset:0
    ds_read_b128 v[28:31], v6 offset:2048
    v_mfma_f32_16x16x32_bf16 v[100:103], a[68:71], v[16:19], v[100:103]
    s_waitcnt lgkmcnt(2)
    v_mfma_f32_16x16x32_bf16 v[104:107], a[64:67], v[20:23], v[104:107]
    ds_read_b128 v[16:19], v3 offset:4096
    v_mfma_f32_16x16x32_bf16 v[108:111], a[68:71], v[20:23], v[108:111]
    s_waitcnt lgkmcnt(2)
    v_mfma_f32_16x16x32_bf16 v[96:99], a[72:75], v[24:27], v[96:99]
    ds_read_b128 v[20:23], v3 offset:6144
    v_mfma_f32_16x16x32_bf16 v[100:103], a[76:79], v[24:27], v[100:103]
    s_waitcnt lgkmcnt(2)
    v_mfma_f32_16x16x32_bf16 v[104:107], a[72:75], v[28:31], v[104:107]
    ds_read_b128 v[24:27], v6 offset:4096
    v_mfma_f32_16x16x32_bf16 v[108:111], a[76:79], v[28:31], v[108:111]
    s_waitcnt lgkmcnt(2)
    v_mfma_f32_16x16x32_bf16 v[96:99], a[80:83], v[16:19], v[96:99]
    ds_read_b128 v[28:31], v6 offset:6144
    v_mfma_f32_16x16x32_bf16 v[100:103], a[84:87], v[16:19], v[100:103]
    s_waitcnt lgkmcnt(2)
    v_mfma_f32_16x16x32_bf16 v[104:107], a[80:83], v[20:23], v[104:107]
    ds_read_b128 v[16:19], v3 offset:8192
    v_mfma_f32_16x16x32_bf16 v[108:111], a[84:87], v[20:23], v[108:111]
    s_waitcnt lgkmcnt(2)
    v_mfma_f32_16x16x32_bf16 v[96:99], a[88:91], v[24:27], v[96:99]
    ds_read_b128 v[20:23], v3 offset:10240
    v_mfma_f32_16x16x32_bf16 v[100:103], a[92:95], v[24:27], v[100:103]
    s_waitcnt lgkmcnt(2)
    v_mfma_f32_16x16x32_bf16 v[104:107], a[88:91], v[28:31], v[104:107]
    ds_read_b128 v[24:27], v6 offset:8192
    v_mfma_f32_16x16x32_bf16 v[108:111], a[92:95], v[28:31], v[108:111]
    s_waitcnt lgkmcnt(2)
    v_mfma_f32_16x16x32_bf16 v[96:99], a[96:99], v[16:19], v[96:99]
    ds_read_b128 v[28:31], v6 offset:10240
    v_mfma_f32_16x16x32_bf16 v[100:103], a[100:103], v[16:19], v[100:103]
    s_waitcnt lgkmcnt(2)
    v_mfma_f32_16x16x32_bf16 v[104:107], a[96:99], v[20:23], v[104:107]
    ds_read_b128 v[16:19], v3 offset:12288
    v_mfma_f32_16x16x32_bf16 v[108:111], a[100:103], v[20:23], v[108:111]
    s_waitcnt lgkmcnt(2)
    v_mfma_f32_16x16x32_bf16 v[96:99], a[104:107], v[24:27], v[96:99]
    ds_read_b128 v[20:23], v3 offset:14336
    v_mfma_f32_16x16x32_bf16 v[100:103], a[108:111], v[24:27], v[100:103]
    s_waitcnt lgkmcnt(2)
    v_mfma_f32_16x16x32_bf16 v[104:107], a[104:107], v[28:31], v[104:107]
    ds_read_b128 v[24:27], v6 offset:12288
    v_mfma_f32_16x16x32_bf16 v[108:111], a[108:111], v[28:31], v[108:111]
    s_waitcnt lgkmcnt(2)
    v_mfma_f32_16x16x32_bf16 v[96:99], a[112:115], v[16:19], v[96:99]
    ds_read_b128 v[28:31], v6 offset:14336
    v_mfma_f32_16x16x32_bf16 v[100:103], a[116:119], v[16:19], v[100:103]
    s_waitcnt lgkmcnt(2)
    v_mfma_f32_16x16x32_bf16 v[104:107], a[112:115], v[20:23], v[104:107]
    ds_read_b128 v[16:19], v4 offset:26624
    v_mfma_f32_16x16x32_bf16 v[108:111], a[116:119], v[20:23], v[108:111]
    s_waitcnt lgkmcnt(2)
    v_mfma_f32_16x16x32_bf16 v[96:99], a[120:123], v[24:27], v[96:99]
    ds_read_b128 v[20:23], v4 offset:28672
    v_mfma_f32_16x16x32_bf16 v[100:103], a[124:127], v[24:27], v[100:103]
    s_waitcnt lgkmcnt(2)
    v_mfma_f32_16x16x32_bf16 v[104:107], a[120:123], v[28:31], v[104:107]
    v_mfma_f32_16x16x32_bf16 v[108:111], a[124:127], v[28:31], v[108:111]
    s_barrier
    s_waitcnt lgkmcnt(1)
    v_mfma_f32_16x16x32_bf16 v[96:99], a[128:131], v[16:19], v[96:99]
    ds_read_b128 v[24:27], v7 offset:26624
    ds_read_b128 v[28:31], v7 offset:28672
    v_mfma_f32_16x16x32_bf16 v[100:103], a[132:135], v[16:19], v[100:103]
    s_add_u32 m0, s52, 0
    s_add_u32 s49, s59, s85
    buffer_load_dwordx4 v1, s[20:23], s49 offen lds
    s_waitcnt lgkmcnt(2)
    v_mfma_f32_16x16x32_bf16 v[104:107], a[128:131], v[20:23], v[104:107]
    v_mfma_f32_16x16x32_bf16 v[108:111], a[132:135], v[20:23], v[108:111]
    s_add_u32 m0, s52, 1024
    s_add_u32 s49, s59, s85
    buffer_load_dwordx4 v2, s[20:23], s49 offen lds
    s_waitcnt lgkmcnt(1)
    v_mfma_f32_16x16x32_bf16 v[96:99], a[136:139], v[24:27], v[96:99]
    v_mfma_f32_16x16x32_bf16 v[100:103], a[140:143], v[24:27], v[100:103]
    s_add_u32 m0, s53, 0
    s_add_u32 s49, s60, s85
    s_mov_b64 exec, 0xffff
    buffer_load_dwordx4 v15, s[20:23], s49 offen lds
    s_mov_b64 exec, -1
    s_waitcnt lgkmcnt(0)
    v_mfma_f32_16x16x32_bf16 v[104:107], a[136:139], v[28:31], v[104:107]
    v_mfma_f32_16x16x32_bf16 v[108:111], a[140:143], v[28:31], v[108:111]
    s_barrier
    ds_read_b64 v[24:25], v14 offset:0
    ds_read_b64 v[26:27], v14 offset:512
    s_waitcnt lgkmcnt(0)
    v_fma_f32 v18, v24, v32, v33
    v_fma_f32 v19, v24, v40, v41
    v_fma_f32 v18, -v25, v40, v18
    v_fma_f32 v19, v25, v32, v19
    v_fma_f32 v22, v26, v48, v49
    v_fma_f32 v23, v26, v56, v57
    v_fma_f32 v22, -v27, v56, v22
    v_fma_f32 v23, v27, v48, v23
    v_fma_f32 v16, v24, v18, v34
    v_fma_f32 v17, v24, v19, v42
    v_fma_f32 v16, -v25, v19, v16
    v_fma_f32 v17, v25, v18, v17
    v_fma_f32 v20, v26, v22, v50
    v_fma_f32 v21, v26, v23, v58
    v_fma_f32 v20, -v27, v23, v20
    v_fma_f32 v21, v27, v22, v21
    v_fma_f32 v18, v24, v16, v35
    v_fma_f32 v19, v24, v17, v43
    v_fma_f32 v18, -v25, v17, v18
    v_fma_f32 v19, v25, v16, v19
    v_fma_f32 v22, v26, v20, v51
    v_fma_f32 v23, v26, v21, v59
    v_fma_f32 v22, -v27, v21, v22
    v_fma_f32 v23, v27, v20, v23
    v_fma_f32 v16, v24, v18, v36
    v_fma_f32 v17, v24, v19, v44
    v_fma_f32 v16, -v25, v19, v16
    v_fma_f32 v17, v25, v18, v17
    v_fma_f32 v20, v26, v22, v52
    v_fma_f32 v21, v26, v23, v60
    v_fma_f32 v20, -v27, v23, v20
    v_fma_f32 v21, v27, v22, v21
    v_fma_f32 v18, v24, v16, v37
    v_fma_f32 v19, v24, v17, v45
    v_fma_f32 v18, -v25, v17, v18
    v_fma_f32 v19, v25, v16, v19
    v_fma_f32 v22, v26, v20, v53
    v_fma_f32 v23, v26, v21, v61
    v_fma_f32 v22, -v27, v21, v22
    v_fma_f32 v23, v27, v20, v23
    v_fma_f32 v16, v24, v18, v38
    v_fma_f32 v17, v24, v19, v46
    v_fma_f32 v16, -v25, v19, v16
    v_fma_f32 v17, v25, v18, v17
    v_fma_f32 v20, v26, v22, v54
    v_fma_f32 v21, v26, v23, v62
    v_fma_f32 v20, -v27, v23, v20
    v_fma_f32 v21, v27, v22, v21
    v_fma_f32 v18, v24, v16, v39
    v_fma_f32 v19, v24, v17, v47
    v_fma_f32 v18, -v25, v17, v18
    v_fma_f32 v19, v25, v16, v19
    v_fma_f32 v22, v26, v20, v55
    v_fma_f32 v23, v26, v21, v63
    v_fma_f32 v22, -v27, v21, v22
    v_fma_f32 v23, v27, v20, v23
    ds_write_b64 v13, v[18:19] offset:0
    ds_write_b64 v13, v[22:23] offset:128
    ds_read_b64 v[28:29], v14 offset:1024
    ds_read_b64 v[30:31], v14 offset:1536
    s_waitcnt lgkmcnt(0)
    v_fma_f32 v18, v28, v64, v65
    v_fma_f32 v19, v28, v72, v73
    v_fma_f32 v18, -v29, v72, v18
    v_fma_f32 v19, v29, v64, v19
    v_fma_f32 v22, v30, v80, v81
    v_fma_f32 v23, v30, v88, v89
    v_fma_f32 v22, -v31, v88, v22
    v_fma_f32 v23, v31, v80, v23
    v_fma_f32 v16, v28, v18, v66
    v_fma_f32 v17, v28, v19, v74
    v_fma_f32 v16, -v29, v19, v16
    v_fma_f32 v17, v29, v18, v17
    v_fma_f32 v20, v30, v22, v82
    v_fma_f32 v21, v30, v23, v90
    v_fma_f32 v20, -v31, v23, v20
    v_fma_f32 v21, v31, v22, v21
    v_fma_f32 v18, v28, v16, v67
    v_fma_f32 v19, v28, v17, v75
    v_fma_f32 v18, -v29, v17, v18
    v_fma_f32 v19, v29, v16, v19
    v_fma_f32 v22, v30, v20, v83
    v_fma_f32 v23, v30, v21, v91
    v_fma_f32 v22, -v31, v21, v22
    v_fma_f32 v23, v31, v20, v23
    v_fma_f32 v16, v28, v18, v68
    v_fma_f32 v17, v28, v19, v76
    v_fma_f32 v16, -v29, v19, v16
    v_fma_f32 v17, v29, v18, v17
    v_fma_f32 v20, v30, v22, v84
    v_fma_f32 v21, v30, v23, v92
    v_fma_f32 v20, -v31, v23, v20
    v_fma_f32 v21, v31, v22, v21
    v_fma_f32 v18, v28, v16, v69
    v_fma_f32 v19, v28, v17, v77
    v_fma_f32 v18, -v29, v17, v18
    v_fma_f32 v19, v29, v16, v19
    v_fma_f32 v22, v30, v20, v85
    v_fma_f32 v23, v30, v21, v93
    v_fma_f32 v22, -v31, v21, v22
    v_fma_f32 v23, v31, v20, v23
    v_fma_f32 v16, v28, v18, v70
    v_fma_f32 v17, v28, v19, v78
    v_fma_f32 v16, -v29, v19, v16
    v_fma_f32 v17, v29, v18, v17
    v_fma_f32 v20, v30, v22, v86
    v_fma_f32 v21, v30, v23, v94
    v_fma_f32 v20, -v31, v23, v20
    v_fma_f32 v21, v31, v22, v21
    v_fma_f32 v18, v28, v16, v71
    v_fma_f32 v19, v28, v17, v79
    v_fma_f32 v18, -v29, v17, v18
    v_fma_f32 v19, v29, v16, v19
    v_fma_f32 v22, v30, v20, v87
    v_fma_f32 v23, v30, v21, v95
    v_fma_f32 v22, -v31, v21, v22
    v_fma_f32 v23, v31, v20, v23
    ds_write_b64 v13, v[18:19] offset:256
    ds_write_b64 v13, v[22:23] offset:384
    s_waitcnt lgkmcnt(0)
    ds_read_b64 v[24:25], v14 offset:4096
    s_waitcnt lgkmcnt(0)
    v_fma_f32 v18, v24, v96, v97
    v_fma_f32 v19, v24, v104, v105
    v_fma_f32 v18, -v25, v104, v18
    v_fma_f32 v19, v25, v96, v19
    v_fma_f32 v16, v24, v18, v98
    v_fma_f32 v17, v24, v19, v106
    v_fma_f32 v16, -v25, v19, v16
    v_fma_f32 v17, v25, v18, v17
    v_fma_f32 v18, v24, v16, v99
    v_fma_f32 v19, v24, v17, v107
    v_fma_f32 v18, -v25, v17, v18
    v_fma_f32 v19, v25, v16, v19
    v_fma_f32 v16, v24, v18, v100
    v_fma_f32 v17, v24, v19, v108
    v_fma_f32 v16, -v25, v19, v16
    v_fma_f32 v17, v25, v18, v17
    v_fma_f32 v18, v24, v16, v101
    v_fma_f32 v19, v24, v17, v109
    v_fma_f32 v18, -v25, v17, v18
    v_fma_f32 v19, v25, v16, v19
    v_fma_f32 v16, v24, v18, v102
    v_fma_f32 v17, v24, v19, v110
    v_fma_f32 v16, -v25, v19, v16
    v_fma_f32 v17, v25, v18, v17
    v_fma_f32 v18, v24, v16, v103
    v_fma_f32 v19, v24, v17, v111
    v_fma_f32 v18, -v25, v17, v18
    v_fma_f32 v19, v25, v16, v19
    ds_write_b64 v13, v[18:19] offset:1024
    s_waitcnt lgkmcnt(0)
    s_branch .join_52
.varB_51:
    s_nop 7
    ds_read_b64 v[96:97], v14 offset:0
    ds_read_b64 v[98:99], v14 offset:512
    ds_read_b64 v[100:101], v14 offset:1024
    ds_read_b64 v[102:103], v14 offset:1536
    s_waitcnt lgkmcnt(0)
    v_fma_f32 v18, v96, v32, v33
    v_fma_f32 v19, v96, v40, v41
    v_fma_f32 v18, -v97, v40, v18
    v_fma_f32 v19, v97, v32, v19
    v_fma_f32 v22, v98, v48, v49
    v_fma_f32 v23, v98, v56, v57
    v_fma_f32 v22, -v99, v56, v22
    v_fma_f32 v23, v99, v48, v23
    v_fma_f32 v26, v100, v64, v65
    v_fma_f32 v27, v100, v72, v73
    v_fma_f32 v26, -v101, v72, v26
    v_fma_f32 v27, v101, v64, v27
    v_fma_f32 v30, v102, v80, v81
    v_fma_f32 v31, v102, v88, v89
    v_fma_f32 v30, -v103, v88, v30
    v_fma_f32 v31, v103, v80, v31
    v_fma_f32 v16, v96, v18, v34
    v_fma_f32 v17, v96, v19, v42
    v_fma_f32 v16, -v97, v19, v16
    v_fma_f32 v17, v97, v18, v17
    v_fma_f32 v20, v98, v22, v50
    v_fma_f32 v21, v98, v23, v58
    v_fma_f32 v20, -v99, v23, v20
    v_fma_f32 v21, v99, v22, v21
    v_fma_f32 v24, v100, v26, v66
    v_fma_f32 v25, v100, v27, v74
    v_fma_f32 v24, -v101, v27, v24
    v_fma_f32 v25, v101, v26, v25
    v_fma_f32 v28, v102, v30, v82
    v_fma_f32 v29, v102, v31, v90
    v_fma_f32 v28, -v103, v31, v28
    v_fma_f32 v29, v103, v30, v29
    v_fma_f32 v18, v96, v16, v35
    v_fma_f32 v19, v96, v17, v43
    v_fma_f32 v18, -v97, v17, v18
    v_fma_f32 v19, v97, v16, v19
    v_fma_f32 v22, v98, v20, v51
    v_fma_f32 v23, v98, v21, v59
    v_fma_f32 v22, -v99, v21, v22
    v_fma_f32 v23, v99, v20, v23
    v_fma_f32 v26, v100, v24, v67
    v_fma_f32 v27, v100, v25, v75
    v_fma_f32 v26, -v101, v25, v26
    v_fma_f32 v27, v101, v24, v27
    v_fma_f32 v30, v102, v28, v83
    v_fma_f32 v31, v102, v29, v91
    v_fma_f32 v30, -v103, v29, v30
    v_fma_f32 v31, v103, v28, v31
    v_fma_f32 v16, v96, v18, v36
    v_fma_f32 v17, v96, v19, v44
    v_fma_f32 v16, -v97, v19, v16
    v_fma_f32 v17, v97, v18, v17
    v_fma_f32 v20, v98, v22, v52
    v_fma_f32 v21, v98, v23, v60
    v_fma_f32 v20, -v99, v23, v20
    v_fma_f32 v21, v99, v22, v21
    v_fma_f32 v24, v100, v26, v68
    v_fma_f32 v25, v100, v27, v76
    v_fma_f32 v24, -v101, v27, v24
    v_fma_f32 v25, v101, v26, v25
    v_fma_f32 v28, v102, v30, v84
    v_fma_f32 v29, v102, v31, v92
    v_fma_f32 v28, -v103, v31, v28
    v_fma_f32 v29, v103, v30, v29
    v_fma_f32 v18, v96, v16, v37
    v_fma_f32 v19, v96, v17, v45
    v_fma_f32 v18, -v97, v17, v18
    v_fma_f32 v19, v97, v16, v19
    v_fma_f32 v22, v98, v20, v53
    v_fma_f32 v23, v98, v21, v61
    v_fma_f32 v22, -v99, v21, v22
    v_fma_f32 v23, v99, v20, v23
    v_fma_f32 v26, v100, v24, v69
    v_fma_f32 v27, v100, v25, v77
    v_fma_f32 v26, -v101, v25, v26
    v_fma_f32 v27, v101, v24, v27
    v_fma_f32 v30, v102, v28, v85
    v_fma_f32 v31, v102, v29, v93
    v_fma_f32 v30, -v103, v29, v30
    v_fma_f32 v31, v103, v28, v31
    v_fma_f32 v16, v96, v18, v38
    v_fma_f32 v17, v96, v19, v46
    v_fma_f32 v16, -v97, v19, v16
    v_fma_f32 v17, v97, v18, v17
    v_fma_f32 v20, v98, v22, v54
    v_fma_f32 v21, v98, v23, v62
    v_fma_f32 v20, -v99, v23, v20
    v_fma_f32 v21, v99, v22, v21
    v_fma_f32 v24, v100, v26, v70
    v_fma_f32 v25, v100, v27, v78
    v_fma_f32 v24, -v101, v27, v24
    v_fma_f32 v25, v101, v26, v25
    v_fma_f32 v28, v102, v30, v86
    v_fma_f32 v29, v102, v31, v94
    v_fma_f32 v28, -v103, v31, v28
    v_fma_f32 v29, v103, v30, v29
    v_fma_f32 v18, v96, v16, v39
    v_fma_f32 v19, v96, v17, v47
    v_fma_f32 v18, -v97, v17, v18
    v_fma_f32 v19, v97, v16, v19
    v_fma_f32 v22, v98, v20, v55
    v_fma_f32 v23, v98, v21, v63
    v_fma_f32 v22, -v99, v21, v22
    v_fma_f32 v23, v99, v20, v23
    v_fma_f32 v26, v100, v24, v71
    v_fma_f32 v27, v100, v25, v79
    v_fma_f32 v26, -v101, v25, v26
    v_fma_f32 v27, v101, v24, v27
    v_fma_f32 v30, v102, v28, v87
    v_fma_f32 v31, v102, v29, v95
    v_fma_f32 v30, -v103, v29, v30
    v_fma_f32 v31, v103, v28, v31
    ds_write_b64 v13, v[18:19] offset:0
    ds_write_b64 v13, v[22:23] offset:128
    ds_write_b64 v13, v[26:27] offset:256
    ds_write_b64 v13, v[30:31] offset:384
    s_waitcnt lgkmcnt(0)
    s_waitcnt vmcnt(7)
    s_barrier
    s_barrier
    s_add_u32 m0, s52, 0
    s_add_u32 s49, s59, s85
    buffer_load_dwordx4 v1, s[20:23], s49 offen lds
    s_add_u32 m0, s52, 1024
    s_add_u32 s49, s59, s85
    buffer_load_dwordx4 v2, s[20:23], s49 offen lds
    s_add_u32 m0, s53, 0
    s_add_u32 s49, s60, s85
    s_mov_b64 exec, 0xffff
    buffer_load_dwordx4 v15, s[20:23], s49 offen lds
    s_mov_b64 exec, -1
    s_barrier
.join_52:
    s_lshl_b32 s41, s47, 4
    s_cmp_eq_u32 s44, 0
    s_cselect_b64 exec, 1, 0

    buffer_load_dwordx4 v[16:19], off, s[28:31], s41 sc0 sc1
    s_mov_b64 exec, -1
    s_barrier
    s_barrier
    s_waitcnt vmcnt(0)
    s_cmp_lg_u32 s44, 0
    s_cbranch_scc1 .mk_53
    s_mov_b32 s82, 20000

.mc_54:
    v_readfirstlane_b32 s36, v16
    v_readfirstlane_b32 s37, v17
    v_readfirstlane_b32 s38, v18
    v_readfirstlane_b32 s39, v19
    s_and_b32 s40, s36, s37
    s_or_b32 s36, s36, s37
    s_and_b32 s37, s38, s39
    s_or_b32 s38, s38, s39
    s_and_b32 s40, s40, s37
    s_or_b32 s36, s36, s38
    s_and_b32 s37, s40, 0x80808080
    s_cmp_eq_u32 s37, 0x80808080
    s_cbranch_scc1 .mo_55
    s_sub_u32 s82, s82, 1
    s_cmp_lt_i32 s82, 1
    s_cbranch_scc1 .mo_55
    s_sleep 2
    s_mov_b64 exec, 1
    buffer_load_dwordx4 v[16:19], off, s[28:31], s41 sc0 sc1
    s_mov_b64 exec, -1
    s_waitcnt vmcnt(0)
    s_branch .mc_54

.mo_55:
    s_mul_i32 s37, s93, 0x01010101
    s_xor_b32 s36, s36, s37
    s_xor_b32 s40, s40, s37
    s_or_b32 s36, s36, s40
    s_cmp_eq_u32 s36, 0
    s_cselect_b32 s36, 1, 0
    v_mov_b32 v16, s36
    v_mov_b32 v17, 155648
    ds_write_b32 v17, v16
    s_waitcnt lgkmcnt(0)

.mk_53:
    s_cmp_lt_u32 s44, 4
    s_cbranch_scc1 .nc_56
    s_cmp_eq_u32 s44, 7
    s_cbranch_scc1 .nc_56
    v_lshrrev_b32 v9, 4, v12
    v_cmp_gt_u32 s[80:81], s47, v9
    s_waitcnt vmcnt(4)
    v_cmp_eq_u32 vcc, 0, v8
    s_and_b64 s[62:63], vcc, s[80:81]
    s_lshl_b32 s49, s45, 6
    v_add_u32 v9, s49, v9
    v_min_u32 v9, 143, v9
    v_lshlrev_b32 v10, 5, v9
    v_lshlrev_b32 v9, 3, v9
    v_add_u32 v10, 147456, v10
    v_add_u32 v0, 129024, v9
    ds_read_b64 v[4:5], v10 offset:16

    ds_read_b64 v[16:17], v0 offset:0
    ds_read_b64 v[18:19], v0 offset:1152
    ds_read_b64 v[20:21], v0 offset:2304
    ds_read_b64 v[22:23], v0 offset:3456
    ds_read_b64 v[24:25], v0 offset:4608
    ds_read_b64 v[26:27], v0 offset:5760
    ds_read_b64 v[28:29], v0 offset:6912
    ds_read_b64 v[30:31], v0 offset:8064
    ds_read_b64 v[96:97], v0 offset:9216
    ds_read_b64 v[98:99], v0 offset:10368
    ds_read_b64 v[100:101], v0 offset:11520
    ds_read_b64 v[102:103], v0 offset:12672
    ds_read_b64 v[104:105], v0 offset:13824
    ds_read_b64 v[106:107], v0 offset:14976
    ds_read_b64 v[108:109], v0 offset:16128
    ds_read_b64 v[110:111], v0 offset:17280
    s_waitcnt lgkmcnt(0)
    v_fma_f32 v6, v4, v16, v18
    v_fma_f32 v7, v4, v17, v19
    v_fma_f32 v6, -v5, v17, v6
    v_fma_f32 v7, v5, v16, v7
    v_fma_f32 v10, v4, v6, v20
    v_fma_f32 v11, v4, v7, v21
    v_fma_f32 v10, -v5, v7, v10
    v_fma_f32 v11, v5, v6, v11
    v_fma_f32 v6, v4, v10, v22
    v_fma_f32 v7, v4, v11, v23
    v_fma_f32 v6, -v5, v11, v6
    v_fma_f32 v7, v5, v10, v7
    v_fma_f32 v10, v4, v6, v24
    v_fma_f32 v11, v4, v7, v25
    v_fma_f32 v10, -v5, v7, v10
    v_fma_f32 v11, v5, v6, v11
    v_fma_f32 v6, v4, v10, v26
    v_fma_f32 v7, v4, v11, v27
    v_fma_f32 v6, -v5, v11, v6
    v_fma_f32 v7, v5, v10, v7
    v_fma_f32 v10, v4, v6, v28
    v_fma_f32 v11, v4, v7, v29
    v_fma_f32 v10, -v5, v7, v10
    v_fma_f32 v11, v5, v6, v11
    v_fma_f32 v6, v4, v10, v30
    v_fma_f32 v7, v4, v11, v31
    v_fma_f32 v6, -v5, v11, v6
    v_fma_f32 v7, v5, v10, v7
    v_fma_f32 v10, v4, v6, v96
    v_fma_f32 v11, v4, v7, v97
    v_fma_f32 v10, -v5, v7, v10
    v_fma_f32 v11, v5, v6, v11
    v_fma_f32 v6, v4, v10, v98
    v_fma_f32 v7, v4, v11, v99
    v_fma_f32 v6, -v5, v11, v6
    v_fma_f32 v7, v5, v10, v7
    v_fma_f32 v10, v4, v6, v100
    v_fma_f32 v11, v4, v7, v101
    v_fma_f32 v10, -v5, v7, v10
    v_fma_f32 v11, v5, v6, v11
    v_fma_f32 v6, v4, v10, v102
    v_fma_f32 v7, v4, v11, v103
    v_fma_f32 v6, -v5, v11, v6
    v_fma_f32 v7, v5, v10, v7
    v_fma_f32 v10, v4, v6, v104
    v_fma_f32 v11, v4, v7, v105
    v_fma_f32 v10, -v5, v7, v10
    v_fma_f32 v11, v5, v6, v11
    v_fma_f32 v6, v4, v10, v106
    v_fma_f32 v7, v4, v11, v107
    v_fma_f32 v6, -v5, v11, v6
    v_fma_f32 v7, v5, v10, v7
    v_fma_f32 v10, v4, v6, v108
    v_fma_f32 v11, v4, v7, v109
    v_fma_f32 v10, -v5, v7, v10
    v_fma_f32 v11, v5, v6, v11
    v_fma_f32 v6, v4, v10, v110
    v_fma_f32 v7, v4, v11, v111
    v_fma_f32 v6, -v5, v11, v6
    v_fma_f32 v7, v5, v10, v7
    s_lshl_b32 s49, s57, 4
    s_add_u32 s49, s49, s47
    s_mul_i32 s49, s49, 1152
    s_add_u32 s49, s49, 38797312
    buffer_store_dwordx2 v[6:7], v9, s[16:19], s49 offen sc0 sc1

    v_mul_f32 v10, v4, v4
    v_mul_f32 v11, v4, v5
    v_fma_f32 v10, -v5, v5, v10
    v_add_f32 v11, v11, v11

    v_mul_f32 v8, v11, v11
    v_mul_f32 v11, v10, v11
    v_fma_f32 v10, v10, v10, -v8
    v_add_f32 v11, v11, v11

    v_mul_f32 v8, v11, v11
    v_mul_f32 v11, v10, v11
    v_fma_f32 v10, v10, v10, -v8
    v_add_f32 v11, v11, v11

    v_mul_f32 v8, v11, v11
    v_mul_f32 v11, v10, v11
    v_fma_f32 v10, v10, v10, -v8
    v_add_f32 v11, v11, v11

    v_accvgpr_write_b32 a40, v1
    v_accvgpr_write_b32 a41, v2
    v_accvgpr_write_b32 a42, v3
    v_accvgpr_write_b32 a43, v14
    v_accvgpr_write_b32 a44, v15
    s_mov_b32 s82, 20000
    s_add_u32 s50, s57, 12
    s_mul_i32 s49, s57, 18432
    s_add_u32 s49, s49, 38797312
    s_add_u32 s32, s16, s49
    s_addc_u32 s33, s17, 0
    s_mul_i32 s34, s47, 1152
    s_cmp_eq_u64 s[62:63], 0
    s_cbranch_scc1 .go_58

.poll_57:
    buffer_load_ubyte v8, v12, s[28:31], s50 offen sc0 sc1
    s_waitcnt vmcnt(0)
    v_cmp_eq_u32 vcc, 0, v8
    s_and_b64 vcc, vcc, s[80:81]
    s_cbranch_vccz .go_58
    s_sub_u32 s82, s82, 1
    s_cmp_lt_i32 s82, 1
    s_cbranch_scc1 .go_58
    s_sleep 1
    s_branch .poll_57

.go_58:
    s_mov_b32 s82, 8000
.el_59:
    v_add_u32 v6, s34, v9
    v_subrev_u32 v7, 1152, v6
    buffer_load_dwordx2 a[0:1], v7, s[32:35], 0 offen sc0 sc1
    v_subrev_u32 v6, 1152, v7
    buffer_load_dwordx2 a[2:3], v6, s[32:35], 0 offen sc0 sc1
    v_subrev_u32 v7, 1152, v6
    buffer_load_dwordx2 a[4:5], v7, s[32:35], 0 offen sc0 sc1
    v_subrev_u32 v6, 1152, v7
    buffer_load_dwordx2 a[6:7], v6, s[32:35], 0 offen sc0 sc1
    v_subrev_u32 v7, 1152, v6
    buffer_load_dwordx2 a[8:9], v7, s[32:35], 0 offen sc0 sc1
    v_subrev_u32 v6, 1152, v7
    buffer_load_dwordx2 a[10:11], v6, s[32:35], 0 offen sc0 sc1
    v_subrev_u32 v7, 1152, v6
    buffer_load_dwordx2 a[12:13], v7, s[32:35], 0 offen sc0 sc1
    v_subrev_u32 v6, 1152, v7
    buffer_load_dwordx2 a[14:15], v6, s[32:35], 0 offen sc0 sc1
    v_subrev_u32 v7, 1152, v6
    buffer_load_dwordx2 a[16:17], v7, s[32:35], 0 offen sc0 sc1
    v_subrev_u32 v6, 1152, v7
    buffer_load_dwordx2 a[18:19], v6, s[32:35], 0 offen sc0 sc1
    v_subrev_u32 v7, 1152, v6
    buffer_load_dwordx2 a[20:21], v7, s[32:35], 0 offen sc0 sc1
    v_subrev_u32 v6, 1152, v7
    buffer_load_dwordx2 a[22:23], v6, s[32:35], 0 offen sc0 sc1
    v_subrev_u32 v7, 1152, v6
    buffer_load_dwordx2 a[24:25], v7, s[32:35], 0 offen sc0 sc1
    v_subrev_u32 v6, 1152, v7
    buffer_load_dwordx2 a[26:27], v6, s[32:35], 0 offen sc0 sc1
    v_subrev_u32 v7, 1152, v6
    buffer_load_dwordx2 a[28:29], v7, s[32:35], 0 offen sc0 sc1
    s_waitcnt vmcnt(0)
    v_accvgpr_read_b32 v6, a28
    v_accvgpr_read_b32 v7, a29
    v_accvgpr_read_b32 v14, a26
    v_accvgpr_read_b32 v15, a27
    v_fma_f32 v2, v10, v6, v14
    v_fma_f32 v3, v10, v7, v15
    v_fma_f32 v2, -v11, v7, v2
    v_fma_f32 v3, v11, v6, v3
    v_accvgpr_read_b32 v14, a24
    v_accvgpr_read_b32 v15, a25
    v_fma_f32 v6, v10, v2, v14
    v_fma_f32 v7, v10, v3, v15
    v_fma_f32 v6, -v11, v3, v6
    v_fma_f32 v7, v11, v2, v7
    v_accvgpr_read_b32 v14, a22
    v_accvgpr_read_b32 v15, a23
    v_fma_f32 v2, v10, v6, v14
    v_fma_f32 v3, v10, v7, v15
    v_fma_f32 v2, -v11, v7, v2
    v_fma_f32 v3, v11, v6, v3
    v_accvgpr_read_b32 v14, a20
    v_accvgpr_read_b32 v15, a21
    v_fma_f32 v6, v10, v2, v14
    v_fma_f32 v7, v10, v3, v15
    v_fma_f32 v6, -v11, v3, v6
    v_fma_f32 v7, v11, v2, v7
    v_accvgpr_read_b32 v14, a18
    v_accvgpr_read_b32 v15, a19
    v_fma_f32 v2, v10, v6, v14
    v_fma_f32 v3, v10, v7, v15
    v_fma_f32 v2, -v11, v7, v2
    v_fma_f32 v3, v11, v6, v3
    v_accvgpr_read_b32 v14, a16
    v_accvgpr_read_b32 v15, a17
    v_fma_f32 v6, v10, v2, v14
    v_fma_f32 v7, v10, v3, v15
    v_fma_f32 v6, -v11, v3, v6
    v_fma_f32 v7, v11, v2, v7
    v_accvgpr_read_b32 v14, a14
    v_accvgpr_read_b32 v15, a15
    v_fma_f32 v2, v10, v6, v14
    v_fma_f32 v3, v10, v7, v15
    v_fma_f32 v2, -v11, v7, v2
    v_fma_f32 v3, v11, v6, v3
    v_accvgpr_read_b32 v14, a12
    v_accvgpr_read_b32 v15, a13
    v_fma_f32 v6, v10, v2, v14
    v_fma_f32 v7, v10, v3, v15
    v_fma_f32 v6, -v11, v3, v6
    v_fma_f32 v7, v11, v2, v7
    v_accvgpr_read_b32 v14, a10
    v_accvgpr_read_b32 v15, a11
    v_fma_f32 v2, v10, v6, v14
    v_fma_f32 v3, v10, v7, v15
    v_fma_f32 v2, -v11, v7, v2
    v_fma_f32 v3, v11, v6, v3
    v_accvgpr_read_b32 v14, a8
    v_accvgpr_read_b32 v15, a9
    v_fma_f32 v6, v10, v2, v14
    v_fma_f32 v7, v10, v3, v15
    v_fma_f32 v6, -v11, v3, v6
    v_fma_f32 v7, v11, v2, v7
    v_accvgpr_read_b32 v14, a6
    v_accvgpr_read_b32 v15, a7
    v_fma_f32 v2, v10, v6, v14
    v_fma_f32 v3, v10, v7, v15
    v_fma_f32 v2, -v11, v7, v2
    v_fma_f32 v3, v11, v6, v3
    v_accvgpr_read_b32 v14, a4
    v_accvgpr_read_b32 v15, a5
    v_fma_f32 v6, v10, v2, v14
    v_fma_f32 v7, v10, v3, v15
    v_fma_f32 v6, -v11, v3, v6
    v_fma_f32 v7, v11, v2, v7
    v_accvgpr_read_b32 v14, a2
    v_accvgpr_read_b32 v15, a3
    v_fma_f32 v2, v10, v6, v14
    v_fma_f32 v3, v10, v7, v15
    v_fma_f32 v2, -v11, v7, v2
    v_fma_f32 v3, v11, v6, v3
    v_accvgpr_read_b32 v14, a0
    v_accvgpr_read_b32 v15, a1
    v_fma_f32 v6, v10, v2, v14
    v_fma_f32 v7, v10, v3, v15
    v_fma_f32 v6, -v11, v3, v6
    v_fma_f32 v7, v11, v2, v7
    v_cmp_u_f32 vcc, v6, v7
    s_cbranch_vccz .eok_60
    s_sub_u32 s82, s82, 1
    s_cmp_lt_i32 s82, 1
    s_cbranch_scc0 .el_59

.eok_60:
    ds_write_b64 v0, v[6:7] offset:0
    v_fma_f32 v2, v4, v6, v16
    v_fma_f32 v3, v4, v7, v17
    v_fma_f32 v2, -v5, v7, v2
    v_fma_f32 v3, v5, v6, v3
    ds_write_b64 v0, v[2:3] offset:1152
    v_fma_f32 v14, v4, v2, v18
    v_fma_f32 v15, v4, v3, v19
    v_fma_f32 v14, -v5, v3, v14
    v_fma_f32 v15, v5, v2, v15
    ds_write_b64 v0, v[14:15] offset:2304
    v_fma_f32 v6, v4, v14, v20
    v_fma_f32 v7, v4, v15, v21
    v_fma_f32 v6, -v5, v15, v6
    v_fma_f32 v7, v5, v14, v7
    ds_write_b64 v0, v[6:7] offset:3456
    v_fma_f32 v2, v4, v6, v22
    v_fma_f32 v3, v4, v7, v23
    v_fma_f32 v2, -v5, v7, v2
    v_fma_f32 v3, v5, v6, v3
    ds_write_b64 v0, v[2:3] offset:4608
    v_fma_f32 v14, v4, v2, v24
    v_fma_f32 v15, v4, v3, v25
    v_fma_f32 v14, -v5, v3, v14
    v_fma_f32 v15, v5, v2, v15
    ds_write_b64 v0, v[14:15] offset:5760
    v_fma_f32 v6, v4, v14, v26
    v_fma_f32 v7, v4, v15, v27
    v_fma_f32 v6, -v5, v15, v6
    v_fma_f32 v7, v5, v14, v7
    ds_write_b64 v0, v[6:7] offset:6912
    v_fma_f32 v2, v4, v6, v28
    v_fma_f32 v3, v4, v7, v29
    v_fma_f32 v2, -v5, v7, v2
    v_fma_f32 v3, v5, v6, v3
    ds_write_b64 v0, v[2:3] offset:8064
    v_fma_f32 v14, v4, v2, v30
    v_fma_f32 v15, v4, v3, v31
    v_fma_f32 v14, -v5, v3, v14
    v_fma_f32 v15, v5, v2, v15
    ds_write_b64 v0, v[14:15] offset:9216
    v_fma_f32 v6, v4, v14, v96
    v_fma_f32 v7, v4, v15, v97
    v_fma_f32 v6, -v5, v15, v6
    v_fma_f32 v7, v5, v14, v7
    ds_write_b64 v0, v[6:7] offset:10368
    v_fma_f32 v2, v4, v6, v98
    v_fma_f32 v3, v4, v7, v99
    v_fma_f32 v2, -v5, v7, v2
    v_fma_f32 v3, v5, v6, v3
    ds_write_b64 v0, v[2:3] offset:11520
    v_fma_f32 v14, v4, v2, v100
    v_fma_f32 v15, v4, v3, v101
    v_fma_f32 v14, -v5, v3, v14
    v_fma_f32 v15, v5, v2, v15
    ds_write_b64 v0, v[14:15] offset:12672
    v_fma_f32 v6, v4, v14, v102
    v_fma_f32 v7, v4, v15, v103
    v_fma_f32 v6, -v5, v15, v6
    v_fma_f32 v7, v5, v14, v7
    ds_write_b64 v0, v[6:7] offset:13824
    v_fma_f32 v2, v4, v6, v104
    v_fma_f32 v3, v4, v7, v105
    v_fma_f32 v2, -v5, v7, v2
    v_fma_f32 v3, v5, v6, v3
    ds_write_b64 v0, v[2:3] offset:14976
    v_fma_f32 v14, v4, v2, v106
    v_fma_f32 v15, v4, v3, v107
    v_fma_f32 v14, -v5, v3, v14
    v_fma_f32 v15, v5, v2, v15
    ds_write_b64 v0, v[14:15] offset:16128
    v_fma_f32 v6, v4, v14, v108
    v_fma_f32 v7, v4, v15, v109
    v_fma_f32 v6, -v5, v15, v6
    v_fma_f32 v7, v5, v14, v7
    ds_write_b64 v0, v[6:7] offset:17280
    s_waitcnt lgkmcnt(0)
    v_accvgpr_read_b32 v1, a40
    v_accvgpr_read_b32 v2, a41
    v_accvgpr_read_b32 v3, a42
    v_accvgpr_read_b32 v14, a43
    v_accvgpr_read_b32 v15, a44
.nc_56:
    s_waitcnt vmcnt(0) lgkmcnt(0)
    s_barrier
    v_lshrrev_b32 v16, 4, v12
    v_and_b32 v17, 15, v16
    v_lshlrev_b32 v17, 6, v17
    v_bfe_u32 v18, v16, 2, 2
    v_lshrrev_b32 v19, 4, v16
    v_xor_b32 v18, v18, v19
    v_lshl_add_u32 v17, v18, 4, v17
    s_mul_i32 s49, s45, 18432
    s_lshl_b32 s50, s46, 12
    s_add_u32 s49, s49, s50
    s_add_u32 s49, s49, 55296
    v_add_u32 v9, s49, v17

    ds_read_b64 v[16:17], v13 offset:0
    ds_read_b128 v[20:23], v14 offset:0
    ds_read_b64 v[24:25], v13 offset:128
    ds_read_b128 v[28:31], v14 offset:512
    s_waitcnt lgkmcnt(0)
    v_fma_f32 v18, v20, v16, v32
    v_fma_f32 v19, v20, v17, v40
    v_fma_f32 v18, -v21, v17, v18
    v_fma_f32 v19, v21, v16, v19
    v_mul_f32 v32, v22, v18
    v_mul_f32 v40, v22, v19
    v_fma_f32 v32, -v23, v19, v32
    v_fma_f32 v40, -v23, v18, -v40
    v_fma_f32 v26, v28, v24, v48
    v_fma_f32 v27, v28, v25, v56
    v_fma_f32 v26, -v29, v25, v26
    v_fma_f32 v27, v29, v24, v27
    v_mul_f32 v48, v30, v26
    v_mul_f32 v56, v30, v27
    v_fma_f32 v48, -v31, v27, v48
    v_fma_f32 v56, -v31, v26, -v56
    v_fma_f32 v16, v20, v18, v33
    v_fma_f32 v17, v20, v19, v41
    v_fma_f32 v16, -v21, v19, v16
    v_fma_f32 v17, v21, v18, v17
    v_mul_f32 v33, v22, v16
    v_mul_f32 v41, v22, v17
    v_fma_f32 v33, -v23, v17, v33
    v_fma_f32 v41, -v23, v16, -v41
    v_fma_f32 v24, v28, v26, v49
    v_fma_f32 v25, v28, v27, v57
    v_fma_f32 v24, -v29, v27, v24
    v_fma_f32 v25, v29, v26, v25
    v_mul_f32 v49, v30, v24
    v_mul_f32 v57, v30, v25
    v_fma_f32 v49, -v31, v25, v49
    v_fma_f32 v57, -v31, v24, -v57
    v_fma_f32 v18, v20, v16, v34
    v_fma_f32 v19, v20, v17, v42
    v_fma_f32 v18, -v21, v17, v18
    v_fma_f32 v19, v21, v16, v19
    v_mul_f32 v34, v22, v18
    v_mul_f32 v42, v22, v19
    v_fma_f32 v34, -v23, v19, v34
    v_fma_f32 v42, -v23, v18, -v42
    v_fma_f32 v26, v28, v24, v50
    v_fma_f32 v27, v28, v25, v58
    v_fma_f32 v26, -v29, v25, v26
    v_fma_f32 v27, v29, v24, v27
    v_mul_f32 v50, v30, v26
    v_mul_f32 v58, v30, v27
    v_fma_f32 v50, -v31, v27, v50
    v_fma_f32 v58, -v31, v26, -v58
    v_fma_f32 v16, v20, v18, v35
    v_fma_f32 v17, v20, v19, v43
    v_fma_f32 v16, -v21, v19, v16
    v_fma_f32 v17, v21, v18, v17
    v_mul_f32 v35, v22, v16
    v_mul_f32 v43, v22, v17
    v_fma_f32 v35, -v23, v17, v35
    v_fma_f32 v43, -v23, v16, -v43
    v_fma_f32 v24, v28, v26, v51
    v_fma_f32 v25, v28, v27, v59
    v_fma_f32 v24, -v29, v27, v24
    v_fma_f32 v25, v29, v26, v25
    v_mul_f32 v51, v30, v24
    v_mul_f32 v59, v30, v25
    v_fma_f32 v51, -v31, v25, v51
    v_fma_f32 v59, -v31, v24, -v59
    v_fma_f32 v18, v20, v16, v36
    v_fma_f32 v19, v20, v17, v44
    v_fma_f32 v18, -v21, v17, v18
    v_fma_f32 v19, v21, v16, v19
    v_mul_f32 v36, v22, v18
    v_mul_f32 v44, v22, v19
    v_fma_f32 v36, -v23, v19, v36
    v_fma_f32 v44, -v23, v18, -v44
    v_fma_f32 v26, v28, v24, v52
    v_fma_f32 v27, v28, v25, v60
    v_fma_f32 v26, -v29, v25, v26
    v_fma_f32 v27, v29, v24, v27
    v_mul_f32 v52, v30, v26
    v_mul_f32 v60, v30, v27
    v_fma_f32 v52, -v31, v27, v52
    v_fma_f32 v60, -v31, v26, -v60
    v_fma_f32 v16, v20, v18, v37
    v_fma_f32 v17, v20, v19, v45
    v_fma_f32 v16, -v21, v19, v16
    v_fma_f32 v17, v21, v18, v17
    v_mul_f32 v37, v22, v16
    v_mul_f32 v45, v22, v17
    v_fma_f32 v37, -v23, v17, v37
    v_fma_f32 v45, -v23, v16, -v45
    v_fma_f32 v24, v28, v26, v53
    v_fma_f32 v25, v28, v27, v61
    v_fma_f32 v24, -v29, v27, v24
    v_fma_f32 v25, v29, v26, v25
    v_mul_f32 v53, v30, v24
    v_mul_f32 v61, v30, v25
    v_fma_f32 v53, -v31, v25, v53
    v_fma_f32 v61, -v31, v24, -v61
    v_fma_f32 v18, v20, v16, v38
    v_fma_f32 v19, v20, v17, v46
    v_fma_f32 v18, -v21, v17, v18
    v_fma_f32 v19, v21, v16, v19
    v_mul_f32 v38, v22, v18
    v_mul_f32 v46, v22, v19
    v_fma_f32 v38, -v23, v19, v38
    v_fma_f32 v46, -v23, v18, -v46
    v_fma_f32 v26, v28, v24, v54
    v_fma_f32 v27, v28, v25, v62
    v_fma_f32 v26, -v29, v25, v26
    v_fma_f32 v27, v29, v24, v27
    v_mul_f32 v54, v30, v26
    v_mul_f32 v62, v30, v27
    v_fma_f32 v54, -v31, v27, v54
    v_fma_f32 v62, -v31, v26, -v62
    v_fma_f32 v16, v20, v18, v39
    v_fma_f32 v17, v20, v19, v47
    v_fma_f32 v16, -v21, v19, v16
    v_fma_f32 v17, v21, v18, v17
    v_mul_f32 v39, v22, v16
    v_mul_f32 v47, v22, v17
    v_fma_f32 v39, -v23, v17, v39
    v_fma_f32 v47, -v23, v16, -v47
    v_fma_f32 v24, v28, v26, v55
    v_fma_f32 v25, v28, v27, v63
    v_fma_f32 v24, -v29, v27, v24
    v_fma_f32 v25, v29, v26, v25
    v_mul_f32 v55, v30, v24
    v_mul_f32 v63, v30, v25
    v_fma_f32 v55, -v31, v25, v55
    v_fma_f32 v63, -v31, v24, -v63
    v_cvt_pk_bf16_f32 v32, v32, v33
    v_cvt_pk_bf16_f32 v33, v34, v35
    v_cvt_pk_bf16_f32 v34, v36, v37
    v_cvt_pk_bf16_f32 v35, v38, v39
    ds_write_b128 v9, v[32:35] offset:0
    v_cvt_pk_bf16_f32 v40, v40, v41
    v_cvt_pk_bf16_f32 v41, v42, v43
    v_cvt_pk_bf16_f32 v42, v44, v45
    v_cvt_pk_bf16_f32 v43, v46, v47
    ds_write_b128 v9, v[40:43] offset:9216
    v_cvt_pk_bf16_f32 v48, v48, v49
    v_cvt_pk_bf16_f32 v49, v50, v51
    v_cvt_pk_bf16_f32 v50, v52, v53
    v_cvt_pk_bf16_f32 v51, v54, v55
    ds_write_b128 v9, v[48:51] offset:1024
    v_cvt_pk_bf16_f32 v56, v56, v57
    v_cvt_pk_bf16_f32 v57, v58, v59
    v_cvt_pk_bf16_f32 v58, v60, v61
    v_cvt_pk_bf16_f32 v59, v62, v63
    ds_write_b128 v9, v[56:59] offset:10240
    ds_read_b64 v[16:17], v13 offset:256
    ds_read_b128 v[20:23], v14 offset:1024
    ds_read_b64 v[24:25], v13 offset:384
    ds_read_b128 v[28:31], v14 offset:1536
    s_waitcnt lgkmcnt(0)
    v_fma_f32 v18, v20, v16, v64
    v_fma_f32 v19, v20, v17, v72
    v_fma_f32 v18, -v21, v17, v18
    v_fma_f32 v19, v21, v16, v19
    v_mul_f32 v64, v22, v18
    v_mul_f32 v72, v22, v19
    v_fma_f32 v64, -v23, v19, v64
    v_fma_f32 v72, -v23, v18, -v72
    v_fma_f32 v26, v28, v24, v80
    v_fma_f32 v27, v28, v25, v88
    v_fma_f32 v26, -v29, v25, v26
    v_fma_f32 v27, v29, v24, v27
    v_mul_f32 v80, v30, v26
    v_mul_f32 v88, v30, v27
    v_fma_f32 v80, -v31, v27, v80
    v_fma_f32 v88, -v31, v26, -v88
    v_fma_f32 v16, v20, v18, v65
    v_fma_f32 v17, v20, v19, v73
    v_fma_f32 v16, -v21, v19, v16
    v_fma_f32 v17, v21, v18, v17
    v_mul_f32 v65, v22, v16
    v_mul_f32 v73, v22, v17
    v_fma_f32 v65, -v23, v17, v65
    v_fma_f32 v73, -v23, v16, -v73
    v_fma_f32 v24, v28, v26, v81
    v_fma_f32 v25, v28, v27, v89
    v_fma_f32 v24, -v29, v27, v24
    v_fma_f32 v25, v29, v26, v25
    v_mul_f32 v81, v30, v24
    v_mul_f32 v89, v30, v25
    v_fma_f32 v81, -v31, v25, v81
    v_fma_f32 v89, -v31, v24, -v89
    v_fma_f32 v18, v20, v16, v66
    v_fma_f32 v19, v20, v17, v74
    v_fma_f32 v18, -v21, v17, v18
    v_fma_f32 v19, v21, v16, v19
    v_mul_f32 v66, v22, v18
    v_mul_f32 v74, v22, v19
    v_fma_f32 v66, -v23, v19, v66
    v_fma_f32 v74, -v23, v18, -v74
    v_fma_f32 v26, v28, v24, v82
    v_fma_f32 v27, v28, v25, v90
    v_fma_f32 v26, -v29, v25, v26
    v_fma_f32 v27, v29, v24, v27
    v_mul_f32 v82, v30, v26
    v_mul_f32 v90, v30, v27
    v_fma_f32 v82, -v31, v27, v82
    v_fma_f32 v90, -v31, v26, -v90
    v_fma_f32 v16, v20, v18, v67
    v_fma_f32 v17, v20, v19, v75
    v_fma_f32 v16, -v21, v19, v16
    v_fma_f32 v17, v21, v18, v17
    v_mul_f32 v67, v22, v16
    v_mul_f32 v75, v22, v17
    v_fma_f32 v67, -v23, v17, v67
    v_fma_f32 v75, -v23, v16, -v75
    v_fma_f32 v24, v28, v26, v83
    v_fma_f32 v25, v28, v27, v91
    v_fma_f32 v24, -v29, v27, v24
    v_fma_f32 v25, v29, v26, v25
    v_mul_f32 v83, v30, v24
    v_mul_f32 v91, v30, v25
    v_fma_f32 v83, -v31, v25, v83
    v_fma_f32 v91, -v31, v24, -v91
    v_fma_f32 v18, v20, v16, v68
    v_fma_f32 v19, v20, v17, v76
    v_fma_f32 v18, -v21, v17, v18
    v_fma_f32 v19, v21, v16, v19
    v_mul_f32 v68, v22, v18
    v_mul_f32 v76, v22, v19
    v_fma_f32 v68, -v23, v19, v68
    v_fma_f32 v76, -v23, v18, -v76
    v_fma_f32 v26, v28, v24, v84
    v_fma_f32 v27, v28, v25, v92
    v_fma_f32 v26, -v29, v25, v26
    v_fma_f32 v27, v29, v24, v27
    v_mul_f32 v84, v30, v26
    v_mul_f32 v92, v30, v27
    v_fma_f32 v84, -v31, v27, v84
    v_fma_f32 v92, -v31, v26, -v92
    v_fma_f32 v16, v20, v18, v69
    v_fma_f32 v17, v20, v19, v77
    v_fma_f32 v16, -v21, v19, v16
    v_fma_f32 v17, v21, v18, v17
    v_mul_f32 v69, v22, v16
    v_mul_f32 v77, v22, v17
    v_fma_f32 v69, -v23, v17, v69
    v_fma_f32 v77, -v23, v16, -v77
    v_fma_f32 v24, v28, v26, v85
    v_fma_f32 v25, v28, v27, v93
    v_fma_f32 v24, -v29, v27, v24
    v_fma_f32 v25, v29, v26, v25
    v_mul_f32 v85, v30, v24
    v_mul_f32 v93, v30, v25
    v_fma_f32 v85, -v31, v25, v85
    v_fma_f32 v93, -v31, v24, -v93
    v_fma_f32 v18, v20, v16, v70
    v_fma_f32 v19, v20, v17, v78
    v_fma_f32 v18, -v21, v17, v18
    v_fma_f32 v19, v21, v16, v19
    v_mul_f32 v70, v22, v18
    v_mul_f32 v78, v22, v19
    v_fma_f32 v70, -v23, v19, v70
    v_fma_f32 v78, -v23, v18, -v78
    v_fma_f32 v26, v28, v24, v86
    v_fma_f32 v27, v28, v25, v94
    v_fma_f32 v26, -v29, v25, v26
    v_fma_f32 v27, v29, v24, v27
    v_mul_f32 v86, v30, v26
    v_mul_f32 v94, v30, v27
    v_fma_f32 v86, -v31, v27, v86
    v_fma_f32 v94, -v31, v26, -v94
    v_fma_f32 v16, v20, v18, v71
    v_fma_f32 v17, v20, v19, v79
    v_fma_f32 v16, -v21, v19, v16
    v_fma_f32 v17, v21, v18, v17
    v_mul_f32 v71, v22, v16
    v_mul_f32 v79, v22, v17
    v_fma_f32 v71, -v23, v17, v71
    v_fma_f32 v79, -v23, v16, -v79
    v_fma_f32 v24, v28, v26, v87
    v_fma_f32 v25, v28, v27, v95
    v_fma_f32 v24, -v29, v27, v24
    v_fma_f32 v25, v29, v26, v25
    v_mul_f32 v87, v30, v24
    v_mul_f32 v95, v30, v25
    v_fma_f32 v87, -v31, v25, v87
    v_fma_f32 v95, -v31, v24, -v95
    v_cvt_pk_bf16_f32 v64, v64, v65
    v_cvt_pk_bf16_f32 v65, v66, v67
    v_cvt_pk_bf16_f32 v66, v68, v69
    v_cvt_pk_bf16_f32 v67, v70, v71
    ds_write_b128 v9, v[64:67] offset:2048
    v_cvt_pk_bf16_f32 v72, v72, v73
    v_cvt_pk_bf16_f32 v73, v74, v75
    v_cvt_pk_bf16_f32 v74, v76, v77
    v_cvt_pk_bf16_f32 v75, v78, v79
    ds_write_b128 v9, v[72:75] offset:11264
    v_cvt_pk_bf16_f32 v80, v80, v81
    v_cvt_pk_bf16_f32 v81, v82, v83
    v_cvt_pk_bf16_f32 v82, v84, v85
    v_cvt_pk_bf16_f32 v83, v86, v87
    ds_write_b128 v9, v[80:83] offset:3072
    v_cvt_pk_bf16_f32 v88, v88, v89
    v_cvt_pk_bf16_f32 v89, v90, v91
    v_cvt_pk_bf16_f32 v90, v92, v93
    v_cvt_pk_bf16_f32 v91, v94, v95
    ds_write_b128 v9, v[88:91] offset:12288
    s_cmp_lg_u32 s46, 0
    s_cbranch_scc1 .scB_61
    ds_read_b64 v[16:17], v13 offset:1024
    ds_read_b128 v[20:23], v14 offset:4096
    s_waitcnt lgkmcnt(0)
    v_fma_f32 v18, v20, v16, v96
    v_fma_f32 v19, v20, v17, v104
    v_fma_f32 v18, -v21, v17, v18
    v_fma_f32 v19, v21, v16, v19
    v_mul_f32 v96, v22, v18
    v_mul_f32 v104, v22, v19
    v_fma_f32 v96, -v23, v19, v96
    v_fma_f32 v104, -v23, v18, -v104
    v_fma_f32 v16, v20, v18, v97
    v_fma_f32 v17, v20, v19, v105
    v_fma_f32 v16, -v21, v19, v16
    v_fma_f32 v17, v21, v18, v17
    v_mul_f32 v97, v22, v16
    v_mul_f32 v105, v22, v17
    v_fma_f32 v97, -v23, v17, v97
    v_fma_f32 v105, -v23, v16, -v105
    v_fma_f32 v18, v20, v16, v98
    v_fma_f32 v19, v20, v17, v106
    v_fma_f32 v18, -v21, v17, v18
    v_fma_f32 v19, v21, v16, v19
    v_mul_f32 v98, v22, v18
    v_mul_f32 v106, v22, v19
    v_fma_f32 v98, -v23, v19, v98
    v_fma_f32 v106, -v23, v18, -v106
    v_fma_f32 v16, v20, v18, v99
    v_fma_f32 v17, v20, v19, v107
    v_fma_f32 v16, -v21, v19, v16
    v_fma_f32 v17, v21, v18, v17
    v_mul_f32 v99, v22, v16
    v_mul_f32 v107, v22, v17
    v_fma_f32 v99, -v23, v17, v99
    v_fma_f32 v107, -v23, v16, -v107
    v_fma_f32 v18, v20, v16, v100
    v_fma_f32 v19, v20, v17, v108
    v_fma_f32 v18, -v21, v17, v18
    v_fma_f32 v19, v21, v16, v19
    v_mul_f32 v100, v22, v18
    v_mul_f32 v108, v22, v19
    v_fma_f32 v100, -v23, v19, v100
    v_fma_f32 v108, -v23, v18, -v108
    v_fma_f32 v16, v20, v18, v101
    v_fma_f32 v17, v20, v19, v109
    v_fma_f32 v16, -v21, v19, v16
    v_fma_f32 v17, v21, v18, v17
    v_mul_f32 v101, v22, v16
    v_mul_f32 v109, v22, v17
    v_fma_f32 v101, -v23, v17, v101
    v_fma_f32 v109, -v23, v16, -v109
    v_fma_f32 v18, v20, v16, v102
    v_fma_f32 v19, v20, v17, v110
    v_fma_f32 v18, -v21, v17, v18
    v_fma_f32 v19, v21, v16, v19
    v_mul_f32 v102, v22, v18
    v_mul_f32 v110, v22, v19
    v_fma_f32 v102, -v23, v19, v102
    v_fma_f32 v110, -v23, v18, -v110
    v_fma_f32 v16, v20, v18, v103
    v_fma_f32 v17, v20, v19, v111
    v_fma_f32 v16, -v21, v19, v16
    v_fma_f32 v17, v21, v18, v17
    v_mul_f32 v103, v22, v16
    v_mul_f32 v111, v22, v17
    v_fma_f32 v103, -v23, v17, v103
    v_fma_f32 v111, -v23, v16, -v111
    v_cvt_pk_bf16_f32 v96, v96, v97
    v_cvt_pk_bf16_f32 v97, v98, v99
    v_cvt_pk_bf16_f32 v98, v100, v101
    v_cvt_pk_bf16_f32 v99, v102, v103
    ds_write_b128 v9, v[96:99] offset:8192
    v_cvt_pk_bf16_f32 v104, v104, v105
    v_cvt_pk_bf16_f32 v105, v106, v107
    v_cvt_pk_bf16_f32 v106, v108, v109
    v_cvt_pk_bf16_f32 v107, v110, v111
    ds_write_b128 v9, v[104:107] offset:17408
.scB_61:
    s_waitcnt lgkmcnt(0)
    v_lshrrev_b32 v16, 4, v12
    v_bfe_u32 v17, v16, 3, 2
    v_lshlrev_b32 v17, 10, v17
    v_and_b32 v18, 7, v16
    v_lshl_add_u32 v17, v18, 7, v17
    v_bfe_u32 v18, v16, 1, 3
    v_lshrrev_b32 v19, 5, v16
    v_xor_b32 v18, v18, v19
    v_lshl_add_u32 v17, v18, 4, v17
    s_lshl_b32 s49, s46, 13
    v_add_u32 v94, s49, v17
    v_add_u32 v95, 0x10000, v94
    v_add_u32 v96, 0x20000, v94

    v_xor_b32 v97, 32, v94
    v_xor_b32 v98, 32, v95
    v_xor_b32 v99, 32, v96
    v_xor_b32 v100, 64, v94
    v_xor_b32 v101, 64, v95
    v_xor_b32 v102, 64, v96
    v_xor_b32 v103, 96, v94
    v_xor_b32 v104, 96, v95
    v_xor_b32 v105, 96, v96
    v_and_b32 v17, 31, v16
    v_lshlrev_b32 v17, 5, v17
    v_bfe_u32 v18, v16, 3, 1
    v_xor_b32 v18, v18, v19
    v_lshl_add_u32 v17, v18, 4, v17
    s_lshl_b32 s49, s46, 10
    s_add_u32 s49, s49, 16384
    v_add_u32 v106, s49, v17
    v_add_u32 v107, 0x10000, v106
    v_add_u32 v108, 0x20000, v106
    v_lshlrev_b32 v17, 9, v19
    v_bfe_u32 v18, v16, 2, 2
    v_lshl_add_u32 v17, v18, 6, v17
    v_bfe_u32 v18, v16, 4, 1
    v_xor_b32 v18, v18, v19
    v_lshl_add_u32 v17, v18, 5, v17
    v_and_b32 v18, 3, v16
    v_lshl_add_u32 v17, v18, 3, v17
    s_mul_i32 s49, s45, 18432
    s_add_u32 s49, s49, 55296
    v_add_u32 v74, s49, v17
    v_xor_b32 v75, 16, v74

    s_load_dwordx2 s[32:33], s[0:1], 64
    s_mov_b32 s34, 1152
    s_mov_b32 s35, 0x00020000
    v_mov_b32 v77, 155648
    ds_read_b32 v77, v77
    s_barrier
    s_waitcnt lgkmcnt(0)
    v_readfirstlane_b32 s83, v77
    s_cmp_eq_u32 s83, 0
    s_cbranch_scc1 .yslow_62
    ds_read_b64_tr_b16 a[0:1], v74 offset:0
    ds_read_b64_tr_b16 a[2:3], v75 offset:256
    ds_read_b64_tr_b16 a[4:5], v74 offset:1024
    ds_read_b64_tr_b16 a[6:7], v75 offset:1280
    ds_read_b64_tr_b16 a[8:9], v74 offset:2048
    ds_read_b64_tr_b16 a[10:11], v75 offset:2304
    ds_read_b64_tr_b16 a[12:13], v74 offset:3072
    ds_read_b64_tr_b16 a[14:15], v75 offset:3328
    ds_read_b128 v[16:19], v94 offset:18432
    ds_read_b128 v[20:23], v97 offset:18432
    ds_read_b128 v[24:27], v100 offset:18432
    s_waitcnt lgkmcnt(2)
    v_mfma_f32_32x32x16_bf16 v[32:47], a[0:3], v[16:19], 0
    ds_read_b128 v[28:31], v103 offset:18432
    ds_read_b64_tr_b16 a[16:17], v74 offset:4096
    ds_read_b64_tr_b16 a[18:19], v75 offset:4352
    ds_read_b64_tr_b16 a[20:21], v74 offset:5120
    ds_read_b64_tr_b16 a[22:23], v75 offset:5376
    s_add_u32 m0, s52, 129024
    s_add_u32 s49, s59, s85
    buffer_load_dwordx4 v1, s[24:27], s49 offen lds
    s_waitcnt lgkmcnt(6)
    v_mfma_f32_32x32x16_bf16 v[32:47], a[4:7], v[20:23], v[32:47]
    ds_read_b128 v[16:19], v94 offset:22528
    ds_read_b64_tr_b16 a[24:25], v74 offset:6144
    ds_read_b64_tr_b16 a[26:27], v75 offset:6400
    ds_read_b64_tr_b16 a[28:29], v74 offset:7168
    ds_read_b64_tr_b16 a[30:31], v75 offset:7424
    s_add_u32 m0, s52, 130048
    s_add_u32 s49, s59, s85
    buffer_load_dwordx4 v2, s[24:27], s49 offen lds
    s_waitcnt lgkmcnt(10)
    v_mfma_f32_32x32x16_bf16 v[32:47], a[8:11], v[24:27], v[32:47]
    ds_read_b128 v[20:23], v97 offset:22528
    ds_read_b64_tr_b16 a[32:33], v74 offset:8192
    ds_read_b64_tr_b16 a[34:35], v75 offset:8448
    ds_read_b64_tr_b16 a[36:37], v74 offset:9216
    ds_read_b64_tr_b16 a[38:39], v75 offset:9472
    s_add_u32 m0, s53, 129024
    s_add_u32 s49, s60, s85
    s_mov_b64 exec, 0xffff
    buffer_load_dwordx4 v15, s[24:27], s49 offen lds
    s_mov_b64 exec, -1
    s_waitcnt lgkmcnt(14)
    v_mfma_f32_32x32x16_bf16 v[32:47], a[12:15], v[28:31], v[32:47]
    ds_read_b128 v[24:27], v100 offset:22528
    ds_read_b64_tr_b16 a[40:41], v74 offset:10240
    ds_read_b64_tr_b16 a[42:43], v75 offset:10496
    ds_read_b64_tr_b16 a[44:45], v74 offset:11264
    ds_read_b64_tr_b16 a[46:47], v75 offset:11520
    s_waitcnt lgkmcnt(14)
    v_mfma_f32_32x32x16_bf16 v[32:47], a[16:19], v[16:19], v[32:47]
    ds_read_b128 v[28:31], v103 offset:22528
    ds_read_b64_tr_b16 a[48:49], v74 offset:12288
    ds_read_b64_tr_b16 a[50:51], v75 offset:12544
    ds_read_b64_tr_b16 a[52:53], v74 offset:13312
    ds_read_b64_tr_b16 a[54:55], v75 offset:13568
    s_waitcnt lgkmcnt(14)
    v_mfma_f32_32x32x16_bf16 v[32:47], a[20:23], v[20:23], v[32:47]
    ds_read_b128 v[16:19], v106 offset:18432
    ds_read_b64_tr_b16 a[56:57], v74 offset:14336
    ds_read_b64_tr_b16 a[58:59], v75 offset:14592
    ds_read_b64_tr_b16 a[60:61], v74 offset:15360
    ds_read_b64_tr_b16 a[62:63], v75 offset:15616
    s_waitcnt lgkmcnt(14)
    v_mfma_f32_32x32x16_bf16 v[32:47], a[24:27], v[24:27], v[32:47]
    ds_read_b128 v[20:23], v94 offset:36864
    ds_read_b64_tr_b16 a[64:65], v74 offset:16384
    ds_read_b64_tr_b16 a[66:67], v75 offset:16640
    ds_read_b64_tr_b16 a[68:69], v74 offset:17408
    ds_read_b64_tr_b16 a[70:71], v75 offset:17664
    s_waitcnt lgkmcnt(14)
    v_mfma_f32_32x32x16_bf16 v[32:47], a[28:31], v[28:31], v[32:47]
    ds_read_b128 v[24:27], v97 offset:36864
    s_waitcnt lgkmcnt(10)
    v_mfma_f32_32x32x16_bf16 v[32:47], a[32:35], v[16:19], v[32:47]
    s_waitcnt lgkmcnt(1)
    s_barrier
    v_mfma_f32_32x32x16_bf16 v[32:47], a[36:39], v[20:23], v[32:47]
    ds_read_b128 v[28:31], v100 offset:36864
    ds_read_b128 v[16:19], v103 offset:36864
    s_add_u32 m0, s52, 18432
    s_add_u32 s49, s59, s86
    buffer_load_dwordx4 v1, s[20:23], s49 offen lds
    s_add_u32 m0, s52, 19456
    s_add_u32 s49, s59, s86
    buffer_load_dwordx4 v2, s[20:23], s49 offen lds
    s_waitcnt lgkmcnt(2)
    v_mfma_f32_32x32x16_bf16 v[32:47], a[40:43], v[24:27], v[32:47]
    ds_read_b128 v[20:23], v94 offset:40960
    s_add_u32 m0, s53, 18432
    s_add_u32 s49, s60, s86
    s_mov_b64 exec, 0xffff
    buffer_load_dwordx4 v15, s[20:23], s49 offen lds
    s_mov_b64 exec, -1
    s_add_u32 m0, s52, 55296
    s_add_u32 s49, s59, s86
    buffer_load_dwordx4 v1, s[24:27], s49 offen lds
    s_waitcnt lgkmcnt(2)
    v_mfma_f32_32x32x16_bf16 v[32:47], a[44:47], v[28:31], v[32:47]
    ds_read_b128 v[24:27], v97 offset:40960
    s_add_u32 m0, s52, 56320
    s_add_u32 s49, s59, s86
    buffer_load_dwordx4 v2, s[24:27], s49 offen lds
    s_add_u32 m0, s53, 55296
    s_add_u32 s49, s60, s86
    s_mov_b64 exec, 0xffff
    buffer_load_dwordx4 v15, s[24:27], s49 offen lds
    s_mov_b64 exec, -1
    s_waitcnt lgkmcnt(2)
    v_mfma_f32_32x32x16_bf16 v[32:47], a[48:51], v[16:19], v[32:47]
    ds_read_b128 v[28:31], v100 offset:40960
    s_add_u32 m0, s52, 73728
    s_add_u32 s49, s59, s87
    buffer_load_dwordx4 v1, s[20:23], s49 offen lds
    s_add_u32 m0, s52, 74752
    s_add_u32 s49, s59, s87
    buffer_load_dwordx4 v2, s[20:23], s49 offen lds
    s_waitcnt lgkmcnt(2)
    v_mfma_f32_32x32x16_bf16 v[32:47], a[52:55], v[20:23], v[32:47]
    ds_read_b128 v[16:19], v103 offset:40960
    s_add_u32 m0, s53, 73728
    s_add_u32 s49, s60, s87
    s_mov_b64 exec, 0xffff
    buffer_load_dwordx4 v15, s[20:23], s49 offen lds
    s_mov_b64 exec, -1
    s_add_u32 m0, s52, 92160
    s_add_u32 s49, s59, s87
    buffer_load_dwordx4 v1, s[24:27], s49 offen lds
    s_waitcnt lgkmcnt(2)
    v_mfma_f32_32x32x16_bf16 v[32:47], a[56:59], v[24:27], v[32:47]
    ds_read_b128 v[20:23], v106 offset:36864
    s_add_u32 m0, s52, 93184
    s_add_u32 s49, s59, s87
    buffer_load_dwordx4 v2, s[24:27], s49 offen lds
    s_add_u32 m0, s53, 92160
    s_add_u32 s49, s60, s87
    s_mov_b64 exec, 0xffff
    buffer_load_dwordx4 v15, s[24:27], s49 offen lds
    s_mov_b64 exec, -1
    s_waitcnt lgkmcnt(2)
    v_mfma_f32_32x32x16_bf16 v[32:47], a[60:63], v[28:31], v[32:47]
    ds_read_b128 v[24:27], v94 offset:0
    s_add_u32 m0, s52, 110592
    s_add_u32 s49, s59, s88
    buffer_load_dwordx4 v1, s[20:23], s49 offen lds
    s_add_u32 m0, s52, 111616
    s_add_u32 s49, s59, s88
    buffer_load_dwordx4 v2, s[20:23], s49 offen lds
    s_waitcnt lgkmcnt(2)
    v_mfma_f32_32x32x16_bf16 v[32:47], a[64:67], v[16:19], v[32:47]
    ds_read_b128 v[28:31], v97 offset:0
    s_add_u32 m0, s53, 110592
    s_add_u32 s49, s60, s88
    s_mov_b64 exec, 0xffff
    buffer_load_dwordx4 v15, s[20:23], s49 offen lds
    s_mov_b64 exec, -1
    s_waitcnt lgkmcnt(2)
    v_mfma_f32_32x32x16_bf16 v[32:47], a[68:71], v[20:23], v[32:47]
    s_waitcnt vmcnt(15)
    s_barrier
    s_waitcnt lgkmcnt(1)
    v_mfma_f32_32x32x16_bf16 v[48:63], a[0:3], v[24:27], 0
    ds_read_b128 v[16:19], v100 offset:0
    ds_read_b128 v[20:23], v103 offset:0
    s_add_u32 m0, s52, 36864
    s_add_u32 s49, s59, s88
    buffer_load_dwordx4 v1, s[24:27], s49 offen lds
    s_waitcnt lgkmcnt(2)
    v_mfma_f32_32x32x16_bf16 v[48:63], a[4:7], v[28:31], v[48:63]
    ds_read_b128 v[24:27], v94 offset:4096
    s_add_u32 m0, s52, 37888
    s_add_u32 s49, s59, s88
    buffer_load_dwordx4 v2, s[24:27], s49 offen lds
    s_waitcnt lgkmcnt(2)
    v_mfma_f32_32x32x16_bf16 v[48:63], a[8:11], v[16:19], v[48:63]
    ds_read_b128 v[28:31], v97 offset:4096
    v_cvt_pk_f16_f32 v32, v32, v33
    v_cvt_pk_f16_f32 v33, v34, v35
    v_cvt_pk_f16_f32 v34, v36, v37
    s_add_u32 m0, s53, 36864
    s_add_u32 s49, s60, s88
    s_mov_b64 exec, 0xffff
    buffer_load_dwordx4 v15, s[24:27], s49 offen lds
    s_mov_b64 exec, -1
    s_waitcnt lgkmcnt(2)
    v_mfma_f32_32x32x16_bf16 v[48:63], a[12:15], v[20:23], v[48:63]
    ds_read_b128 v[16:19], v100 offset:4096
    v_cvt_pk_f16_f32 v35, v38, v39
    v_cvt_pk_f16_f32 v36, v40, v41
    s_waitcnt lgkmcnt(2)
    v_mfma_f32_32x32x16_bf16 v[48:63], a[16:19], v[24:27], v[48:63]
    ds_read_b128 v[20:23], v103 offset:4096
    v_cvt_pk_f16_f32 v37, v42, v43
    v_cvt_pk_f16_f32 v38, v44, v45
    v_cvt_pk_f16_f32 v39, v46, v47
    s_waitcnt lgkmcnt(2)
    v_mfma_f32_32x32x16_bf16 v[48:63], a[20:23], v[28:31], v[48:63]
    ds_read_b128 v[24:27], v106 offset:0
    v_mov_b32 v80, 0
    v_mov_b32 v81, 0
    v_mov_b32 v82, 0
    v_mov_b32 v83, 0
    v_mov_b32 v84, 0
    v_mov_b32 v85, 0
    v_mov_b32 v86, 0
    v_mov_b32 v87, 0
    s_mov_b32 s82, 30000
    s_lshl_b32 s50, s70, 7
    s_add_u32 s50, s50, s56
    buffer_store_dwordx4 v[32:35], v12, s[16:19], s50 offen offset:0
    buffer_store_dwordx4 v[36:39], v12, s[16:19], s50 offen offset:1024
    s_waitcnt lgkmcnt(2)
    v_mfma_f32_32x32x16_bf16 v[48:63], a[24:27], v[16:19], v[48:63]
    ds_read_b128 v[28:31], v95 offset:63488
    s_waitcnt lgkmcnt(2)
    v_mfma_f32_32x32x16_bf16 v[48:63], a[28:31], v[20:23], v[48:63]
    ds_read_b128 v[16:19], v98 offset:63488
    s_waitcnt lgkmcnt(2)
    v_mfma_f32_32x32x16_bf16 v[48:63], a[32:35], v[24:27], v[48:63]
    s_waitcnt vmcnt(17)
    s_barrier
    s_waitcnt lgkmcnt(1)
    v_mfma_f32_32x32x16_bf16 v[48:63], a[36:39], v[28:31], v[48:63]
    ds_read_b128 v[20:23], v101 offset:63488
    ds_read_b128 v[24:27], v104 offset:63488
    s_add_u32 m0, s52, 0
    s_add_u32 s49, s59, s89
    buffer_load_dwordx4 v1, s[20:23], s49 offen lds
    s_waitcnt lgkmcnt(2)
    v_mfma_f32_32x32x16_bf16 v[48:63], a[40:43], v[16:19], v[48:63]
    ds_read_b128 v[28:31], v96 offset:2048
    s_add_u32 m0, s52, 1024
    s_add_u32 s49, s59, s89
    buffer_load_dwordx4 v2, s[20:23], s49 offen lds
    s_waitcnt lgkmcnt(2)
    v_mfma_f32_32x32x16_bf16 v[48:63], a[44:47], v[20:23], v[48:63]
    ds_read_b128 v[16:19], v99 offset:2048
    s_add_u32 m0, s53, 0
    s_add_u32 s49, s60, s89
    s_mov_b64 exec, 0xffff
    buffer_load_dwordx4 v15, s[20:23], s49 offen lds
    s_mov_b64 exec, -1
    s_waitcnt lgkmcnt(2)
    v_mfma_f32_32x32x16_bf16 v[48:63], a[48:51], v[24:27], v[48:63]
    ds_read_b128 v[20:23], v102 offset:2048
    v_mov_b32 v89, 1
    s_waitcnt vmcnt(3)
    s_mov_b64 exec, 1
    buffer_store_dword v89, off, s[16:19], s42
    s_mov_b64 exec, -1
    s_waitcnt lgkmcnt(2)
    v_mfma_f32_32x32x16_bf16 v[48:63], a[52:55], v[28:31], v[48:63]
    ds_read_b128 v[24:27], v105 offset:2048
    s_waitcnt lgkmcnt(2)
    v_mfma_f32_32x32x16_bf16 v[48:63], a[56:59], v[16:19], v[48:63]
    ds_read_b128 v[28:31], v107 offset:63488
    s_waitcnt lgkmcnt(2)
    v_mfma_f32_32x32x16_bf16 v[48:63], a[60:63], v[20:23], v[48:63]
    ds_read_b128 v[16:19], v94 offset:18432
    s_waitcnt lgkmcnt(2)
    v_mfma_f32_32x32x16_bf16 v[48:63], a[64:67], v[24:27], v[48:63]
    ds_read_b128 v[20:23], v97 offset:18432
    s_waitcnt lgkmcnt(2)
    v_mfma_f32_32x32x16_bf16 v[48:63], a[68:71], v[28:31], v[48:63]
    s_barrier
    s_waitcnt lgkmcnt(1)
    v_mfma_f32_32x32x16_bf16 v[32:47], a[0:3], v[16:19], 0
    ds_read_b128 v[24:27], v100 offset:18432
    ds_read_b128 v[28:31], v103 offset:18432
    s_add_u32 m0, s52, 129024
    s_add_u32 s49, s59, s89
    buffer_load_dwordx4 v1, s[24:27], s49 offen lds
    s_waitcnt lgkmcnt(2)
    v_mfma_f32_32x32x16_bf16 v[32:47], a[4:7], v[20:23], v[32:47]
    ds_read_b128 v[16:19], v94 offset:22528
    s_add_u32 m0, s52, 130048
    s_add_u32 s49, s59, s89
    buffer_load_dwordx4 v2, s[24:27], s49 offen lds
    s_waitcnt lgkmcnt(2)
    v_mfma_f32_32x32x16_bf16 v[32:47], a[8:11], v[24:27], v[32:47]
    ds_read_b128 v[20:23], v97 offset:22528
    v_cvt_pk_f16_f32 v48, v48, v49
    v_cvt_pk_f16_f32 v49, v50, v51
    v_cvt_pk_f16_f32 v50, v52, v53
    s_add_u32 m0, s53, 129024
    s_add_u32 s49, s60, s89
    s_mov_b64 exec, 0xffff
    buffer_load_dwordx4 v15, s[24:27], s49 offen lds
    s_mov_b64 exec, -1
    s_waitcnt lgkmcnt(2)
    v_mfma_f32_32x32x16_bf16 v[32:47], a[12:15], v[28:31], v[32:47]
    ds_read_b128 v[24:27], v100 offset:22528
    v_cvt_pk_f16_f32 v51, v54, v55
    v_cvt_pk_f16_f32 v52, v56, v57
    s_waitcnt lgkmcnt(2)
    v_mfma_f32_32x32x16_bf16 v[32:47], a[16:19], v[16:19], v[32:47]
    ds_read_b128 v[28:31], v103 offset:22528
    v_cvt_pk_f16_f32 v53, v58, v59
    v_cvt_pk_f16_f32 v54, v60, v61
    v_cvt_pk_f16_f32 v55, v62, v63
    s_waitcnt lgkmcnt(2)
    v_mfma_f32_32x32x16_bf16 v[32:47], a[20:23], v[20:23], v[32:47]
    ds_read_b128 v[16:19], v106 offset:18432
    s_lshl_b32 s50, s71, 7
    s_add_u32 s50, s50, s56
    buffer_store_dwordx4 v[48:51], v12, s[16:19], s50 offen offset:0
    buffer_store_dwordx4 v[52:55], v12, s[16:19], s50 offen offset:1024
    s_waitcnt lgkmcnt(2)
    v_mfma_f32_32x32x16_bf16 v[32:47], a[24:27], v[24:27], v[32:47]
    ds_read_b128 v[20:23], v94 offset:55296
    buffer_load_dword v88, off, s[16:19], s43 sc1
    s_waitcnt lgkmcnt(2)
    v_mfma_f32_32x32x16_bf16 v[32:47], a[28:31], v[28:31], v[32:47]
    ds_read_b128 v[24:27], v97 offset:55296
    s_waitcnt lgkmcnt(2)
    v_mfma_f32_32x32x16_bf16 v[32:47], a[32:35], v[16:19], v[32:47]
    s_barrier
    s_waitcnt lgkmcnt(1)
    v_mfma_f32_32x32x16_bf16 v[32:47], a[36:39], v[20:23], v[32:47]
    ds_read_b128 v[28:31], v100 offset:55296
    ds_read_b128 v[16:19], v103 offset:55296
    s_add_u32 m0, s52, 18432
    s_add_u32 s49, s59, s90
    buffer_load_dwordx4 v1, s[20:23], s49 offen lds
    s_waitcnt lgkmcnt(2)
    v_mfma_f32_32x32x16_bf16 v[32:47], a[40:43], v[24:27], v[32:47]
    ds_read_b128 v[20:23], v94 offset:59392
    s_add_u32 m0, s52, 19456
    s_add_u32 s49, s59, s90
    buffer_load_dwordx4 v2, s[20:23], s49 offen lds
    s_waitcnt lgkmcnt(2)
    v_mfma_f32_32x32x16_bf16 v[32:47], a[44:47], v[28:31], v[32:47]
    ds_read_b128 v[24:27], v97 offset:59392
    s_add_u32 m0, s53, 18432
    s_add_u32 s49, s60, s90
    s_mov_b64 exec, 0xffff
    buffer_load_dwordx4 v15, s[20:23], s49 offen lds
    s_mov_b64 exec, -1
    s_waitcnt lgkmcnt(2)
    v_mfma_f32_32x32x16_bf16 v[32:47], a[48:51], v[16:19], v[32:47]
    ds_read_b128 v[28:31], v100 offset:59392
    v_mov_b32 v89, 2
    s_waitcnt vmcnt(4)
    s_mov_b64 exec, 1
    buffer_store_dword v89, off, s[16:19], s42
    s_mov_b64 exec, -1
    s_waitcnt lgkmcnt(2)
    v_mfma_f32_32x32x16_bf16 v[32:47], a[52:55], v[20:23], v[32:47]
    ds_read_b128 v[16:19], v103 offset:59392
    s_waitcnt lgkmcnt(2)
    v_mfma_f32_32x32x16_bf16 v[32:47], a[56:59], v[24:27], v[32:47]
    ds_read_b128 v[20:23], v106 offset:55296
    s_waitcnt vmcnt(4)
.sp_63:
    v_readfirstlane_b32 s50, v88
    s_add_u32 s50, s50, s100
    s_cmp_ge_u32 s50, 3
    s_cbranch_scc1 .ok_64
    s_sub_u32 s82, s82, 1
    s_cmp_lt_i32 s82, 1
    s_cbranch_scc1 .ok_64
    buffer_load_dword v88, off, s[16:19], s43 sc1
    s_waitcnt vmcnt(0)
    s_branch .sp_63

.ok_64:
    s_lshl_b32 s50, s72, 7
    s_add_u32 s50, s50, s56
    s_cmp_eq_u32 s100, 2
    s_cselect_b64 exec, -1, 0
    buffer_load_dwordx4 v[80:83], v12, s[16:19], s50 offen offset:0 sc1
    buffer_load_dwordx4 v[84:87], v12, s[16:19], s50 offen offset:1024 sc1
    s_mov_b64 exec, -1
    s_waitcnt lgkmcnt(2)
    v_mfma_f32_32x32x16_bf16 v[32:47], a[60:63], v[28:31], v[32:47]
    ds_read_b128 v[24:27], v95 offset:8192
    s_waitcnt lgkmcnt(2)
    v_mfma_f32_32x32x16_bf16 v[32:47], a[64:67], v[16:19], v[32:47]
    ds_read_b128 v[28:31], v98 offset:8192
    s_waitcnt lgkmcnt(2)
    v_mfma_f32_32x32x16_bf16 v[32:47], a[68:71], v[20:23], v[32:47]
    s_barrier
    s_waitcnt lgkmcnt(1)
    v_mfma_f32_32x32x16_bf16 v[48:63], a[0:3], v[24:27], 0
    ds_read_b128 v[16:19], v101 offset:8192
    ds_read_b128 v[20:23], v104 offset:8192
    s_add_u32 m0, s52, 55296
    s_add_u32 s49, s59, s90
    buffer_load_dwordx4 v1, s[24:27], s49 offen lds
    s_waitcnt lgkmcnt(2)
    v_mfma_f32_32x32x16_bf16 v[48:63], a[4:7], v[28:31], v[48:63]
    ds_read_b128 v[24:27], v95 offset:12288
    s_add_u32 m0, s52, 56320
    s_add_u32 s49, s59, s90
    buffer_load_dwordx4 v2, s[24:27], s49 offen lds
    s_waitcnt lgkmcnt(2)
    v_mfma_f32_32x32x16_bf16 v[48:63], a[8:11], v[16:19], v[48:63]
    ds_read_b128 v[28:31], v98 offset:12288
    s_waitcnt vmcnt(2)
    v_fma_mix_f32 v32, v80, 1.0, v32 op_sel:[0,0,0] op_sel_hi:[1,0,0]
    v_fma_mix_f32 v33, v80, 1.0, v33 op_sel:[1,0,0] op_sel_hi:[1,0,0]
    v_fma_mix_f32 v34, v81, 1.0, v34 op_sel:[0,0,0] op_sel_hi:[1,0,0]
    v_fma_mix_f32 v35, v81, 1.0, v35 op_sel:[1,0,0] op_sel_hi:[1,0,0]
    v_fma_mix_f32 v36, v82, 1.0, v36 op_sel:[0,0,0] op_sel_hi:[1,0,0]
    s_add_u32 m0, s53, 55296
    s_add_u32 s49, s60, s90
    s_mov_b64 exec, 0xffff
    buffer_load_dwordx4 v15, s[24:27], s49 offen lds
    s_mov_b64 exec, -1
    s_waitcnt lgkmcnt(2)
    v_mfma_f32_32x32x16_bf16 v[48:63], a[12:15], v[20:23], v[48:63]
    ds_read_b128 v[16:19], v101 offset:12288
    v_fma_mix_f32 v37, v82, 1.0, v37 op_sel:[1,0,0] op_sel_hi:[1,0,0]
    v_fma_mix_f32 v38, v83, 1.0, v38 op_sel:[0,0,0] op_sel_hi:[1,0,0]
    v_fma_mix_f32 v39, v83, 1.0, v39 op_sel:[1,0,0] op_sel_hi:[1,0,0]
    v_fma_mix_f32 v40, v84, 1.0, v40 op_sel:[0,0,0] op_sel_hi:[1,0,0]
    v_fma_mix_f32 v41, v84, 1.0, v41 op_sel:[1,0,0] op_sel_hi:[1,0,0]
    v_fma_mix_f32 v42, v85, 1.0, v42 op_sel:[0,0,0] op_sel_hi:[1,0,0]
    s_waitcnt lgkmcnt(2)
    v_mfma_f32_32x32x16_bf16 v[48:63], a[16:19], v[24:27], v[48:63]
    ds_read_b128 v[20:23], v104 offset:12288
    v_fma_mix_f32 v43, v85, 1.0, v43 op_sel:[1,0,0] op_sel_hi:[1,0,0]
    v_fma_mix_f32 v44, v86, 1.0, v44 op_sel:[0,0,0] op_sel_hi:[1,0,0]
    v_fma_mix_f32 v45, v86, 1.0, v45 op_sel:[1,0,0] op_sel_hi:[1,0,0]
    v_fma_mix_f32 v46, v87, 1.0, v46 op_sel:[0,0,0] op_sel_hi:[1,0,0]
    v_fma_mix_f32 v47, v87, 1.0, v47 op_sel:[1,0,0] op_sel_hi:[1,0,0]
    v_cvt_pk_f16_f32 v32, v32, v33
    v_cvt_pk_f16_f32 v33, v34, v35
    s_waitcnt lgkmcnt(2)
    v_mfma_f32_32x32x16_bf16 v[48:63], a[20:23], v[28:31], v[48:63]
    ds_read_b128 v[24:27], v107 offset:8192
    v_cvt_pk_f16_f32 v34, v36, v37
    v_cvt_pk_f16_f32 v35, v38, v39
    v_cvt_pk_f16_f32 v36, v40, v41
    v_cvt_pk_f16_f32 v37, v42, v43
    v_cvt_pk_f16_f32 v38, v44, v45
    v_cvt_pk_f16_f32 v39, v46, v47
    s_waitcnt lgkmcnt(2)
    v_mfma_f32_32x32x16_bf16 v[48:63], a[24:27], v[16:19], v[48:63]
    ds_read_b128 v[28:31], v95 offset:26624
    s_lshl_b32 s50, s72, 7
    s_add_u32 s50, s50, s56
    buffer_store_dwordx4 v[32:35], v12, s[16:19], s50 offen offset:0
    buffer_store_dwordx4 v[36:39], v12, s[16:19], s50 offen offset:1024
    buffer_load_dword v88, off, s[16:19], s43 sc1
    s_waitcnt lgkmcnt(2)
    v_mfma_f32_32x32x16_bf16 v[48:63], a[28:31], v[20:23], v[48:63]
    ds_read_b128 v[16:19], v98 offset:26624
    s_waitcnt lgkmcnt(2)
    v_mfma_f32_32x32x16_bf16 v[48:63], a[32:35], v[24:27], v[48:63]
    s_barrier
    s_waitcnt lgkmcnt(1)
    v_mfma_f32_32x32x16_bf16 v[48:63], a[36:39], v[28:31], v[48:63]
    ds_read_b128 v[20:23], v101 offset:26624
    ds_read_b128 v[24:27], v104 offset:26624
    s_add_u32 m0, s52, 73728
    s_add_u32 s49, s59, s91
    buffer_load_dwordx4 v1, s[20:23], s49 offen lds
    s_waitcnt lgkmcnt(2)
    v_mfma_f32_32x32x16_bf16 v[48:63], a[40:43], v[16:19], v[48:63]
    ds_read_b128 v[28:31], v95 offset:30720
    s_add_u32 m0, s52, 74752
    s_add_u32 s49, s59, s91
    buffer_load_dwordx4 v2, s[20:23], s49 offen lds
    s_waitcnt lgkmcnt(2)
    v_mfma_f32_32x32x16_bf16 v[48:63], a[44:47], v[20:23], v[48:63]
    ds_read_b128 v[16:19], v98 offset:30720
    s_add_u32 m0, s53, 73728
    s_add_u32 s49, s60, s91
    s_mov_b64 exec, 0xffff
    buffer_load_dwordx4 v15, s[20:23], s49 offen lds
    s_mov_b64 exec, -1
    s_waitcnt lgkmcnt(2)
    v_mfma_f32_32x32x16_bf16 v[48:63], a[48:51], v[24:27], v[48:63]
    ds_read_b128 v[20:23], v101 offset:30720
    v_mov_b32 v89, 3
    s_waitcnt vmcnt(4)
    s_mov_b64 exec, 1
    buffer_store_dword v89, off, s[16:19], s42
    s_mov_b64 exec, -1
    s_waitcnt lgkmcnt(2)
    v_mfma_f32_32x32x16_bf16 v[48:63], a[52:55], v[28:31], v[48:63]
    ds_read_b128 v[24:27], v104 offset:30720
    s_waitcnt lgkmcnt(2)
    v_mfma_f32_32x32x16_bf16 v[48:63], a[56:59], v[16:19], v[48:63]
    ds_read_b128 v[28:31], v107 offset:26624
    s_waitcnt vmcnt(4)
.sp_65:
    v_readfirstlane_b32 s50, v88
    s_add_u32 s50, s50, s100
    s_cmp_ge_u32 s50, 4
    s_cbranch_scc1 .ok_66
    s_sub_u32 s82, s82, 1
    s_cmp_lt_i32 s82, 1
    s_cbranch_scc1 .ok_66
    buffer_load_dword v88, off, s[16:19], s43 sc1
    s_waitcnt vmcnt(0)
    s_branch .sp_65

.ok_66:
    s_lshl_b32 s50, s73, 7
    s_add_u32 s50, s50, s56
    buffer_load_dwordx4 v[80:83], v12, s[16:19], s50 offen offset:0 sc1
    buffer_load_dwordx4 v[84:87], v12, s[16:19], s50 offen offset:1024 sc1
    s_waitcnt lgkmcnt(2)
    v_mfma_f32_32x32x16_bf16 v[48:63], a[60:63], v[20:23], v[48:63]
    ds_read_b128 v[16:19], v95 offset:45056
    s_waitcnt lgkmcnt(2)
    v_mfma_f32_32x32x16_bf16 v[48:63], a[64:67], v[24:27], v[48:63]
    ds_read_b128 v[20:23], v98 offset:45056
    s_waitcnt lgkmcnt(2)
    v_mfma_f32_32x32x16_bf16 v[48:63], a[68:71], v[28:31], v[48:63]
    s_barrier
    s_waitcnt lgkmcnt(1)
    v_mfma_f32_32x32x16_bf16 v[32:47], a[0:3], v[16:19], 0
    ds_read_b128 v[24:27], v101 offset:45056
    ds_read_b128 v[28:31], v104 offset:45056
    s_add_u32 m0, s52, 92160
    s_add_u32 s49, s59, s91
    buffer_load_dwordx4 v1, s[24:27], s49 offen lds
    s_waitcnt lgkmcnt(2)
    v_mfma_f32_32x32x16_bf16 v[32:47], a[4:7], v[20:23], v[32:47]
    ds_read_b128 v[16:19], v95 offset:49152
    s_add_u32 m0, s52, 93184
    s_add_u32 s49, s59, s91
    buffer_load_dwordx4 v2, s[24:27], s49 offen lds
    s_waitcnt lgkmcnt(2)
    v_mfma_f32_32x32x16_bf16 v[32:47], a[8:11], v[24:27], v[32:47]
    ds_read_b128 v[20:23], v98 offset:49152
    s_waitcnt vmcnt(2)
    v_fma_mix_f32 v48, v80, 1.0, v48 op_sel:[0,0,0] op_sel_hi:[1,0,0]
    v_fma_mix_f32 v49, v80, 1.0, v49 op_sel:[1,0,0] op_sel_hi:[1,0,0]
    v_fma_mix_f32 v50, v81, 1.0, v50 op_sel:[0,0,0] op_sel_hi:[1,0,0]
    v_fma_mix_f32 v51, v81, 1.0, v51 op_sel:[1,0,0] op_sel_hi:[1,0,0]
    v_fma_mix_f32 v52, v82, 1.0, v52 op_sel:[0,0,0] op_sel_hi:[1,0,0]
    s_add_u32 m0, s53, 92160
    s_add_u32 s49, s60, s91
    s_mov_b64 exec, 0xffff
    buffer_load_dwordx4 v15, s[24:27], s49 offen lds
    s_mov_b64 exec, -1
    s_waitcnt lgkmcnt(2)
    v_mfma_f32_32x32x16_bf16 v[32:47], a[12:15], v[28:31], v[32:47]
    ds_read_b128 v[24:27], v101 offset:49152
    v_fma_mix_f32 v53, v82, 1.0, v53 op_sel:[1,0,0] op_sel_hi:[1,0,0]
    v_fma_mix_f32 v54, v83, 1.0, v54 op_sel:[0,0,0] op_sel_hi:[1,0,0]
    v_fma_mix_f32 v55, v83, 1.0, v55 op_sel:[1,0,0] op_sel_hi:[1,0,0]
    v_fma_mix_f32 v56, v84, 1.0, v56 op_sel:[0,0,0] op_sel_hi:[1,0,0]
    v_fma_mix_f32 v57, v84, 1.0, v57 op_sel:[1,0,0] op_sel_hi:[1,0,0]
    v_fma_mix_f32 v58, v85, 1.0, v58 op_sel:[0,0,0] op_sel_hi:[1,0,0]
    s_waitcnt lgkmcnt(2)
    v_mfma_f32_32x32x16_bf16 v[32:47], a[16:19], v[16:19], v[32:47]
    ds_read_b128 v[28:31], v104 offset:49152
    v_fma_mix_f32 v59, v85, 1.0, v59 op_sel:[1,0,0] op_sel_hi:[1,0,0]
    v_fma_mix_f32 v60, v86, 1.0, v60 op_sel:[0,0,0] op_sel_hi:[1,0,0]
    v_fma_mix_f32 v61, v86, 1.0, v61 op_sel:[1,0,0] op_sel_hi:[1,0,0]
    v_fma_mix_f32 v62, v87, 1.0, v62 op_sel:[0,0,0] op_sel_hi:[1,0,0]
    v_fma_mix_f32 v63, v87, 1.0, v63 op_sel:[1,0,0] op_sel_hi:[1,0,0]
    v_cvt_pk_f16_f32 v48, v48, v49
    v_cvt_pk_f16_f32 v49, v50, v51
    s_waitcnt lgkmcnt(2)
    v_mfma_f32_32x32x16_bf16 v[32:47], a[20:23], v[20:23], v[32:47]
    ds_read_b128 v[16:19], v107 offset:45056
    v_cvt_pk_f16_f32 v50, v52, v53
    v_cvt_pk_f16_f32 v51, v54, v55
    v_cvt_pk_f16_f32 v52, v56, v57
    v_cvt_pk_f16_f32 v53, v58, v59
    v_cvt_pk_f16_f32 v54, v60, v61
    v_cvt_pk_f16_f32 v55, v62, v63
    s_waitcnt lgkmcnt(2)
    v_mfma_f32_32x32x16_bf16 v[32:47], a[24:27], v[24:27], v[32:47]
    ds_read_b128 v[20:23], v94 offset:36864
    s_lshl_b32 s50, s73, 7
    s_add_u32 s50, s50, s56
    buffer_store_dwordx4 v[48:51], v12, s[16:19], s50 offen offset:0
    buffer_store_dwordx4 v[52:55], v12, s[16:19], s50 offen offset:1024
    buffer_load_dword v88, off, s[16:19], s43 sc1
    s_waitcnt lgkmcnt(2)
    v_mfma_f32_32x32x16_bf16 v[32:47], a[28:31], v[28:31], v[32:47]
    ds_read_b128 v[24:27], v97 offset:36864
    s_waitcnt lgkmcnt(2)
    v_mfma_f32_32x32x16_bf16 v[32:47], a[32:35], v[16:19], v[32:47]
    s_barrier
    s_waitcnt lgkmcnt(1)
    v_mfma_f32_32x32x16_bf16 v[32:47], a[36:39], v[20:23], v[32:47]
    ds_read_b128 v[28:31], v100 offset:36864
    ds_read_b128 v[16:19], v103 offset:36864
    s_add_u32 m0, s52, 110592
    s_add_u32 s49, s59, s92
    buffer_load_dwordx4 v1, s[20:23], s49 offen lds
    s_waitcnt lgkmcnt(2)
    v_mfma_f32_32x32x16_bf16 v[32:47], a[40:43], v[24:27], v[32:47]
    ds_read_b128 v[20:23], v94 offset:40960
    s_add_u32 m0, s52, 111616
    s_add_u32 s49, s59, s92
    buffer_load_dwordx4 v2, s[20:23], s49 offen lds
    s_waitcnt lgkmcnt(2)
    v_mfma_f32_32x32x16_bf16 v[32:47], a[44:47], v[28:31], v[32:47]
    ds_read_b128 v[24:27], v97 offset:40960
    s_add_u32 m0, s53, 110592
    s_add_u32 s49, s60, s92
    s_mov_b64 exec, 0xffff
    buffer_load_dwordx4 v15, s[20:23], s49 offen lds
    s_mov_b64 exec, -1
    s_waitcnt lgkmcnt(2)
    v_mfma_f32_32x32x16_bf16 v[32:47], a[48:51], v[16:19], v[32:47]
    ds_read_b128 v[28:31], v100 offset:40960
    v_mov_b32 v89, 4
    s_waitcnt vmcnt(4)
    s_mov_b64 exec, 1
    buffer_store_dword v89, off, s[16:19], s42
    s_mov_b64 exec, -1
    s_waitcnt lgkmcnt(2)
    v_mfma_f32_32x32x16_bf16 v[32:47], a[52:55], v[20:23], v[32:47]
    ds_read_b128 v[16:19], v103 offset:40960
    s_waitcnt lgkmcnt(2)
    v_mfma_f32_32x32x16_bf16 v[32:47], a[56:59], v[24:27], v[32:47]
    ds_read_b128 v[20:23], v106 offset:36864
    s_waitcnt vmcnt(4)
.sp_67:
    v_readfirstlane_b32 s50, v88
    s_add_u32 s50, s50, s100
    s_cmp_ge_u32 s50, 5
    s_cbranch_scc1 .ok_68
    s_sub_u32 s82, s82, 1
    s_cmp_lt_i32 s82, 1
    s_cbranch_scc1 .ok_68
    buffer_load_dword v88, off, s[16:19], s43 sc1
    s_waitcnt vmcnt(0)
    s_branch .sp_67

.ok_68:
    s_lshl_b32 s50, s74, 7
    s_add_u32 s50, s50, s56
    buffer_load_dwordx4 v[80:83], v12, s[16:19], s50 offen offset:0 sc1
    buffer_load_dwordx4 v[84:87], v12, s[16:19], s50 offen offset:1024 sc1
    s_waitcnt lgkmcnt(2)
    v_mfma_f32_32x32x16_bf16 v[32:47], a[60:63], v[28:31], v[32:47]
    ds_read_b128 v[24:27], v94 offset:0
    s_waitcnt lgkmcnt(2)
    v_mfma_f32_32x32x16_bf16 v[32:47], a[64:67], v[16:19], v[32:47]
    ds_read_b128 v[28:31], v97 offset:0
    s_waitcnt lgkmcnt(2)
    v_mfma_f32_32x32x16_bf16 v[32:47], a[68:71], v[20:23], v[32:47]
    s_barrier
    s_waitcnt lgkmcnt(1)
    v_mfma_f32_32x32x16_bf16 v[48:63], a[0:3], v[24:27], 0
    ds_read_b128 v[16:19], v100 offset:0
    ds_read_b128 v[20:23], v103 offset:0
    s_add_u32 m0, s52, 36864
    s_add_u32 s49, s59, s92
    buffer_load_dwordx4 v1, s[24:27], s49 offen lds
    s_waitcnt lgkmcnt(2)
    v_mfma_f32_32x32x16_bf16 v[48:63], a[4:7], v[28:31], v[48:63]
    ds_read_b128 v[24:27], v94 offset:4096
    s_add_u32 m0, s52, 37888
    s_add_u32 s49, s59, s92
    buffer_load_dwordx4 v2, s[24:27], s49 offen lds
    s_waitcnt lgkmcnt(2)
    v_mfma_f32_32x32x16_bf16 v[48:63], a[8:11], v[16:19], v[48:63]
    ds_read_b128 v[28:31], v97 offset:4096
    s_waitcnt vmcnt(2)
    v_fma_mix_f32 v32, v80, 1.0, v32 op_sel:[0,0,0] op_sel_hi:[1,0,0]
    v_fma_mix_f32 v33, v80, 1.0, v33 op_sel:[1,0,0] op_sel_hi:[1,0,0]
    v_fma_mix_f32 v34, v81, 1.0, v34 op_sel:[0,0,0] op_sel_hi:[1,0,0]
    v_fma_mix_f32 v35, v81, 1.0, v35 op_sel:[1,0,0] op_sel_hi:[1,0,0]
    v_fma_mix_f32 v36, v82, 1.0, v36 op_sel:[0,0,0] op_sel_hi:[1,0,0]
    s_add_u32 m0, s53, 36864
    s_add_u32 s49, s60, s92
    s_mov_b64 exec, 0xffff
    buffer_load_dwordx4 v15, s[24:27], s49 offen lds
    s_mov_b64 exec, -1
    s_waitcnt lgkmcnt(2)
    v_mfma_f32_32x32x16_bf16 v[48:63], a[12:15], v[20:23], v[48:63]
    ds_read_b128 v[16:19], v100 offset:4096
    v_fma_mix_f32 v37, v82, 1.0, v37 op_sel:[1,0,0] op_sel_hi:[1,0,0]
    v_fma_mix_f32 v38, v83, 1.0, v38 op_sel:[0,0,0] op_sel_hi:[1,0,0]
    v_fma_mix_f32 v39, v83, 1.0, v39 op_sel:[1,0,0] op_sel_hi:[1,0,0]
    v_fma_mix_f32 v40, v84, 1.0, v40 op_sel:[0,0,0] op_sel_hi:[1,0,0]
    v_fma_mix_f32 v41, v84, 1.0, v41 op_sel:[1,0,0] op_sel_hi:[1,0,0]
    v_fma_mix_f32 v42, v85, 1.0, v42 op_sel:[0,0,0] op_sel_hi:[1,0,0]
    s_waitcnt lgkmcnt(2)
    v_mfma_f32_32x32x16_bf16 v[48:63], a[16:19], v[24:27], v[48:63]
    ds_read_b128 v[20:23], v103 offset:4096
    v_fma_mix_f32 v43, v85, 1.0, v43 op_sel:[1,0,0] op_sel_hi:[1,0,0]
    v_fma_mix_f32 v44, v86, 1.0, v44 op_sel:[0,0,0] op_sel_hi:[1,0,0]
    v_fma_mix_f32 v45, v86, 1.0, v45 op_sel:[1,0,0] op_sel_hi:[1,0,0]
    v_fma_mix_f32 v46, v87, 1.0, v46 op_sel:[0,0,0] op_sel_hi:[1,0,0]
    v_fma_mix_f32 v47, v87, 1.0, v47 op_sel:[1,0,0] op_sel_hi:[1,0,0]
    v_cvt_pk_f16_f32 v32, v32, v33
    v_cvt_pk_f16_f32 v33, v34, v35
    s_waitcnt lgkmcnt(2)
    v_mfma_f32_32x32x16_bf16 v[48:63], a[20:23], v[28:31], v[48:63]
    ds_read_b128 v[24:27], v106 offset:0
    v_cvt_pk_f16_f32 v34, v36, v37
    v_cvt_pk_f16_f32 v35, v38, v39
    v_cvt_pk_f16_f32 v36, v40, v41
    v_cvt_pk_f16_f32 v37, v42, v43
    v_cvt_pk_f16_f32 v38, v44, v45
    v_cvt_pk_f16_f32 v39, v46, v47
    s_waitcnt lgkmcnt(2)
    v_mfma_f32_32x32x16_bf16 v[48:63], a[24:27], v[16:19], v[48:63]
    ds_read_b128 v[28:31], v95 offset:63488
    s_lshl_b32 s50, s74, 7
    s_add_u32 s50, s50, s56
    buffer_store_dwordx4 v[32:35], v12, s[16:19], s50 offen offset:0
    buffer_store_dwordx4 v[36:39], v12, s[16:19], s50 offen offset:1024
    buffer_load_dword v88, off, s[16:19], s43 sc1
    s_waitcnt lgkmcnt(2)
    v_mfma_f32_32x32x16_bf16 v[48:63], a[28:31], v[20:23], v[48:63]
    ds_read_b128 v[16:19], v98 offset:63488
    s_waitcnt lgkmcnt(2)
    v_mfma_f32_32x32x16_bf16 v[48:63], a[32:35], v[24:27], v[48:63]
    s_barrier
    s_waitcnt lgkmcnt(1)
    v_mfma_f32_32x32x16_bf16 v[48:63], a[36:39], v[28:31], v[48:63]
    ds_read_b128 v[20:23], v101 offset:63488
    ds_read_b128 v[24:27], v104 offset:63488
    s_waitcnt lgkmcnt(2)
    v_mfma_f32_32x32x16_bf16 v[48:63], a[40:43], v[16:19], v[48:63]
    ds_read_b128 v[28:31], v96 offset:2048
    s_waitcnt lgkmcnt(2)
    v_mfma_f32_32x32x16_bf16 v[48:63], a[44:47], v[20:23], v[48:63]
    ds_read_b128 v[16:19], v99 offset:2048
    s_waitcnt lgkmcnt(2)
    v_mfma_f32_32x32x16_bf16 v[48:63], a[48:51], v[24:27], v[48:63]
    ds_read_b128 v[20:23], v102 offset:2048
    v_mov_b32 v89, 5
    s_waitcnt vmcnt(1)
    s_mov_b64 exec, 1
    buffer_store_dword v89, off, s[16:19], s42
    s_mov_b64 exec, -1
    s_waitcnt lgkmcnt(2)
    v_mfma_f32_32x32x16_bf16 v[48:63], a[52:55], v[28:31], v[48:63]
    ds_read_b128 v[24:27], v105 offset:2048
    s_waitcnt lgkmcnt(2)
    v_mfma_f32_32x32x16_bf16 v[48:63], a[56:59], v[16:19], v[48:63]
    ds_read_b128 v[28:31], v107 offset:63488
    s_waitcnt vmcnt(1)
.sp_69:
    v_readfirstlane_b32 s50, v88
    s_add_u32 s50, s50, s100
    s_cmp_ge_u32 s50, 6
    s_cbranch_scc1 .ok_70
    s_sub_u32 s82, s82, 1
    s_cmp_lt_i32 s82, 1
    s_cbranch_scc1 .ok_70
    buffer_load_dword v88, off, s[16:19], s43 sc1
    s_waitcnt vmcnt(0)
    s_branch .sp_69

.ok_70:
    s_lshl_b32 s50, s75, 7
    s_add_u32 s50, s50, s56
    buffer_load_dwordx4 v[80:83], v12, s[16:19], s50 offen offset:0 sc1
    buffer_load_dwordx4 v[84:87], v12, s[16:19], s50 offen offset:1024 sc1
    s_waitcnt lgkmcnt(2)
    v_mfma_f32_32x32x16_bf16 v[48:63], a[60:63], v[20:23], v[48:63]
    ds_read_b128 v[16:19], v94 offset:18432
    s_waitcnt lgkmcnt(2)
    v_mfma_f32_32x32x16_bf16 v[48:63], a[64:67], v[24:27], v[48:63]
    ds_read_b128 v[20:23], v97 offset:18432
    s_waitcnt lgkmcnt(2)
    v_mfma_f32_32x32x16_bf16 v[48:63], a[68:71], v[28:31], v[48:63]
    s_barrier
    s_waitcnt lgkmcnt(1)
    v_mfma_f32_32x32x16_bf16 v[32:47], a[0:3], v[16:19], 0
    ds_read_b128 v[24:27], v100 offset:18432
    ds_read_b128 v[28:31], v103 offset:18432
    s_waitcnt lgkmcnt(2)
    v_mfma_f32_32x32x16_bf16 v[32:47], a[4:7], v[20:23], v[32:47]
    ds_read_b128 v[16:19], v94 offset:22528
    s_waitcnt lgkmcnt(2)
    v_mfma_f32_32x32x16_bf16 v[32:47], a[8:11], v[24:27], v[32:47]
    ds_read_b128 v[20:23], v97 offset:22528
    s_waitcnt vmcnt(0)
    v_fma_mix_f32 v48, v80, 1.0, v48 op_sel:[0,0,0] op_sel_hi:[1,0,0]
    v_fma_mix_f32 v49, v80, 1.0, v49 op_sel:[1,0,0] op_sel_hi:[1,0,0]
    v_fma_mix_f32 v50, v81, 1.0, v50 op_sel:[0,0,0] op_sel_hi:[1,0,0]
    v_fma_mix_f32 v51, v81, 1.0, v51 op_sel:[1,0,0] op_sel_hi:[1,0,0]
    v_fma_mix_f32 v52, v82, 1.0, v52 op_sel:[0,0,0] op_sel_hi:[1,0,0]
    s_waitcnt lgkmcnt(2)
    v_mfma_f32_32x32x16_bf16 v[32:47], a[12:15], v[28:31], v[32:47]
    ds_read_b128 v[24:27], v100 offset:22528
    v_fma_mix_f32 v53, v82, 1.0, v53 op_sel:[1,0,0] op_sel_hi:[1,0,0]
    v_fma_mix_f32 v54, v83, 1.0, v54 op_sel:[0,0,0] op_sel_hi:[1,0,0]
    v_fma_mix_f32 v55, v83, 1.0, v55 op_sel:[1,0,0] op_sel_hi:[1,0,0]
    v_fma_mix_f32 v56, v84, 1.0, v56 op_sel:[0,0,0] op_sel_hi:[1,0,0]
    v_fma_mix_f32 v57, v84, 1.0, v57 op_sel:[1,0,0] op_sel_hi:[1,0,0]
    v_fma_mix_f32 v58, v85, 1.0, v58 op_sel:[0,0,0] op_sel_hi:[1,0,0]
    s_waitcnt lgkmcnt(2)
    v_mfma_f32_32x32x16_bf16 v[32:47], a[16:19], v[16:19], v[32:47]
    ds_read_b128 v[28:31], v103 offset:22528
    v_fma_mix_f32 v59, v85, 1.0, v59 op_sel:[1,0,0] op_sel_hi:[1,0,0]
    v_fma_mix_f32 v60, v86, 1.0, v60 op_sel:[0,0,0] op_sel_hi:[1,0,0]
    v_fma_mix_f32 v61, v86, 1.0, v61 op_sel:[1,0,0] op_sel_hi:[1,0,0]
    v_fma_mix_f32 v62, v87, 1.0, v62 op_sel:[0,0,0] op_sel_hi:[1,0,0]
    v_fma_mix_f32 v63, v87, 1.0, v63 op_sel:[1,0,0] op_sel_hi:[1,0,0]
    v_cvt_pk_f16_f32 v48, v48, v49
    v_cvt_pk_f16_f32 v49, v50, v51
    s_waitcnt lgkmcnt(2)
    v_mfma_f32_32x32x16_bf16 v[32:47], a[20:23], v[20:23], v[32:47]
    ds_read_b128 v[16:19], v106 offset:18432
    v_cvt_pk_f16_f32 v50, v52, v53
    v_cvt_pk_f16_f32 v51, v54, v55
    v_cvt_pk_f16_f32 v52, v56, v57
    v_cvt_pk_f16_f32 v53, v58, v59
    v_cvt_pk_f16_f32 v54, v60, v61
    v_cvt_pk_f16_f32 v55, v62, v63
    s_waitcnt lgkmcnt(2)
    v_mfma_f32_32x32x16_bf16 v[32:47], a[24:27], v[24:27], v[32:47]
    ds_read_b128 v[20:23], v94 offset:55296
    s_lshl_b32 s50, s75, 7
    s_add_u32 s50, s50, s56
    buffer_store_dwordx4 v[48:51], v12, s[16:19], s50 offen offset:0
    buffer_store_dwordx4 v[52:55], v12, s[16:19], s50 offen offset:1024
    buffer_load_dword v88, off, s[16:19], s43 sc1
    s_waitcnt lgkmcnt(2)
    v_mfma_f32_32x32x16_bf16 v[32:47], a[28:31], v[28:31], v[32:47]
    ds_read_b128 v[24:27], v97 offset:55296
    s_waitcnt lgkmcnt(2)
    v_mfma_f32_32x32x16_bf16 v[32:47], a[32:35], v[16:19], v[32:47]
    s_barrier
    s_waitcnt lgkmcnt(1)
    v_mfma_f32_32x32x16_bf16 v[32:47], a[36:39], v[20:23], v[32:47]
    ds_read_b128 v[28:31], v100 offset:55296
    ds_read_b128 v[16:19], v103 offset:55296
    s_waitcnt lgkmcnt(2)
    v_mfma_f32_32x32x16_bf16 v[32:47], a[40:43], v[24:27], v[32:47]
    ds_read_b128 v[20:23], v94 offset:59392
    s_waitcnt lgkmcnt(2)
    v_mfma_f32_32x32x16_bf16 v[32:47], a[44:47], v[28:31], v[32:47]
    ds_read_b128 v[24:27], v97 offset:59392
    s_waitcnt lgkmcnt(2)
    v_mfma_f32_32x32x16_bf16 v[32:47], a[48:51], v[16:19], v[32:47]
    ds_read_b128 v[28:31], v100 offset:59392
    v_mov_b32 v89, 6
    s_waitcnt vmcnt(1)
    s_mov_b64 exec, 1
    buffer_store_dword v89, off, s[16:19], s42
    s_mov_b64 exec, -1
    s_waitcnt lgkmcnt(2)
    v_mfma_f32_32x32x16_bf16 v[32:47], a[52:55], v[20:23], v[32:47]
    ds_read_b128 v[16:19], v103 offset:59392
    s_waitcnt lgkmcnt(2)
    v_mfma_f32_32x32x16_bf16 v[32:47], a[56:59], v[24:27], v[32:47]
    ds_read_b128 v[20:23], v106 offset:55296
    s_waitcnt vmcnt(1)
.sp_71:
    v_readfirstlane_b32 s50, v88
    s_add_u32 s50, s50, s100
    s_cmp_ge_u32 s50, 7
    s_cbranch_scc1 .ok_72
    s_sub_u32 s82, s82, 1
    s_cmp_lt_i32 s82, 1
    s_cbranch_scc1 .ok_72
    buffer_load_dword v88, off, s[16:19], s43 sc1
    s_waitcnt vmcnt(0)
    s_branch .sp_71

.ok_72:
    s_lshl_b32 s50, s76, 7
    s_add_u32 s50, s50, s56
    buffer_load_dwordx4 v[80:83], v12, s[16:19], s50 offen offset:0 sc1
    buffer_load_dwordx4 v[84:87], v12, s[16:19], s50 offen offset:1024 sc1
    s_waitcnt lgkmcnt(2)
    v_mfma_f32_32x32x16_bf16 v[32:47], a[60:63], v[28:31], v[32:47]
    ds_read_b128 v[24:27], v95 offset:8192
    v_lshrrev_b32 v4, 8, v12
    v_bfe_u32 v3, v12, 4, 4
    v_lshlrev_b32 v3, 1, v3
    v_lshlrev_b32 v0, 6, v4
    v_mul_u32_u24 v4, 9216, v4
    v_add_u32 v4, v4, v3
    v_lshlrev_b32 v5, 1, v4
    s_lshr_b32 s49, s48, 2
    s_lshr_b32 s51, s48, 3
    s_lshl_b32 s50, s45, 3
    s_add_u32 s50, s50, s51
    s_lshl_b32 s51, s50, 5
    s_add_u32 s51, s51, 153600
    v_add_u32 v0, s51, v0
    s_lshl_b32 s51, s47, 5
    s_add_u32 s50, s50, s51
    s_mul_i32 s64, s50, 4608
    s_lshl_b32 s63, s46, 6
    s_and_b32 s51, s49, 1
    s_lshl_b32 s51, s51, 5
    s_add_u32 s63, s63, s51
    s_add_u32 s64, s64, s63
    s_mul_i32 s65, s47, 147456
    s_lshl_b32 s50, s44, 11
    s_add_u32 s65, s65, s50
    s_lshl_b32 s50, s49, 8
    s_add_u32 s65, s65, s50
    s_add_u32 s65, s65, 4718592
    s_lshl_b32 s49, s49, 2
    s_sub_u32 s62, s42, s49

    ds_read_b128 a[96:99], v0
    ds_read_b128 a[100:103], v0 offset:16
    s_waitcnt lgkmcnt(4)
    v_mfma_f32_32x32x16_bf16 v[32:47], a[64:67], v[16:19], v[32:47]
    ds_read_b128 v[28:31], v98 offset:8192
    s_add_u32 s50, s76, s64
    buffer_load_ushort a80, v4, s[4:7], s50 offen offset:0
    buffer_load_ushort a81, v4, s[4:7], s50 offen offset:1152
    buffer_load_ushort a82, v4, s[4:7], s50 offen offset:2304
    buffer_load_ushort a83, v4, s[4:7], s50 offen offset:3456
    s_add_u32 s50, s76, s63
    buffer_load_ushort a84, v3, s[32:35], s50 offen
    s_waitcnt lgkmcnt(4)
    v_mfma_f32_32x32x16_bf16 v[32:47], a[68:71], v[20:23], v[32:47]
    s_barrier
    s_waitcnt lgkmcnt(3)
    v_mfma_f32_32x32x16_bf16 v[48:63], a[0:3], v[24:27], 0
    ds_read_b128 v[16:19], v101 offset:8192
    ds_read_b128 v[20:23], v104 offset:8192
    s_add_u32 s50, s77, s64
    buffer_load_ushort a85, v4, s[4:7], s50 offen offset:0
    buffer_load_ushort a86, v4, s[4:7], s50 offen offset:1152
    buffer_load_ushort a87, v4, s[4:7], s50 offen offset:2304
    buffer_load_ushort a88, v4, s[4:7], s50 offen offset:3456
    s_add_u32 s50, s77, s63
    buffer_load_ushort a89, v3, s[32:35], s50 offen
    s_add_u32 s50, s78, s64
    buffer_load_ushort a90, v4, s[4:7], s50 offen offset:0
    buffer_load_ushort a91, v4, s[4:7], s50 offen offset:1152
    buffer_load_ushort a92, v4, s[4:7], s50 offen offset:2304
    buffer_load_ushort a93, v4, s[4:7], s50 offen offset:3456
    s_add_u32 s50, s78, s63
    buffer_load_ushort a94, v3, s[32:35], s50 offen
    s_waitcnt lgkmcnt(2)
    v_mfma_f32_32x32x16_bf16 v[48:63], a[4:7], v[28:31], v[48:63]
    ds_read_b128 v[24:27], v95 offset:12288
    s_waitcnt lgkmcnt(2)
    v_mfma_f32_32x32x16_bf16 v[48:63], a[8:11], v[16:19], v[48:63]
    ds_read_b128 v[28:31], v98 offset:12288
    s_waitcnt vmcnt(15)
    v_fma_mix_f32 v32, v80, 1.0, v32 op_sel:[0,0,0] op_sel_hi:[1,0,0]
    v_fma_mix_f32 v33, v80, 1.0, v33 op_sel:[1,0,0] op_sel_hi:[1,0,0]
    v_fma_mix_f32 v34, v81, 1.0, v34 op_sel:[0,0,0] op_sel_hi:[1,0,0]
    v_fma_mix_f32 v35, v81, 1.0, v35 op_sel:[1,0,0] op_sel_hi:[1,0,0]
    v_fma_mix_f32 v36, v82, 1.0, v36 op_sel:[0,0,0] op_sel_hi:[1,0,0]
    s_waitcnt lgkmcnt(2)
    v_mfma_f32_32x32x16_bf16 v[48:63], a[12:15], v[20:23], v[48:63]
    ds_read_b128 v[16:19], v101 offset:12288
    v_fma_mix_f32 v37, v82, 1.0, v37 op_sel:[1,0,0] op_sel_hi:[1,0,0]
    v_fma_mix_f32 v38, v83, 1.0, v38 op_sel:[0,0,0] op_sel_hi:[1,0,0]
    v_fma_mix_f32 v39, v83, 1.0, v39 op_sel:[1,0,0] op_sel_hi:[1,0,0]
    v_fma_mix_f32 v40, v84, 1.0, v40 op_sel:[0,0,0] op_sel_hi:[1,0,0]
    v_fma_mix_f32 v41, v84, 1.0, v41 op_sel:[1,0,0] op_sel_hi:[1,0,0]
    v_fma_mix_f32 v42, v85, 1.0, v42 op_sel:[0,0,0] op_sel_hi:[1,0,0]
    s_waitcnt lgkmcnt(2)
    v_mfma_f32_32x32x16_bf16 v[48:63], a[16:19], v[24:27], v[48:63]
    ds_read_b128 v[20:23], v104 offset:12288
    v_fma_mix_f32 v43, v85, 1.0, v43 op_sel:[1,0,0] op_sel_hi:[1,0,0]
    v_fma_mix_f32 v44, v86, 1.0, v44 op_sel:[0,0,0] op_sel_hi:[1,0,0]
    v_fma_mix_f32 v45, v86, 1.0, v45 op_sel:[1,0,0] op_sel_hi:[1,0,0]
    v_fma_mix_f32 v46, v87, 1.0, v46 op_sel:[0,0,0] op_sel_hi:[1,0,0]
    v_fma_mix_f32 v47, v87, 1.0, v47 op_sel:[1,0,0] op_sel_hi:[1,0,0]
    v_cvt_pk_f16_f32 v32, v32, v33
    v_cvt_pk_f16_f32 v33, v34, v35
    s_waitcnt lgkmcnt(2)
    v_mfma_f32_32x32x16_bf16 v[48:63], a[20:23], v[28:31], v[48:63]
    ds_read_b128 v[24:27], v107 offset:8192
    v_cvt_pk_f16_f32 v34, v36, v37
    v_cvt_pk_f16_f32 v35, v38, v39
    v_cvt_pk_f16_f32 v36, v40, v41
    v_cvt_pk_f16_f32 v37, v42, v43
    v_cvt_pk_f16_f32 v38, v44, v45
    v_cvt_pk_f16_f32 v39, v46, v47
    s_waitcnt lgkmcnt(2)
    v_mfma_f32_32x32x16_bf16 v[48:63], a[24:27], v[16:19], v[48:63]
    ds_read_b128 v[28:31], v95 offset:26624
    s_lshl_b32 s50, s76, 7
    s_add_u32 s50, s50, s56
    buffer_store_dwordx4 v[32:35], v12, s[16:19], s50 offen offset:0
    buffer_store_dwordx4 v[36:39], v12, s[16:19], s50 offen offset:1024
    buffer_load_dword v88, off, s[16:19], s43 sc1
    s_waitcnt lgkmcnt(2)
    v_mfma_f32_32x32x16_bf16 v[48:63], a[28:31], v[20:23], v[48:63]
    ds_read_b128 v[16:19], v98 offset:26624
    s_waitcnt lgkmcnt(2)
    v_mfma_f32_32x32x16_bf16 v[48:63], a[32:35], v[24:27], v[48:63]
    s_barrier
    s_waitcnt lgkmcnt(1)
    v_mfma_f32_32x32x16_bf16 v[48:63], a[36:39], v[28:31], v[48:63]
    ds_read_b128 v[20:23], v101 offset:26624
    ds_read_b128 v[24:27], v104 offset:26624
    s_waitcnt lgkmcnt(2)
    v_mfma_f32_32x32x16_bf16 v[48:63], a[40:43], v[16:19], v[48:63]
    ds_read_b128 v[28:31], v95 offset:30720
    s_waitcnt lgkmcnt(2)
    v_mfma_f32_32x32x16_bf16 v[48:63], a[44:47], v[20:23], v[48:63]
    ds_read_b128 v[16:19], v98 offset:30720
    s_waitcnt lgkmcnt(2)
    v_mfma_f32_32x32x16_bf16 v[48:63], a[48:51], v[24:27], v[48:63]
    ds_read_b128 v[20:23], v101 offset:30720
    v_mov_b32 v89, 7
    s_waitcnt vmcnt(1)
    s_mov_b64 exec, 1
    buffer_store_dword v89, off, s[16:19], s42
    s_mov_b64 exec, -1
    s_waitcnt lgkmcnt(2)
    v_mfma_f32_32x32x16_bf16 v[48:63], a[52:55], v[28:31], v[48:63]
    ds_read_b128 v[24:27], v104 offset:30720
    s_waitcnt lgkmcnt(2)
    v_mfma_f32_32x32x16_bf16 v[48:63], a[56:59], v[16:19], v[48:63]
    ds_read_b128 v[28:31], v107 offset:26624
    s_waitcnt vmcnt(1)
.sp_73:
    v_readfirstlane_b32 s50, v88
    s_add_u32 s50, s50, s100
    s_cmp_ge_u32 s50, 8
    s_cbranch_scc1 .ok_74
    s_sub_u32 s82, s82, 1
    s_cmp_lt_i32 s82, 1
    s_cbranch_scc1 .ok_74
    buffer_load_dword v88, off, s[16:19], s43 sc1
    s_waitcnt vmcnt(0)
    s_branch .sp_73

.ok_74:
    s_lshl_b32 s50, s77, 7
    s_add_u32 s50, s50, s56
    buffer_load_dwordx4 v[80:83], v12, s[16:19], s50 offen offset:0 sc1
    buffer_load_dwordx4 v[84:87], v12, s[16:19], s50 offen offset:1024 sc1
    s_waitcnt lgkmcnt(2)
    v_mfma_f32_32x32x16_bf16 v[48:63], a[60:63], v[20:23], v[48:63]
    ds_read_b128 v[16:19], v95 offset:45056
    s_waitcnt lgkmcnt(2)
    v_mfma_f32_32x32x16_bf16 v[48:63], a[64:67], v[24:27], v[48:63]
    ds_read_b128 v[20:23], v98 offset:45056
    s_waitcnt lgkmcnt(2)
    v_mfma_f32_32x32x16_bf16 v[48:63], a[68:71], v[28:31], v[48:63]
    s_barrier
    s_waitcnt lgkmcnt(1)
    v_mfma_f32_32x32x16_bf16 v[32:47], a[0:3], v[16:19], 0
    ds_read_b128 v[24:27], v101 offset:45056
    ds_read_b128 v[28:31], v104 offset:45056
    s_waitcnt lgkmcnt(2)
    v_mfma_f32_32x32x16_bf16 v[32:47], a[4:7], v[20:23], v[32:47]
    ds_read_b128 v[16:19], v95 offset:49152
    s_waitcnt lgkmcnt(2)
    v_mfma_f32_32x32x16_bf16 v[32:47], a[8:11], v[24:27], v[32:47]
    ds_read_b128 v[20:23], v98 offset:49152
    s_waitcnt vmcnt(0)
    v_fma_mix_f32 v48, v80, 1.0, v48 op_sel:[0,0,0] op_sel_hi:[1,0,0]
    v_fma_mix_f32 v49, v80, 1.0, v49 op_sel:[1,0,0] op_sel_hi:[1,0,0]
    v_fma_mix_f32 v50, v81, 1.0, v50 op_sel:[0,0,0] op_sel_hi:[1,0,0]
    v_fma_mix_f32 v51, v81, 1.0, v51 op_sel:[1,0,0] op_sel_hi:[1,0,0]
    v_fma_mix_f32 v52, v82, 1.0, v52 op_sel:[0,0,0] op_sel_hi:[1,0,0]
    s_waitcnt lgkmcnt(2)
    v_mfma_f32_32x32x16_bf16 v[32:47], a[12:15], v[28:31], v[32:47]
    ds_read_b128 v[24:27], v101 offset:49152
    v_fma_mix_f32 v53, v82, 1.0, v53 op_sel:[1,0,0] op_sel_hi:[1,0,0]
    v_fma_mix_f32 v54, v83, 1.0, v54 op_sel:[0,0,0] op_sel_hi:[1,0,0]
    v_fma_mix_f32 v55, v83, 1.0, v55 op_sel:[1,0,0] op_sel_hi:[1,0,0]
    v_fma_mix_f32 v56, v84, 1.0, v56 op_sel:[0,0,0] op_sel_hi:[1,0,0]
    v_fma_mix_f32 v57, v84, 1.0, v57 op_sel:[1,0,0] op_sel_hi:[1,0,0]
    v_fma_mix_f32 v58, v85, 1.0, v58 op_sel:[0,0,0] op_sel_hi:[1,0,0]
    s_waitcnt lgkmcnt(2)
    v_mfma_f32_32x32x16_bf16 v[32:47], a[16:19], v[16:19], v[32:47]
    ds_read_b128 v[28:31], v104 offset:49152
    v_fma_mix_f32 v59, v85, 1.0, v59 op_sel:[1,0,0] op_sel_hi:[1,0,0]
    v_fma_mix_f32 v60, v86, 1.0, v60 op_sel:[0,0,0] op_sel_hi:[1,0,0]
    v_fma_mix_f32 v61, v86, 1.0, v61 op_sel:[1,0,0] op_sel_hi:[1,0,0]
    v_fma_mix_f32 v62, v87, 1.0, v62 op_sel:[0,0,0] op_sel_hi:[1,0,0]
    v_fma_mix_f32 v63, v87, 1.0, v63 op_sel:[1,0,0] op_sel_hi:[1,0,0]
    v_cvt_pk_f16_f32 v48, v48, v49
    v_cvt_pk_f16_f32 v49, v50, v51
    s_waitcnt lgkmcnt(2)
    v_mfma_f32_32x32x16_bf16 v[32:47], a[20:23], v[20:23], v[32:47]
    ds_read_b128 v[16:19], v107 offset:45056
    v_cvt_pk_f16_f32 v50, v52, v53
    v_cvt_pk_f16_f32 v51, v54, v55
    v_cvt_pk_f16_f32 v52, v56, v57
    v_cvt_pk_f16_f32 v53, v58, v59
    v_cvt_pk_f16_f32 v54, v60, v61
    v_cvt_pk_f16_f32 v55, v62, v63
    s_waitcnt lgkmcnt(2)
    v_mfma_f32_32x32x16_bf16 v[32:47], a[24:27], v[24:27], v[32:47]
    ds_read_b128 v[20:23], v94 offset:36864
    s_lshl_b32 s50, s77, 7
    s_add_u32 s50, s50, s56
    buffer_store_dwordx4 v[48:51], v12, s[16:19], s50 offen offset:0
    buffer_store_dwordx4 v[52:55], v12, s[16:19], s50 offen offset:1024
    buffer_load_dword v88, off, s[16:19], s43 sc1
    s_waitcnt lgkmcnt(2)
    v_mfma_f32_32x32x16_bf16 v[32:47], a[28:31], v[28:31], v[32:47]
    ds_read_b128 v[24:27], v97 offset:36864
    s_waitcnt lgkmcnt(2)
    v_mfma_f32_32x32x16_bf16 v[32:47], a[32:35], v[16:19], v[32:47]
    s_barrier
    s_waitcnt lgkmcnt(1)
    v_mfma_f32_32x32x16_bf16 v[32:47], a[36:39], v[20:23], v[32:47]
    ds_read_b128 v[28:31], v100 offset:36864
    ds_read_b128 v[16:19], v103 offset:36864
    s_waitcnt lgkmcnt(2)
    v_mfma_f32_32x32x16_bf16 v[32:47], a[40:43], v[24:27], v[32:47]
    ds_read_b128 v[20:23], v94 offset:40960
    s_waitcnt lgkmcnt(2)
    v_mfma_f32_32x32x16_bf16 v[32:47], a[44:47], v[28:31], v[32:47]
    ds_read_b128 v[24:27], v97 offset:40960
    s_waitcnt lgkmcnt(2)
    v_mfma_f32_32x32x16_bf16 v[32:47], a[48:51], v[16:19], v[32:47]
    ds_read_b128 v[28:31], v100 offset:40960
    v_mov_b32 v89, 8
    s_waitcnt vmcnt(1)
    s_mov_b64 exec, 1
    buffer_store_dword v89, off, s[16:19], s42
    s_mov_b64 exec, -1
    s_waitcnt lgkmcnt(2)
    v_mfma_f32_32x32x16_bf16 v[32:47], a[52:55], v[20:23], v[32:47]
    ds_read_b128 v[16:19], v103 offset:40960
    s_waitcnt lgkmcnt(2)
    v_mfma_f32_32x32x16_bf16 v[32:47], a[56:59], v[24:27], v[32:47]
    ds_read_b128 v[20:23], v106 offset:36864
    s_waitcnt vmcnt(1)
.sp_75:
    v_readfirstlane_b32 s50, v88
    s_add_u32 s50, s50, s100
    s_cmp_ge_u32 s50, 9
    s_cbranch_scc1 .ok_76
    s_sub_u32 s82, s82, 1
    s_cmp_lt_i32 s82, 1
    s_cbranch_scc1 .ok_76
    buffer_load_dword v88, off, s[16:19], s43 sc1
    s_waitcnt vmcnt(0)
    s_branch .sp_75

.ok_76:
    s_lshl_b32 s50, s78, 7
    s_add_u32 s50, s50, s56
    buffer_load_dwordx4 v[80:83], v12, s[16:19], s50 offen offset:0 sc1
    buffer_load_dwordx4 v[84:87], v12, s[16:19], s50 offen offset:1024 sc1
    s_waitcnt lgkmcnt(2)
    v_mfma_f32_32x32x16_bf16 v[32:47], a[60:63], v[28:31], v[32:47]
    s_waitcnt lgkmcnt(1)
    v_mfma_f32_32x32x16_bf16 v[32:47], a[64:67], v[16:19], v[32:47]
    s_waitcnt lgkmcnt(0)
    v_mfma_f32_32x32x16_bf16 v[32:47], a[68:71], v[20:23], v[32:47]
    s_barrier
    s_nop 7
    s_nop 7
    s_waitcnt vmcnt(0)
    v_fma_mix_f32 v32, v80, 1.0, v32 op_sel:[0,0,0] op_sel_hi:[1,0,0]
    v_fma_mix_f32 v33, v80, 1.0, v33 op_sel:[1,0,0] op_sel_hi:[1,0,0]
    v_fma_mix_f32 v34, v81, 1.0, v34 op_sel:[0,0,0] op_sel_hi:[1,0,0]
    v_fma_mix_f32 v35, v81, 1.0, v35 op_sel:[1,0,0] op_sel_hi:[1,0,0]
    v_fma_mix_f32 v36, v82, 1.0, v36 op_sel:[0,0,0] op_sel_hi:[1,0,0]
    v_fma_mix_f32 v37, v82, 1.0, v37 op_sel:[1,0,0] op_sel_hi:[1,0,0]
    v_fma_mix_f32 v38, v83, 1.0, v38 op_sel:[0,0,0] op_sel_hi:[1,0,0]
    v_fma_mix_f32 v39, v83, 1.0, v39 op_sel:[1,0,0] op_sel_hi:[1,0,0]
    v_fma_mix_f32 v40, v84, 1.0, v40 op_sel:[0,0,0] op_sel_hi:[1,0,0]
    v_fma_mix_f32 v41, v84, 1.0, v41 op_sel:[1,0,0] op_sel_hi:[1,0,0]
    v_fma_mix_f32 v42, v85, 1.0, v42 op_sel:[0,0,0] op_sel_hi:[1,0,0]
    v_fma_mix_f32 v43, v85, 1.0, v43 op_sel:[1,0,0] op_sel_hi:[1,0,0]
    v_fma_mix_f32 v44, v86, 1.0, v44 op_sel:[0,0,0] op_sel_hi:[1,0,0]
    v_fma_mix_f32 v45, v86, 1.0, v45 op_sel:[1,0,0] op_sel_hi:[1,0,0]
    v_fma_mix_f32 v46, v87, 1.0, v46 op_sel:[0,0,0] op_sel_hi:[1,0,0]
    v_fma_mix_f32 v47, v87, 1.0, v47 op_sel:[1,0,0] op_sel_hi:[1,0,0]
    v_cvt_pk_f16_f32 v32, v32, v33
    v_cvt_pk_f16_f32 v33, v34, v35
    v_cvt_pk_f16_f32 v34, v36, v37
    v_cvt_pk_f16_f32 v35, v38, v39
    v_cvt_pk_f16_f32 v36, v40, v41
    v_cvt_pk_f16_f32 v37, v42, v43
    v_cvt_pk_f16_f32 v38, v44, v45
    v_cvt_pk_f16_f32 v39, v46, v47
    s_lshl_b32 s50, s78, 7
    s_add_u32 s50, s50, s56
    buffer_store_dwordx4 v[32:35], v12, s[16:19], s50 offen offset:0
    buffer_store_dwordx4 v[36:39], v12, s[16:19], s50 offen offset:1024
    v_bfe_u32 v17, v12, 4, 2
    v_lshlrev_b32 v17, 2, v17
    buffer_load_dword v16, v17, s[16:19], s62 offen sc1
    v_lshrrev_b32 v8, 9, v12
    v_bfe_u32 v9, v12, 8, 1
    v_lshlrev_b32 v9, 3, v9
    v_and_b32 v7, 0xf0, v12
    v_lshl_add_u32 v7, v8, 10, v7
    v_add_u32 v7, v7, v9
    v_bfe_u32 v6, v12, 6, 2
    v_lshl_add_u32 v6, v8, 3, v6
    v_mul_u32_u24 v6, 2304, v6
    v_and_b32 v8, 0x30, v12
    v_add3_u32 v6, v6, v8, v9

    v_accvgpr_read_b32 v88, a96
    v_accvgpr_read_b32 v89, a97
    v_accvgpr_read_b32 v90, a98
    v_accvgpr_read_b32 v91, a99
    v_accvgpr_read_b32 v92, a100
    v_accvgpr_read_b32 v93, a101
    v_accvgpr_read_b32 v94, a102
    v_accvgpr_read_b32 v95, a103
    v_accvgpr_read_b32 v64, a80
    v_accvgpr_read_b32 v65, a81
    v_accvgpr_read_b32 v66, a82
    v_accvgpr_read_b32 v67, a83
    v_accvgpr_read_b32 v96, a84
    v_lshlrev_b32 v64, 16, v64
    v_lshlrev_b32 v65, 16, v65
    v_lshlrev_b32 v66, 16, v66
    v_lshlrev_b32 v67, 16, v67
    v_lshlrev_b32 v96, 16, v96
    v_fma_f32 v76, v64, v88, v89
    v_fma_f32 v77, v65, v90, v91
    v_fma_f32 v78, v66, v92, v93
    v_fma_f32 v79, v67, v94, v95
    v_cvt_pk_bf16_f32 v77, v76, v77
    v_cvt_pk_bf16_f32 v79, v78, v79
    v_lshlrev_b32 v76, 16, v77
    v_lshlrev_b32 v78, 16, v79
    v_and_b32 v77, s99, v77
    v_and_b32 v79, s99, v79
    v_mul_f32 v76, v76, v96
    v_mul_f32 v77, v77, v96
    v_mul_f32 v78, v78, v96
    v_mul_f32 v79, v79, v96
    v_cvt_pk_bf16_f32 v77, v76, v77
    v_cvt_pk_bf16_f32 v79, v78, v79
    v_lshlrev_b32 v76, 16, v77
    v_lshlrev_b32 v78, 16, v79
    v_and_b32 v77, s99, v77
    v_and_b32 v79, s99, v79
    v_accvgpr_read_b32 v68, a85
    v_accvgpr_read_b32 v69, a86
    v_accvgpr_read_b32 v70, a87
    v_accvgpr_read_b32 v71, a88
    v_accvgpr_read_b32 v97, a89
    v_lshlrev_b32 v68, 16, v68
    v_lshlrev_b32 v69, 16, v69
    v_lshlrev_b32 v70, 16, v70
    v_lshlrev_b32 v71, 16, v71
    v_lshlrev_b32 v97, 16, v97
    v_fma_f32 v80, v68, v88, v89
    v_fma_f32 v81, v69, v90, v91
    v_fma_f32 v82, v70, v92, v93
    v_fma_f32 v83, v71, v94, v95
    v_cvt_pk_bf16_f32 v81, v80, v81
    v_cvt_pk_bf16_f32 v83, v82, v83
    v_lshlrev_b32 v80, 16, v81
    v_lshlrev_b32 v82, 16, v83
    v_and_b32 v81, s99, v81
    v_and_b32 v83, s99, v83
    v_mul_f32 v80, v80, v97
    v_mul_f32 v81, v81, v97
    v_mul_f32 v82, v82, v97
    v_mul_f32 v83, v83, v97
    v_cvt_pk_bf16_f32 v81, v80, v81
    v_cvt_pk_bf16_f32 v83, v82, v83
    v_lshlrev_b32 v80, 16, v81
    v_lshlrev_b32 v82, 16, v83
    v_and_b32 v81, s99, v81
    v_and_b32 v83, s99, v83
    v_accvgpr_read_b32 v72, a90
    v_accvgpr_read_b32 v73, a91
    v_accvgpr_read_b32 v74, a92
    v_accvgpr_read_b32 v75, a93
    v_accvgpr_read_b32 v98, a94
    v_lshlrev_b32 v72, 16, v72
    v_lshlrev_b32 v73, 16, v73
    v_lshlrev_b32 v74, 16, v74
    v_lshlrev_b32 v75, 16, v75
    v_lshlrev_b32 v98, 16, v98
    v_fma_f32 v84, v72, v88, v89
    v_fma_f32 v85, v73, v90, v91
    v_fma_f32 v86, v74, v92, v93
    v_fma_f32 v87, v75, v94, v95
    v_cvt_pk_bf16_f32 v85, v84, v85
    v_cvt_pk_bf16_f32 v87, v86, v87
    v_lshlrev_b32 v84, 16, v85
    v_lshlrev_b32 v86, 16, v87
    v_and_b32 v85, s99, v85
    v_and_b32 v87, s99, v87
    v_mul_f32 v84, v84, v98
    v_mul_f32 v85, v85, v98
    v_mul_f32 v86, v86, v98
    v_mul_f32 v87, v87, v98
    v_cvt_pk_bf16_f32 v85, v84, v85
    v_cvt_pk_bf16_f32 v87, v86, v87
    v_lshlrev_b32 v84, 16, v85
    v_lshlrev_b32 v86, 16, v87
    v_and_b32 v85, s99, v85
    v_and_b32 v87, s99, v87
    v_mov_b32 v19, 9
    s_waitcnt vmcnt(1)
    s_mov_b64 exec, 1
    buffer_store_dword v19, off, s[16:19], s42
    s_mov_b64 exec, -1
    s_lshr_b32 s49, s48, 2
    s_lshl_b32 s49, 1, s49
    s_waitcnt vmcnt(0)
    v_cmp_gt_u32 vcc, 9, v16
    s_andn2_b32 s49, vcc_lo, s49
    s_and_b32 s49, s49, 15
    s_cbranch_scc0 .batch_77

    s_branch .f1_80
.fp_78:
    buffer_load_dword v16, v17, s[16:19], s62 offen sc1
.f1_80:
    s_waitcnt vmcnt(0)
    v_cmp_gt_u32 vcc, 8, v16
    s_cbranch_vccz .fg_79
    s_sub_u32 s82, s82, 1
    s_cmp_lt_i32 s82, 1
    s_cbranch_scc0 .fp_78

.fg_79:
    s_and_b32 s49, s48, 3
    s_cmp_eq_u32 s49, 3
    s_cselect_b64 exec, -1, 0
    s_lshl_b32 s50, s76, 7
    s_add_u32 s50, s50, s65
    s_add_u32 s51, s76, s64
    s_lshl_b32 s51, s51, 1
    buffer_load_dwordx2 v[96:97], v6, s[12:15], s51 offen sc1
    s_add_u32 s51, s51, 36864
    buffer_load_dwordx2 v[98:99], v6, s[12:15], s51 offen sc1
    buffer_load_dwordx2 v[100:101], v7, s[16:19], s50 offen sc1
    s_add_u32 s50, s50, 2359296
    buffer_load_dwordx2 v[20:21], v7, s[16:19], s50 offen sc1
    s_mov_b64 exec, -1
    s_lshl_b32 s50, s77, 7
    s_add_u32 s50, s50, s65
    s_add_u32 s51, s77, s64
    s_lshl_b32 s51, s51, 1
    buffer_load_dwordx2 v[102:103], v6, s[12:15], s51 offen sc1
    s_add_u32 s51, s51, 36864
    buffer_load_dwordx2 v[104:105], v6, s[12:15], s51 offen sc1
    buffer_load_dwordx2 v[106:107], v7, s[16:19], s50 offen sc1
    s_add_u32 s50, s50, 2359296
    buffer_load_dwordx2 v[22:23], v7, s[16:19], s50 offen sc1
    s_waitcnt vmcnt(0)
    v_fma_mix_f32 v32, v96, 1.0, v98 op_sel:[0,0,0] op_sel_hi:[1,0,1]
    v_fma_mix_f32 v33, v96, 1.0, v98 op_sel:[1,0,1] op_sel_hi:[1,0,1]
    v_fma_mix_f32 v34, v97, 1.0, v99 op_sel:[0,0,0] op_sel_hi:[1,0,1]
    v_fma_mix_f32 v35, v97, 1.0, v99 op_sel:[1,0,1] op_sel_hi:[1,0,1]
    v_fma_mix_f32 v36, v102, 1.0, v104 op_sel:[0,0,0] op_sel_hi:[1,0,1]
    v_fma_mix_f32 v37, v102, 1.0, v104 op_sel:[1,0,1] op_sel_hi:[1,0,1]
    v_fma_mix_f32 v38, v103, 1.0, v105 op_sel:[0,0,0] op_sel_hi:[1,0,1]
    v_fma_mix_f32 v39, v103, 1.0, v105 op_sel:[1,0,1] op_sel_hi:[1,0,1]
    v_fma_mix_f32 v32, v100, 1.0, v32 op_sel:[0,0,0] op_sel_hi:[1,0,0]
    v_fma_mix_f32 v33, v100, 1.0, v33 op_sel:[1,0,0] op_sel_hi:[1,0,0]
    v_fma_mix_f32 v34, v101, 1.0, v34 op_sel:[0,0,0] op_sel_hi:[1,0,0]
    v_fma_mix_f32 v35, v101, 1.0, v35 op_sel:[1,0,0] op_sel_hi:[1,0,0]
    v_fma_mix_f32 v36, v106, 1.0, v36 op_sel:[0,0,0] op_sel_hi:[1,0,0]
    v_fma_mix_f32 v37, v106, 1.0, v37 op_sel:[1,0,0] op_sel_hi:[1,0,0]
    v_fma_mix_f32 v38, v107, 1.0, v38 op_sel:[0,0,0] op_sel_hi:[1,0,0]
    v_fma_mix_f32 v39, v107, 1.0, v39 op_sel:[1,0,0] op_sel_hi:[1,0,0]
    v_fma_mix_f32 v44, v20, 1.0, v76 op_sel:[0,0,0] op_sel_hi:[1,0,0]
    v_fma_mix_f32 v45, v20, 1.0, v77 op_sel:[1,0,0] op_sel_hi:[1,0,0]
    v_fma_mix_f32 v46, v21, 1.0, v78 op_sel:[0,0,0] op_sel_hi:[1,0,0]
    v_fma_mix_f32 v47, v21, 1.0, v79 op_sel:[1,0,0] op_sel_hi:[1,0,0]
    v_fma_mix_f32 v48, v22, 1.0, v80 op_sel:[0,0,0] op_sel_hi:[1,0,0]
    v_fma_mix_f32 v49, v22, 1.0, v81 op_sel:[1,0,0] op_sel_hi:[1,0,0]
    v_fma_mix_f32 v50, v23, 1.0, v82 op_sel:[0,0,0] op_sel_hi:[1,0,0]
    v_fma_mix_f32 v51, v23, 1.0, v83 op_sel:[1,0,0] op_sel_hi:[1,0,0]
    v_cvt_pk_bf16_f32 v33, v32, v33
    v_cvt_pk_bf16_f32 v35, v34, v35
    v_lshlrev_b32 v32, 16, v33
    v_lshlrev_b32 v34, 16, v35
    v_and_b32 v33, s99, v33
    v_and_b32 v35, s99, v35
    v_cvt_pk_bf16_f32 v37, v36, v37
    v_cvt_pk_bf16_f32 v39, v38, v39
    v_lshlrev_b32 v36, 16, v37
    v_lshlrev_b32 v38, 16, v39
    v_and_b32 v37, s99, v37
    v_and_b32 v39, s99, v39
    v_mul_f32 v96, s98, v32
    v_mul_f32 v97, s98, v33
    v_mul_f32 v98, s98, v34
    v_mul_f32 v99, s98, v35
    v_mul_f32 v100, s98, v36
    v_mul_f32 v101, s98, v37
    v_mul_f32 v102, s98, v38
    v_mul_f32 v103, s98, v39
    v_exp_f32 v96, -v96
    v_exp_f32 v97, -v97
    v_exp_f32 v98, -v98
    v_exp_f32 v99, -v99
    v_exp_f32 v100, -v100
    v_exp_f32 v101, -v101
    v_exp_f32 v102, -v102
    v_exp_f32 v103, -v103
    v_add_f32 v96, 1.0, v96
    v_add_f32 v97, 1.0, v97
    v_add_f32 v98, 1.0, v98
    v_add_f32 v99, 1.0, v99
    v_add_f32 v100, 1.0, v100
    v_add_f32 v101, 1.0, v101
    v_add_f32 v102, 1.0, v102
    v_add_f32 v103, 1.0, v103
    v_rcp_f32 v96, v96
    v_rcp_f32 v97, v97
    v_rcp_f32 v98, v98
    v_rcp_f32 v99, v99
    v_rcp_f32 v100, v100
    v_rcp_f32 v101, v101
    v_rcp_f32 v102, v102
    v_rcp_f32 v103, v103
    v_mul_f32 v32, v32, v96
    v_mul_f32 v33, v33, v97
    v_mul_f32 v34, v34, v98
    v_mul_f32 v35, v35, v99
    v_mul_f32 v36, v36, v100
    v_mul_f32 v37, v37, v101
    v_mul_f32 v38, v38, v102
    v_mul_f32 v39, v39, v103
    v_cvt_pk_bf16_f32 v33, v32, v33
    v_cvt_pk_bf16_f32 v35, v34, v35
    v_lshlrev_b32 v32, 16, v33
    v_lshlrev_b32 v34, 16, v35
    v_and_b32 v33, s99, v33
    v_and_b32 v35, s99, v35
    v_cvt_pk_bf16_f32 v37, v36, v37
    v_cvt_pk_bf16_f32 v39, v38, v39
    v_lshlrev_b32 v36, 16, v37
    v_lshlrev_b32 v38, 16, v39
    v_and_b32 v37, s99, v37
    v_and_b32 v39, s99, v39
    v_fmac_f32 v64, v44, v32
    v_fmac_f32 v65, v45, v33
    v_fmac_f32 v66, v46, v34
    v_fmac_f32 v67, v47, v35
    v_fmac_f32 v68, v48, v36
    v_fmac_f32 v69, v49, v37
    v_fmac_f32 v70, v50, v38
    v_fmac_f32 v71, v51, v39
    s_and_b32 s49, s48, 3
    s_cmp_eq_u32 s49, 3
    s_cselect_b64 exec, -1, 0
    s_add_u32 s50, s76, s64
    s_lshl_b32 s50, s50, 1
    s_add_u32 s51, s50, 4608
    buffer_store_dword v64, v5, s[12:15], s50 offen offset:0
    buffer_store_dword v65, v5, s[12:15], s50 offen offset:2304
    buffer_store_dword v66, v5, s[12:15], s51 offen offset:0
    buffer_store_dword v67, v5, s[12:15], s51 offen offset:2304
    s_mov_b64 exec, -1
    s_add_u32 s50, s77, s64
    s_lshl_b32 s50, s50, 1
    s_add_u32 s51, s50, 4608
    buffer_store_dword v68, v5, s[12:15], s50 offen offset:0
    buffer_store_dword v69, v5, s[12:15], s50 offen offset:2304
    buffer_store_dword v70, v5, s[12:15], s51 offen offset:0
    buffer_store_dword v71, v5, s[12:15], s51 offen offset:2304
.fp_81:
    buffer_load_dword v16, v17, s[16:19], s62 offen sc1
.f1_83:
    s_waitcnt vmcnt(0)
    v_cmp_gt_u32 vcc, 9, v16
    s_cbranch_vccz .fg_82
    s_sub_u32 s82, s82, 1
    s_cmp_lt_i32 s82, 1
    s_cbranch_scc0 .fp_81

.fg_82:
    s_lshl_b32 s50, s78, 7
    s_add_u32 s50, s50, s65
    s_add_u32 s51, s78, s64
    s_lshl_b32 s51, s51, 1
    buffer_load_dwordx2 v[26:27], v6, s[12:15], s51 offen sc1
    s_add_u32 s51, s51, 36864
    buffer_load_dwordx2 v[28:29], v6, s[12:15], s51 offen sc1
    buffer_load_dwordx2 v[30:31], v7, s[16:19], s50 offen sc1
    s_add_u32 s50, s50, 2359296
    buffer_load_dwordx2 v[24:25], v7, s[16:19], s50 offen sc1
    s_waitcnt vmcnt(0)
    v_fma_mix_f32 v40, v26, 1.0, v28 op_sel:[0,0,0] op_sel_hi:[1,0,1]
    v_fma_mix_f32 v41, v26, 1.0, v28 op_sel:[1,0,1] op_sel_hi:[1,0,1]
    v_fma_mix_f32 v42, v27, 1.0, v29 op_sel:[0,0,0] op_sel_hi:[1,0,1]
    v_fma_mix_f32 v43, v27, 1.0, v29 op_sel:[1,0,1] op_sel_hi:[1,0,1]
    v_fma_mix_f32 v40, v30, 1.0, v40 op_sel:[0,0,0] op_sel_hi:[1,0,0]
    v_fma_mix_f32 v41, v30, 1.0, v41 op_sel:[1,0,0] op_sel_hi:[1,0,0]
    v_fma_mix_f32 v42, v31, 1.0, v42 op_sel:[0,0,0] op_sel_hi:[1,0,0]
    v_fma_mix_f32 v43, v31, 1.0, v43 op_sel:[1,0,0] op_sel_hi:[1,0,0]
    v_fma_mix_f32 v52, v24, 1.0, v84 op_sel:[0,0,0] op_sel_hi:[1,0,0]
    v_fma_mix_f32 v53, v24, 1.0, v85 op_sel:[1,0,0] op_sel_hi:[1,0,0]
    v_fma_mix_f32 v54, v25, 1.0, v86 op_sel:[0,0,0] op_sel_hi:[1,0,0]
    v_fma_mix_f32 v55, v25, 1.0, v87 op_sel:[1,0,0] op_sel_hi:[1,0,0]
    v_cvt_pk_bf16_f32 v41, v40, v41
    v_cvt_pk_bf16_f32 v43, v42, v43
    v_lshlrev_b32 v40, 16, v41
    v_lshlrev_b32 v42, 16, v43
    v_and_b32 v41, s99, v41
    v_and_b32 v43, s99, v43
    v_mul_f32 v104, s98, v40
    v_mul_f32 v105, s98, v41
    v_mul_f32 v106, s98, v42
    v_mul_f32 v107, s98, v43
    v_exp_f32 v104, -v104
    v_exp_f32 v105, -v105
    v_exp_f32 v106, -v106
    v_exp_f32 v107, -v107
    v_add_f32 v104, 1.0, v104
    v_add_f32 v105, 1.0, v105
    v_add_f32 v106, 1.0, v106
    v_add_f32 v107, 1.0, v107
    v_rcp_f32 v104, v104
    v_rcp_f32 v105, v105
    v_rcp_f32 v106, v106
    v_rcp_f32 v107, v107
    v_mul_f32 v40, v40, v104
    v_mul_f32 v41, v41, v105
    v_mul_f32 v42, v42, v106
    v_mul_f32 v43, v43, v107
    v_cvt_pk_bf16_f32 v41, v40, v41
    v_cvt_pk_bf16_f32 v43, v42, v43
    v_lshlrev_b32 v40, 16, v41
    v_lshlrev_b32 v42, 16, v43
    v_and_b32 v41, s99, v41
    v_and_b32 v43, s99, v43
    v_fmac_f32 v72, v52, v40
    v_fmac_f32 v73, v53, v41
    v_fmac_f32 v74, v54, v42
    v_fmac_f32 v75, v55, v43
    s_add_u32 s50, s78, s64
    s_lshl_b32 s50, s50, 1
    s_add_u32 s51, s50, 4608
    buffer_store_dword v72, v5, s[12:15], s50 offen offset:0
    buffer_store_dword v73, v5, s[12:15], s50 offen offset:2304
    buffer_store_dword v74, v5, s[12:15], s51 offen offset:0
    buffer_store_dword v75, v5, s[12:15], s51 offen offset:2304
    s_endpgm
.batch_77:
    s_and_b32 s49, s48, 3
    s_cmp_eq_u32 s49, 3
    s_cselect_b64 exec, -1, 0
    s_lshl_b32 s50, s76, 7
    s_add_u32 s50, s50, s65
    s_add_u32 s51, s76, s64
    s_lshl_b32 s51, s51, 1
    buffer_load_dwordx2 v[96:97], v6, s[12:15], s51 offen sc1
    s_add_u32 s51, s51, 36864
    buffer_load_dwordx2 v[98:99], v6, s[12:15], s51 offen sc1
    buffer_load_dwordx2 v[100:101], v7, s[16:19], s50 offen sc1
    s_add_u32 s50, s50, 2359296
    buffer_load_dwordx2 v[20:21], v7, s[16:19], s50 offen sc1
    s_mov_b64 exec, -1
    s_lshl_b32 s50, s77, 7
    s_add_u32 s50, s50, s65
    s_add_u32 s51, s77, s64
    s_lshl_b32 s51, s51, 1
    buffer_load_dwordx2 v[102:103], v6, s[12:15], s51 offen sc1
    s_add_u32 s51, s51, 36864
    buffer_load_dwordx2 v[104:105], v6, s[12:15], s51 offen sc1
    buffer_load_dwordx2 v[106:107], v7, s[16:19], s50 offen sc1
    s_add_u32 s50, s50, 2359296
    buffer_load_dwordx2 v[22:23], v7, s[16:19], s50 offen sc1
    s_lshl_b32 s50, s78, 7
    s_add_u32 s50, s50, s65
    s_add_u32 s51, s78, s64
    s_lshl_b32 s51, s51, 1
    buffer_load_dwordx2 v[26:27], v6, s[12:15], s51 offen sc1
    s_add_u32 s51, s51, 36864
    buffer_load_dwordx2 v[28:29], v6, s[12:15], s51 offen sc1
    buffer_load_dwordx2 v[30:31], v7, s[16:19], s50 offen sc1
    s_add_u32 s50, s50, 2359296
    buffer_load_dwordx2 v[24:25], v7, s[16:19], s50 offen sc1
    s_waitcnt vmcnt(0)
    v_fma_mix_f32 v32, v96, 1.0, v98 op_sel:[0,0,0] op_sel_hi:[1,0,1]
    v_fma_mix_f32 v33, v96, 1.0, v98 op_sel:[1,0,1] op_sel_hi:[1,0,1]
    v_fma_mix_f32 v34, v97, 1.0, v99 op_sel:[0,0,0] op_sel_hi:[1,0,1]
    v_fma_mix_f32 v35, v97, 1.0, v99 op_sel:[1,0,1] op_sel_hi:[1,0,1]
    v_fma_mix_f32 v36, v102, 1.0, v104 op_sel:[0,0,0] op_sel_hi:[1,0,1]
    v_fma_mix_f32 v37, v102, 1.0, v104 op_sel:[1,0,1] op_sel_hi:[1,0,1]
    v_fma_mix_f32 v38, v103, 1.0, v105 op_sel:[0,0,0] op_sel_hi:[1,0,1]
    v_fma_mix_f32 v39, v103, 1.0, v105 op_sel:[1,0,1] op_sel_hi:[1,0,1]
    v_fma_mix_f32 v40, v26, 1.0, v28 op_sel:[0,0,0] op_sel_hi:[1,0,1]
    v_fma_mix_f32 v41, v26, 1.0, v28 op_sel:[1,0,1] op_sel_hi:[1,0,1]
    v_fma_mix_f32 v42, v27, 1.0, v29 op_sel:[0,0,0] op_sel_hi:[1,0,1]
    v_fma_mix_f32 v43, v27, 1.0, v29 op_sel:[1,0,1] op_sel_hi:[1,0,1]
    v_fma_mix_f32 v32, v100, 1.0, v32 op_sel:[0,0,0] op_sel_hi:[1,0,0]
    v_fma_mix_f32 v33, v100, 1.0, v33 op_sel:[1,0,0] op_sel_hi:[1,0,0]
    v_fma_mix_f32 v34, v101, 1.0, v34 op_sel:[0,0,0] op_sel_hi:[1,0,0]
    v_fma_mix_f32 v35, v101, 1.0, v35 op_sel:[1,0,0] op_sel_hi:[1,0,0]
    v_fma_mix_f32 v36, v106, 1.0, v36 op_sel:[0,0,0] op_sel_hi:[1,0,0]
    v_fma_mix_f32 v37, v106, 1.0, v37 op_sel:[1,0,0] op_sel_hi:[1,0,0]
    v_fma_mix_f32 v38, v107, 1.0, v38 op_sel:[0,0,0] op_sel_hi:[1,0,0]
    v_fma_mix_f32 v39, v107, 1.0, v39 op_sel:[1,0,0] op_sel_hi:[1,0,0]
    v_fma_mix_f32 v40, v30, 1.0, v40 op_sel:[0,0,0] op_sel_hi:[1,0,0]
    v_fma_mix_f32 v41, v30, 1.0, v41 op_sel:[1,0,0] op_sel_hi:[1,0,0]
    v_fma_mix_f32 v42, v31, 1.0, v42 op_sel:[0,0,0] op_sel_hi:[1,0,0]
    v_fma_mix_f32 v43, v31, 1.0, v43 op_sel:[1,0,0] op_sel_hi:[1,0,0]
    v_fma_mix_f32 v44, v20, 1.0, v76 op_sel:[0,0,0] op_sel_hi:[1,0,0]
    v_fma_mix_f32 v45, v20, 1.0, v77 op_sel:[1,0,0] op_sel_hi:[1,0,0]
    v_fma_mix_f32 v46, v21, 1.0, v78 op_sel:[0,0,0] op_sel_hi:[1,0,0]
    v_fma_mix_f32 v47, v21, 1.0, v79 op_sel:[1,0,0] op_sel_hi:[1,0,0]
    v_fma_mix_f32 v48, v22, 1.0, v80 op_sel:[0,0,0] op_sel_hi:[1,0,0]
    v_fma_mix_f32 v49, v22, 1.0, v81 op_sel:[1,0,0] op_sel_hi:[1,0,0]
    v_fma_mix_f32 v50, v23, 1.0, v82 op_sel:[0,0,0] op_sel_hi:[1,0,0]
    v_fma_mix_f32 v51, v23, 1.0, v83 op_sel:[1,0,0] op_sel_hi:[1,0,0]
    v_fma_mix_f32 v52, v24, 1.0, v84 op_sel:[0,0,0] op_sel_hi:[1,0,0]
    v_fma_mix_f32 v53, v24, 1.0, v85 op_sel:[1,0,0] op_sel_hi:[1,0,0]
    v_fma_mix_f32 v54, v25, 1.0, v86 op_sel:[0,0,0] op_sel_hi:[1,0,0]
    v_fma_mix_f32 v55, v25, 1.0, v87 op_sel:[1,0,0] op_sel_hi:[1,0,0]
    v_cvt_pk_bf16_f32 v33, v32, v33
    v_cvt_pk_bf16_f32 v35, v34, v35
    v_lshlrev_b32 v32, 16, v33
    v_lshlrev_b32 v34, 16, v35
    v_and_b32 v33, s99, v33
    v_and_b32 v35, s99, v35
    v_cvt_pk_bf16_f32 v37, v36, v37
    v_cvt_pk_bf16_f32 v39, v38, v39
    v_lshlrev_b32 v36, 16, v37
    v_lshlrev_b32 v38, 16, v39
    v_and_b32 v37, s99, v37
    v_and_b32 v39, s99, v39
    v_cvt_pk_bf16_f32 v41, v40, v41
    v_cvt_pk_bf16_f32 v43, v42, v43
    v_lshlrev_b32 v40, 16, v41
    v_lshlrev_b32 v42, 16, v43
    v_and_b32 v41, s99, v41
    v_and_b32 v43, s99, v43
    v_mul_f32 v96, s98, v32
    v_mul_f32 v97, s98, v33
    v_mul_f32 v98, s98, v34
    v_mul_f32 v99, s98, v35
    v_mul_f32 v100, s98, v36
    v_mul_f32 v101, s98, v37
    v_mul_f32 v102, s98, v38
    v_mul_f32 v103, s98, v39
    v_mul_f32 v104, s98, v40
    v_mul_f32 v105, s98, v41
    v_mul_f32 v106, s98, v42
    v_mul_f32 v107, s98, v43
    v_exp_f32 v96, -v96
    v_exp_f32 v97, -v97
    v_exp_f32 v98, -v98
    v_exp_f32 v99, -v99
    v_exp_f32 v100, -v100
    v_exp_f32 v101, -v101
    v_exp_f32 v102, -v102
    v_exp_f32 v103, -v103
    v_exp_f32 v104, -v104
    v_exp_f32 v105, -v105
    v_exp_f32 v106, -v106
    v_exp_f32 v107, -v107
    v_add_f32 v96, 1.0, v96
    v_add_f32 v97, 1.0, v97
    v_add_f32 v98, 1.0, v98
    v_add_f32 v99, 1.0, v99
    v_add_f32 v100, 1.0, v100
    v_add_f32 v101, 1.0, v101
    v_add_f32 v102, 1.0, v102
    v_add_f32 v103, 1.0, v103
    v_add_f32 v104, 1.0, v104
    v_add_f32 v105, 1.0, v105
    v_add_f32 v106, 1.0, v106
    v_add_f32 v107, 1.0, v107
    v_rcp_f32 v96, v96
    v_rcp_f32 v97, v97
    v_rcp_f32 v98, v98
    v_rcp_f32 v99, v99
    v_rcp_f32 v100, v100
    v_rcp_f32 v101, v101
    v_rcp_f32 v102, v102
    v_rcp_f32 v103, v103
    v_rcp_f32 v104, v104
    v_rcp_f32 v105, v105
    v_rcp_f32 v106, v106
    v_rcp_f32 v107, v107
    v_mul_f32 v32, v32, v96
    v_mul_f32 v33, v33, v97
    v_mul_f32 v34, v34, v98
    v_mul_f32 v35, v35, v99
    v_mul_f32 v36, v36, v100
    v_mul_f32 v37, v37, v101
    v_mul_f32 v38, v38, v102
    v_mul_f32 v39, v39, v103
    v_mul_f32 v40, v40, v104
    v_mul_f32 v41, v41, v105
    v_mul_f32 v42, v42, v106
    v_mul_f32 v43, v43, v107
    v_cvt_pk_bf16_f32 v33, v32, v33
    v_cvt_pk_bf16_f32 v35, v34, v35
    v_lshlrev_b32 v32, 16, v33
    v_lshlrev_b32 v34, 16, v35
    v_and_b32 v33, s99, v33
    v_and_b32 v35, s99, v35
    v_cvt_pk_bf16_f32 v37, v36, v37
    v_cvt_pk_bf16_f32 v39, v38, v39
    v_lshlrev_b32 v36, 16, v37
    v_lshlrev_b32 v38, 16, v39
    v_and_b32 v37, s99, v37
    v_and_b32 v39, s99, v39
    v_cvt_pk_bf16_f32 v41, v40, v41
    v_cvt_pk_bf16_f32 v43, v42, v43
    v_lshlrev_b32 v40, 16, v41
    v_lshlrev_b32 v42, 16, v43
    v_and_b32 v41, s99, v41
    v_and_b32 v43, s99, v43
    v_fmac_f32 v64, v44, v32
    v_fmac_f32 v65, v45, v33
    v_fmac_f32 v66, v46, v34
    v_fmac_f32 v67, v47, v35
    v_fmac_f32 v68, v48, v36
    v_fmac_f32 v69, v49, v37
    v_fmac_f32 v70, v50, v38
    v_fmac_f32 v71, v51, v39
    v_fmac_f32 v72, v52, v40
    v_fmac_f32 v73, v53, v41
    v_fmac_f32 v74, v54, v42
    v_fmac_f32 v75, v55, v43
    s_and_b32 s49, s48, 3
    s_cmp_eq_u32 s49, 3
    s_cselect_b64 exec, -1, 0
    s_add_u32 s50, s76, s64
    s_lshl_b32 s50, s50, 1
    s_add_u32 s51, s50, 4608
    buffer_store_dword v64, v5, s[12:15], s50 offen offset:0
    buffer_store_dword v65, v5, s[12:15], s50 offen offset:2304
    buffer_store_dword v66, v5, s[12:15], s51 offen offset:0
    buffer_store_dword v67, v5, s[12:15], s51 offen offset:2304
    s_mov_b64 exec, -1
    s_add_u32 s50, s77, s64
    s_lshl_b32 s50, s50, 1
    s_add_u32 s51, s50, 4608
    buffer_store_dword v68, v5, s[12:15], s50 offen offset:0
    buffer_store_dword v69, v5, s[12:15], s50 offen offset:2304
    buffer_store_dword v70, v5, s[12:15], s51 offen offset:0
    buffer_store_dword v71, v5, s[12:15], s51 offen offset:2304
    s_add_u32 s50, s78, s64
    s_lshl_b32 s50, s50, 1
    s_add_u32 s51, s50, 4608
    buffer_store_dword v72, v5, s[12:15], s50 offen offset:0
    buffer_store_dword v73, v5, s[12:15], s50 offen offset:2304
    buffer_store_dword v74, v5, s[12:15], s51 offen offset:0
    buffer_store_dword v75, v5, s[12:15], s51 offen offset:2304
    s_endpgm
.yslow_62:
    ds_read_b64_tr_b16 a[0:1], v74 offset:0
    ds_read_b64_tr_b16 a[2:3], v75 offset:256
    ds_read_b64_tr_b16 a[4:5], v74 offset:1024
    ds_read_b64_tr_b16 a[6:7], v75 offset:1280
    ds_read_b64_tr_b16 a[8:9], v74 offset:2048
    ds_read_b64_tr_b16 a[10:11], v75 offset:2304
    ds_read_b64_tr_b16 a[12:13], v74 offset:3072
    ds_read_b64_tr_b16 a[14:15], v75 offset:3328
    ds_read_b128 v[16:19], v94 offset:18432
    ds_read_b128 v[20:23], v97 offset:18432
    ds_read_b128 v[24:27], v100 offset:18432
    s_waitcnt lgkmcnt(2)
    v_mfma_f32_32x32x16_bf16 v[32:47], a[0:3], v[16:19], 0
    ds_read_b128 v[28:31], v103 offset:18432
    ds_read_b64_tr_b16 a[16:17], v74 offset:4096
    ds_read_b64_tr_b16 a[18:19], v75 offset:4352
    ds_read_b64_tr_b16 a[20:21], v74 offset:5120
    ds_read_b64_tr_b16 a[22:23], v75 offset:5376
    s_add_u32 m0, s52, 129024
    s_add_u32 s49, s59, s85
    buffer_load_dwordx4 v1, s[24:27], s49 offen lds
    s_waitcnt lgkmcnt(6)
    v_mfma_f32_32x32x16_bf16 v[32:47], a[4:7], v[20:23], v[32:47]
    ds_read_b128 v[16:19], v94 offset:22528
    ds_read_b64_tr_b16 a[24:25], v74 offset:6144
    ds_read_b64_tr_b16 a[26:27], v75 offset:6400
    ds_read_b64_tr_b16 a[28:29], v74 offset:7168
    ds_read_b64_tr_b16 a[30:31], v75 offset:7424
    s_add_u32 m0, s52, 130048
    s_add_u32 s49, s59, s85
    buffer_load_dwordx4 v2, s[24:27], s49 offen lds
    s_waitcnt lgkmcnt(10)
    v_mfma_f32_32x32x16_bf16 v[32:47], a[8:11], v[24:27], v[32:47]
    ds_read_b128 v[20:23], v97 offset:22528
    ds_read_b64_tr_b16 a[32:33], v74 offset:8192
    ds_read_b64_tr_b16 a[34:35], v75 offset:8448
    ds_read_b64_tr_b16 a[36:37], v74 offset:9216
    ds_read_b64_tr_b16 a[38:39], v75 offset:9472
    s_add_u32 m0, s53, 129024
    s_add_u32 s49, s60, s85
    s_mov_b64 exec, 0xffff
    buffer_load_dwordx4 v15, s[24:27], s49 offen lds
    s_mov_b64 exec, -1
    s_waitcnt lgkmcnt(14)
    v_mfma_f32_32x32x16_bf16 v[32:47], a[12:15], v[28:31], v[32:47]
    ds_read_b128 v[24:27], v100 offset:22528
    ds_read_b64_tr_b16 a[40:41], v74 offset:10240
    ds_read_b64_tr_b16 a[42:43], v75 offset:10496
    ds_read_b64_tr_b16 a[44:45], v74 offset:11264
    ds_read_b64_tr_b16 a[46:47], v75 offset:11520
    s_waitcnt lgkmcnt(14)
    v_mfma_f32_32x32x16_bf16 v[32:47], a[16:19], v[16:19], v[32:47]
    ds_read_b128 v[28:31], v103 offset:22528
    ds_read_b64_tr_b16 a[48:49], v74 offset:12288
    ds_read_b64_tr_b16 a[50:51], v75 offset:12544
    ds_read_b64_tr_b16 a[52:53], v74 offset:13312
    ds_read_b64_tr_b16 a[54:55], v75 offset:13568
    s_waitcnt lgkmcnt(14)
    v_mfma_f32_32x32x16_bf16 v[32:47], a[20:23], v[20:23], v[32:47]
    ds_read_b128 v[16:19], v106 offset:18432
    ds_read_b64_tr_b16 a[56:57], v74 offset:14336
    ds_read_b64_tr_b16 a[58:59], v75 offset:14592
    ds_read_b64_tr_b16 a[60:61], v74 offset:15360
    ds_read_b64_tr_b16 a[62:63], v75 offset:15616
    s_waitcnt lgkmcnt(14)
    v_mfma_f32_32x32x16_bf16 v[32:47], a[24:27], v[24:27], v[32:47]
    ds_read_b128 v[20:23], v94 offset:36864
    ds_read_b64_tr_b16 a[64:65], v74 offset:16384
    ds_read_b64_tr_b16 a[66:67], v75 offset:16640
    ds_read_b64_tr_b16 a[68:69], v74 offset:17408
    ds_read_b64_tr_b16 a[70:71], v75 offset:17664
    s_waitcnt lgkmcnt(14)
    v_mfma_f32_32x32x16_bf16 v[32:47], a[28:31], v[28:31], v[32:47]
    ds_read_b128 v[24:27], v97 offset:36864
    s_waitcnt lgkmcnt(10)
    v_mfma_f32_32x32x16_bf16 v[32:47], a[32:35], v[16:19], v[32:47]
    s_waitcnt lgkmcnt(1)
    s_barrier
    v_mfma_f32_32x32x16_bf16 v[32:47], a[36:39], v[20:23], v[32:47]
    ds_read_b128 v[28:31], v100 offset:36864
    ds_read_b128 v[16:19], v103 offset:36864
    s_add_u32 m0, s52, 18432
    s_add_u32 s49, s59, s86
    buffer_load_dwordx4 v1, s[20:23], s49 offen lds
    s_add_u32 m0, s52, 19456
    s_add_u32 s49, s59, s86
    buffer_load_dwordx4 v2, s[20:23], s49 offen lds
    s_waitcnt lgkmcnt(2)
    v_mfma_f32_32x32x16_bf16 v[32:47], a[40:43], v[24:27], v[32:47]
    ds_read_b128 v[20:23], v94 offset:40960
    s_add_u32 m0, s53, 18432
    s_add_u32 s49, s60, s86
    s_mov_b64 exec, 0xffff
    buffer_load_dwordx4 v15, s[20:23], s49 offen lds
    s_mov_b64 exec, -1
    s_add_u32 m0, s52, 55296
    s_add_u32 s49, s59, s86
    buffer_load_dwordx4 v1, s[24:27], s49 offen lds
    s_waitcnt lgkmcnt(2)
    v_mfma_f32_32x32x16_bf16 v[32:47], a[44:47], v[28:31], v[32:47]
    ds_read_b128 v[24:27], v97 offset:40960
    s_add_u32 m0, s52, 56320
    s_add_u32 s49, s59, s86
    buffer_load_dwordx4 v2, s[24:27], s49 offen lds
    s_add_u32 m0, s53, 55296
    s_add_u32 s49, s60, s86
    s_mov_b64 exec, 0xffff
    buffer_load_dwordx4 v15, s[24:27], s49 offen lds
    s_mov_b64 exec, -1
    s_waitcnt lgkmcnt(2)
    v_mfma_f32_32x32x16_bf16 v[32:47], a[48:51], v[16:19], v[32:47]
    ds_read_b128 v[28:31], v100 offset:40960
    s_add_u32 m0, s52, 73728
    s_add_u32 s49, s59, s87
    buffer_load_dwordx4 v1, s[20:23], s49 offen lds
    s_add_u32 m0, s52, 74752
    s_add_u32 s49, s59, s87
    buffer_load_dwordx4 v2, s[20:23], s49 offen lds
    s_waitcnt lgkmcnt(2)
    v_mfma_f32_32x32x16_bf16 v[32:47], a[52:55], v[20:23], v[32:47]
    ds_read_b128 v[16:19], v103 offset:40960
    s_add_u32 m0, s53, 73728
    s_add_u32 s49, s60, s87
    s_mov_b64 exec, 0xffff
    buffer_load_dwordx4 v15, s[20:23], s49 offen lds
    s_mov_b64 exec, -1
    s_add_u32 m0, s52, 92160
    s_add_u32 s49, s59, s87
    buffer_load_dwordx4 v1, s[24:27], s49 offen lds
    s_waitcnt lgkmcnt(2)
    v_mfma_f32_32x32x16_bf16 v[32:47], a[56:59], v[24:27], v[32:47]
    ds_read_b128 v[20:23], v106 offset:36864
    s_add_u32 m0, s52, 93184
    s_add_u32 s49, s59, s87
    buffer_load_dwordx4 v2, s[24:27], s49 offen lds
    s_add_u32 m0, s53, 92160
    s_add_u32 s49, s60, s87
    s_mov_b64 exec, 0xffff
    buffer_load_dwordx4 v15, s[24:27], s49 offen lds
    s_mov_b64 exec, -1
    s_waitcnt lgkmcnt(2)
    v_mfma_f32_32x32x16_bf16 v[32:47], a[60:63], v[28:31], v[32:47]
    ds_read_b128 v[24:27], v94 offset:0
    s_add_u32 m0, s52, 110592
    s_add_u32 s49, s59, s88
    buffer_load_dwordx4 v1, s[20:23], s49 offen lds
    s_add_u32 m0, s52, 111616
    s_add_u32 s49, s59, s88
    buffer_load_dwordx4 v2, s[20:23], s49 offen lds
    s_waitcnt lgkmcnt(2)
    v_mfma_f32_32x32x16_bf16 v[32:47], a[64:67], v[16:19], v[32:47]
    ds_read_b128 v[28:31], v97 offset:0
    s_add_u32 m0, s53, 110592
    s_add_u32 s49, s60, s88
    s_mov_b64 exec, 0xffff
    buffer_load_dwordx4 v15, s[20:23], s49 offen lds
    s_mov_b64 exec, -1
    s_waitcnt lgkmcnt(2)
    v_mfma_f32_32x32x16_bf16 v[32:47], a[68:71], v[20:23], v[32:47]
    s_waitcnt vmcnt(15)
    s_barrier
    s_waitcnt lgkmcnt(1)
    v_mfma_f32_32x32x16_bf16 v[48:63], a[0:3], v[24:27], 0
    ds_read_b128 v[16:19], v100 offset:0
    ds_read_b128 v[20:23], v103 offset:0
    s_add_u32 m0, s52, 36864
    s_add_u32 s49, s59, s88
    buffer_load_dwordx4 v1, s[24:27], s49 offen lds
    s_waitcnt lgkmcnt(2)
    v_mfma_f32_32x32x16_bf16 v[48:63], a[4:7], v[28:31], v[48:63]
    ds_read_b128 v[24:27], v94 offset:4096
    s_add_u32 m0, s52, 37888
    s_add_u32 s49, s59, s88
    buffer_load_dwordx4 v2, s[24:27], s49 offen lds
    s_waitcnt lgkmcnt(2)
    v_mfma_f32_32x32x16_bf16 v[48:63], a[8:11], v[16:19], v[48:63]
    ds_read_b128 v[28:31], v97 offset:4096
    v_cvt_pk_f16_f32 v32, v32, v33
    v_cvt_pk_f16_f32 v33, v34, v35
    v_cvt_pk_f16_f32 v34, v36, v37
    s_add_u32 m0, s53, 36864
    s_add_u32 s49, s60, s88
    s_mov_b64 exec, 0xffff
    buffer_load_dwordx4 v15, s[24:27], s49 offen lds
    s_mov_b64 exec, -1
    s_waitcnt lgkmcnt(2)
    v_mfma_f32_32x32x16_bf16 v[48:63], a[12:15], v[20:23], v[48:63]
    ds_read_b128 v[16:19], v100 offset:4096
    v_cvt_pk_f16_f32 v35, v38, v39
    v_cvt_pk_f16_f32 v36, v40, v41
    s_waitcnt lgkmcnt(2)
    v_mfma_f32_32x32x16_bf16 v[48:63], a[16:19], v[24:27], v[48:63]
    ds_read_b128 v[20:23], v103 offset:4096
    v_cvt_pk_f16_f32 v37, v42, v43
    v_cvt_pk_f16_f32 v38, v44, v45
    v_cvt_pk_f16_f32 v39, v46, v47
    s_waitcnt lgkmcnt(2)
    v_mfma_f32_32x32x16_bf16 v[48:63], a[20:23], v[28:31], v[48:63]
    ds_read_b128 v[24:27], v106 offset:0
    v_mov_b32 v80, 0
    v_mov_b32 v81, 0
    v_mov_b32 v82, 0
    v_mov_b32 v83, 0
    v_mov_b32 v84, 0
    v_mov_b32 v85, 0
    v_mov_b32 v86, 0
    v_mov_b32 v87, 0
    s_mov_b32 s82, 30000
    s_lshl_b32 s50, s70, 7
    s_add_u32 s50, s50, s56
    buffer_store_dwordx4 v[32:35], v12, s[16:19], s50 offen offset:0 sc0 sc1
    buffer_store_dwordx4 v[36:39], v12, s[16:19], s50 offen offset:1024 sc0 sc1
    s_waitcnt lgkmcnt(2)
    v_mfma_f32_32x32x16_bf16 v[48:63], a[24:27], v[16:19], v[48:63]
    ds_read_b128 v[28:31], v95 offset:63488
    s_waitcnt lgkmcnt(2)
    v_mfma_f32_32x32x16_bf16 v[48:63], a[28:31], v[20:23], v[48:63]
    ds_read_b128 v[16:19], v98 offset:63488
    s_waitcnt lgkmcnt(2)
    v_mfma_f32_32x32x16_bf16 v[48:63], a[32:35], v[24:27], v[48:63]
    s_waitcnt vmcnt(17)
    s_barrier
    s_waitcnt lgkmcnt(1)
    v_mfma_f32_32x32x16_bf16 v[48:63], a[36:39], v[28:31], v[48:63]
    ds_read_b128 v[20:23], v101 offset:63488
    ds_read_b128 v[24:27], v104 offset:63488
    s_add_u32 m0, s52, 0
    s_add_u32 s49, s59, s89
    buffer_load_dwordx4 v1, s[20:23], s49 offen lds
    s_waitcnt lgkmcnt(2)
    v_mfma_f32_32x32x16_bf16 v[48:63], a[40:43], v[16:19], v[48:63]
    ds_read_b128 v[28:31], v96 offset:2048
    s_add_u32 m0, s52, 1024
    s_add_u32 s49, s59, s89
    buffer_load_dwordx4 v2, s[20:23], s49 offen lds
    s_waitcnt lgkmcnt(2)
    v_mfma_f32_32x32x16_bf16 v[48:63], a[44:47], v[20:23], v[48:63]
    ds_read_b128 v[16:19], v99 offset:2048
    s_add_u32 m0, s53, 0
    s_add_u32 s49, s60, s89
    s_mov_b64 exec, 0xffff
    buffer_load_dwordx4 v15, s[20:23], s49 offen lds
    s_mov_b64 exec, -1
    s_waitcnt lgkmcnt(2)
    v_mfma_f32_32x32x16_bf16 v[48:63], a[48:51], v[24:27], v[48:63]
    ds_read_b128 v[20:23], v102 offset:2048
    v_mov_b32 v89, 1
    s_waitcnt vmcnt(3)
    s_mov_b64 exec, 1
    buffer_store_dword v89, off, s[16:19], s42 sc0 sc1
    s_mov_b64 exec, -1
    s_waitcnt lgkmcnt(2)
    v_mfma_f32_32x32x16_bf16 v[48:63], a[52:55], v[28:31], v[48:63]
    ds_read_b128 v[24:27], v105 offset:2048
    s_waitcnt lgkmcnt(2)
    v_mfma_f32_32x32x16_bf16 v[48:63], a[56:59], v[16:19], v[48:63]
    ds_read_b128 v[28:31], v107 offset:63488
    s_waitcnt lgkmcnt(2)
    v_mfma_f32_32x32x16_bf16 v[48:63], a[60:63], v[20:23], v[48:63]
    ds_read_b128 v[16:19], v94 offset:18432
    s_waitcnt lgkmcnt(2)
    v_mfma_f32_32x32x16_bf16 v[48:63], a[64:67], v[24:27], v[48:63]
    ds_read_b128 v[20:23], v97 offset:18432
    s_waitcnt lgkmcnt(2)
    v_mfma_f32_32x32x16_bf16 v[48:63], a[68:71], v[28:31], v[48:63]
    s_barrier
    s_waitcnt lgkmcnt(1)
    v_mfma_f32_32x32x16_bf16 v[32:47], a[0:3], v[16:19], 0
    ds_read_b128 v[24:27], v100 offset:18432
    ds_read_b128 v[28:31], v103 offset:18432
    s_add_u32 m0, s52, 129024
    s_add_u32 s49, s59, s89
    buffer_load_dwordx4 v1, s[24:27], s49 offen lds
    s_waitcnt lgkmcnt(2)
    v_mfma_f32_32x32x16_bf16 v[32:47], a[4:7], v[20:23], v[32:47]
    ds_read_b128 v[16:19], v94 offset:22528
    s_add_u32 m0, s52, 130048
    s_add_u32 s49, s59, s89
    buffer_load_dwordx4 v2, s[24:27], s49 offen lds
    s_waitcnt lgkmcnt(2)
    v_mfma_f32_32x32x16_bf16 v[32:47], a[8:11], v[24:27], v[32:47]
    ds_read_b128 v[20:23], v97 offset:22528
    v_cvt_pk_f16_f32 v48, v48, v49
    v_cvt_pk_f16_f32 v49, v50, v51
    v_cvt_pk_f16_f32 v50, v52, v53
    s_add_u32 m0, s53, 129024
    s_add_u32 s49, s60, s89
    s_mov_b64 exec, 0xffff
    buffer_load_dwordx4 v15, s[24:27], s49 offen lds
    s_mov_b64 exec, -1
    s_waitcnt lgkmcnt(2)
    v_mfma_f32_32x32x16_bf16 v[32:47], a[12:15], v[28:31], v[32:47]
    ds_read_b128 v[24:27], v100 offset:22528
    v_cvt_pk_f16_f32 v51, v54, v55
    v_cvt_pk_f16_f32 v52, v56, v57
    s_waitcnt lgkmcnt(2)
    v_mfma_f32_32x32x16_bf16 v[32:47], a[16:19], v[16:19], v[32:47]
    ds_read_b128 v[28:31], v103 offset:22528
    v_cvt_pk_f16_f32 v53, v58, v59
    v_cvt_pk_f16_f32 v54, v60, v61
    v_cvt_pk_f16_f32 v55, v62, v63
    s_waitcnt lgkmcnt(2)
    v_mfma_f32_32x32x16_bf16 v[32:47], a[20:23], v[20:23], v[32:47]
    ds_read_b128 v[16:19], v106 offset:18432
    s_lshl_b32 s50, s71, 7
    s_add_u32 s50, s50, s56
    buffer_store_dwordx4 v[48:51], v12, s[16:19], s50 offen offset:0 sc0 sc1
    buffer_store_dwordx4 v[52:55], v12, s[16:19], s50 offen offset:1024 sc0 sc1
    s_waitcnt lgkmcnt(2)
    v_mfma_f32_32x32x16_bf16 v[32:47], a[24:27], v[24:27], v[32:47]
    ds_read_b128 v[20:23], v94 offset:55296
    buffer_load_dword v88, off, s[16:19], s43 sc0 sc1
    s_waitcnt lgkmcnt(2)
    v_mfma_f32_32x32x16_bf16 v[32:47], a[28:31], v[28:31], v[32:47]
    ds_read_b128 v[24:27], v97 offset:55296
    s_waitcnt lgkmcnt(2)
    v_mfma_f32_32x32x16_bf16 v[32:47], a[32:35], v[16:19], v[32:47]
    s_barrier
    s_waitcnt lgkmcnt(1)
    v_mfma_f32_32x32x16_bf16 v[32:47], a[36:39], v[20:23], v[32:47]
    ds_read_b128 v[28:31], v100 offset:55296
    ds_read_b128 v[16:19], v103 offset:55296
    s_add_u32 m0, s52, 18432
    s_add_u32 s49, s59, s90
    buffer_load_dwordx4 v1, s[20:23], s49 offen lds
    s_waitcnt lgkmcnt(2)
    v_mfma_f32_32x32x16_bf16 v[32:47], a[40:43], v[24:27], v[32:47]
    ds_read_b128 v[20:23], v94 offset:59392
    s_add_u32 m0, s52, 19456
    s_add_u32 s49, s59, s90
    buffer_load_dwordx4 v2, s[20:23], s49 offen lds
    s_waitcnt lgkmcnt(2)
    v_mfma_f32_32x32x16_bf16 v[32:47], a[44:47], v[28:31], v[32:47]
    ds_read_b128 v[24:27], v97 offset:59392
    s_add_u32 m0, s53, 18432
    s_add_u32 s49, s60, s90
    s_mov_b64 exec, 0xffff
    buffer_load_dwordx4 v15, s[20:23], s49 offen lds
    s_mov_b64 exec, -1
    s_waitcnt lgkmcnt(2)
    v_mfma_f32_32x32x16_bf16 v[32:47], a[48:51], v[16:19], v[32:47]
    ds_read_b128 v[28:31], v100 offset:59392
    v_mov_b32 v89, 2
    s_waitcnt vmcnt(4)
    s_mov_b64 exec, 1
    buffer_store_dword v89, off, s[16:19], s42 sc0 sc1
    s_mov_b64 exec, -1
    s_waitcnt lgkmcnt(2)
    v_mfma_f32_32x32x16_bf16 v[32:47], a[52:55], v[20:23], v[32:47]
    ds_read_b128 v[16:19], v103 offset:59392
    s_waitcnt lgkmcnt(2)
    v_mfma_f32_32x32x16_bf16 v[32:47], a[56:59], v[24:27], v[32:47]
    ds_read_b128 v[20:23], v106 offset:55296
    s_waitcnt vmcnt(4)
.sp_84:
    v_readfirstlane_b32 s50, v88
    s_add_u32 s50, s50, s100
    s_cmp_ge_u32 s50, 3
    s_cbranch_scc1 .ok_85
    s_sub_u32 s82, s82, 1
    s_cmp_lt_i32 s82, 1
    s_cbranch_scc1 .ok_85
    buffer_load_dword v88, off, s[16:19], s43 sc0 sc1
    s_waitcnt vmcnt(0)
    s_branch .sp_84

.ok_85:
    s_lshl_b32 s50, s72, 7
    s_add_u32 s50, s50, s56
    s_cmp_eq_u32 s100, 2
    s_cselect_b64 exec, -1, 0
    buffer_load_dwordx4 v[80:83], v12, s[16:19], s50 offen offset:0 sc0 sc1
    buffer_load_dwordx4 v[84:87], v12, s[16:19], s50 offen offset:1024 sc0 sc1
    s_mov_b64 exec, -1
    s_waitcnt lgkmcnt(2)
    v_mfma_f32_32x32x16_bf16 v[32:47], a[60:63], v[28:31], v[32:47]
    ds_read_b128 v[24:27], v95 offset:8192
    s_waitcnt lgkmcnt(2)
    v_mfma_f32_32x32x16_bf16 v[32:47], a[64:67], v[16:19], v[32:47]
    ds_read_b128 v[28:31], v98 offset:8192
    s_waitcnt lgkmcnt(2)
    v_mfma_f32_32x32x16_bf16 v[32:47], a[68:71], v[20:23], v[32:47]
    s_barrier
    s_waitcnt lgkmcnt(1)
    v_mfma_f32_32x32x16_bf16 v[48:63], a[0:3], v[24:27], 0
    ds_read_b128 v[16:19], v101 offset:8192
    ds_read_b128 v[20:23], v104 offset:8192
    s_add_u32 m0, s52, 55296
    s_add_u32 s49, s59, s90
    buffer_load_dwordx4 v1, s[24:27], s49 offen lds
    s_waitcnt lgkmcnt(2)
    v_mfma_f32_32x32x16_bf16 v[48:63], a[4:7], v[28:31], v[48:63]
    ds_read_b128 v[24:27], v95 offset:12288
    s_add_u32 m0, s52, 56320
    s_add_u32 s49, s59, s90
    buffer_load_dwordx4 v2, s[24:27], s49 offen lds
    s_waitcnt lgkmcnt(2)
    v_mfma_f32_32x32x16_bf16 v[48:63], a[8:11], v[16:19], v[48:63]
    ds_read_b128 v[28:31], v98 offset:12288
    s_waitcnt vmcnt(2)
    v_fma_mix_f32 v32, v80, 1.0, v32 op_sel:[0,0,0] op_sel_hi:[1,0,0]
    v_fma_mix_f32 v33, v80, 1.0, v33 op_sel:[1,0,0] op_sel_hi:[1,0,0]
    v_fma_mix_f32 v34, v81, 1.0, v34 op_sel:[0,0,0] op_sel_hi:[1,0,0]
    v_fma_mix_f32 v35, v81, 1.0, v35 op_sel:[1,0,0] op_sel_hi:[1,0,0]
    v_fma_mix_f32 v36, v82, 1.0, v36 op_sel:[0,0,0] op_sel_hi:[1,0,0]
    s_add_u32 m0, s53, 55296
    s_add_u32 s49, s60, s90
    s_mov_b64 exec, 0xffff
    buffer_load_dwordx4 v15, s[24:27], s49 offen lds
    s_mov_b64 exec, -1
    s_waitcnt lgkmcnt(2)
    v_mfma_f32_32x32x16_bf16 v[48:63], a[12:15], v[20:23], v[48:63]
    ds_read_b128 v[16:19], v101 offset:12288
    v_fma_mix_f32 v37, v82, 1.0, v37 op_sel:[1,0,0] op_sel_hi:[1,0,0]
    v_fma_mix_f32 v38, v83, 1.0, v38 op_sel:[0,0,0] op_sel_hi:[1,0,0]
    v_fma_mix_f32 v39, v83, 1.0, v39 op_sel:[1,0,0] op_sel_hi:[1,0,0]
    v_fma_mix_f32 v40, v84, 1.0, v40 op_sel:[0,0,0] op_sel_hi:[1,0,0]
    v_fma_mix_f32 v41, v84, 1.0, v41 op_sel:[1,0,0] op_sel_hi:[1,0,0]
    v_fma_mix_f32 v42, v85, 1.0, v42 op_sel:[0,0,0] op_sel_hi:[1,0,0]
    s_waitcnt lgkmcnt(2)
    v_mfma_f32_32x32x16_bf16 v[48:63], a[16:19], v[24:27], v[48:63]
    ds_read_b128 v[20:23], v104 offset:12288
    v_fma_mix_f32 v43, v85, 1.0, v43 op_sel:[1,0,0] op_sel_hi:[1,0,0]
    v_fma_mix_f32 v44, v86, 1.0, v44 op_sel:[0,0,0] op_sel_hi:[1,0,0]
    v_fma_mix_f32 v45, v86, 1.0, v45 op_sel:[1,0,0] op_sel_hi:[1,0,0]
    v_fma_mix_f32 v46, v87, 1.0, v46 op_sel:[0,0,0] op_sel_hi:[1,0,0]
    v_fma_mix_f32 v47, v87, 1.0, v47 op_sel:[1,0,0] op_sel_hi:[1,0,0]
    v_cvt_pk_f16_f32 v32, v32, v33
    v_cvt_pk_f16_f32 v33, v34, v35
    s_waitcnt lgkmcnt(2)
    v_mfma_f32_32x32x16_bf16 v[48:63], a[20:23], v[28:31], v[48:63]
    ds_read_b128 v[24:27], v107 offset:8192
    v_cvt_pk_f16_f32 v34, v36, v37
    v_cvt_pk_f16_f32 v35, v38, v39
    v_cvt_pk_f16_f32 v36, v40, v41
    v_cvt_pk_f16_f32 v37, v42, v43
    v_cvt_pk_f16_f32 v38, v44, v45
    v_cvt_pk_f16_f32 v39, v46, v47
    s_waitcnt lgkmcnt(2)
    v_mfma_f32_32x32x16_bf16 v[48:63], a[24:27], v[16:19], v[48:63]
    ds_read_b128 v[28:31], v95 offset:26624
    s_lshl_b32 s50, s72, 7
    s_add_u32 s50, s50, s56
    buffer_store_dwordx4 v[32:35], v12, s[16:19], s50 offen offset:0 sc0 sc1
    buffer_store_dwordx4 v[36:39], v12, s[16:19], s50 offen offset:1024 sc0 sc1
    buffer_load_dword v88, off, s[16:19], s43 sc0 sc1
    s_waitcnt lgkmcnt(2)
    v_mfma_f32_32x32x16_bf16 v[48:63], a[28:31], v[20:23], v[48:63]
    ds_read_b128 v[16:19], v98 offset:26624
    s_waitcnt lgkmcnt(2)
    v_mfma_f32_32x32x16_bf16 v[48:63], a[32:35], v[24:27], v[48:63]
    s_barrier
    s_waitcnt lgkmcnt(1)
    v_mfma_f32_32x32x16_bf16 v[48:63], a[36:39], v[28:31], v[48:63]
    ds_read_b128 v[20:23], v101 offset:26624
    ds_read_b128 v[24:27], v104 offset:26624
    s_add_u32 m0, s52, 73728
    s_add_u32 s49, s59, s91
    buffer_load_dwordx4 v1, s[20:23], s49 offen lds
    s_waitcnt lgkmcnt(2)
    v_mfma_f32_32x32x16_bf16 v[48:63], a[40:43], v[16:19], v[48:63]
    ds_read_b128 v[28:31], v95 offset:30720
    s_add_u32 m0, s52, 74752
    s_add_u32 s49, s59, s91
    buffer_load_dwordx4 v2, s[20:23], s49 offen lds
    s_waitcnt lgkmcnt(2)
    v_mfma_f32_32x32x16_bf16 v[48:63], a[44:47], v[20:23], v[48:63]
    ds_read_b128 v[16:19], v98 offset:30720
    s_add_u32 m0, s53, 73728
    s_add_u32 s49, s60, s91
    s_mov_b64 exec, 0xffff
    buffer_load_dwordx4 v15, s[20:23], s49 offen lds
    s_mov_b64 exec, -1
    s_waitcnt lgkmcnt(2)
    v_mfma_f32_32x32x16_bf16 v[48:63], a[48:51], v[24:27], v[48:63]
    ds_read_b128 v[20:23], v101 offset:30720
    v_mov_b32 v89, 3
    s_waitcnt vmcnt(4)
    s_mov_b64 exec, 1
    buffer_store_dword v89, off, s[16:19], s42 sc0 sc1
    s_mov_b64 exec, -1
    s_waitcnt lgkmcnt(2)
    v_mfma_f32_32x32x16_bf16 v[48:63], a[52:55], v[28:31], v[48:63]
    ds_read_b128 v[24:27], v104 offset:30720
    s_waitcnt lgkmcnt(2)
    v_mfma_f32_32x32x16_bf16 v[48:63], a[56:59], v[16:19], v[48:63]
    ds_read_b128 v[28:31], v107 offset:26624
    s_waitcnt vmcnt(4)
.sp_86:
    v_readfirstlane_b32 s50, v88
    s_add_u32 s50, s50, s100
    s_cmp_ge_u32 s50, 4
    s_cbranch_scc1 .ok_87
    s_sub_u32 s82, s82, 1
    s_cmp_lt_i32 s82, 1
    s_cbranch_scc1 .ok_87
    buffer_load_dword v88, off, s[16:19], s43 sc0 sc1
    s_waitcnt vmcnt(0)
    s_branch .sp_86

.ok_87:
    s_lshl_b32 s50, s73, 7
    s_add_u32 s50, s50, s56
    buffer_load_dwordx4 v[80:83], v12, s[16:19], s50 offen offset:0 sc0 sc1
    buffer_load_dwordx4 v[84:87], v12, s[16:19], s50 offen offset:1024 sc0 sc1
    s_waitcnt lgkmcnt(2)
    v_mfma_f32_32x32x16_bf16 v[48:63], a[60:63], v[20:23], v[48:63]
    ds_read_b128 v[16:19], v95 offset:45056
    s_waitcnt lgkmcnt(2)
    v_mfma_f32_32x32x16_bf16 v[48:63], a[64:67], v[24:27], v[48:63]
    ds_read_b128 v[20:23], v98 offset:45056
    s_waitcnt lgkmcnt(2)
    v_mfma_f32_32x32x16_bf16 v[48:63], a[68:71], v[28:31], v[48:63]
    s_barrier
    s_waitcnt lgkmcnt(1)
    v_mfma_f32_32x32x16_bf16 v[32:47], a[0:3], v[16:19], 0
    ds_read_b128 v[24:27], v101 offset:45056
    ds_read_b128 v[28:31], v104 offset:45056
    s_add_u32 m0, s52, 92160
    s_add_u32 s49, s59, s91
    buffer_load_dwordx4 v1, s[24:27], s49 offen lds
    s_waitcnt lgkmcnt(2)
    v_mfma_f32_32x32x16_bf16 v[32:47], a[4:7], v[20:23], v[32:47]
    ds_read_b128 v[16:19], v95 offset:49152
    s_add_u32 m0, s52, 93184
    s_add_u32 s49, s59, s91
    buffer_load_dwordx4 v2, s[24:27], s49 offen lds
    s_waitcnt lgkmcnt(2)
    v_mfma_f32_32x32x16_bf16 v[32:47], a[8:11], v[24:27], v[32:47]
    ds_read_b128 v[20:23], v98 offset:49152
    s_waitcnt vmcnt(2)
    v_fma_mix_f32 v48, v80, 1.0, v48 op_sel:[0,0,0] op_sel_hi:[1,0,0]
    v_fma_mix_f32 v49, v80, 1.0, v49 op_sel:[1,0,0] op_sel_hi:[1,0,0]
    v_fma_mix_f32 v50, v81, 1.0, v50 op_sel:[0,0,0] op_sel_hi:[1,0,0]
    v_fma_mix_f32 v51, v81, 1.0, v51 op_sel:[1,0,0] op_sel_hi:[1,0,0]
    v_fma_mix_f32 v52, v82, 1.0, v52 op_sel:[0,0,0] op_sel_hi:[1,0,0]
    s_add_u32 m0, s53, 92160
    s_add_u32 s49, s60, s91
    s_mov_b64 exec, 0xffff
    buffer_load_dwordx4 v15, s[24:27], s49 offen lds
    s_mov_b64 exec, -1
    s_waitcnt lgkmcnt(2)
    v_mfma_f32_32x32x16_bf16 v[32:47], a[12:15], v[28:31], v[32:47]
    ds_read_b128 v[24:27], v101 offset:49152
    v_fma_mix_f32 v53, v82, 1.0, v53 op_sel:[1,0,0] op_sel_hi:[1,0,0]
    v_fma_mix_f32 v54, v83, 1.0, v54 op_sel:[0,0,0] op_sel_hi:[1,0,0]
    v_fma_mix_f32 v55, v83, 1.0, v55 op_sel:[1,0,0] op_sel_hi:[1,0,0]
    v_fma_mix_f32 v56, v84, 1.0, v56 op_sel:[0,0,0] op_sel_hi:[1,0,0]
    v_fma_mix_f32 v57, v84, 1.0, v57 op_sel:[1,0,0] op_sel_hi:[1,0,0]
    v_fma_mix_f32 v58, v85, 1.0, v58 op_sel:[0,0,0] op_sel_hi:[1,0,0]
    s_waitcnt lgkmcnt(2)
    v_mfma_f32_32x32x16_bf16 v[32:47], a[16:19], v[16:19], v[32:47]
    ds_read_b128 v[28:31], v104 offset:49152
    v_fma_mix_f32 v59, v85, 1.0, v59 op_sel:[1,0,0] op_sel_hi:[1,0,0]
    v_fma_mix_f32 v60, v86, 1.0, v60 op_sel:[0,0,0] op_sel_hi:[1,0,0]
    v_fma_mix_f32 v61, v86, 1.0, v61 op_sel:[1,0,0] op_sel_hi:[1,0,0]
    v_fma_mix_f32 v62, v87, 1.0, v62 op_sel:[0,0,0] op_sel_hi:[1,0,0]
    v_fma_mix_f32 v63, v87, 1.0, v63 op_sel:[1,0,0] op_sel_hi:[1,0,0]
    v_cvt_pk_f16_f32 v48, v48, v49
    v_cvt_pk_f16_f32 v49, v50, v51
    s_waitcnt lgkmcnt(2)
    v_mfma_f32_32x32x16_bf16 v[32:47], a[20:23], v[20:23], v[32:47]
    ds_read_b128 v[16:19], v107 offset:45056
    v_cvt_pk_f16_f32 v50, v52, v53
    v_cvt_pk_f16_f32 v51, v54, v55
    v_cvt_pk_f16_f32 v52, v56, v57
    v_cvt_pk_f16_f32 v53, v58, v59
    v_cvt_pk_f16_f32 v54, v60, v61
    v_cvt_pk_f16_f32 v55, v62, v63
    s_waitcnt lgkmcnt(2)
    v_mfma_f32_32x32x16_bf16 v[32:47], a[24:27], v[24:27], v[32:47]
    ds_read_b128 v[20:23], v94 offset:36864
    s_lshl_b32 s50, s73, 7
    s_add_u32 s50, s50, s56
    buffer_store_dwordx4 v[48:51], v12, s[16:19], s50 offen offset:0 sc0 sc1
    buffer_store_dwordx4 v[52:55], v12, s[16:19], s50 offen offset:1024 sc0 sc1
    buffer_load_dword v88, off, s[16:19], s43 sc0 sc1
    s_waitcnt lgkmcnt(2)
    v_mfma_f32_32x32x16_bf16 v[32:47], a[28:31], v[28:31], v[32:47]
    ds_read_b128 v[24:27], v97 offset:36864
    s_waitcnt lgkmcnt(2)
    v_mfma_f32_32x32x16_bf16 v[32:47], a[32:35], v[16:19], v[32:47]
    s_barrier
    s_waitcnt lgkmcnt(1)
    v_mfma_f32_32x32x16_bf16 v[32:47], a[36:39], v[20:23], v[32:47]
    ds_read_b128 v[28:31], v100 offset:36864
    ds_read_b128 v[16:19], v103 offset:36864
    s_add_u32 m0, s52, 110592
    s_add_u32 s49, s59, s92
    buffer_load_dwordx4 v1, s[20:23], s49 offen lds
    s_waitcnt lgkmcnt(2)
    v_mfma_f32_32x32x16_bf16 v[32:47], a[40:43], v[24:27], v[32:47]
    ds_read_b128 v[20:23], v94 offset:40960
    s_add_u32 m0, s52, 111616
    s_add_u32 s49, s59, s92
    buffer_load_dwordx4 v2, s[20:23], s49 offen lds
    s_waitcnt lgkmcnt(2)
    v_mfma_f32_32x32x16_bf16 v[32:47], a[44:47], v[28:31], v[32:47]
    ds_read_b128 v[24:27], v97 offset:40960
    s_add_u32 m0, s53, 110592
    s_add_u32 s49, s60, s92
    s_mov_b64 exec, 0xffff
    buffer_load_dwordx4 v15, s[20:23], s49 offen lds
    s_mov_b64 exec, -1
    s_waitcnt lgkmcnt(2)
    v_mfma_f32_32x32x16_bf16 v[32:47], a[48:51], v[16:19], v[32:47]
    ds_read_b128 v[28:31], v100 offset:40960
    v_mov_b32 v89, 4
    s_waitcnt vmcnt(4)
    s_mov_b64 exec, 1
    buffer_store_dword v89, off, s[16:19], s42 sc0 sc1
    s_mov_b64 exec, -1
    s_waitcnt lgkmcnt(2)
    v_mfma_f32_32x32x16_bf16 v[32:47], a[52:55], v[20:23], v[32:47]
    ds_read_b128 v[16:19], v103 offset:40960
    s_waitcnt lgkmcnt(2)
    v_mfma_f32_32x32x16_bf16 v[32:47], a[56:59], v[24:27], v[32:47]
    ds_read_b128 v[20:23], v106 offset:36864
    s_waitcnt vmcnt(4)
.sp_88:
    v_readfirstlane_b32 s50, v88
    s_add_u32 s50, s50, s100
    s_cmp_ge_u32 s50, 5
    s_cbranch_scc1 .ok_89
    s_sub_u32 s82, s82, 1
    s_cmp_lt_i32 s82, 1
    s_cbranch_scc1 .ok_89
    buffer_load_dword v88, off, s[16:19], s43 sc0 sc1
    s_waitcnt vmcnt(0)
    s_branch .sp_88

.ok_89:
    s_lshl_b32 s50, s74, 7
    s_add_u32 s50, s50, s56
    buffer_load_dwordx4 v[80:83], v12, s[16:19], s50 offen offset:0 sc0 sc1
    buffer_load_dwordx4 v[84:87], v12, s[16:19], s50 offen offset:1024 sc0 sc1
    s_waitcnt lgkmcnt(2)
    v_mfma_f32_32x32x16_bf16 v[32:47], a[60:63], v[28:31], v[32:47]
    ds_read_b128 v[24:27], v94 offset:0
    s_waitcnt lgkmcnt(2)
    v_mfma_f32_32x32x16_bf16 v[32:47], a[64:67], v[16:19], v[32:47]
    ds_read_b128 v[28:31], v97 offset:0
    s_waitcnt lgkmcnt(2)
    v_mfma_f32_32x32x16_bf16 v[32:47], a[68:71], v[20:23], v[32:47]
    s_barrier
    s_waitcnt lgkmcnt(1)
    v_mfma_f32_32x32x16_bf16 v[48:63], a[0:3], v[24:27], 0
    ds_read_b128 v[16:19], v100 offset:0
    ds_read_b128 v[20:23], v103 offset:0
    s_add_u32 m0, s52, 36864
    s_add_u32 s49, s59, s92
    buffer_load_dwordx4 v1, s[24:27], s49 offen lds
    s_waitcnt lgkmcnt(2)
    v_mfma_f32_32x32x16_bf16 v[48:63], a[4:7], v[28:31], v[48:63]
    ds_read_b128 v[24:27], v94 offset:4096
    s_add_u32 m0, s52, 37888
    s_add_u32 s49, s59, s92
    buffer_load_dwordx4 v2, s[24:27], s49 offen lds
    s_waitcnt lgkmcnt(2)
    v_mfma_f32_32x32x16_bf16 v[48:63], a[8:11], v[16:19], v[48:63]
    ds_read_b128 v[28:31], v97 offset:4096
    s_waitcnt vmcnt(2)
    v_fma_mix_f32 v32, v80, 1.0, v32 op_sel:[0,0,0] op_sel_hi:[1,0,0]
    v_fma_mix_f32 v33, v80, 1.0, v33 op_sel:[1,0,0] op_sel_hi:[1,0,0]
    v_fma_mix_f32 v34, v81, 1.0, v34 op_sel:[0,0,0] op_sel_hi:[1,0,0]
    v_fma_mix_f32 v35, v81, 1.0, v35 op_sel:[1,0,0] op_sel_hi:[1,0,0]
    v_fma_mix_f32 v36, v82, 1.0, v36 op_sel:[0,0,0] op_sel_hi:[1,0,0]
    s_add_u32 m0, s53, 36864
    s_add_u32 s49, s60, s92
    s_mov_b64 exec, 0xffff
    buffer_load_dwordx4 v15, s[24:27], s49 offen lds
    s_mov_b64 exec, -1
    s_waitcnt lgkmcnt(2)
    v_mfma_f32_32x32x16_bf16 v[48:63], a[12:15], v[20:23], v[48:63]
    ds_read_b128 v[16:19], v100 offset:4096
    v_fma_mix_f32 v37, v82, 1.0, v37 op_sel:[1,0,0] op_sel_hi:[1,0,0]
    v_fma_mix_f32 v38, v83, 1.0, v38 op_sel:[0,0,0] op_sel_hi:[1,0,0]
    v_fma_mix_f32 v39, v83, 1.0, v39 op_sel:[1,0,0] op_sel_hi:[1,0,0]
    v_fma_mix_f32 v40, v84, 1.0, v40 op_sel:[0,0,0] op_sel_hi:[1,0,0]
    v_fma_mix_f32 v41, v84, 1.0, v41 op_sel:[1,0,0] op_sel_hi:[1,0,0]
    v_fma_mix_f32 v42, v85, 1.0, v42 op_sel:[0,0,0] op_sel_hi:[1,0,0]
    s_waitcnt lgkmcnt(2)
    v_mfma_f32_32x32x16_bf16 v[48:63], a[16:19], v[24:27], v[48:63]
    ds_read_b128 v[20:23], v103 offset:4096
    v_fma_mix_f32 v43, v85, 1.0, v43 op_sel:[1,0,0] op_sel_hi:[1,0,0]
    v_fma_mix_f32 v44, v86, 1.0, v44 op_sel:[0,0,0] op_sel_hi:[1,0,0]
    v_fma_mix_f32 v45, v86, 1.0, v45 op_sel:[1,0,0] op_sel_hi:[1,0,0]
    v_fma_mix_f32 v46, v87, 1.0, v46 op_sel:[0,0,0] op_sel_hi:[1,0,0]
    v_fma_mix_f32 v47, v87, 1.0, v47 op_sel:[1,0,0] op_sel_hi:[1,0,0]
    v_cvt_pk_f16_f32 v32, v32, v33
    v_cvt_pk_f16_f32 v33, v34, v35
    s_waitcnt lgkmcnt(2)
    v_mfma_f32_32x32x16_bf16 v[48:63], a[20:23], v[28:31], v[48:63]
    ds_read_b128 v[24:27], v106 offset:0
    v_cvt_pk_f16_f32 v34, v36, v37
    v_cvt_pk_f16_f32 v35, v38, v39
    v_cvt_pk_f16_f32 v36, v40, v41
    v_cvt_pk_f16_f32 v37, v42, v43
    v_cvt_pk_f16_f32 v38, v44, v45
    v_cvt_pk_f16_f32 v39, v46, v47
    s_waitcnt lgkmcnt(2)
    v_mfma_f32_32x32x16_bf16 v[48:63], a[24:27], v[16:19], v[48:63]
    ds_read_b128 v[28:31], v95 offset:63488
    s_lshl_b32 s50, s74, 7
    s_add_u32 s50, s50, s56
    buffer_store_dwordx4 v[32:35], v12, s[16:19], s50 offen offset:0 sc0 sc1
    buffer_store_dwordx4 v[36:39], v12, s[16:19], s50 offen offset:1024 sc0 sc1
    buffer_load_dword v88, off, s[16:19], s43 sc0 sc1
    s_waitcnt lgkmcnt(2)
    v_mfma_f32_32x32x16_bf16 v[48:63], a[28:31], v[20:23], v[48:63]
    ds_read_b128 v[16:19], v98 offset:63488
    s_waitcnt lgkmcnt(2)
    v_mfma_f32_32x32x16_bf16 v[48:63], a[32:35], v[24:27], v[48:63]
    s_barrier
    s_waitcnt lgkmcnt(1)
    v_mfma_f32_32x32x16_bf16 v[48:63], a[36:39], v[28:31], v[48:63]
    ds_read_b128 v[20:23], v101 offset:63488
    ds_read_b128 v[24:27], v104 offset:63488
    s_waitcnt lgkmcnt(2)
    v_mfma_f32_32x32x16_bf16 v[48:63], a[40:43], v[16:19], v[48:63]
    ds_read_b128 v[28:31], v96 offset:2048
    s_waitcnt lgkmcnt(2)
    v_mfma_f32_32x32x16_bf16 v[48:63], a[44:47], v[20:23], v[48:63]
    ds_read_b128 v[16:19], v99 offset:2048
    s_waitcnt lgkmcnt(2)
    v_mfma_f32_32x32x16_bf16 v[48:63], a[48:51], v[24:27], v[48:63]
    ds_read_b128 v[20:23], v102 offset:2048
    v_mov_b32 v89, 5
    s_waitcnt vmcnt(1)
    s_mov_b64 exec, 1
    buffer_store_dword v89, off, s[16:19], s42 sc0 sc1
    s_mov_b64 exec, -1
    s_waitcnt lgkmcnt(2)
    v_mfma_f32_32x32x16_bf16 v[48:63], a[52:55], v[28:31], v[48:63]
    ds_read_b128 v[24:27], v105 offset:2048
    s_waitcnt lgkmcnt(2)
    v_mfma_f32_32x32x16_bf16 v[48:63], a[56:59], v[16:19], v[48:63]
    ds_read_b128 v[28:31], v107 offset:63488
    s_waitcnt vmcnt(1)
.sp_90:
    v_readfirstlane_b32 s50, v88
    s_add_u32 s50, s50, s100
    s_cmp_ge_u32 s50, 6
    s_cbranch_scc1 .ok_91
    s_sub_u32 s82, s82, 1
    s_cmp_lt_i32 s82, 1
    s_cbranch_scc1 .ok_91
    buffer_load_dword v88, off, s[16:19], s43 sc0 sc1
    s_waitcnt vmcnt(0)
    s_branch .sp_90

.ok_91:
    s_lshl_b32 s50, s75, 7
    s_add_u32 s50, s50, s56
    buffer_load_dwordx4 v[80:83], v12, s[16:19], s50 offen offset:0 sc0 sc1
    buffer_load_dwordx4 v[84:87], v12, s[16:19], s50 offen offset:1024 sc0 sc1
    s_waitcnt lgkmcnt(2)
    v_mfma_f32_32x32x16_bf16 v[48:63], a[60:63], v[20:23], v[48:63]
    ds_read_b128 v[16:19], v94 offset:18432
    s_waitcnt lgkmcnt(2)
    v_mfma_f32_32x32x16_bf16 v[48:63], a[64:67], v[24:27], v[48:63]
    ds_read_b128 v[20:23], v97 offset:18432
    s_waitcnt lgkmcnt(2)
    v_mfma_f32_32x32x16_bf16 v[48:63], a[68:71], v[28:31], v[48:63]
    s_barrier
    s_waitcnt lgkmcnt(1)
    v_mfma_f32_32x32x16_bf16 v[32:47], a[0:3], v[16:19], 0
    ds_read_b128 v[24:27], v100 offset:18432
    ds_read_b128 v[28:31], v103 offset:18432
    s_waitcnt lgkmcnt(2)
    v_mfma_f32_32x32x16_bf16 v[32:47], a[4:7], v[20:23], v[32:47]
    ds_read_b128 v[16:19], v94 offset:22528
    s_waitcnt lgkmcnt(2)
    v_mfma_f32_32x32x16_bf16 v[32:47], a[8:11], v[24:27], v[32:47]
    ds_read_b128 v[20:23], v97 offset:22528
    s_waitcnt vmcnt(0)
    v_fma_mix_f32 v48, v80, 1.0, v48 op_sel:[0,0,0] op_sel_hi:[1,0,0]
    v_fma_mix_f32 v49, v80, 1.0, v49 op_sel:[1,0,0] op_sel_hi:[1,0,0]
    v_fma_mix_f32 v50, v81, 1.0, v50 op_sel:[0,0,0] op_sel_hi:[1,0,0]
    v_fma_mix_f32 v51, v81, 1.0, v51 op_sel:[1,0,0] op_sel_hi:[1,0,0]
    v_fma_mix_f32 v52, v82, 1.0, v52 op_sel:[0,0,0] op_sel_hi:[1,0,0]
    s_waitcnt lgkmcnt(2)
    v_mfma_f32_32x32x16_bf16 v[32:47], a[12:15], v[28:31], v[32:47]
    ds_read_b128 v[24:27], v100 offset:22528
    v_fma_mix_f32 v53, v82, 1.0, v53 op_sel:[1,0,0] op_sel_hi:[1,0,0]
    v_fma_mix_f32 v54, v83, 1.0, v54 op_sel:[0,0,0] op_sel_hi:[1,0,0]
    v_fma_mix_f32 v55, v83, 1.0, v55 op_sel:[1,0,0] op_sel_hi:[1,0,0]
    v_fma_mix_f32 v56, v84, 1.0, v56 op_sel:[0,0,0] op_sel_hi:[1,0,0]
    v_fma_mix_f32 v57, v84, 1.0, v57 op_sel:[1,0,0] op_sel_hi:[1,0,0]
    v_fma_mix_f32 v58, v85, 1.0, v58 op_sel:[0,0,0] op_sel_hi:[1,0,0]
    s_waitcnt lgkmcnt(2)
    v_mfma_f32_32x32x16_bf16 v[32:47], a[16:19], v[16:19], v[32:47]
    ds_read_b128 v[28:31], v103 offset:22528
    v_fma_mix_f32 v59, v85, 1.0, v59 op_sel:[1,0,0] op_sel_hi:[1,0,0]
    v_fma_mix_f32 v60, v86, 1.0, v60 op_sel:[0,0,0] op_sel_hi:[1,0,0]
    v_fma_mix_f32 v61, v86, 1.0, v61 op_sel:[1,0,0] op_sel_hi:[1,0,0]
    v_fma_mix_f32 v62, v87, 1.0, v62 op_sel:[0,0,0] op_sel_hi:[1,0,0]
    v_fma_mix_f32 v63, v87, 1.0, v63 op_sel:[1,0,0] op_sel_hi:[1,0,0]
    v_cvt_pk_f16_f32 v48, v48, v49
    v_cvt_pk_f16_f32 v49, v50, v51
    s_waitcnt lgkmcnt(2)
    v_mfma_f32_32x32x16_bf16 v[32:47], a[20:23], v[20:23], v[32:47]
    ds_read_b128 v[16:19], v106 offset:18432
    v_cvt_pk_f16_f32 v50, v52, v53
    v_cvt_pk_f16_f32 v51, v54, v55
    v_cvt_pk_f16_f32 v52, v56, v57
    v_cvt_pk_f16_f32 v53, v58, v59
    v_cvt_pk_f16_f32 v54, v60, v61
    v_cvt_pk_f16_f32 v55, v62, v63
    s_waitcnt lgkmcnt(2)
    v_mfma_f32_32x32x16_bf16 v[32:47], a[24:27], v[24:27], v[32:47]
    ds_read_b128 v[20:23], v94 offset:55296
    s_lshl_b32 s50, s75, 7
    s_add_u32 s50, s50, s56
    buffer_store_dwordx4 v[48:51], v12, s[16:19], s50 offen offset:0 sc0 sc1
    buffer_store_dwordx4 v[52:55], v12, s[16:19], s50 offen offset:1024 sc0 sc1
    buffer_load_dword v88, off, s[16:19], s43 sc0 sc1
    s_waitcnt lgkmcnt(2)
    v_mfma_f32_32x32x16_bf16 v[32:47], a[28:31], v[28:31], v[32:47]
    ds_read_b128 v[24:27], v97 offset:55296
    s_waitcnt lgkmcnt(2)
    v_mfma_f32_32x32x16_bf16 v[32:47], a[32:35], v[16:19], v[32:47]
    s_barrier
    s_waitcnt lgkmcnt(1)
    v_mfma_f32_32x32x16_bf16 v[32:47], a[36:39], v[20:23], v[32:47]
    ds_read_b128 v[28:31], v100 offset:55296
    ds_read_b128 v[16:19], v103 offset:55296
    s_waitcnt lgkmcnt(2)
    v_mfma_f32_32x32x16_bf16 v[32:47], a[40:43], v[24:27], v[32:47]
    ds_read_b128 v[20:23], v94 offset:59392
    s_waitcnt lgkmcnt(2)
    v_mfma_f32_32x32x16_bf16 v[32:47], a[44:47], v[28:31], v[32:47]
    ds_read_b128 v[24:27], v97 offset:59392
    s_waitcnt lgkmcnt(2)
    v_mfma_f32_32x32x16_bf16 v[32:47], a[48:51], v[16:19], v[32:47]
    ds_read_b128 v[28:31], v100 offset:59392
    v_mov_b32 v89, 6
    s_waitcnt vmcnt(1)
    s_mov_b64 exec, 1
    buffer_store_dword v89, off, s[16:19], s42 sc0 sc1
    s_mov_b64 exec, -1
    s_waitcnt lgkmcnt(2)
    v_mfma_f32_32x32x16_bf16 v[32:47], a[52:55], v[20:23], v[32:47]
    ds_read_b128 v[16:19], v103 offset:59392
    s_waitcnt lgkmcnt(2)
    v_mfma_f32_32x32x16_bf16 v[32:47], a[56:59], v[24:27], v[32:47]
    ds_read_b128 v[20:23], v106 offset:55296
    s_waitcnt vmcnt(1)
.sp_92:
    v_readfirstlane_b32 s50, v88
    s_add_u32 s50, s50, s100
    s_cmp_ge_u32 s50, 7
    s_cbranch_scc1 .ok_93
    s_sub_u32 s82, s82, 1
    s_cmp_lt_i32 s82, 1
    s_cbranch_scc1 .ok_93
    buffer_load_dword v88, off, s[16:19], s43 sc0 sc1
    s_waitcnt vmcnt(0)
    s_branch .sp_92

.ok_93:
    s_lshl_b32 s50, s76, 7
    s_add_u32 s50, s50, s56
    buffer_load_dwordx4 v[80:83], v12, s[16:19], s50 offen offset:0 sc0 sc1
    buffer_load_dwordx4 v[84:87], v12, s[16:19], s50 offen offset:1024 sc0 sc1
    s_waitcnt lgkmcnt(2)
    v_mfma_f32_32x32x16_bf16 v[32:47], a[60:63], v[28:31], v[32:47]
    ds_read_b128 v[24:27], v95 offset:8192
    v_lshrrev_b32 v4, 8, v12
    v_bfe_u32 v3, v12, 4, 4
    v_lshlrev_b32 v3, 1, v3
    v_lshlrev_b32 v0, 6, v4
    v_mul_u32_u24 v4, 9216, v4
    v_add_u32 v4, v4, v3
    v_lshlrev_b32 v5, 1, v4
    s_lshr_b32 s49, s48, 2
    s_lshr_b32 s51, s48, 3
    s_lshl_b32 s50, s45, 3
    s_add_u32 s50, s50, s51
    s_lshl_b32 s51, s50, 5
    s_add_u32 s51, s51, 153600
    v_add_u32 v0, s51, v0
    s_lshl_b32 s51, s47, 5
    s_add_u32 s50, s50, s51
    s_mul_i32 s64, s50, 4608
    s_lshl_b32 s63, s46, 6
    s_and_b32 s51, s49, 1
    s_lshl_b32 s51, s51, 5
    s_add_u32 s63, s63, s51
    s_add_u32 s64, s64, s63
    s_mul_i32 s65, s47, 147456
    s_lshl_b32 s50, s44, 11
    s_add_u32 s65, s65, s50
    s_lshl_b32 s50, s49, 8
    s_add_u32 s65, s65, s50
    s_add_u32 s65, s65, 4718592
    s_lshl_b32 s49, s49, 2
    s_sub_u32 s62, s42, s49

    ds_read_b128 a[96:99], v0
    ds_read_b128 a[100:103], v0 offset:16
    s_waitcnt lgkmcnt(4)
    v_mfma_f32_32x32x16_bf16 v[32:47], a[64:67], v[16:19], v[32:47]
    ds_read_b128 v[28:31], v98 offset:8192
    s_add_u32 s50, s76, s64
    buffer_load_ushort a80, v4, s[4:7], s50 offen offset:0
    buffer_load_ushort a81, v4, s[4:7], s50 offen offset:1152
    buffer_load_ushort a82, v4, s[4:7], s50 offen offset:2304
    buffer_load_ushort a83, v4, s[4:7], s50 offen offset:3456
    s_add_u32 s50, s76, s63
    buffer_load_ushort a84, v3, s[32:35], s50 offen
    s_waitcnt lgkmcnt(4)
    v_mfma_f32_32x32x16_bf16 v[32:47], a[68:71], v[20:23], v[32:47]
    s_barrier
    s_waitcnt lgkmcnt(3)
    v_mfma_f32_32x32x16_bf16 v[48:63], a[0:3], v[24:27], 0
    ds_read_b128 v[16:19], v101 offset:8192
    ds_read_b128 v[20:23], v104 offset:8192
    s_add_u32 s50, s77, s64
    buffer_load_ushort a85, v4, s[4:7], s50 offen offset:0
    buffer_load_ushort a86, v4, s[4:7], s50 offen offset:1152
    buffer_load_ushort a87, v4, s[4:7], s50 offen offset:2304
    buffer_load_ushort a88, v4, s[4:7], s50 offen offset:3456
    s_add_u32 s50, s77, s63
    buffer_load_ushort a89, v3, s[32:35], s50 offen
    s_add_u32 s50, s78, s64
    buffer_load_ushort a90, v4, s[4:7], s50 offen offset:0
    buffer_load_ushort a91, v4, s[4:7], s50 offen offset:1152
    buffer_load_ushort a92, v4, s[4:7], s50 offen offset:2304
    buffer_load_ushort a93, v4, s[4:7], s50 offen offset:3456
    s_add_u32 s50, s78, s63
    buffer_load_ushort a94, v3, s[32:35], s50 offen
    s_waitcnt lgkmcnt(2)
    v_mfma_f32_32x32x16_bf16 v[48:63], a[4:7], v[28:31], v[48:63]
    ds_read_b128 v[24:27], v95 offset:12288
    s_waitcnt lgkmcnt(2)
    v_mfma_f32_32x32x16_bf16 v[48:63], a[8:11], v[16:19], v[48:63]
    ds_read_b128 v[28:31], v98 offset:12288
    s_waitcnt vmcnt(15)
    v_fma_mix_f32 v32, v80, 1.0, v32 op_sel:[0,0,0] op_sel_hi:[1,0,0]
    v_fma_mix_f32 v33, v80, 1.0, v33 op_sel:[1,0,0] op_sel_hi:[1,0,0]
    v_fma_mix_f32 v34, v81, 1.0, v34 op_sel:[0,0,0] op_sel_hi:[1,0,0]
    v_fma_mix_f32 v35, v81, 1.0, v35 op_sel:[1,0,0] op_sel_hi:[1,0,0]
    v_fma_mix_f32 v36, v82, 1.0, v36 op_sel:[0,0,0] op_sel_hi:[1,0,0]
    s_waitcnt lgkmcnt(2)
    v_mfma_f32_32x32x16_bf16 v[48:63], a[12:15], v[20:23], v[48:63]
    ds_read_b128 v[16:19], v101 offset:12288
    v_fma_mix_f32 v37, v82, 1.0, v37 op_sel:[1,0,0] op_sel_hi:[1,0,0]
    v_fma_mix_f32 v38, v83, 1.0, v38 op_sel:[0,0,0] op_sel_hi:[1,0,0]
    v_fma_mix_f32 v39, v83, 1.0, v39 op_sel:[1,0,0] op_sel_hi:[1,0,0]
    v_fma_mix_f32 v40, v84, 1.0, v40 op_sel:[0,0,0] op_sel_hi:[1,0,0]
    v_fma_mix_f32 v41, v84, 1.0, v41 op_sel:[1,0,0] op_sel_hi:[1,0,0]
    v_fma_mix_f32 v42, v85, 1.0, v42 op_sel:[0,0,0] op_sel_hi:[1,0,0]
    s_waitcnt lgkmcnt(2)
    v_mfma_f32_32x32x16_bf16 v[48:63], a[16:19], v[24:27], v[48:63]
    ds_read_b128 v[20:23], v104 offset:12288
    v_fma_mix_f32 v43, v85, 1.0, v43 op_sel:[1,0,0] op_sel_hi:[1,0,0]
    v_fma_mix_f32 v44, v86, 1.0, v44 op_sel:[0,0,0] op_sel_hi:[1,0,0]
    v_fma_mix_f32 v45, v86, 1.0, v45 op_sel:[1,0,0] op_sel_hi:[1,0,0]
    v_fma_mix_f32 v46, v87, 1.0, v46 op_sel:[0,0,0] op_sel_hi:[1,0,0]
    v_fma_mix_f32 v47, v87, 1.0, v47 op_sel:[1,0,0] op_sel_hi:[1,0,0]
    v_cvt_pk_f16_f32 v32, v32, v33
    v_cvt_pk_f16_f32 v33, v34, v35
    s_waitcnt lgkmcnt(2)
    v_mfma_f32_32x32x16_bf16 v[48:63], a[20:23], v[28:31], v[48:63]
    ds_read_b128 v[24:27], v107 offset:8192
    v_cvt_pk_f16_f32 v34, v36, v37
    v_cvt_pk_f16_f32 v35, v38, v39
    v_cvt_pk_f16_f32 v36, v40, v41
    v_cvt_pk_f16_f32 v37, v42, v43
    v_cvt_pk_f16_f32 v38, v44, v45
    v_cvt_pk_f16_f32 v39, v46, v47
    s_waitcnt lgkmcnt(2)
    v_mfma_f32_32x32x16_bf16 v[48:63], a[24:27], v[16:19], v[48:63]
    ds_read_b128 v[28:31], v95 offset:26624
    s_lshl_b32 s50, s76, 7
    s_add_u32 s50, s50, s56
    buffer_store_dwordx4 v[32:35], v12, s[16:19], s50 offen offset:0 sc0 sc1
    buffer_store_dwordx4 v[36:39], v12, s[16:19], s50 offen offset:1024 sc0 sc1
    buffer_load_dword v88, off, s[16:19], s43 sc0 sc1
    s_waitcnt lgkmcnt(2)
    v_mfma_f32_32x32x16_bf16 v[48:63], a[28:31], v[20:23], v[48:63]
    ds_read_b128 v[16:19], v98 offset:26624
    s_waitcnt lgkmcnt(2)
    v_mfma_f32_32x32x16_bf16 v[48:63], a[32:35], v[24:27], v[48:63]
    s_barrier
    s_waitcnt lgkmcnt(1)
    v_mfma_f32_32x32x16_bf16 v[48:63], a[36:39], v[28:31], v[48:63]
    ds_read_b128 v[20:23], v101 offset:26624
    ds_read_b128 v[24:27], v104 offset:26624
    s_waitcnt lgkmcnt(2)
    v_mfma_f32_32x32x16_bf16 v[48:63], a[40:43], v[16:19], v[48:63]
    ds_read_b128 v[28:31], v95 offset:30720
    s_waitcnt lgkmcnt(2)
    v_mfma_f32_32x32x16_bf16 v[48:63], a[44:47], v[20:23], v[48:63]
    ds_read_b128 v[16:19], v98 offset:30720
    s_waitcnt lgkmcnt(2)
    v_mfma_f32_32x32x16_bf16 v[48:63], a[48:51], v[24:27], v[48:63]
    ds_read_b128 v[20:23], v101 offset:30720
    v_mov_b32 v89, 7
    s_waitcnt vmcnt(1)
    s_mov_b64 exec, 1
    buffer_store_dword v89, off, s[16:19], s42 sc0 sc1
    s_mov_b64 exec, -1
    s_waitcnt lgkmcnt(2)
    v_mfma_f32_32x32x16_bf16 v[48:63], a[52:55], v[28:31], v[48:63]
    ds_read_b128 v[24:27], v104 offset:30720
    s_waitcnt lgkmcnt(2)
    v_mfma_f32_32x32x16_bf16 v[48:63], a[56:59], v[16:19], v[48:63]
    ds_read_b128 v[28:31], v107 offset:26624
    s_waitcnt vmcnt(1)
.sp_94:
    v_readfirstlane_b32 s50, v88
    s_add_u32 s50, s50, s100
    s_cmp_ge_u32 s50, 8
    s_cbranch_scc1 .ok_95
    s_sub_u32 s82, s82, 1
    s_cmp_lt_i32 s82, 1
    s_cbranch_scc1 .ok_95
    buffer_load_dword v88, off, s[16:19], s43 sc0 sc1
    s_waitcnt vmcnt(0)
    s_branch .sp_94

.ok_95:
    s_lshl_b32 s50, s77, 7
    s_add_u32 s50, s50, s56
    buffer_load_dwordx4 v[80:83], v12, s[16:19], s50 offen offset:0 sc0 sc1
    buffer_load_dwordx4 v[84:87], v12, s[16:19], s50 offen offset:1024 sc0 sc1
    s_waitcnt lgkmcnt(2)
    v_mfma_f32_32x32x16_bf16 v[48:63], a[60:63], v[20:23], v[48:63]
    ds_read_b128 v[16:19], v95 offset:45056
    s_waitcnt lgkmcnt(2)
    v_mfma_f32_32x32x16_bf16 v[48:63], a[64:67], v[24:27], v[48:63]
    ds_read_b128 v[20:23], v98 offset:45056
    s_waitcnt lgkmcnt(2)
    v_mfma_f32_32x32x16_bf16 v[48:63], a[68:71], v[28:31], v[48:63]
    s_barrier
    s_waitcnt lgkmcnt(1)
    v_mfma_f32_32x32x16_bf16 v[32:47], a[0:3], v[16:19], 0
    ds_read_b128 v[24:27], v101 offset:45056
    ds_read_b128 v[28:31], v104 offset:45056
    s_waitcnt lgkmcnt(2)
    v_mfma_f32_32x32x16_bf16 v[32:47], a[4:7], v[20:23], v[32:47]
    ds_read_b128 v[16:19], v95 offset:49152
    s_waitcnt lgkmcnt(2)
    v_mfma_f32_32x32x16_bf16 v[32:47], a[8:11], v[24:27], v[32:47]
    ds_read_b128 v[20:23], v98 offset:49152
    s_waitcnt vmcnt(0)
    v_fma_mix_f32 v48, v80, 1.0, v48 op_sel:[0,0,0] op_sel_hi:[1,0,0]
    v_fma_mix_f32 v49, v80, 1.0, v49 op_sel:[1,0,0] op_sel_hi:[1,0,0]
    v_fma_mix_f32 v50, v81, 1.0, v50 op_sel:[0,0,0] op_sel_hi:[1,0,0]
    v_fma_mix_f32 v51, v81, 1.0, v51 op_sel:[1,0,0] op_sel_hi:[1,0,0]
    v_fma_mix_f32 v52, v82, 1.0, v52 op_sel:[0,0,0] op_sel_hi:[1,0,0]
    s_waitcnt lgkmcnt(2)
    v_mfma_f32_32x32x16_bf16 v[32:47], a[12:15], v[28:31], v[32:47]
    ds_read_b128 v[24:27], v101 offset:49152
    v_fma_mix_f32 v53, v82, 1.0, v53 op_sel:[1,0,0] op_sel_hi:[1,0,0]
    v_fma_mix_f32 v54, v83, 1.0, v54 op_sel:[0,0,0] op_sel_hi:[1,0,0]
    v_fma_mix_f32 v55, v83, 1.0, v55 op_sel:[1,0,0] op_sel_hi:[1,0,0]
    v_fma_mix_f32 v56, v84, 1.0, v56 op_sel:[0,0,0] op_sel_hi:[1,0,0]
    v_fma_mix_f32 v57, v84, 1.0, v57 op_sel:[1,0,0] op_sel_hi:[1,0,0]
    v_fma_mix_f32 v58, v85, 1.0, v58 op_sel:[0,0,0] op_sel_hi:[1,0,0]
    s_waitcnt lgkmcnt(2)
    v_mfma_f32_32x32x16_bf16 v[32:47], a[16:19], v[16:19], v[32:47]
    ds_read_b128 v[28:31], v104 offset:49152
    v_fma_mix_f32 v59, v85, 1.0, v59 op_sel:[1,0,0] op_sel_hi:[1,0,0]
    v_fma_mix_f32 v60, v86, 1.0, v60 op_sel:[0,0,0] op_sel_hi:[1,0,0]
    v_fma_mix_f32 v61, v86, 1.0, v61 op_sel:[1,0,0] op_sel_hi:[1,0,0]
    v_fma_mix_f32 v62, v87, 1.0, v62 op_sel:[0,0,0] op_sel_hi:[1,0,0]
    v_fma_mix_f32 v63, v87, 1.0, v63 op_sel:[1,0,0] op_sel_hi:[1,0,0]
    v_cvt_pk_f16_f32 v48, v48, v49
    v_cvt_pk_f16_f32 v49, v50, v51
    s_waitcnt lgkmcnt(2)
    v_mfma_f32_32x32x16_bf16 v[32:47], a[20:23], v[20:23], v[32:47]
    ds_read_b128 v[16:19], v107 offset:45056
    v_cvt_pk_f16_f32 v50, v52, v53
    v_cvt_pk_f16_f32 v51, v54, v55
    v_cvt_pk_f16_f32 v52, v56, v57
    v_cvt_pk_f16_f32 v53, v58, v59
    v_cvt_pk_f16_f32 v54, v60, v61
    v_cvt_pk_f16_f32 v55, v62, v63
    s_waitcnt lgkmcnt(2)
    v_mfma_f32_32x32x16_bf16 v[32:47], a[24:27], v[24:27], v[32:47]
    ds_read_b128 v[20:23], v94 offset:36864
    s_lshl_b32 s50, s77, 7
    s_add_u32 s50, s50, s56
    buffer_store_dwordx4 v[48:51], v12, s[16:19], s50 offen offset:0 sc0 sc1
    buffer_store_dwordx4 v[52:55], v12, s[16:19], s50 offen offset:1024 sc0 sc1
    buffer_load_dword v88, off, s[16:19], s43 sc0 sc1
    s_waitcnt lgkmcnt(2)
    v_mfma_f32_32x32x16_bf16 v[32:47], a[28:31], v[28:31], v[32:47]
    ds_read_b128 v[24:27], v97 offset:36864
    s_waitcnt lgkmcnt(2)
    v_mfma_f32_32x32x16_bf16 v[32:47], a[32:35], v[16:19], v[32:47]
    s_barrier
    s_waitcnt lgkmcnt(1)
    v_mfma_f32_32x32x16_bf16 v[32:47], a[36:39], v[20:23], v[32:47]
    ds_read_b128 v[28:31], v100 offset:36864
    ds_read_b128 v[16:19], v103 offset:36864
    s_waitcnt lgkmcnt(2)
    v_mfma_f32_32x32x16_bf16 v[32:47], a[40:43], v[24:27], v[32:47]
    ds_read_b128 v[20:23], v94 offset:40960
    s_waitcnt lgkmcnt(2)
    v_mfma_f32_32x32x16_bf16 v[32:47], a[44:47], v[28:31], v[32:47]
    ds_read_b128 v[24:27], v97 offset:40960
    s_waitcnt lgkmcnt(2)
    v_mfma_f32_32x32x16_bf16 v[32:47], a[48:51], v[16:19], v[32:47]
    ds_read_b128 v[28:31], v100 offset:40960
    v_mov_b32 v89, 8
    s_waitcnt vmcnt(1)
    s_mov_b64 exec, 1
    buffer_store_dword v89, off, s[16:19], s42 sc0 sc1
    s_mov_b64 exec, -1
    s_waitcnt lgkmcnt(2)
    v_mfma_f32_32x32x16_bf16 v[32:47], a[52:55], v[20:23], v[32:47]
    ds_read_b128 v[16:19], v103 offset:40960
    s_waitcnt lgkmcnt(2)
    v_mfma_f32_32x32x16_bf16 v[32:47], a[56:59], v[24:27], v[32:47]
    ds_read_b128 v[20:23], v106 offset:36864
    s_waitcnt vmcnt(1)
.sp_96:
    v_readfirstlane_b32 s50, v88
    s_add_u32 s50, s50, s100
    s_cmp_ge_u32 s50, 9
    s_cbranch_scc1 .ok_97
    s_sub_u32 s82, s82, 1
    s_cmp_lt_i32 s82, 1
    s_cbranch_scc1 .ok_97
    buffer_load_dword v88, off, s[16:19], s43 sc0 sc1
    s_waitcnt vmcnt(0)
    s_branch .sp_96

.ok_97:
    s_lshl_b32 s50, s78, 7
    s_add_u32 s50, s50, s56
    buffer_load_dwordx4 v[80:83], v12, s[16:19], s50 offen offset:0 sc0 sc1
    buffer_load_dwordx4 v[84:87], v12, s[16:19], s50 offen offset:1024 sc0 sc1
    s_waitcnt lgkmcnt(2)
    v_mfma_f32_32x32x16_bf16 v[32:47], a[60:63], v[28:31], v[32:47]
    s_waitcnt lgkmcnt(1)
    v_mfma_f32_32x32x16_bf16 v[32:47], a[64:67], v[16:19], v[32:47]
    s_waitcnt lgkmcnt(0)
    v_mfma_f32_32x32x16_bf16 v[32:47], a[68:71], v[20:23], v[32:47]
    s_barrier
    s_nop 7
    s_nop 7
    s_waitcnt vmcnt(0)
    v_fma_mix_f32 v32, v80, 1.0, v32 op_sel:[0,0,0] op_sel_hi:[1,0,0]
    v_fma_mix_f32 v33, v80, 1.0, v33 op_sel:[1,0,0] op_sel_hi:[1,0,0]
    v_fma_mix_f32 v34, v81, 1.0, v34 op_sel:[0,0,0] op_sel_hi:[1,0,0]
    v_fma_mix_f32 v35, v81, 1.0, v35 op_sel:[1,0,0] op_sel_hi:[1,0,0]
    v_fma_mix_f32 v36, v82, 1.0, v36 op_sel:[0,0,0] op_sel_hi:[1,0,0]
    v_fma_mix_f32 v37, v82, 1.0, v37 op_sel:[1,0,0] op_sel_hi:[1,0,0]
    v_fma_mix_f32 v38, v83, 1.0, v38 op_sel:[0,0,0] op_sel_hi:[1,0,0]
    v_fma_mix_f32 v39, v83, 1.0, v39 op_sel:[1,0,0] op_sel_hi:[1,0,0]
    v_fma_mix_f32 v40, v84, 1.0, v40 op_sel:[0,0,0] op_sel_hi:[1,0,0]
    v_fma_mix_f32 v41, v84, 1.0, v41 op_sel:[1,0,0] op_sel_hi:[1,0,0]
    v_fma_mix_f32 v42, v85, 1.0, v42 op_sel:[0,0,0] op_sel_hi:[1,0,0]
    v_fma_mix_f32 v43, v85, 1.0, v43 op_sel:[1,0,0] op_sel_hi:[1,0,0]
    v_fma_mix_f32 v44, v86, 1.0, v44 op_sel:[0,0,0] op_sel_hi:[1,0,0]
    v_fma_mix_f32 v45, v86, 1.0, v45 op_sel:[1,0,0] op_sel_hi:[1,0,0]
    v_fma_mix_f32 v46, v87, 1.0, v46 op_sel:[0,0,0] op_sel_hi:[1,0,0]
    v_fma_mix_f32 v47, v87, 1.0, v47 op_sel:[1,0,0] op_sel_hi:[1,0,0]
    v_cvt_pk_f16_f32 v32, v32, v33
    v_cvt_pk_f16_f32 v33, v34, v35
    v_cvt_pk_f16_f32 v34, v36, v37
    v_cvt_pk_f16_f32 v35, v38, v39
    v_cvt_pk_f16_f32 v36, v40, v41
    v_cvt_pk_f16_f32 v37, v42, v43
    v_cvt_pk_f16_f32 v38, v44, v45
    v_cvt_pk_f16_f32 v39, v46, v47
    s_lshl_b32 s50, s78, 7
    s_add_u32 s50, s50, s56
    buffer_store_dwordx4 v[32:35], v12, s[16:19], s50 offen offset:0 sc0 sc1
    buffer_store_dwordx4 v[36:39], v12, s[16:19], s50 offen offset:1024 sc0 sc1
    v_bfe_u32 v17, v12, 4, 2
    v_lshlrev_b32 v17, 2, v17
    buffer_load_dword v16, v17, s[16:19], s62 offen sc0 sc1
    v_lshrrev_b32 v8, 9, v12
    v_bfe_u32 v9, v12, 8, 1
    v_lshlrev_b32 v9, 3, v9
    v_and_b32 v7, 0xf0, v12
    v_lshl_add_u32 v7, v8, 10, v7
    v_add_u32 v7, v7, v9
    v_bfe_u32 v6, v12, 6, 2
    v_lshl_add_u32 v6, v8, 3, v6
    v_mul_u32_u24 v6, 2304, v6
    v_and_b32 v8, 0x30, v12
    v_add3_u32 v6, v6, v8, v9

    v_accvgpr_read_b32 v88, a96
    v_accvgpr_read_b32 v89, a97
    v_accvgpr_read_b32 v90, a98
    v_accvgpr_read_b32 v91, a99
    v_accvgpr_read_b32 v92, a100
    v_accvgpr_read_b32 v93, a101
    v_accvgpr_read_b32 v94, a102
    v_accvgpr_read_b32 v95, a103
    v_accvgpr_read_b32 v64, a80
    v_accvgpr_read_b32 v65, a81
    v_accvgpr_read_b32 v66, a82
    v_accvgpr_read_b32 v67, a83
    v_accvgpr_read_b32 v96, a84
    v_lshlrev_b32 v64, 16, v64
    v_lshlrev_b32 v65, 16, v65
    v_lshlrev_b32 v66, 16, v66
    v_lshlrev_b32 v67, 16, v67
    v_lshlrev_b32 v96, 16, v96
    v_fma_f32 v76, v64, v88, v89
    v_fma_f32 v77, v65, v90, v91
    v_fma_f32 v78, v66, v92, v93
    v_fma_f32 v79, v67, v94, v95
    v_cvt_pk_bf16_f32 v77, v76, v77
    v_cvt_pk_bf16_f32 v79, v78, v79
    v_lshlrev_b32 v76, 16, v77
    v_lshlrev_b32 v78, 16, v79
    v_and_b32 v77, s99, v77
    v_and_b32 v79, s99, v79
    v_mul_f32 v76, v76, v96
    v_mul_f32 v77, v77, v96
    v_mul_f32 v78, v78, v96
    v_mul_f32 v79, v79, v96
    v_cvt_pk_bf16_f32 v77, v76, v77
    v_cvt_pk_bf16_f32 v79, v78, v79
    v_lshlrev_b32 v76, 16, v77
    v_lshlrev_b32 v78, 16, v79
    v_and_b32 v77, s99, v77
    v_and_b32 v79, s99, v79
    v_accvgpr_read_b32 v68, a85
    v_accvgpr_read_b32 v69, a86
    v_accvgpr_read_b32 v70, a87
    v_accvgpr_read_b32 v71, a88
    v_accvgpr_read_b32 v97, a89
    v_lshlrev_b32 v68, 16, v68
    v_lshlrev_b32 v69, 16, v69
    v_lshlrev_b32 v70, 16, v70
    v_lshlrev_b32 v71, 16, v71
    v_lshlrev_b32 v97, 16, v97
    v_fma_f32 v80, v68, v88, v89
    v_fma_f32 v81, v69, v90, v91
    v_fma_f32 v82, v70, v92, v93
    v_fma_f32 v83, v71, v94, v95
    v_cvt_pk_bf16_f32 v81, v80, v81
    v_cvt_pk_bf16_f32 v83, v82, v83
    v_lshlrev_b32 v80, 16, v81
    v_lshlrev_b32 v82, 16, v83
    v_and_b32 v81, s99, v81
    v_and_b32 v83, s99, v83
    v_mul_f32 v80, v80, v97
    v_mul_f32 v81, v81, v97
    v_mul_f32 v82, v82, v97
    v_mul_f32 v83, v83, v97
    v_cvt_pk_bf16_f32 v81, v80, v81
    v_cvt_pk_bf16_f32 v83, v82, v83
    v_lshlrev_b32 v80, 16, v81
    v_lshlrev_b32 v82, 16, v83
    v_and_b32 v81, s99, v81
    v_and_b32 v83, s99, v83
    v_accvgpr_read_b32 v72, a90
    v_accvgpr_read_b32 v73, a91
    v_accvgpr_read_b32 v74, a92
    v_accvgpr_read_b32 v75, a93
    v_accvgpr_read_b32 v98, a94
    v_lshlrev_b32 v72, 16, v72
    v_lshlrev_b32 v73, 16, v73
    v_lshlrev_b32 v74, 16, v74
    v_lshlrev_b32 v75, 16, v75
    v_lshlrev_b32 v98, 16, v98
    v_fma_f32 v84, v72, v88, v89
    v_fma_f32 v85, v73, v90, v91
    v_fma_f32 v86, v74, v92, v93
    v_fma_f32 v87, v75, v94, v95
    v_cvt_pk_bf16_f32 v85, v84, v85
    v_cvt_pk_bf16_f32 v87, v86, v87
    v_lshlrev_b32 v84, 16, v85
    v_lshlrev_b32 v86, 16, v87
    v_and_b32 v85, s99, v85
    v_and_b32 v87, s99, v87
    v_mul_f32 v84, v84, v98
    v_mul_f32 v85, v85, v98
    v_mul_f32 v86, v86, v98
    v_mul_f32 v87, v87, v98
    v_cvt_pk_bf16_f32 v85, v84, v85
    v_cvt_pk_bf16_f32 v87, v86, v87
    v_lshlrev_b32 v84, 16, v85
    v_lshlrev_b32 v86, 16, v87
    v_and_b32 v85, s99, v85
    v_and_b32 v87, s99, v87
    v_mov_b32 v19, 9
    s_waitcnt vmcnt(1)
    s_mov_b64 exec, 1
    buffer_store_dword v19, off, s[16:19], s42 sc0 sc1
    s_mov_b64 exec, -1
    s_lshr_b32 s49, s48, 2
    s_lshl_b32 s49, 1, s49
    s_waitcnt vmcnt(0)
    v_cmp_gt_u32 vcc, 9, v16
    s_andn2_b32 s49, vcc_lo, s49
    s_and_b32 s49, s49, 15
    s_cbranch_scc0 .batch_98

    s_branch .f1_101
.fp_99:
    buffer_load_dword v16, v17, s[16:19], s62 offen sc0 sc1
.f1_101:
    s_waitcnt vmcnt(0)
    v_cmp_gt_u32 vcc, 8, v16
    s_cbranch_vccz .fg_100
    s_sub_u32 s82, s82, 1
    s_cmp_lt_i32 s82, 1
    s_cbranch_scc0 .fp_99

.fg_100:
    s_and_b32 s49, s48, 3
    s_cmp_eq_u32 s49, 3
    s_cselect_b64 exec, -1, 0
    s_lshl_b32 s50, s76, 7
    s_add_u32 s50, s50, s65
    s_add_u32 s51, s76, s64
    s_lshl_b32 s51, s51, 1
    buffer_load_dwordx2 v[96:97], v6, s[12:15], s51 offen sc0 sc1
    s_add_u32 s51, s51, 36864
    buffer_load_dwordx2 v[98:99], v6, s[12:15], s51 offen sc0 sc1
    buffer_load_dwordx2 v[100:101], v7, s[16:19], s50 offen sc0 sc1
    s_add_u32 s50, s50, 2359296
    buffer_load_dwordx2 v[20:21], v7, s[16:19], s50 offen sc0 sc1
    s_mov_b64 exec, -1
    s_lshl_b32 s50, s77, 7
    s_add_u32 s50, s50, s65
    s_add_u32 s51, s77, s64
    s_lshl_b32 s51, s51, 1
    buffer_load_dwordx2 v[102:103], v6, s[12:15], s51 offen sc0 sc1
    s_add_u32 s51, s51, 36864
    buffer_load_dwordx2 v[104:105], v6, s[12:15], s51 offen sc0 sc1
    buffer_load_dwordx2 v[106:107], v7, s[16:19], s50 offen sc0 sc1
    s_add_u32 s50, s50, 2359296
    buffer_load_dwordx2 v[22:23], v7, s[16:19], s50 offen sc0 sc1
    s_waitcnt vmcnt(0)
    v_fma_mix_f32 v32, v96, 1.0, v98 op_sel:[0,0,0] op_sel_hi:[1,0,1]
    v_fma_mix_f32 v33, v96, 1.0, v98 op_sel:[1,0,1] op_sel_hi:[1,0,1]
    v_fma_mix_f32 v34, v97, 1.0, v99 op_sel:[0,0,0] op_sel_hi:[1,0,1]
    v_fma_mix_f32 v35, v97, 1.0, v99 op_sel:[1,0,1] op_sel_hi:[1,0,1]
    v_fma_mix_f32 v36, v102, 1.0, v104 op_sel:[0,0,0] op_sel_hi:[1,0,1]
    v_fma_mix_f32 v37, v102, 1.0, v104 op_sel:[1,0,1] op_sel_hi:[1,0,1]
    v_fma_mix_f32 v38, v103, 1.0, v105 op_sel:[0,0,0] op_sel_hi:[1,0,1]
    v_fma_mix_f32 v39, v103, 1.0, v105 op_sel:[1,0,1] op_sel_hi:[1,0,1]
    v_fma_mix_f32 v32, v100, 1.0, v32 op_sel:[0,0,0] op_sel_hi:[1,0,0]
    v_fma_mix_f32 v33, v100, 1.0, v33 op_sel:[1,0,0] op_sel_hi:[1,0,0]
    v_fma_mix_f32 v34, v101, 1.0, v34 op_sel:[0,0,0] op_sel_hi:[1,0,0]
    v_fma_mix_f32 v35, v101, 1.0, v35 op_sel:[1,0,0] op_sel_hi:[1,0,0]
    v_fma_mix_f32 v36, v106, 1.0, v36 op_sel:[0,0,0] op_sel_hi:[1,0,0]
    v_fma_mix_f32 v37, v106, 1.0, v37 op_sel:[1,0,0] op_sel_hi:[1,0,0]
    v_fma_mix_f32 v38, v107, 1.0, v38 op_sel:[0,0,0] op_sel_hi:[1,0,0]
    v_fma_mix_f32 v39, v107, 1.0, v39 op_sel:[1,0,0] op_sel_hi:[1,0,0]
    v_fma_mix_f32 v44, v20, 1.0, v76 op_sel:[0,0,0] op_sel_hi:[1,0,0]
    v_fma_mix_f32 v45, v20, 1.0, v77 op_sel:[1,0,0] op_sel_hi:[1,0,0]
    v_fma_mix_f32 v46, v21, 1.0, v78 op_sel:[0,0,0] op_sel_hi:[1,0,0]
    v_fma_mix_f32 v47, v21, 1.0, v79 op_sel:[1,0,0] op_sel_hi:[1,0,0]
    v_fma_mix_f32 v48, v22, 1.0, v80 op_sel:[0,0,0] op_sel_hi:[1,0,0]
    v_fma_mix_f32 v49, v22, 1.0, v81 op_sel:[1,0,0] op_sel_hi:[1,0,0]
    v_fma_mix_f32 v50, v23, 1.0, v82 op_sel:[0,0,0] op_sel_hi:[1,0,0]
    v_fma_mix_f32 v51, v23, 1.0, v83 op_sel:[1,0,0] op_sel_hi:[1,0,0]
    v_cvt_pk_bf16_f32 v33, v32, v33
    v_cvt_pk_bf16_f32 v35, v34, v35
    v_lshlrev_b32 v32, 16, v33
    v_lshlrev_b32 v34, 16, v35
    v_and_b32 v33, s99, v33
    v_and_b32 v35, s99, v35
    v_cvt_pk_bf16_f32 v37, v36, v37
    v_cvt_pk_bf16_f32 v39, v38, v39
    v_lshlrev_b32 v36, 16, v37
    v_lshlrev_b32 v38, 16, v39
    v_and_b32 v37, s99, v37
    v_and_b32 v39, s99, v39
    v_mul_f32 v96, s98, v32
    v_mul_f32 v97, s98, v33
    v_mul_f32 v98, s98, v34
    v_mul_f32 v99, s98, v35
    v_mul_f32 v100, s98, v36
    v_mul_f32 v101, s98, v37
    v_mul_f32 v102, s98, v38
    v_mul_f32 v103, s98, v39
    v_exp_f32 v96, -v96
    v_exp_f32 v97, -v97
    v_exp_f32 v98, -v98
    v_exp_f32 v99, -v99
    v_exp_f32 v100, -v100
    v_exp_f32 v101, -v101
    v_exp_f32 v102, -v102
    v_exp_f32 v103, -v103
    v_add_f32 v96, 1.0, v96
    v_add_f32 v97, 1.0, v97
    v_add_f32 v98, 1.0, v98
    v_add_f32 v99, 1.0, v99
    v_add_f32 v100, 1.0, v100
    v_add_f32 v101, 1.0, v101
    v_add_f32 v102, 1.0, v102
    v_add_f32 v103, 1.0, v103
    v_rcp_f32 v96, v96
    v_rcp_f32 v97, v97
    v_rcp_f32 v98, v98
    v_rcp_f32 v99, v99
    v_rcp_f32 v100, v100
    v_rcp_f32 v101, v101
    v_rcp_f32 v102, v102
    v_rcp_f32 v103, v103
    v_mul_f32 v32, v32, v96
    v_mul_f32 v33, v33, v97
    v_mul_f32 v34, v34, v98
    v_mul_f32 v35, v35, v99
    v_mul_f32 v36, v36, v100
    v_mul_f32 v37, v37, v101
    v_mul_f32 v38, v38, v102
    v_mul_f32 v39, v39, v103
    v_cvt_pk_bf16_f32 v33, v32, v33
    v_cvt_pk_bf16_f32 v35, v34, v35
    v_lshlrev_b32 v32, 16, v33
    v_lshlrev_b32 v34, 16, v35
    v_and_b32 v33, s99, v33
    v_and_b32 v35, s99, v35
    v_cvt_pk_bf16_f32 v37, v36, v37
    v_cvt_pk_bf16_f32 v39, v38, v39
    v_lshlrev_b32 v36, 16, v37
    v_lshlrev_b32 v38, 16, v39
    v_and_b32 v37, s99, v37
    v_and_b32 v39, s99, v39
    v_fmac_f32 v64, v44, v32
    v_fmac_f32 v65, v45, v33
    v_fmac_f32 v66, v46, v34
    v_fmac_f32 v67, v47, v35
    v_fmac_f32 v68, v48, v36
    v_fmac_f32 v69, v49, v37
    v_fmac_f32 v70, v50, v38
    v_fmac_f32 v71, v51, v39
    s_and_b32 s49, s48, 3
    s_cmp_eq_u32 s49, 3
    s_cselect_b64 exec, -1, 0
    s_add_u32 s50, s76, s64
    s_lshl_b32 s50, s50, 1
    s_add_u32 s51, s50, 4608
    buffer_store_dword v64, v5, s[12:15], s50 offen offset:0
    buffer_store_dword v65, v5, s[12:15], s50 offen offset:2304
    buffer_store_dword v66, v5, s[12:15], s51 offen offset:0
    buffer_store_dword v67, v5, s[12:15], s51 offen offset:2304
    s_mov_b64 exec, -1
    s_add_u32 s50, s77, s64
    s_lshl_b32 s50, s50, 1
    s_add_u32 s51, s50, 4608
    buffer_store_dword v68, v5, s[12:15], s50 offen offset:0
    buffer_store_dword v69, v5, s[12:15], s50 offen offset:2304
    buffer_store_dword v70, v5, s[12:15], s51 offen offset:0
    buffer_store_dword v71, v5, s[12:15], s51 offen offset:2304
.fp_102:
    buffer_load_dword v16, v17, s[16:19], s62 offen sc0 sc1
.f1_104:
    s_waitcnt vmcnt(0)
    v_cmp_gt_u32 vcc, 9, v16
    s_cbranch_vccz .fg_103
    s_sub_u32 s82, s82, 1
    s_cmp_lt_i32 s82, 1
    s_cbranch_scc0 .fp_102

.fg_103:
    s_lshl_b32 s50, s78, 7
    s_add_u32 s50, s50, s65
    s_add_u32 s51, s78, s64
    s_lshl_b32 s51, s51, 1
    buffer_load_dwordx2 v[26:27], v6, s[12:15], s51 offen sc0 sc1
    s_add_u32 s51, s51, 36864
    buffer_load_dwordx2 v[28:29], v6, s[12:15], s51 offen sc0 sc1
    buffer_load_dwordx2 v[30:31], v7, s[16:19], s50 offen sc0 sc1
    s_add_u32 s50, s50, 2359296
    buffer_load_dwordx2 v[24:25], v7, s[16:19], s50 offen sc0 sc1
    s_waitcnt vmcnt(0)
    v_fma_mix_f32 v40, v26, 1.0, v28 op_sel:[0,0,0] op_sel_hi:[1,0,1]
    v_fma_mix_f32 v41, v26, 1.0, v28 op_sel:[1,0,1] op_sel_hi:[1,0,1]
    v_fma_mix_f32 v42, v27, 1.0, v29 op_sel:[0,0,0] op_sel_hi:[1,0,1]
    v_fma_mix_f32 v43, v27, 1.0, v29 op_sel:[1,0,1] op_sel_hi:[1,0,1]
    v_fma_mix_f32 v40, v30, 1.0, v40 op_sel:[0,0,0] op_sel_hi:[1,0,0]
    v_fma_mix_f32 v41, v30, 1.0, v41 op_sel:[1,0,0] op_sel_hi:[1,0,0]
    v_fma_mix_f32 v42, v31, 1.0, v42 op_sel:[0,0,0] op_sel_hi:[1,0,0]
    v_fma_mix_f32 v43, v31, 1.0, v43 op_sel:[1,0,0] op_sel_hi:[1,0,0]
    v_fma_mix_f32 v52, v24, 1.0, v84 op_sel:[0,0,0] op_sel_hi:[1,0,0]
    v_fma_mix_f32 v53, v24, 1.0, v85 op_sel:[1,0,0] op_sel_hi:[1,0,0]
    v_fma_mix_f32 v54, v25, 1.0, v86 op_sel:[0,0,0] op_sel_hi:[1,0,0]
    v_fma_mix_f32 v55, v25, 1.0, v87 op_sel:[1,0,0] op_sel_hi:[1,0,0]
    v_cvt_pk_bf16_f32 v41, v40, v41
    v_cvt_pk_bf16_f32 v43, v42, v43
    v_lshlrev_b32 v40, 16, v41
    v_lshlrev_b32 v42, 16, v43
    v_and_b32 v41, s99, v41
    v_and_b32 v43, s99, v43
    v_mul_f32 v104, s98, v40
    v_mul_f32 v105, s98, v41
    v_mul_f32 v106, s98, v42
    v_mul_f32 v107, s98, v43
    v_exp_f32 v104, -v104
    v_exp_f32 v105, -v105
    v_exp_f32 v106, -v106
    v_exp_f32 v107, -v107
    v_add_f32 v104, 1.0, v104
    v_add_f32 v105, 1.0, v105
    v_add_f32 v106, 1.0, v106
    v_add_f32 v107, 1.0, v107
    v_rcp_f32 v104, v104
    v_rcp_f32 v105, v105
    v_rcp_f32 v106, v106
    v_rcp_f32 v107, v107
    v_mul_f32 v40, v40, v104
    v_mul_f32 v41, v41, v105
    v_mul_f32 v42, v42, v106
    v_mul_f32 v43, v43, v107
    v_cvt_pk_bf16_f32 v41, v40, v41
    v_cvt_pk_bf16_f32 v43, v42, v43
    v_lshlrev_b32 v40, 16, v41
    v_lshlrev_b32 v42, 16, v43
    v_and_b32 v41, s99, v41
    v_and_b32 v43, s99, v43
    v_fmac_f32 v72, v52, v40
    v_fmac_f32 v73, v53, v41
    v_fmac_f32 v74, v54, v42
    v_fmac_f32 v75, v55, v43
    s_add_u32 s50, s78, s64
    s_lshl_b32 s50, s50, 1
    s_add_u32 s51, s50, 4608
    buffer_store_dword v72, v5, s[12:15], s50 offen offset:0
    buffer_store_dword v73, v5, s[12:15], s50 offen offset:2304
    buffer_store_dword v74, v5, s[12:15], s51 offen offset:0
    buffer_store_dword v75, v5, s[12:15], s51 offen offset:2304
    s_endpgm
.batch_98:
    s_and_b32 s49, s48, 3
    s_cmp_eq_u32 s49, 3
    s_cselect_b64 exec, -1, 0
    s_lshl_b32 s50, s76, 7
    s_add_u32 s50, s50, s65
    s_add_u32 s51, s76, s64
    s_lshl_b32 s51, s51, 1
    buffer_load_dwordx2 v[96:97], v6, s[12:15], s51 offen sc0 sc1
    s_add_u32 s51, s51, 36864
    buffer_load_dwordx2 v[98:99], v6, s[12:15], s51 offen sc0 sc1
    buffer_load_dwordx2 v[100:101], v7, s[16:19], s50 offen sc0 sc1
    s_add_u32 s50, s50, 2359296
    buffer_load_dwordx2 v[20:21], v7, s[16:19], s50 offen sc0 sc1
    s_mov_b64 exec, -1
    s_lshl_b32 s50, s77, 7
    s_add_u32 s50, s50, s65
    s_add_u32 s51, s77, s64
    s_lshl_b32 s51, s51, 1
    buffer_load_dwordx2 v[102:103], v6, s[12:15], s51 offen sc0 sc1
    s_add_u32 s51, s51, 36864
    buffer_load_dwordx2 v[104:105], v6, s[12:15], s51 offen sc0 sc1
    buffer_load_dwordx2 v[106:107], v7, s[16:19], s50 offen sc0 sc1
    s_add_u32 s50, s50, 2359296
    buffer_load_dwordx2 v[22:23], v7, s[16:19], s50 offen sc0 sc1
    s_lshl_b32 s50, s78, 7
    s_add_u32 s50, s50, s65
    s_add_u32 s51, s78, s64
    s_lshl_b32 s51, s51, 1
    buffer_load_dwordx2 v[26:27], v6, s[12:15], s51 offen sc0 sc1
    s_add_u32 s51, s51, 36864
    buffer_load_dwordx2 v[28:29], v6, s[12:15], s51 offen sc0 sc1
    buffer_load_dwordx2 v[30:31], v7, s[16:19], s50 offen sc0 sc1
    s_add_u32 s50, s50, 2359296
    buffer_load_dwordx2 v[24:25], v7, s[16:19], s50 offen sc0 sc1
    s_waitcnt vmcnt(0)
    v_fma_mix_f32 v32, v96, 1.0, v98 op_sel:[0,0,0] op_sel_hi:[1,0,1]
    v_fma_mix_f32 v33, v96, 1.0, v98 op_sel:[1,0,1] op_sel_hi:[1,0,1]
    v_fma_mix_f32 v34, v97, 1.0, v99 op_sel:[0,0,0] op_sel_hi:[1,0,1]
    v_fma_mix_f32 v35, v97, 1.0, v99 op_sel:[1,0,1] op_sel_hi:[1,0,1]
    v_fma_mix_f32 v36, v102, 1.0, v104 op_sel:[0,0,0] op_sel_hi:[1,0,1]
    v_fma_mix_f32 v37, v102, 1.0, v104 op_sel:[1,0,1] op_sel_hi:[1,0,1]
    v_fma_mix_f32 v38, v103, 1.0, v105 op_sel:[0,0,0] op_sel_hi:[1,0,1]
    v_fma_mix_f32 v39, v103, 1.0, v105 op_sel:[1,0,1] op_sel_hi:[1,0,1]
    v_fma_mix_f32 v40, v26, 1.0, v28 op_sel:[0,0,0] op_sel_hi:[1,0,1]
    v_fma_mix_f32 v41, v26, 1.0, v28 op_sel:[1,0,1] op_sel_hi:[1,0,1]
    v_fma_mix_f32 v42, v27, 1.0, v29 op_sel:[0,0,0] op_sel_hi:[1,0,1]
    v_fma_mix_f32 v43, v27, 1.0, v29 op_sel:[1,0,1] op_sel_hi:[1,0,1]
    v_fma_mix_f32 v32, v100, 1.0, v32 op_sel:[0,0,0] op_sel_hi:[1,0,0]
    v_fma_mix_f32 v33, v100, 1.0, v33 op_sel:[1,0,0] op_sel_hi:[1,0,0]
    v_fma_mix_f32 v34, v101, 1.0, v34 op_sel:[0,0,0] op_sel_hi:[1,0,0]
    v_fma_mix_f32 v35, v101, 1.0, v35 op_sel:[1,0,0] op_sel_hi:[1,0,0]
    v_fma_mix_f32 v36, v106, 1.0, v36 op_sel:[0,0,0] op_sel_hi:[1,0,0]
    v_fma_mix_f32 v37, v106, 1.0, v37 op_sel:[1,0,0] op_sel_hi:[1,0,0]
    v_fma_mix_f32 v38, v107, 1.0, v38 op_sel:[0,0,0] op_sel_hi:[1,0,0]
    v_fma_mix_f32 v39, v107, 1.0, v39 op_sel:[1,0,0] op_sel_hi:[1,0,0]
    v_fma_mix_f32 v40, v30, 1.0, v40 op_sel:[0,0,0] op_sel_hi:[1,0,0]
    v_fma_mix_f32 v41, v30, 1.0, v41 op_sel:[1,0,0] op_sel_hi:[1,0,0]
    v_fma_mix_f32 v42, v31, 1.0, v42 op_sel:[0,0,0] op_sel_hi:[1,0,0]
    v_fma_mix_f32 v43, v31, 1.0, v43 op_sel:[1,0,0] op_sel_hi:[1,0,0]
    v_fma_mix_f32 v44, v20, 1.0, v76 op_sel:[0,0,0] op_sel_hi:[1,0,0]
    v_fma_mix_f32 v45, v20, 1.0, v77 op_sel:[1,0,0] op_sel_hi:[1,0,0]
    v_fma_mix_f32 v46, v21, 1.0, v78 op_sel:[0,0,0] op_sel_hi:[1,0,0]
    v_fma_mix_f32 v47, v21, 1.0, v79 op_sel:[1,0,0] op_sel_hi:[1,0,0]
    v_fma_mix_f32 v48, v22, 1.0, v80 op_sel:[0,0,0] op_sel_hi:[1,0,0]
    v_fma_mix_f32 v49, v22, 1.0, v81 op_sel:[1,0,0] op_sel_hi:[1,0,0]
    v_fma_mix_f32 v50, v23, 1.0, v82 op_sel:[0,0,0] op_sel_hi:[1,0,0]
    v_fma_mix_f32 v51, v23, 1.0, v83 op_sel:[1,0,0] op_sel_hi:[1,0,0]
    v_fma_mix_f32 v52, v24, 1.0, v84 op_sel:[0,0,0] op_sel_hi:[1,0,0]
    v_fma_mix_f32 v53, v24, 1.0, v85 op_sel:[1,0,0] op_sel_hi:[1,0,0]
    v_fma_mix_f32 v54, v25, 1.0, v86 op_sel:[0,0,0] op_sel_hi:[1,0,0]
    v_fma_mix_f32 v55, v25, 1.0, v87 op_sel:[1,0,0] op_sel_hi:[1,0,0]
    v_cvt_pk_bf16_f32 v33, v32, v33
    v_cvt_pk_bf16_f32 v35, v34, v35
    v_lshlrev_b32 v32, 16, v33
    v_lshlrev_b32 v34, 16, v35
    v_and_b32 v33, s99, v33
    v_and_b32 v35, s99, v35
    v_cvt_pk_bf16_f32 v37, v36, v37
    v_cvt_pk_bf16_f32 v39, v38, v39
    v_lshlrev_b32 v36, 16, v37
    v_lshlrev_b32 v38, 16, v39
    v_and_b32 v37, s99, v37
    v_and_b32 v39, s99, v39
    v_cvt_pk_bf16_f32 v41, v40, v41
    v_cvt_pk_bf16_f32 v43, v42, v43
    v_lshlrev_b32 v40, 16, v41
    v_lshlrev_b32 v42, 16, v43
    v_and_b32 v41, s99, v41
    v_and_b32 v43, s99, v43
    v_mul_f32 v96, s98, v32
    v_mul_f32 v97, s98, v33
    v_mul_f32 v98, s98, v34
    v_mul_f32 v99, s98, v35
    v_mul_f32 v100, s98, v36
    v_mul_f32 v101, s98, v37
    v_mul_f32 v102, s98, v38
    v_mul_f32 v103, s98, v39
    v_mul_f32 v104, s98, v40
    v_mul_f32 v105, s98, v41
    v_mul_f32 v106, s98, v42
    v_mul_f32 v107, s98, v43
    v_exp_f32 v96, -v96
    v_exp_f32 v97, -v97
    v_exp_f32 v98, -v98
    v_exp_f32 v99, -v99
    v_exp_f32 v100, -v100
    v_exp_f32 v101, -v101
    v_exp_f32 v102, -v102
    v_exp_f32 v103, -v103
    v_exp_f32 v104, -v104
    v_exp_f32 v105, -v105
    v_exp_f32 v106, -v106
    v_exp_f32 v107, -v107
    v_add_f32 v96, 1.0, v96
    v_add_f32 v97, 1.0, v97
    v_add_f32 v98, 1.0, v98
    v_add_f32 v99, 1.0, v99
    v_add_f32 v100, 1.0, v100
    v_add_f32 v101, 1.0, v101
    v_add_f32 v102, 1.0, v102
    v_add_f32 v103, 1.0, v103
    v_add_f32 v104, 1.0, v104
    v_add_f32 v105, 1.0, v105
    v_add_f32 v106, 1.0, v106
    v_add_f32 v107, 1.0, v107
    v_rcp_f32 v96, v96
    v_rcp_f32 v97, v97
    v_rcp_f32 v98, v98
    v_rcp_f32 v99, v99
    v_rcp_f32 v100, v100
    v_rcp_f32 v101, v101
    v_rcp_f32 v102, v102
    v_rcp_f32 v103, v103
    v_rcp_f32 v104, v104
    v_rcp_f32 v105, v105
    v_rcp_f32 v106, v106
    v_rcp_f32 v107, v107
    v_mul_f32 v32, v32, v96
    v_mul_f32 v33, v33, v97
    v_mul_f32 v34, v34, v98
    v_mul_f32 v35, v35, v99
    v_mul_f32 v36, v36, v100
    v_mul_f32 v37, v37, v101
    v_mul_f32 v38, v38, v102
    v_mul_f32 v39, v39, v103
    v_mul_f32 v40, v40, v104
    v_mul_f32 v41, v41, v105
    v_mul_f32 v42, v42, v106
    v_mul_f32 v43, v43, v107
    v_cvt_pk_bf16_f32 v33, v32, v33
    v_cvt_pk_bf16_f32 v35, v34, v35
    v_lshlrev_b32 v32, 16, v33
    v_lshlrev_b32 v34, 16, v35
    v_and_b32 v33, s99, v33
    v_and_b32 v35, s99, v35
    v_cvt_pk_bf16_f32 v37, v36, v37
    v_cvt_pk_bf16_f32 v39, v38, v39
    v_lshlrev_b32 v36, 16, v37
    v_lshlrev_b32 v38, 16, v39
    v_and_b32 v37, s99, v37
    v_and_b32 v39, s99, v39
    v_cvt_pk_bf16_f32 v41, v40, v41
    v_cvt_pk_bf16_f32 v43, v42, v43
    v_lshlrev_b32 v40, 16, v41
    v_lshlrev_b32 v42, 16, v43
    v_and_b32 v41, s99, v41
    v_and_b32 v43, s99, v43
    v_fmac_f32 v64, v44, v32
    v_fmac_f32 v65, v45, v33
    v_fmac_f32 v66, v46, v34
    v_fmac_f32 v67, v47, v35
    v_fmac_f32 v68, v48, v36
    v_fmac_f32 v69, v49, v37
    v_fmac_f32 v70, v50, v38
    v_fmac_f32 v71, v51, v39
    v_fmac_f32 v72, v52, v40
    v_fmac_f32 v73, v53, v41
    v_fmac_f32 v74, v54, v42
    v_fmac_f32 v75, v55, v43
    s_and_b32 s49, s48, 3
    s_cmp_eq_u32 s49, 3
    s_cselect_b64 exec, -1, 0
    s_add_u32 s50, s76, s64
    s_lshl_b32 s50, s50, 1
    s_add_u32 s51, s50, 4608
    buffer_store_dword v64, v5, s[12:15], s50 offen offset:0
    buffer_store_dword v65, v5, s[12:15], s50 offen offset:2304
    buffer_store_dword v66, v5, s[12:15], s51 offen offset:0
    buffer_store_dword v67, v5, s[12:15], s51 offen offset:2304
    s_mov_b64 exec, -1
    s_add_u32 s50, s77, s64
    s_lshl_b32 s50, s50, 1
    s_add_u32 s51, s50, 4608
    buffer_store_dword v68, v5, s[12:15], s50 offen offset:0
    buffer_store_dword v69, v5, s[12:15], s50 offen offset:2304
    buffer_store_dword v70, v5, s[12:15], s51 offen offset:0
    buffer_store_dword v71, v5, s[12:15], s51 offen offset:2304
    s_add_u32 s50, s78, s64
    s_lshl_b32 s50, s50, 1
    s_add_u32 s51, s50, 4608
    buffer_store_dword v72, v5, s[12:15], s50 offen offset:0
    buffer_store_dword v73, v5, s[12:15], s50 offen offset:2304
    buffer_store_dword v74, v5, s[12:15], s51 offen offset:0
    buffer_store_dword v75, v5, s[12:15], s51 offen offset:2304
    s_endpgm

.section .rodata,"a"
.p2align 6
.amdhsa_kernel recurrent_scan__ssm_conv_s5__dense_activation_mish__prompt_kernel
  .amdhsa_next_free_vgpr 256
  .amdhsa_next_free_sgpr 102
  .amdhsa_accum_offset 112
  .amdhsa_group_segment_fixed_size 0
  .amdhsa_kernarg_size 128
  .amdhsa_user_sgpr_count 2
  .amdhsa_user_sgpr_kernarg_segment_ptr 1
  .amdhsa_system_sgpr_workgroup_id_x 1
.end_amdhsa_kernel
```
